```python
import torch

def _softmax(x, axis=-1):
    return torch.softmax(x, dim=axis)
def _gelu(x):
    return torch.nn.functional.gelu(x, approximate="tanh")
def _silu(x):
    return torch.nn.functional.silu(x)
def _sigmoid(x):
    return torch.sigmoid(x)
def _layernorm(x, axis=-1, eps=1e-5):
    m = x.mean(dim=axis, keepdim=True)
    v = x.var(dim=axis, keepdim=True, unbiased=False)
    return (x - m) / torch.sqrt(v + eps)
def _scatter_add(tgt, idx, src, axis=0):
    return tgt.clone().index_add_(axis, idx, src)
def _segment_sum(src, seg, n):
    out = torch.zeros((n,) + src.shape[1:], dtype=src.dtype)
    return out.index_add_(0, seg, src)
def _pad(x, pw):
    flat = tuple(v for pair in reversed(pw) for v in pair)
    return torch.nn.functional.pad(x, flat)

kernel_name = 'standalone__gqa_block_cached__near_ridge'

def setup_inputs():

    _w = (lambda a: (lambda t: t.to(torch.bfloat16) if t.is_floating_point() else t)(torch.as_tensor(a)))
    B, Sq, D = 16, 240, 512
    Hq, Hkv, Sk, Dh = 32, 32, 512, 128
    assert Hq % Hkv == 0, (Hq, Hkv)
    return {
        "x": _w((lambda *s: torch.randn(*s, dtype=torch.bfloat16) * 0.8)(B, Sq, D)),
        "k_cache": _w((lambda *s: torch.randn(*s, dtype=torch.bfloat16) * 0.8)(B, Hkv, Sk, Dh)),
        "v_cache": _w((lambda *s: torch.randn(*s, dtype=torch.bfloat16) * 0.05)(B, Hkv, Sk, Dh)),
        "wq": _w((lambda *s: torch.randn(*s, dtype=torch.bfloat16) * 0.8)(D, Hq * Dh) * (D ** -0.5)),
        "wo": _w((lambda *s: torch.randn(*s, dtype=torch.bfloat16) * 0.05)(Hq * Dh, D) * ((Hq * Dh) ** -0.5)),
    }

def reference(x, k_cache, v_cache, wq, wo):
    B, Sq, D = x.shape
    Hq, Dh = 32, 128
    Hkv = k_cache.shape[1]
    rep = Hq // Hkv
    q = (lambda x, *d: x.permute(*d))((x @ wq).reshape(B, Sq, Hq, Dh), 0, 2, 1, 3)
    k = (lambda x, n, axis: torch.repeat_interleave(x, n, dim=axis))(k_cache, rep, axis=1)
    v = (lambda x, n, axis: torch.repeat_interleave(x, n, dim=axis))(v_cache, rep, axis=1)
    scores = torch.einsum("bhqd,bhkd->bhqk", q, k) * (Dh ** -0.5)
    p = _softmax(scores, axis=-1)
    o = torch.einsum("bhqk,bhkd->bhqd", p, v)
    return (lambda x, *d: x.permute(*d))(o, 0, 2, 1, 3).reshape(B, Sq, Hq * Dh) @ wo
```

```asm
; @launch kernel=attn_kernel grid=(256,1,1) block=(256,1,1) lds=163840
; @launch kernel=oproj_kernel grid=(256,1,1) block=(256,1,1) lds=131072
.amdgcn_target "amdgcn-amd-amdhsa--gfx950"
.text
.globl attn_kernel
.p2align 8
.type attn_kernel,@function
attn_kernel:
 s_cmp_ge_u32 s2, 256
 s_cbranch_scc1 A_END
 s_load_dwordx4 s[56:59], s[0:1], 0
 s_load_dwordx4 s[48:51], s[0:1], 16
 s_load_dwordx2 s[52:53], s[0:1], 56
 s_load_dwordx2 s[84:85], s[0:1], 32
 v_and_b32 v224, 63, v0
 v_lshrrev_b32 v225, 6, v0
 v_and_b32 v231, 15, v224
 v_readfirstlane_b32 s54, v225
 v_lshrrev_b32 v232, 4, v224
 s_and_b32 s5, s2, 7
 s_lshr_b32 s6, s2, 3
 s_lshr_b32 s3, s5, 2
 s_lshl_b32 s3, s3, 3
 s_lshr_b32 s7, s6, 2
 s_add_u32 s3, s3, s7
 s_and_b32 s4, s5, 3
 s_lshl_b32 s4, s4, 2
 s_and_b32 s7, s6, 3
 s_add_u32 s4, s4, s7
 s_lshl_b32 s28, s54, 11
 s_lshl_b32 s31, s54, 13
 v_lshlrev_b32 v234, 2, v232
 v_xor_b32 v234, v234, v231
 v_lshlrev_b32 v234, 4, v234
 v_lshrrev_b32 v235, 1, v225
 v_lshlrev_b32 v235, 4, v235
 v_and_b32 v236, 1, v225
 v_lshl_add_u32 v235, v236, 2, v235
 v_add_u32 v235, v235, v232
 v_lshl_add_u32 v211, v235, 13, v234
 v_lshrrev_b32 v235, 3, v224
 v_lshl_add_u32 v235, v225, 6, v235
 v_lshlrev_b32 v235, 10, v235
 v_and_b32 v236, 7, v224
 v_xor_b32 v236, v236, v232
 v_lshl_add_u32 v212, v236, 4, v235
 v_xor_b32 v213, 64, v212
 s_and_b32 s91, s6, 1
 s_lshl_b32 s91, s91, 2
 s_add_u32 s55, s91, 0
 s_and_b32 s55, s55, 7
 s_lshl_b32 s60, s55, 7
 s_lshl_b32 s68, s55, 19
 s_add_u32 s55, s91, 1
 s_and_b32 s55, s55, 7
 s_lshl_b32 s61, s55, 7
 s_lshl_b32 s69, s55, 19
 s_lshl_b32 s5, s4, 9
 s_mul_i32 s7, s3, 245760
 s_mov_b32 s19, 0x20000
 s_mov_b32 s22, 245760
 s_mov_b32 s23, 0x20000
 s_sub_u32 s18, 4194304, s5
 s_waitcnt lgkmcnt(0)
 s_add_u32 s16, s50, s5
 s_addc_u32 s17, s51, 0
 s_add_u32 s20, s56, s7
 s_addc_u32 s21, s57, 0
.p2align 3
A_BODY:
 s_add_u32 m0, s28, 65536
 s_add_u32 s34, s68, 256
 s_add_u32 s35, s68, 64768
 buffer_load_dwordx4 v211, s[16:19], s34 offen lds
 buffer_load_dwordx4 v211, s[16:19], s35 offen offset:1024 lds
 s_add_u32 m0, s31, 0
 s_add_u32 s44, s60, 0
 buffer_load_dwordx4 v212, s[20:23], s44 offen offset:0 lds
 s_add_u32 s45, s60, 7168
 buffer_load_dwordx4 v213, s[20:23], s45 offen offset:1024 lds
 s_add_u32 s46, s60, 14336
 buffer_load_dwordx4 v212, s[20:23], s46 offen offset:2048 lds
 s_add_u32 s47, s60, 21504
 buffer_load_dwordx4 v213, s[20:23], s47 offen offset:3072 lds
 s_add_u32 m0, s31, 4096
 s_add_u32 s44, s60, 32768
 buffer_load_dwordx4 v212, s[20:23], s44 offen offset:0 lds
 s_add_u32 s45, s60, 39936
 buffer_load_dwordx4 v213, s[20:23], s45 offen offset:1024 lds
 s_add_u32 s46, s60, 47104
 buffer_load_dwordx4 v212, s[20:23], s46 offen offset:2048 lds
 s_add_u32 s47, s60, 54272
 buffer_load_dwordx4 v213, s[20:23], s47 offen offset:3072 lds
 s_add_u32 m0, s28, 73728
 s_add_u32 s34, s68, 262400
 s_add_u32 s35, s68, 326912
 buffer_load_dwordx4 v211, s[16:19], s34 offen lds
 buffer_load_dwordx4 v211, s[16:19], s35 offen offset:1024 lds
 s_add_u32 m0, s28, 81920
 s_add_u32 s34, s68, 0
 s_add_u32 s35, s68, 64512
 s_add_u32 s55, s91, 2
 s_and_b32 s55, s55, 7
 s_lshl_b32 s62, s55, 7
 s_lshl_b32 s70, s55, 19
 s_add_u32 s55, s91, 3
 s_and_b32 s55, s55, 7
 s_lshl_b32 s63, s55, 7
 s_lshl_b32 s71, s55, 19
 s_add_u32 s55, s91, 4
 s_and_b32 s55, s55, 7
 s_lshl_b32 s64, s55, 7
 s_lshl_b32 s72, s55, 19
 s_add_u32 s55, s91, 5
 s_and_b32 s55, s55, 7
 s_lshl_b32 s65, s55, 7
 s_lshl_b32 s73, s55, 19
 s_add_u32 s55, s91, 6
 s_and_b32 s55, s55, 7
 s_lshl_b32 s66, s55, 7
 s_lshl_b32 s74, s55, 19
 s_add_u32 s55, s91, 7
 s_and_b32 s55, s55, 7
 s_lshl_b32 s67, s55, 7
 s_lshl_b32 s75, s55, 19
 v_lshrrev_b32 v226, 5, v224
 v_and_b32 v227, 31, v224
 v_bfe_u32 v228, v224, 4, 1
 v_bfe_u32 v229, v224, 2, 2
 v_and_b32 v230, 3, v224
 s_mov_b32 s29, 0x3e0293ee
 s_mov_b32 s30, 0x47800000
 s_lshl_b32 s36, s4, 17
 v_xor_b32 v233, v226, v231
 v_lshlrev_b32 v233, 4, v233
 v_lshl_add_u32 v192, v227, 8, v233
 v_xor_b32 v193, 32, v192
 v_xor_b32 v194, 64, v192
 v_xor_b32 v195, 96, v192
 v_xor_b32 v196, 128, v192
 v_xor_b32 v197, 160, v192
 v_xor_b32 v198, 192, v192
 v_xor_b32 v199, 224, v192
 v_lshl_add_u32 v233, v226, 2, v229
 v_lshlrev_b32 v233, 8, v233
 v_lshl_add_u32 v233, v229, 6, v233
 v_lshl_add_u32 v233, v228, 5, v233
 v_and_b32 v237, 1, v230
 v_lshl_add_u32 v233, v237, 4, v233
 v_lshrrev_b32 v237, 1, v230
 v_lshl_add_u32 v233, v237, 3, v233
 v_add_u32 v200, 0x10000, v233
 v_xor_b32 v201, 64, v200
 v_xor_b32 v202, 128, v200
 v_xor_b32 v203, 192, v200
 v_bfe_u32 v233, v227, 1, 3
 v_xor_b32 v233, v233, v226
 v_lshlrev_b32 v233, 4, v233
 v_lshl_add_u32 v233, v227, 7, v233
 v_lshl_add_u32 v244, v225, 13, v233
 v_xor_b32 v245, 32, v244
 v_xor_b32 v246, 64, v244
 v_xor_b32 v247, 96, v244
 v_add_u32 v204, 0x20000, v244
 v_add_u32 v205, 0x20000, v245
 v_add_u32 v206, 0x20000, v246
 v_add_u32 v207, 0x20000, v247
 v_lshl_add_u32 v233, v225, 3, v232
 v_and_b32 v237, 15, v233
 v_xor_b32 v237, v237, v231
 v_lshlrev_b32 v237, 4, v237
 v_lshl_add_u32 v208, v233, 8, v237
 v_xor_b32 v209, 64, v208
 v_lshl_add_u32 v210, v233, 8, v234
 v_lshlrev_b32 v235, 11, v225
 v_lshl_add_u32 v214, v224, 4, v235
 s_lshl_b32 s5, s3, 4
 s_add_u32 s5, s5, s4
 s_lshl_b32 s5, s5, 18
 s_add_u32 s8, s58, s5
 s_addc_u32 s9, s59, 0
 s_mov_b32 s10, 262144
 s_mov_b32 s11, 0x20000
 s_add_u32 s12, s48, s5
 s_addc_u32 s13, s49, 0
 s_mov_b32 s14, 262144
 s_mov_b32 s15, 0x20000
 s_lshl_b32 s5, s3, 21
 s_add_u32 s24, s52, s5
 s_addc_u32 s25, s53, 0
 s_mov_b32 s26, 2097152
 s_mov_b32 s27, 0x20000
 s_add_u32 s96, s52, 0x4000000
 s_addc_u32 s97, s53, 0
 s_mov_b32 s98, 0x2020000
 s_mov_b32 s99, 0x20000
 s_mov_b32 s86, 4194304
 s_mov_b32 s87, 0x20000
 s_getpc_b64 s[88:89]
A_PC:
 s_lshl_b32 s5, s6, 2
 s_add_u32 s5, s5, s54
 s_mul_hi_u32 s55, s5, 0x1c71c71d
 s_mul_i32 s55, s55, 9
 s_sub_u32 s5, s5, s55
 s_lshl_b32 s5, s5, 13
 v_lshlrev_b32 v218, 7, v224
 v_add_u32 v218, s5, v218
 v_min_u32 v218, CODE_END-A_PC-4, v218
 global_load_dword v219, v218, s[88:89]
.p2align 3
 buffer_load_dwordx4 v211, s[16:19], s34 offen lds
 buffer_load_dwordx4 v211, s[16:19], s35 offen offset:1024 lds
 s_waitcnt vmcnt(0)
 s_barrier
 ds_read_b128 a[128:131], v244 offset:0
 ds_read_b64_tr_b16 v[220:221], v200 offset:0
 ds_read_b64_tr_b16 v[222:223], v200 offset:2048
 s_waitcnt lgkmcnt(0)
 v_mfma_f32_32x32x16_bf16 a[0:15], v[220:223], a[128:131], 0
 ds_read_b64_tr_b16 v[224:225], v201 offset:0
 ds_read_b64_tr_b16 v[226:227], v201 offset:2048
 ds_read_b64_tr_b16 v[228:229], v202 offset:0
 ds_read_b64_tr_b16 v[230:231], v202 offset:2048
 ds_read_b64_tr_b16 v[232:233], v203 offset:0
 ds_read_b64_tr_b16 v[234:235], v203 offset:2048
 ds_read_b128 a[144:147], v244 offset:4096
 s_waitcnt lgkmcnt(0)
 v_mfma_f32_32x32x16_bf16 a[16:31], v[220:223], a[144:147], 0
 ds_read_b64_tr_b16 v[236:237], v200 offset:4096
 ds_read_b64_tr_b16 v[238:239], v200 offset:6144
 ds_read_b64_tr_b16 v[220:221], v201 offset:4096
 ds_read_b64_tr_b16 v[222:223], v201 offset:6144
 s_add_u32 m0, s28, 90112
 s_add_u32 s34, s68, 262144
 v_mfma_f32_32x32x16_bf16 a[32:47], v[224:227], a[128:131], 0
 s_add_u32 s35, s68, 326656
 buffer_load_dwordx4 v211, s[16:19], s34 offen lds
 s_mov_b32 s32, 0
 ds_read_b128 a[132:135], v245 offset:0
 ds_read_b128 a[148:151], v245 offset:4096
 v_mfma_f32_32x32x16_bf16 a[48:63], v[224:227], a[144:147], 0
 ds_read_b64_tr_b16 v[224:225], v202 offset:4096
 ds_read_b64_tr_b16 v[226:227], v202 offset:6144
 ds_read_b128 a[136:139], v246 offset:0
 ds_read_b128 a[152:155], v246 offset:4096
 ds_read_b128 a[140:143], v247 offset:0
 ds_read_b128 a[156:159], v247 offset:4096
 v_mfma_f32_32x32x16_bf16 a[64:79], v[228:231], a[128:131], 0
 v_mov_b32 v216, 0
 buffer_load_dwordx4 v211, s[16:19], s35 offen offset:1024 lds
 s_add_u32 m0, s28, 98304
 s_add_u32 s34, s69, 256
 s_add_u32 s35, s69, 64768
 v_mfma_f32_32x32x16_bf16 a[80:95], v[228:231], a[144:147], 0
 ds_read_b64_tr_b16 v[228:229], v203 offset:4096
 ds_read_b64_tr_b16 v[230:231], v203 offset:6144
 v_mov_b32 v217, 0
 v_mfma_f32_32x32x16_bf16 a[96:111], v[232:235], a[128:131], 0
 v_mfma_f32_32x32x16_bf16 a[112:127], v[232:235], a[144:147], 0
 ds_read_b64_tr_b16 v[232:233], v200 offset:8192
 ds_read_b64_tr_b16 v[234:235], v200 offset:10240
 buffer_load_dwordx4 v211, s[16:19], s34 offen lds
 s_waitcnt lgkmcnt(10)
 v_mfma_f32_32x32x16_bf16 a[0:15], v[236:239], a[132:135], a[0:15]
 v_mfma_f32_32x32x16_bf16 a[16:31], v[236:239], a[148:151], a[16:31]
 ds_read_b64_tr_b16 v[236:237], v201 offset:8192
 ds_read_b64_tr_b16 v[238:239], v201 offset:10240
 buffer_load_dwordx4 v211, s[16:19], s35 offen offset:1024 lds
 s_add_u32 m0, s31, 32768
 s_add_u32 s44, s61, 0
 v_mfma_f32_32x32x16_bf16 a[32:47], v[220:223], a[132:135], a[32:47]
 s_add_u32 s45, s61, 7168
 s_add_u32 s46, s61, 14336
 s_add_u32 s47, s61, 21504
 v_mfma_f32_32x32x16_bf16 a[48:63], v[220:223], a[148:151], a[48:63]
 ds_read_b64_tr_b16 v[220:221], v202 offset:8192
 ds_read_b64_tr_b16 v[222:223], v202 offset:10240
 buffer_load_dwordx4 v212, s[20:23], s44 offen offset:0 lds
 s_waitcnt lgkmcnt(6)
 v_mfma_f32_32x32x16_bf16 a[64:79], v[224:227], a[132:135], a[64:79]
 v_mfma_f32_32x32x16_bf16 a[80:95], v[224:227], a[148:151], a[80:95]
 ds_read_b64_tr_b16 v[224:225], v203 offset:8192
 ds_read_b64_tr_b16 v[226:227], v203 offset:10240
 buffer_load_dwordx4 v213, s[20:23], s45 offen offset:1024 lds
 v_mfma_f32_32x32x16_bf16 a[96:111], v[228:231], a[132:135], a[96:111]
 v_mfma_f32_32x32x16_bf16 a[112:127], v[228:231], a[148:151], a[112:127]
 ds_read_b64_tr_b16 v[228:229], v200 offset:12288
 ds_read_b64_tr_b16 v[230:231], v200 offset:14336
 buffer_load_dwordx4 v212, s[20:23], s46 offen offset:2048 lds
 s_waitcnt lgkmcnt(6)
 v_mfma_f32_32x32x16_bf16 a[0:15], v[232:235], a[136:139], a[0:15]
 v_mfma_f32_32x32x16_bf16 a[16:31], v[232:235], a[152:155], a[16:31]
 ds_read_b64_tr_b16 v[232:233], v201 offset:12288
 ds_read_b64_tr_b16 v[234:235], v201 offset:14336
 buffer_load_dwordx4 v213, s[20:23], s47 offen offset:3072 lds
 s_add_u32 m0, s31, 36864
 s_add_u32 s44, s61, 32768
 v_mfma_f32_32x32x16_bf16 a[32:47], v[236:239], a[136:139], a[32:47]
 s_add_u32 s45, s61, 39936
 s_add_u32 s46, s61, 47104
 s_add_u32 s47, s61, 54272
 v_mfma_f32_32x32x16_bf16 a[48:63], v[236:239], a[152:155], a[48:63]
 ds_read_b64_tr_b16 v[236:237], v202 offset:12288
 ds_read_b64_tr_b16 v[238:239], v202 offset:14336
 buffer_load_dwordx4 v212, s[20:23], s44 offen offset:0 lds
 s_waitcnt lgkmcnt(6)
 v_mfma_f32_32x32x16_bf16 a[64:79], v[220:223], a[136:139], a[64:79]
 v_mfma_f32_32x32x16_bf16 a[80:95], v[220:223], a[152:155], a[80:95]
 ds_read_b64_tr_b16 v[220:221], v203 offset:12288
 ds_read_b64_tr_b16 v[222:223], v203 offset:14336
 buffer_load_dwordx4 v213, s[20:23], s45 offen offset:1024 lds
 v_mfma_f32_32x32x16_bf16 a[96:111], v[224:227], a[136:139], a[96:111]
 v_mfma_f32_32x32x16_bf16 a[112:127], v[224:227], a[152:155], a[112:127]
 ds_read_b64_tr_b16 v[224:225], v200 offset:16384
 ds_read_b64_tr_b16 v[226:227], v200 offset:18432
 buffer_load_dwordx4 v212, s[20:23], s46 offen offset:2048 lds
 s_waitcnt lgkmcnt(6)
 v_mfma_f32_32x32x16_bf16 a[0:15], v[228:231], a[140:143], a[0:15]
 v_mfma_f32_32x32x16_bf16 a[16:31], v[228:231], a[156:159], a[16:31]
 ds_read_b64_tr_b16 v[228:229], v201 offset:16384
 ds_read_b64_tr_b16 v[230:231], v201 offset:18432
 buffer_load_dwordx4 v213, s[20:23], s47 offen offset:3072 lds
 s_add_u32 m0, s28, 106496
 s_add_u32 s34, s69, 262400
 v_mfma_f32_32x32x16_bf16 a[32:47], v[232:235], a[140:143], a[32:47]
 s_add_u32 s35, s69, 326912
 v_mfma_f32_32x32x16_bf16 a[48:63], v[232:235], a[156:159], a[48:63]
 ds_read_b64_tr_b16 v[232:233], v202 offset:16384
 ds_read_b64_tr_b16 v[234:235], v202 offset:18432
 buffer_load_dwordx4 v211, s[16:19], s34 offen lds
 s_waitcnt lgkmcnt(6)
 v_mfma_f32_32x32x16_bf16 a[64:79], v[236:239], a[140:143], a[64:79]
 v_mfma_f32_32x32x16_bf16 a[80:95], v[236:239], a[156:159], a[80:95]
 ds_read_b64_tr_b16 v[236:237], v203 offset:16384
 ds_read_b64_tr_b16 v[238:239], v203 offset:18432
 buffer_load_dwordx4 v211, s[16:19], s35 offen offset:1024 lds
 s_add_u32 m0, s28, 114688
 s_add_u32 s34, s69, 0
 v_mfma_f32_32x32x16_bf16 a[96:111], v[220:223], a[140:143], a[96:111]
 s_add_u32 s35, s69, 64512
 v_mfma_f32_32x32x16_bf16 a[112:127], v[220:223], a[156:159], a[112:127]
 s_waitcnt vmcnt(10)
 s_barrier
 ds_read_b64_tr_b16 v[220:221], v200 offset:20480
 ds_read_b64_tr_b16 v[222:223], v200 offset:22528
 buffer_load_dwordx4 v211, s[16:19], s34 offen lds
 s_waitcnt lgkmcnt(6)
 v_mfma_f32_32x32x16_bf16 v[64:79], v[224:227], a[128:131], 0
 v_mfma_f32_32x32x16_bf16 v[80:95], v[224:227], a[144:147], 0
 ds_read_b64_tr_b16 v[224:225], v201 offset:20480
 ds_read_b64_tr_b16 v[226:227], v201 offset:22528
 v_mfma_f32_32x32x16_bf16 v[96:111], v[228:231], a[128:131], 0
 buffer_load_dwordx4 v211, s[16:19], s35 offen offset:1024 lds
 s_add_u32 m0, s28, 122880
 s_add_u32 s34, s69, 262144
 s_add_u32 s35, s69, 326656
 v_mfma_f32_32x32x16_bf16 v[112:127], v[228:231], a[144:147], 0
 ds_read_b64_tr_b16 v[228:229], v202 offset:20480
 ds_read_b64_tr_b16 v[230:231], v202 offset:22528
 s_waitcnt lgkmcnt(6)
 v_mfma_f32_32x32x16_bf16 v[128:143], v[232:235], a[128:131], 0
 buffer_load_dwordx4 v211, s[16:19], s34 offen lds
 v_mfma_f32_32x32x16_bf16 v[144:159], v[232:235], a[144:147], 0
 ds_read_b64_tr_b16 v[232:233], v203 offset:20480
 ds_read_b64_tr_b16 v[234:235], v203 offset:22528
 v_mfma_f32_32x32x16_bf16 v[160:175], v[236:239], a[128:131], 0
 buffer_load_dwordx4 v211, s[16:19], s35 offen offset:1024 lds
 s_add_u32 m0, s31, 131072
 s_add_u32 s44, s62, 0
 s_add_u32 s45, s62, 7168
 s_add_u32 s46, s62, 14336
 v_mfma_f32_32x32x16_bf16 v[176:191], v[236:239], a[144:147], 0
 ds_read_b64_tr_b16 v[236:237], v200 offset:24576
 ds_read_b64_tr_b16 v[238:239], v200 offset:26624
 s_add_u32 s47, s62, 21504
 s_waitcnt lgkmcnt(6)
 v_mfma_f32_32x32x16_bf16 v[64:79], v[220:223], a[132:135], v[64:79]
 buffer_load_dwordx4 v212, s[20:23], s44 offen offset:0 lds
 v_mfma_f32_32x32x16_bf16 v[80:95], v[220:223], a[148:151], v[80:95]
 ds_read_b64_tr_b16 v[220:221], v201 offset:24576
 ds_read_b64_tr_b16 v[222:223], v201 offset:26624
 v_mfma_f32_32x32x16_bf16 v[96:111], v[224:227], a[132:135], v[96:111]
 buffer_load_dwordx4 v213, s[20:23], s45 offen offset:1024 lds
 v_mfma_f32_32x32x16_bf16 v[112:127], v[224:227], a[148:151], v[112:127]
 ds_read_b64_tr_b16 v[224:225], v202 offset:24576
 ds_read_b64_tr_b16 v[226:227], v202 offset:26624
 s_waitcnt lgkmcnt(6)
 v_mfma_f32_32x32x16_bf16 v[128:143], v[228:231], a[132:135], v[128:143]
 buffer_load_dwordx4 v212, s[20:23], s46 offen offset:2048 lds
 v_mfma_f32_32x32x16_bf16 v[144:159], v[228:231], a[148:151], v[144:159]
 ds_read_b64_tr_b16 v[228:229], v203 offset:24576
 ds_read_b64_tr_b16 v[230:231], v203 offset:26624
 v_mfma_f32_32x32x16_bf16 v[160:175], v[232:235], a[132:135], v[160:175]
 buffer_load_dwordx4 v213, s[20:23], s47 offen offset:3072 lds
 s_add_u32 m0, s31, 135168
 s_add_u32 s44, s62, 32768
 s_add_u32 s45, s62, 39936
 s_add_u32 s46, s62, 47104
 v_mfma_f32_32x32x16_bf16 v[176:191], v[232:235], a[148:151], v[176:191]
 ds_read_b64_tr_b16 v[232:233], v200 offset:28672
 ds_read_b64_tr_b16 v[234:235], v200 offset:30720
 s_add_u32 s47, s62, 54272
 s_waitcnt lgkmcnt(6)
 v_mfma_f32_32x32x16_bf16 v[64:79], v[236:239], a[136:139], v[64:79]
 buffer_load_dwordx4 v212, s[20:23], s44 offen offset:0 lds
 v_mfma_f32_32x32x16_bf16 v[80:95], v[236:239], a[152:155], v[80:95]
 ds_read_b64_tr_b16 v[236:237], v201 offset:28672
 ds_read_b64_tr_b16 v[238:239], v201 offset:30720
 s_waitcnt vmcnt(15)
 s_nop 1
 ds_read_b128 a[160:163], v244 offset:32768
 s_waitcnt vmcnt(11)
 ds_read_b128 a[176:179], v244 offset:36864
 ds_read_b128 a[164:167], v245 offset:32768
 ds_read_b128 a[180:183], v245 offset:36864
 v_mfma_f32_32x32x16_bf16 v[96:111], v[220:223], a[136:139], v[96:111]
 buffer_load_dwordx4 v213, s[20:23], s45 offen offset:1024 lds
 ds_read_b128 a[168:171], v246 offset:32768
 ds_read_b128 a[184:187], v246 offset:36864
 ds_read_b128 a[172:175], v247 offset:32768
 ds_read_b128 a[188:191], v247 offset:36864
 v_mfma_f32_32x32x16_bf16 v[112:127], v[220:223], a[152:155], v[112:127]
 ds_read_b64_tr_b16 v[220:221], v202 offset:28672
 ds_read_b64_tr_b16 v[222:223], v202 offset:30720
 s_waitcnt lgkmcnt(14)
 v_mfma_f32_32x32x16_bf16 v[128:143], v[224:227], a[136:139], v[128:143]
 buffer_load_dwordx4 v212, s[20:23], s46 offen offset:2048 lds
 v_mfma_f32_32x32x16_bf16 v[144:159], v[224:227], a[152:155], v[144:159]
 ds_read_b64_tr_b16 v[224:225], v203 offset:28672
 ds_read_b64_tr_b16 v[226:227], v203 offset:30720
 v_mfma_f32_32x32x16_bf16 v[160:175], v[228:231], a[136:139], v[160:175]
 buffer_load_dwordx4 v213, s[20:23], s47 offen offset:3072 lds
 s_add_u32 m0, s28, 65536
 s_add_u32 s34, s70, 256
 s_add_u32 s35, s70, 64768
 v_mfma_f32_32x32x16_bf16 v[176:191], v[228:231], a[152:155], v[176:191]
 ds_read_b64_tr_b16 v[228:229], v200 offset:32768
 ds_read_b64_tr_b16 v[230:231], v200 offset:34816
 s_waitcnt lgkmcnt(6)
 v_mfma_f32_32x32x16_bf16 v[64:79], v[232:235], a[140:143], v[64:79]
 buffer_load_dwordx4 v211, s[16:19], s34 offen lds
 v_mfma_f32_32x32x16_bf16 v[80:95], v[232:235], a[156:159], v[80:95]
 ds_read_b64_tr_b16 v[232:233], v201 offset:32768
 ds_read_b64_tr_b16 v[234:235], v201 offset:34816
 v_mfma_f32_32x32x16_bf16 v[96:111], v[236:239], a[140:143], v[96:111]
 buffer_load_dwordx4 v211, s[16:19], s35 offen offset:1024 lds
 s_add_u32 m0, s28, 73728
 s_add_u32 s34, s70, 262400
 s_add_u32 s35, s70, 326912
 v_mfma_f32_32x32x16_bf16 v[112:127], v[236:239], a[156:159], v[112:127]
 ds_read_b64_tr_b16 v[236:237], v202 offset:32768
 ds_read_b64_tr_b16 v[238:239], v202 offset:34816
 s_waitcnt lgkmcnt(6)
 v_mfma_f32_32x32x16_bf16 v[128:143], v[220:223], a[140:143], v[128:143]
 buffer_load_dwordx4 v211, s[16:19], s34 offen lds
 v_mfma_f32_32x32x16_bf16 v[144:159], v[220:223], a[156:159], v[144:159]
 ds_read_b64_tr_b16 v[220:221], v203 offset:32768
 ds_read_b64_tr_b16 v[222:223], v203 offset:34816
 v_mfma_f32_32x32x16_bf16 v[160:175], v[224:227], a[140:143], v[160:175]
 buffer_load_dwordx4 v211, s[16:19], s35 offen offset:1024 lds
 v_mfma_f32_32x32x16_bf16 v[176:191], v[224:227], a[156:159], v[176:191]
 s_waitcnt vmcnt(14)
 s_barrier
 ds_read_b64_tr_b16 v[224:225], v200 offset:36864
 ds_read_b64_tr_b16 v[226:227], v200 offset:38912
 s_add_u32 m0, s28, 81920
 s_add_u32 s34, s70, 0
 s_add_u32 s35, s70, 64512
 s_waitcnt lgkmcnt(6)
 v_mfma_f32_32x32x16_bf16 a[0:15], v[228:231], a[160:163], a[0:15]
 buffer_load_dwordx4 v211, s[16:19], s34 offen lds
 v_mfma_f32_32x32x16_bf16 a[16:31], v[228:231], a[176:179], a[16:31]
 ds_read_b64_tr_b16 v[228:229], v201 offset:36864
 ds_read_b64_tr_b16 v[230:231], v201 offset:38912
 v_mfma_f32_32x32x16_bf16 a[32:47], v[232:235], a[160:163], a[32:47]
 buffer_load_dwordx4 v211, s[16:19], s35 offen offset:1024 lds
 s_add_u32 m0, s28, 90112
 s_add_u32 s34, s70, 262144
 s_add_u32 s35, s70, 326656
 v_mfma_f32_32x32x16_bf16 a[48:63], v[232:235], a[176:179], a[48:63]
 ds_read_b64_tr_b16 v[232:233], v202 offset:36864
 ds_read_b64_tr_b16 v[234:235], v202 offset:38912
 s_waitcnt lgkmcnt(6)
 v_mfma_f32_32x32x16_bf16 a[64:79], v[236:239], a[160:163], a[64:79]
 buffer_load_dwordx4 v211, s[16:19], s34 offen lds
 v_mfma_f32_32x32x16_bf16 a[80:95], v[236:239], a[176:179], a[80:95]
 ds_read_b64_tr_b16 v[236:237], v203 offset:36864
 ds_read_b64_tr_b16 v[238:239], v203 offset:38912
 v_mfma_f32_32x32x16_bf16 a[96:111], v[220:223], a[160:163], a[96:111]
 buffer_load_dwordx4 v211, s[16:19], s35 offen offset:1024 lds
 v_mfma_f32_32x32x16_bf16 a[112:127], v[220:223], a[176:179], a[112:127]
 ds_read_b64_tr_b16 v[220:221], v200 offset:40960
 ds_read_b64_tr_b16 v[222:223], v200 offset:43008
 s_waitcnt lgkmcnt(6)
 v_mfma_f32_32x32x16_bf16 a[0:15], v[224:227], a[164:167], a[0:15]
 v_mfma_f32_32x32x16_bf16 a[16:31], v[224:227], a[180:183], a[16:31]
 ds_read_b64_tr_b16 v[224:225], v201 offset:40960
 ds_read_b64_tr_b16 v[226:227], v201 offset:43008
 v_mfma_f32_32x32x16_bf16 a[32:47], v[228:231], a[164:167], a[32:47]
 v_mfma_f32_32x32x16_bf16 a[48:63], v[228:231], a[180:183], a[48:63]
 ds_read_b64_tr_b16 v[228:229], v202 offset:40960
 ds_read_b64_tr_b16 v[230:231], v202 offset:43008
 s_waitcnt lgkmcnt(6)
 v_mfma_f32_32x32x16_bf16 a[64:79], v[232:235], a[164:167], a[64:79]
 v_mfma_f32_32x32x16_bf16 a[80:95], v[232:235], a[180:183], a[80:95]
 ds_read_b64_tr_b16 v[232:233], v203 offset:40960
 ds_read_b64_tr_b16 v[234:235], v203 offset:43008
 v_mfma_f32_32x32x16_bf16 a[96:111], v[236:239], a[164:167], a[96:111]
 v_mfma_f32_32x32x16_bf16 a[112:127], v[236:239], a[180:183], a[112:127]
 ds_read_b64_tr_b16 v[236:237], v200 offset:45056
 ds_read_b64_tr_b16 v[238:239], v200 offset:47104
 s_waitcnt lgkmcnt(6)
 v_mfma_f32_32x32x16_bf16 a[0:15], v[220:223], a[168:171], a[0:15]
 v_mfma_f32_32x32x16_bf16 a[16:31], v[220:223], a[184:187], a[16:31]
 ds_read_b64_tr_b16 v[220:221], v201 offset:45056
 ds_read_b64_tr_b16 v[222:223], v201 offset:47104
 v_mfma_f32_32x32x16_bf16 a[32:47], v[224:227], a[168:171], a[32:47]
 v_mfma_f32_32x32x16_bf16 a[48:63], v[224:227], a[184:187], a[48:63]
 ds_read_b64_tr_b16 v[224:225], v202 offset:45056
 ds_read_b64_tr_b16 v[226:227], v202 offset:47104
 s_waitcnt lgkmcnt(6)
 v_mfma_f32_32x32x16_bf16 a[64:79], v[228:231], a[168:171], a[64:79]
 v_mfma_f32_32x32x16_bf16 a[80:95], v[228:231], a[184:187], a[80:95]
 ds_read_b64_tr_b16 v[228:229], v203 offset:45056
 ds_read_b64_tr_b16 v[230:231], v203 offset:47104
 v_mfma_f32_32x32x16_bf16 a[96:111], v[232:235], a[168:171], a[96:111]
 v_mfma_f32_32x32x16_bf16 a[112:127], v[232:235], a[184:187], a[112:127]
 ds_read_b64_tr_b16 v[232:233], v200 offset:49152
 ds_read_b64_tr_b16 v[234:235], v200 offset:51200
 s_waitcnt lgkmcnt(6)
 v_mfma_f32_32x32x16_bf16 a[0:15], v[236:239], a[172:175], a[0:15]
 v_mfma_f32_32x32x16_bf16 a[16:31], v[236:239], a[188:191], a[16:31]
 ds_read_b64_tr_b16 v[236:237], v201 offset:49152
 ds_read_b64_tr_b16 v[238:239], v201 offset:51200
 v_mfma_f32_32x32x16_bf16 a[32:47], v[220:223], a[172:175], a[32:47]
 v_mfma_f32_32x32x16_bf16 a[48:63], v[220:223], a[188:191], a[48:63]
 ds_read_b64_tr_b16 v[220:221], v202 offset:49152
 ds_read_b64_tr_b16 v[222:223], v202 offset:51200
 s_waitcnt lgkmcnt(6)
 v_mfma_f32_32x32x16_bf16 a[64:79], v[224:227], a[172:175], a[64:79]
 v_mfma_f32_32x32x16_bf16 a[80:95], v[224:227], a[188:191], a[80:95]
 ds_read_b64_tr_b16 v[224:225], v203 offset:49152
 ds_read_b64_tr_b16 v[226:227], v203 offset:51200
 v_mfma_f32_32x32x16_bf16 a[96:111], v[228:231], a[172:175], a[96:111]
 v_mfma_f32_32x32x16_bf16 a[112:127], v[228:231], a[188:191], a[112:127]
 s_waitcnt vmcnt(6)
 s_barrier
 ds_read_b64_tr_b16 v[228:229], v200 offset:53248
 ds_read_b64_tr_b16 v[230:231], v200 offset:55296
 s_add_u32 m0, s28, 98304
 s_add_u32 s34, s71, 256
 s_add_u32 s35, s71, 64768
 s_waitcnt lgkmcnt(6)
 v_mfma_f32_32x32x16_bf16 v[64:79], v[232:235], a[160:163], v[64:79]
 buffer_load_dwordx4 v211, s[16:19], s34 offen lds
 ds_read_b128 a[192:195], v204 offset:0
 ds_read_b128 a[208:211], v204 offset:4096
 ds_read_b128 a[196:199], v205 offset:0
 ds_read_b128 a[212:215], v205 offset:4096
 v_mfma_f32_32x32x16_bf16 v[80:95], v[232:235], a[176:179], v[80:95]
 ds_read_b64_tr_b16 v[232:233], v201 offset:53248
 ds_read_b64_tr_b16 v[234:235], v201 offset:55296
 ds_read_b128 a[200:203], v206 offset:0
 ds_read_b128 a[216:219], v206 offset:4096
 ds_read_b128 a[204:207], v207 offset:0
 ds_read_b128 a[220:223], v207 offset:4096
 v_mfma_f32_32x32x16_bf16 v[96:111], v[236:239], a[160:163], v[96:111]
 buffer_load_dwordx4 v211, s[16:19], s35 offen offset:1024 lds
 s_add_u32 m0, s28, 106496
 s_add_u32 s34, s71, 262400
 s_add_u32 s35, s71, 326912
 v_mfma_f32_32x32x16_bf16 v[112:127], v[236:239], a[176:179], v[112:127]
 ds_read_b64_tr_b16 v[236:237], v202 offset:53248
 ds_read_b64_tr_b16 v[238:239], v202 offset:55296
 s_waitcnt lgkmcnt(14)
 v_mfma_f32_32x32x16_bf16 v[128:143], v[220:223], a[160:163], v[128:143]
 buffer_load_dwordx4 v211, s[16:19], s34 offen lds
 v_mfma_f32_32x32x16_bf16 v[144:159], v[220:223], a[176:179], v[144:159]
 ds_read_b64_tr_b16 v[220:221], v203 offset:53248
 ds_read_b64_tr_b16 v[222:223], v203 offset:55296
 v_mfma_f32_32x32x16_bf16 v[160:175], v[224:227], a[160:163], v[160:175]
 buffer_load_dwordx4 v211, s[16:19], s35 offen offset:1024 lds
 s_waitcnt lgkmcnt(4)
 s_add_u32 m0, s31, 131072
 s_add_u32 s44, s63, 0
 s_add_u32 s45, s63, 7168
 s_add_u32 s46, s63, 14336
 v_mfma_f32_32x32x16_bf16 v[176:191], v[224:227], a[176:179], v[176:191]
 ds_read_b64_tr_b16 v[224:225], v200 offset:57344
 ds_read_b64_tr_b16 v[226:227], v200 offset:59392
 s_add_u32 s47, s63, 21504
 v_mfma_f32_32x32x16_bf16 v[64:79], v[228:231], a[164:167], v[64:79]
 buffer_load_dwordx4 v212, s[20:23], s44 offen offset:0 lds
 v_mfma_f32_32x32x16_bf16 v[80:95], v[228:231], a[180:183], v[80:95]
 ds_read_b64_tr_b16 v[228:229], v201 offset:57344
 ds_read_b64_tr_b16 v[230:231], v201 offset:59392
 v_mfma_f32_32x32x16_bf16 v[96:111], v[232:235], a[164:167], v[96:111]
 buffer_load_dwordx4 v213, s[20:23], s45 offen offset:1024 lds
 v_mfma_f32_32x32x16_bf16 v[112:127], v[232:235], a[180:183], v[112:127]
 ds_read_b64_tr_b16 v[232:233], v202 offset:57344
 ds_read_b64_tr_b16 v[234:235], v202 offset:59392
 s_waitcnt lgkmcnt(6)
 v_mfma_f32_32x32x16_bf16 v[128:143], v[236:239], a[164:167], v[128:143]
 buffer_load_dwordx4 v212, s[20:23], s46 offen offset:2048 lds
 v_mfma_f32_32x32x16_bf16 v[144:159], v[236:239], a[180:183], v[144:159]
 ds_read_b64_tr_b16 v[236:237], v203 offset:57344
 ds_read_b64_tr_b16 v[238:239], v203 offset:59392
 v_mfma_f32_32x32x16_bf16 v[160:175], v[220:223], a[164:167], v[160:175]
 buffer_load_dwordx4 v213, s[20:23], s47 offen offset:3072 lds
 s_add_u32 m0, s31, 135168
 s_add_u32 s44, s63, 32768
 s_add_u32 s45, s63, 39936
 s_add_u32 s46, s63, 47104
 v_mfma_f32_32x32x16_bf16 v[176:191], v[220:223], a[180:183], v[176:191]
 ds_read_b64_tr_b16 v[220:221], v200 offset:61440
 ds_read_b64_tr_b16 v[222:223], v200 offset:63488
 s_add_u32 s47, s63, 54272
 s_waitcnt lgkmcnt(6)
 v_mfma_f32_32x32x16_bf16 v[64:79], v[224:227], a[168:171], v[64:79]
 buffer_load_dwordx4 v212, s[20:23], s44 offen offset:0 lds
 v_mfma_f32_32x32x16_bf16 v[80:95], v[224:227], a[184:187], v[80:95]
 ds_read_b64_tr_b16 v[224:225], v201 offset:61440
 ds_read_b64_tr_b16 v[226:227], v201 offset:63488
 v_mfma_f32_32x32x16_bf16 v[96:111], v[228:231], a[168:171], v[96:111]
 buffer_load_dwordx4 v213, s[20:23], s45 offen offset:1024 lds
 v_mfma_f32_32x32x16_bf16 v[112:127], v[228:231], a[184:187], v[112:127]
 ds_read_b64_tr_b16 v[228:229], v202 offset:61440
 ds_read_b64_tr_b16 v[230:231], v202 offset:63488
 s_waitcnt lgkmcnt(6)
 v_mfma_f32_32x32x16_bf16 v[128:143], v[232:235], a[168:171], v[128:143]
 buffer_load_dwordx4 v212, s[20:23], s46 offen offset:2048 lds
 v_mfma_f32_32x32x16_bf16 v[144:159], v[232:235], a[184:187], v[144:159]
 ds_read_b64_tr_b16 v[232:233], v203 offset:61440
 ds_read_b64_tr_b16 v[234:235], v203 offset:63488
 v_mfma_f32_32x32x16_bf16 v[160:175], v[236:239], a[168:171], v[160:175]
 buffer_load_dwordx4 v213, s[20:23], s47 offen offset:3072 lds
 s_add_u32 m0, s28, 0
 v_mfma_f32_32x32x16_bf16 v[176:191], v[236:239], a[184:187], v[176:191]
 ds_read_b64_tr_b16 v[236:237], v200 offset:0
 ds_read_b64_tr_b16 v[238:239], v200 offset:2048
 s_waitcnt lgkmcnt(6)
 v_mfma_f32_32x32x16_bf16 v[64:79], v[220:223], a[172:175], v[64:79]
 buffer_load_dwordx4 v208, s[8:11], s32 offen nt lds
 v_mfma_f32_32x32x16_bf16 v[80:95], v[220:223], a[188:191], v[80:95]
 ds_read_b64_tr_b16 v[220:221], v201 offset:0
 ds_read_b64_tr_b16 v[222:223], v201 offset:2048
 v_mfma_f32_32x32x16_bf16 v[96:111], v[224:227], a[172:175], v[96:111]
 buffer_load_dwordx4 v209, s[8:11], s32 offen offset:1024 nt lds
 s_mov_b32 s32, 8192
 v_mfma_f32_32x32x16_bf16 v[112:127], v[224:227], a[188:191], v[112:127]
 ds_read_b64_tr_b16 v[224:225], v202 offset:0
 ds_read_b64_tr_b16 v[226:227], v202 offset:2048
 s_waitcnt lgkmcnt(6)
 v_mfma_f32_32x32x16_bf16 v[128:143], v[228:231], a[172:175], v[128:143]
 v_mfma_f32_32x32x16_bf16 v[144:159], v[228:231], a[188:191], v[144:159]
 ds_read_b64_tr_b16 v[228:229], v203 offset:0
 ds_read_b64_tr_b16 v[230:231], v203 offset:2048
 v_mfma_f32_32x32x16_bf16 v[160:175], v[232:235], a[172:175], v[160:175]
 v_mfma_f32_32x32x16_bf16 v[176:191], v[232:235], a[188:191], v[176:191]
 s_waitcnt vmcnt(16)
 s_barrier
 ds_read_b64_tr_b16 v[232:233], v200 offset:4096
 ds_read_b64_tr_b16 v[234:235], v200 offset:6144
 s_add_u32 m0, s28, 114688
 s_add_u32 s34, s71, 0
 s_add_u32 s35, s71, 64512
 s_waitcnt lgkmcnt(6)
 v_mfma_f32_32x32x16_bf16 a[0:15], v[236:239], a[192:195], a[0:15]
 buffer_load_dwordx4 v211, s[16:19], s34 offen lds
 v_mfma_f32_32x32x16_bf16 a[16:31], v[236:239], a[208:211], a[16:31]
 ds_read_b64_tr_b16 v[236:237], v201 offset:4096
 ds_read_b64_tr_b16 v[238:239], v201 offset:6144
 v_mfma_f32_32x32x16_bf16 a[32:47], v[220:223], a[192:195], a[32:47]
 buffer_load_dwordx4 v211, s[16:19], s35 offen offset:1024 lds
 s_add_u32 m0, s28, 122880
 s_add_u32 s34, s71, 262144
 s_add_u32 s35, s71, 326656
 v_mfma_f32_32x32x16_bf16 a[48:63], v[220:223], a[208:211], a[48:63]
 ds_read_b64_tr_b16 v[220:221], v202 offset:4096
 ds_read_b64_tr_b16 v[222:223], v202 offset:6144
 s_waitcnt lgkmcnt(6)
 v_mfma_f32_32x32x16_bf16 a[64:79], v[224:227], a[192:195], a[64:79]
 buffer_load_dwordx4 v211, s[16:19], s34 offen lds
 v_mfma_f32_32x32x16_bf16 a[80:95], v[224:227], a[208:211], a[80:95]
 ds_read_b64_tr_b16 v[224:225], v203 offset:4096
 ds_read_b64_tr_b16 v[226:227], v203 offset:6144
 v_mfma_f32_32x32x16_bf16 a[96:111], v[228:231], a[192:195], a[96:111]
 buffer_load_dwordx4 v211, s[16:19], s35 offen offset:1024 lds
 s_add_u32 m0, s28, 8192
 v_mfma_f32_32x32x16_bf16 a[112:127], v[228:231], a[208:211], a[112:127]
 ds_read_b64_tr_b16 v[228:229], v200 offset:8192
 ds_read_b64_tr_b16 v[230:231], v200 offset:10240
 s_waitcnt lgkmcnt(6)
 v_mfma_f32_32x32x16_bf16 a[0:15], v[232:235], a[196:199], a[0:15]
 buffer_load_dwordx4 v208, s[8:11], s32 offen nt lds
 v_mfma_f32_32x32x16_bf16 a[16:31], v[232:235], a[212:215], a[16:31]
 ds_read_b64_tr_b16 v[232:233], v201 offset:8192
 ds_read_b64_tr_b16 v[234:235], v201 offset:10240
 v_mfma_f32_32x32x16_bf16 a[32:47], v[236:239], a[196:199], a[32:47]
 buffer_load_dwordx4 v209, s[8:11], s32 offen offset:1024 nt lds
 s_mov_b32 s32, 16384
 v_mfma_f32_32x32x16_bf16 a[48:63], v[236:239], a[212:215], a[48:63]
 ds_read_b64_tr_b16 v[236:237], v202 offset:8192
 ds_read_b64_tr_b16 v[238:239], v202 offset:10240
 s_waitcnt lgkmcnt(6)
 v_mfma_f32_32x32x16_bf16 a[64:79], v[220:223], a[196:199], a[64:79]
 v_mfma_f32_32x32x16_bf16 a[80:95], v[220:223], a[212:215], a[80:95]
 ds_read_b64_tr_b16 v[220:221], v203 offset:8192
 ds_read_b64_tr_b16 v[222:223], v203 offset:10240
 v_mfma_f32_32x32x16_bf16 a[96:111], v[224:227], a[196:199], a[96:111]
 v_mfma_f32_32x32x16_bf16 a[112:127], v[224:227], a[212:215], a[112:127]
 ds_read_b64_tr_b16 v[224:225], v200 offset:12288
 ds_read_b64_tr_b16 v[226:227], v200 offset:14336
 s_waitcnt lgkmcnt(6)
 v_mfma_f32_32x32x16_bf16 a[0:15], v[228:231], a[200:203], a[0:15]
 v_mfma_f32_32x32x16_bf16 a[16:31], v[228:231], a[216:219], a[16:31]
 ds_read_b64_tr_b16 v[228:229], v201 offset:12288
 ds_read_b64_tr_b16 v[230:231], v201 offset:14336
 v_mfma_f32_32x32x16_bf16 a[32:47], v[232:235], a[200:203], a[32:47]
 v_mfma_f32_32x32x16_bf16 a[48:63], v[232:235], a[216:219], a[48:63]
 ds_read_b64_tr_b16 v[232:233], v202 offset:12288
 ds_read_b64_tr_b16 v[234:235], v202 offset:14336
 s_waitcnt lgkmcnt(6)
 v_mfma_f32_32x32x16_bf16 a[64:79], v[236:239], a[200:203], a[64:79]
 v_mfma_f32_32x32x16_bf16 a[80:95], v[236:239], a[216:219], a[80:95]
 ds_read_b64_tr_b16 v[236:237], v203 offset:12288
 ds_read_b64_tr_b16 v[238:239], v203 offset:14336
 v_mfma_f32_32x32x16_bf16 a[96:111], v[220:223], a[200:203], a[96:111]
 v_mfma_f32_32x32x16_bf16 a[112:127], v[220:223], a[216:219], a[112:127]
 ds_read_b64_tr_b16 v[220:221], v200 offset:16384
 ds_read_b64_tr_b16 v[222:223], v200 offset:18432
 s_waitcnt lgkmcnt(6)
 v_mfma_f32_32x32x16_bf16 a[0:15], v[224:227], a[204:207], a[0:15]
 v_mfma_f32_32x32x16_bf16 a[16:31], v[224:227], a[220:223], a[16:31]
 ds_read_b64_tr_b16 v[224:225], v201 offset:16384
 ds_read_b64_tr_b16 v[226:227], v201 offset:18432
 v_mfma_f32_32x32x16_bf16 a[32:47], v[228:231], a[204:207], a[32:47]
 v_mfma_f32_32x32x16_bf16 a[48:63], v[228:231], a[220:223], a[48:63]
 ds_read_b64_tr_b16 v[228:229], v202 offset:16384
 ds_read_b64_tr_b16 v[230:231], v202 offset:18432
 s_waitcnt lgkmcnt(6)
 v_mfma_f32_32x32x16_bf16 a[64:79], v[232:235], a[204:207], a[64:79]
 v_mfma_f32_32x32x16_bf16 a[80:95], v[232:235], a[220:223], a[80:95]
 ds_read_b64_tr_b16 v[232:233], v203 offset:16384
 ds_read_b64_tr_b16 v[234:235], v203 offset:18432
 v_mfma_f32_32x32x16_bf16 a[96:111], v[236:239], a[204:207], a[96:111]
 v_mfma_f32_32x32x16_bf16 a[112:127], v[236:239], a[220:223], a[112:127]
 s_waitcnt vmcnt(18)
 s_barrier
 ds_read_b64_tr_b16 v[236:237], v200 offset:20480
 ds_read_b64_tr_b16 v[238:239], v200 offset:22528
 s_add_u32 m0, s28, 65536
 s_add_u32 s34, s72, 256
 s_add_u32 s35, s72, 64768
 s_waitcnt lgkmcnt(6)
 v_mfma_f32_32x32x16_bf16 v[64:79], v[220:223], a[192:195], v[64:79]
 buffer_load_dwordx4 v211, s[16:19], s34 offen lds
 s_waitcnt vmcnt(13)
 ds_read_b128 a[224:227], v204 offset:0
 s_waitcnt vmcnt(9)
 ds_read_b128 a[240:243], v204 offset:4096
 ds_read_b128 a[228:231], v205 offset:0
 ds_read_b128 a[244:247], v205 offset:4096
 v_mfma_f32_32x32x16_bf16 v[80:95], v[220:223], a[208:211], v[80:95]
 ds_read_b64_tr_b16 v[220:221], v201 offset:20480
 ds_read_b64_tr_b16 v[222:223], v201 offset:22528
 ds_read_b128 a[232:235], v206 offset:0
 ds_read_b128 a[248:251], v206 offset:4096
 ds_read_b128 a[236:239], v207 offset:0
 ds_read_b128 a[252:255], v207 offset:4096
 v_mfma_f32_32x32x16_bf16 v[96:111], v[224:227], a[192:195], v[96:111]
 buffer_load_dwordx4 v211, s[16:19], s35 offen offset:1024 lds
 s_add_u32 m0, s28, 73728
 s_add_u32 s34, s72, 262400
 s_add_u32 s35, s72, 326912
 v_mfma_f32_32x32x16_bf16 v[112:127], v[224:227], a[208:211], v[112:127]
 ds_read_b64_tr_b16 v[224:225], v202 offset:20480
 ds_read_b64_tr_b16 v[226:227], v202 offset:22528
 s_waitcnt lgkmcnt(14)
 v_mfma_f32_32x32x16_bf16 v[128:143], v[228:231], a[192:195], v[128:143]
 buffer_load_dwordx4 v211, s[16:19], s34 offen lds
 v_mfma_f32_32x32x16_bf16 v[144:159], v[228:231], a[208:211], v[144:159]
 ds_read_b64_tr_b16 v[228:229], v203 offset:20480
 ds_read_b64_tr_b16 v[230:231], v203 offset:22528
 v_mfma_f32_32x32x16_bf16 v[160:175], v[232:235], a[192:195], v[160:175]
 buffer_load_dwordx4 v211, s[16:19], s35 offen offset:1024 lds
 s_waitcnt lgkmcnt(4)
 s_add_u32 m0, s31, 131072
 s_add_u32 s44, s64, 0
 s_add_u32 s45, s64, 7168
 s_add_u32 s46, s64, 14336
 v_mfma_f32_32x32x16_bf16 v[176:191], v[232:235], a[208:211], v[176:191]
 ds_read_b64_tr_b16 v[232:233], v200 offset:24576
 ds_read_b64_tr_b16 v[234:235], v200 offset:26624
 s_add_u32 s47, s64, 21504
 v_mfma_f32_32x32x16_bf16 v[64:79], v[236:239], a[196:199], v[64:79]
 buffer_load_dwordx4 v212, s[20:23], s44 offen offset:0 lds
 v_mfma_f32_32x32x16_bf16 v[80:95], v[236:239], a[212:215], v[80:95]
 ds_read_b64_tr_b16 v[236:237], v201 offset:24576
 ds_read_b64_tr_b16 v[238:239], v201 offset:26624
 v_mfma_f32_32x32x16_bf16 v[96:111], v[220:223], a[196:199], v[96:111]
 buffer_load_dwordx4 v213, s[20:23], s45 offen offset:1024 lds
 v_mfma_f32_32x32x16_bf16 v[112:127], v[220:223], a[212:215], v[112:127]
 ds_read_b64_tr_b16 v[220:221], v202 offset:24576
 ds_read_b64_tr_b16 v[222:223], v202 offset:26624
 s_waitcnt lgkmcnt(6)
 v_mfma_f32_32x32x16_bf16 v[128:143], v[224:227], a[196:199], v[128:143]
 buffer_load_dwordx4 v212, s[20:23], s46 offen offset:2048 lds
 v_mfma_f32_32x32x16_bf16 v[144:159], v[224:227], a[212:215], v[144:159]
 ds_read_b64_tr_b16 v[224:225], v203 offset:24576
 ds_read_b64_tr_b16 v[226:227], v203 offset:26624
 v_mfma_f32_32x32x16_bf16 v[160:175], v[228:231], a[196:199], v[160:175]
 buffer_load_dwordx4 v213, s[20:23], s47 offen offset:3072 lds
 s_add_u32 m0, s31, 135168
 s_add_u32 s44, s64, 32768
 s_add_u32 s45, s64, 39936
 s_add_u32 s46, s64, 47104
 v_mfma_f32_32x32x16_bf16 v[176:191], v[228:231], a[212:215], v[176:191]
 ds_read_b64_tr_b16 v[228:229], v200 offset:28672
 ds_read_b64_tr_b16 v[230:231], v200 offset:30720
 s_add_u32 s47, s64, 54272
 s_waitcnt lgkmcnt(6)
 v_mfma_f32_32x32x16_bf16 v[64:79], v[232:235], a[200:203], v[64:79]
 buffer_load_dwordx4 v212, s[20:23], s44 offen offset:0 lds
 v_mfma_f32_32x32x16_bf16 v[80:95], v[232:235], a[216:219], v[80:95]
 ds_read_b64_tr_b16 v[232:233], v201 offset:28672
 ds_read_b64_tr_b16 v[234:235], v201 offset:30720
 v_mfma_f32_32x32x16_bf16 v[96:111], v[236:239], a[200:203], v[96:111]
 buffer_load_dwordx4 v213, s[20:23], s45 offen offset:1024 lds
 v_mfma_f32_32x32x16_bf16 v[112:127], v[236:239], a[216:219], v[112:127]
 ds_read_b64_tr_b16 v[236:237], v202 offset:28672
 ds_read_b64_tr_b16 v[238:239], v202 offset:30720
 s_waitcnt lgkmcnt(6)
 v_mfma_f32_32x32x16_bf16 v[128:143], v[220:223], a[200:203], v[128:143]
 buffer_load_dwordx4 v212, s[20:23], s46 offen offset:2048 lds
 v_mfma_f32_32x32x16_bf16 v[144:159], v[220:223], a[216:219], v[144:159]
 ds_read_b64_tr_b16 v[220:221], v203 offset:28672
 ds_read_b64_tr_b16 v[222:223], v203 offset:30720
 v_mfma_f32_32x32x16_bf16 v[160:175], v[224:227], a[200:203], v[160:175]
 buffer_load_dwordx4 v213, s[20:23], s47 offen offset:3072 lds
 s_add_u32 m0, s28, 16384
 v_mfma_f32_32x32x16_bf16 v[176:191], v[224:227], a[216:219], v[176:191]
 ds_read_b64_tr_b16 v[224:225], v200 offset:32768
 ds_read_b64_tr_b16 v[226:227], v200 offset:34816
 s_waitcnt lgkmcnt(6)
 v_mfma_f32_32x32x16_bf16 v[64:79], v[228:231], a[204:207], v[64:79]
 buffer_load_dwordx4 v208, s[8:11], s32 offen nt lds
 v_mfma_f32_32x32x16_bf16 v[80:95], v[228:231], a[220:223], v[80:95]
 ds_read_b64_tr_b16 v[228:229], v201 offset:32768
 ds_read_b64_tr_b16 v[230:231], v201 offset:34816
 v_mfma_f32_32x32x16_bf16 v[96:111], v[232:235], a[204:207], v[96:111]
 buffer_load_dwordx4 v209, s[8:11], s32 offen offset:1024 nt lds
 s_mov_b32 s32, 24576
 v_mfma_f32_32x32x16_bf16 v[112:127], v[232:235], a[220:223], v[112:127]
 ds_read_b64_tr_b16 v[232:233], v202 offset:32768
 ds_read_b64_tr_b16 v[234:235], v202 offset:34816
 s_waitcnt lgkmcnt(6)
 v_mfma_f32_32x32x16_bf16 v[128:143], v[236:239], a[204:207], v[128:143]
 v_mfma_f32_32x32x16_bf16 v[144:159], v[236:239], a[220:223], v[144:159]
 ds_read_b64_tr_b16 v[236:237], v203 offset:32768
 ds_read_b64_tr_b16 v[238:239], v203 offset:34816
 v_mfma_f32_32x32x16_bf16 v[160:175], v[220:223], a[204:207], v[160:175]
 v_mfma_f32_32x32x16_bf16 v[176:191], v[220:223], a[220:223], v[176:191]
 s_waitcnt vmcnt(18)
 s_barrier
 ds_read_b64_tr_b16 v[220:221], v200 offset:36864
 ds_read_b64_tr_b16 v[222:223], v200 offset:38912
 s_add_u32 m0, s28, 81920
 s_add_u32 s34, s72, 0
 s_add_u32 s35, s72, 64512
 s_waitcnt lgkmcnt(6)
 v_mfma_f32_32x32x16_bf16 a[0:15], v[224:227], a[224:227], a[0:15]
 buffer_load_dwordx4 v211, s[16:19], s34 offen lds
 v_mfma_f32_32x32x16_bf16 a[16:31], v[224:227], a[240:243], a[16:31]
 ds_read_b64_tr_b16 v[224:225], v201 offset:36864
 ds_read_b64_tr_b16 v[226:227], v201 offset:38912
 v_mfma_f32_32x32x16_bf16 a[32:47], v[228:231], a[224:227], a[32:47]
 buffer_load_dwordx4 v211, s[16:19], s35 offen offset:1024 lds
 s_add_u32 m0, s28, 90112
 s_add_u32 s34, s72, 262144
 s_add_u32 s35, s72, 326656
 v_mfma_f32_32x32x16_bf16 a[48:63], v[228:231], a[240:243], a[48:63]
 ds_read_b64_tr_b16 v[228:229], v202 offset:36864
 ds_read_b64_tr_b16 v[230:231], v202 offset:38912
 s_waitcnt lgkmcnt(6)
 v_mfma_f32_32x32x16_bf16 a[64:79], v[232:235], a[224:227], a[64:79]
 buffer_load_dwordx4 v211, s[16:19], s34 offen lds
 v_mfma_f32_32x32x16_bf16 a[80:95], v[232:235], a[240:243], a[80:95]
 ds_read_b64_tr_b16 v[232:233], v203 offset:36864
 ds_read_b64_tr_b16 v[234:235], v203 offset:38912
 v_mfma_f32_32x32x16_bf16 a[96:111], v[236:239], a[224:227], a[96:111]
 buffer_load_dwordx4 v211, s[16:19], s35 offen offset:1024 lds
 s_add_u32 m0, s28, 24576
 v_mfma_f32_32x32x16_bf16 a[112:127], v[236:239], a[240:243], a[112:127]
 ds_read_b64_tr_b16 v[236:237], v200 offset:40960
 ds_read_b64_tr_b16 v[238:239], v200 offset:43008
 s_waitcnt lgkmcnt(6)
 v_mfma_f32_32x32x16_bf16 a[0:15], v[220:223], a[228:231], a[0:15]
 buffer_load_dwordx4 v208, s[8:11], s32 offen nt lds
 v_mfma_f32_32x32x16_bf16 a[16:31], v[220:223], a[244:247], a[16:31]
 ds_read_b64_tr_b16 v[220:221], v201 offset:40960
 ds_read_b64_tr_b16 v[222:223], v201 offset:43008
 v_mfma_f32_32x32x16_bf16 a[32:47], v[224:227], a[228:231], a[32:47]
 buffer_load_dwordx4 v209, s[8:11], s32 offen offset:1024 nt lds
 s_mov_b32 s32, 32768
 v_mfma_f32_32x32x16_bf16 a[48:63], v[224:227], a[244:247], a[48:63]
 ds_read_b64_tr_b16 v[224:225], v202 offset:40960
 ds_read_b64_tr_b16 v[226:227], v202 offset:43008
 s_waitcnt lgkmcnt(6)
 v_mfma_f32_32x32x16_bf16 a[64:79], v[228:231], a[228:231], a[64:79]
 v_mfma_f32_32x32x16_bf16 a[80:95], v[228:231], a[244:247], a[80:95]
 ds_read_b64_tr_b16 v[228:229], v203 offset:40960
 ds_read_b64_tr_b16 v[230:231], v203 offset:43008
 v_mfma_f32_32x32x16_bf16 a[96:111], v[232:235], a[228:231], a[96:111]
 v_mfma_f32_32x32x16_bf16 a[112:127], v[232:235], a[244:247], a[112:127]
 ds_read_b64_tr_b16 v[232:233], v200 offset:45056
 ds_read_b64_tr_b16 v[234:235], v200 offset:47104
 s_waitcnt lgkmcnt(6)
 v_mfma_f32_32x32x16_bf16 a[0:15], v[236:239], a[232:235], a[0:15]
 v_mfma_f32_32x32x16_bf16 a[16:31], v[236:239], a[248:251], a[16:31]
 ds_read_b64_tr_b16 v[236:237], v201 offset:45056
 ds_read_b64_tr_b16 v[238:239], v201 offset:47104
 v_mfma_f32_32x32x16_bf16 a[32:47], v[220:223], a[232:235], a[32:47]
 v_mfma_f32_32x32x16_bf16 a[48:63], v[220:223], a[248:251], a[48:63]
 ds_read_b64_tr_b16 v[220:221], v202 offset:45056
 ds_read_b64_tr_b16 v[222:223], v202 offset:47104
 s_waitcnt lgkmcnt(6)
 v_mfma_f32_32x32x16_bf16 a[64:79], v[224:227], a[232:235], a[64:79]
 v_mfma_f32_32x32x16_bf16 a[80:95], v[224:227], a[248:251], a[80:95]
 ds_read_b64_tr_b16 v[224:225], v203 offset:45056
 ds_read_b64_tr_b16 v[226:227], v203 offset:47104
 v_mfma_f32_32x32x16_bf16 a[96:111], v[228:231], a[232:235], a[96:111]
 v_mfma_f32_32x32x16_bf16 a[112:127], v[228:231], a[248:251], a[112:127]
 ds_read_b64_tr_b16 v[228:229], v200 offset:49152
 ds_read_b64_tr_b16 v[230:231], v200 offset:51200
 s_waitcnt lgkmcnt(6)
 v_mfma_f32_32x32x16_bf16 a[0:15], v[232:235], a[236:239], a[0:15]
 v_mfma_f32_32x32x16_bf16 a[16:31], v[232:235], a[252:255], a[16:31]
 ds_read_b64_tr_b16 v[232:233], v201 offset:49152
 ds_read_b64_tr_b16 v[234:235], v201 offset:51200
 v_mfma_f32_32x32x16_bf16 a[32:47], v[236:239], a[236:239], a[32:47]
 v_mfma_f32_32x32x16_bf16 a[48:63], v[236:239], a[252:255], a[48:63]
 ds_read_b64_tr_b16 v[236:237], v202 offset:49152
 ds_read_b64_tr_b16 v[238:239], v202 offset:51200
 s_waitcnt lgkmcnt(6)
 v_mfma_f32_32x32x16_bf16 a[64:79], v[220:223], a[236:239], a[64:79]
 v_mfma_f32_32x32x16_bf16 a[80:95], v[220:223], a[252:255], a[80:95]
 ds_read_b64_tr_b16 v[220:221], v203 offset:49152
 ds_read_b64_tr_b16 v[222:223], v203 offset:51200
 v_mfma_f32_32x32x16_bf16 a[96:111], v[224:227], a[236:239], a[96:111]
 v_mfma_f32_32x32x16_bf16 a[112:127], v[224:227], a[252:255], a[112:127]
 s_waitcnt vmcnt(18)
 s_barrier
 ds_read_b64_tr_b16 v[224:225], v200 offset:53248
 ds_read_b64_tr_b16 v[226:227], v200 offset:55296
 s_add_u32 m0, s28, 98304
 s_add_u32 s34, s73, 256
 s_add_u32 s35, s73, 64768
 s_waitcnt lgkmcnt(6)
 v_mfma_f32_32x32x16_bf16 v[64:79], v[228:231], a[224:227], v[64:79]
 buffer_load_dwordx4 v211, s[16:19], s34 offen lds
 s_waitcnt vmcnt(13)
 ds_read_b128 a[128:131], v204 offset:0
 s_waitcnt vmcnt(9)
 ds_read_b128 a[144:147], v204 offset:4096
 ds_read_b128 a[132:135], v205 offset:0
 ds_read_b128 a[148:151], v205 offset:4096
 v_mfma_f32_32x32x16_bf16 v[80:95], v[228:231], a[240:243], v[80:95]
 ds_read_b64_tr_b16 v[228:229], v201 offset:53248
 ds_read_b64_tr_b16 v[230:231], v201 offset:55296
 ds_read_b128 a[136:139], v206 offset:0
 ds_read_b128 a[152:155], v206 offset:4096
 ds_read_b128 a[140:143], v207 offset:0
 ds_read_b128 a[156:159], v207 offset:4096
 v_mfma_f32_32x32x16_bf16 v[96:111], v[232:235], a[224:227], v[96:111]
 buffer_load_dwordx4 v211, s[16:19], s35 offen offset:1024 lds
 s_add_u32 m0, s28, 106496
 s_add_u32 s34, s73, 262400
 s_add_u32 s35, s73, 326912
 v_mfma_f32_32x32x16_bf16 v[112:127], v[232:235], a[240:243], v[112:127]
 ds_read_b64_tr_b16 v[232:233], v202 offset:53248
 ds_read_b64_tr_b16 v[234:235], v202 offset:55296
 s_waitcnt lgkmcnt(14)
 v_mfma_f32_32x32x16_bf16 v[128:143], v[236:239], a[224:227], v[128:143]
 buffer_load_dwordx4 v211, s[16:19], s34 offen lds
 v_mfma_f32_32x32x16_bf16 v[144:159], v[236:239], a[240:243], v[144:159]
 ds_read_b64_tr_b16 v[236:237], v203 offset:53248
 ds_read_b64_tr_b16 v[238:239], v203 offset:55296
 v_mfma_f32_32x32x16_bf16 v[160:175], v[220:223], a[224:227], v[160:175]
 buffer_load_dwordx4 v211, s[16:19], s35 offen offset:1024 lds
 s_waitcnt lgkmcnt(4)
 s_add_u32 m0, s31, 131072
 s_add_u32 s44, s65, 0
 s_add_u32 s45, s65, 7168
 s_add_u32 s46, s65, 14336
 v_mfma_f32_32x32x16_bf16 v[176:191], v[220:223], a[240:243], v[176:191]
 ds_read_b64_tr_b16 v[220:221], v200 offset:57344
 ds_read_b64_tr_b16 v[222:223], v200 offset:59392
 s_add_u32 s47, s65, 21504
 v_mfma_f32_32x32x16_bf16 v[64:79], v[224:227], a[228:231], v[64:79]
 buffer_load_dwordx4 v212, s[20:23], s44 offen offset:0 lds
 v_mfma_f32_32x32x16_bf16 v[80:95], v[224:227], a[244:247], v[80:95]
 ds_read_b64_tr_b16 v[224:225], v201 offset:57344
 ds_read_b64_tr_b16 v[226:227], v201 offset:59392
 v_mfma_f32_32x32x16_bf16 v[96:111], v[228:231], a[228:231], v[96:111]
 buffer_load_dwordx4 v213, s[20:23], s45 offen offset:1024 lds
 v_mfma_f32_32x32x16_bf16 v[112:127], v[228:231], a[244:247], v[112:127]
 ds_read_b64_tr_b16 v[228:229], v202 offset:57344
 ds_read_b64_tr_b16 v[230:231], v202 offset:59392
 s_waitcnt lgkmcnt(6)
 v_mfma_f32_32x32x16_bf16 v[128:143], v[232:235], a[228:231], v[128:143]
 buffer_load_dwordx4 v212, s[20:23], s46 offen offset:2048 lds
 v_mfma_f32_32x32x16_bf16 v[144:159], v[232:235], a[244:247], v[144:159]
 ds_read_b64_tr_b16 v[232:233], v203 offset:57344
 ds_read_b64_tr_b16 v[234:235], v203 offset:59392
 v_mfma_f32_32x32x16_bf16 v[160:175], v[236:239], a[228:231], v[160:175]
 buffer_load_dwordx4 v213, s[20:23], s47 offen offset:3072 lds
 s_add_u32 m0, s31, 135168
 s_add_u32 s44, s65, 32768
 s_add_u32 s45, s65, 39936
 s_add_u32 s46, s65, 47104
 v_mfma_f32_32x32x16_bf16 v[176:191], v[236:239], a[244:247], v[176:191]
 ds_read_b64_tr_b16 v[236:237], v200 offset:61440
 ds_read_b64_tr_b16 v[238:239], v200 offset:63488
 s_add_u32 s47, s65, 54272
 s_waitcnt lgkmcnt(6)
 v_mfma_f32_32x32x16_bf16 v[64:79], v[220:223], a[232:235], v[64:79]
 buffer_load_dwordx4 v212, s[20:23], s44 offen offset:0 lds
 v_mfma_f32_32x32x16_bf16 v[80:95], v[220:223], a[248:251], v[80:95]
 ds_read_b64_tr_b16 v[220:221], v201 offset:61440
 ds_read_b64_tr_b16 v[222:223], v201 offset:63488
 v_mfma_f32_32x32x16_bf16 v[96:111], v[224:227], a[232:235], v[96:111]
 buffer_load_dwordx4 v213, s[20:23], s45 offen offset:1024 lds
 v_mfma_f32_32x32x16_bf16 v[112:127], v[224:227], a[248:251], v[112:127]
 ds_read_b64_tr_b16 v[224:225], v202 offset:61440
 ds_read_b64_tr_b16 v[226:227], v202 offset:63488
 s_waitcnt lgkmcnt(6)
 v_mfma_f32_32x32x16_bf16 v[128:143], v[228:231], a[232:235], v[128:143]
 buffer_load_dwordx4 v212, s[20:23], s46 offen offset:2048 lds
 v_mfma_f32_32x32x16_bf16 v[144:159], v[228:231], a[248:251], v[144:159]
 ds_read_b64_tr_b16 v[228:229], v203 offset:61440
 ds_read_b64_tr_b16 v[230:231], v203 offset:63488
 v_mfma_f32_32x32x16_bf16 v[160:175], v[232:235], a[232:235], v[160:175]
 buffer_load_dwordx4 v213, s[20:23], s47 offen offset:3072 lds
 s_add_u32 m0, s28, 32768
 v_mfma_f32_32x32x16_bf16 v[176:191], v[232:235], a[248:251], v[176:191]
 ds_read_b64_tr_b16 v[232:233], v200 offset:0
 ds_read_b64_tr_b16 v[234:235], v200 offset:2048
 s_waitcnt lgkmcnt(6)
 v_mfma_f32_32x32x16_bf16 v[64:79], v[236:239], a[236:239], v[64:79]
 buffer_load_dwordx4 v208, s[8:11], s32 offen nt lds
 v_mfma_f32_32x32x16_bf16 v[80:95], v[236:239], a[252:255], v[80:95]
 ds_read_b64_tr_b16 v[236:237], v201 offset:0
 ds_read_b64_tr_b16 v[238:239], v201 offset:2048
 v_mfma_f32_32x32x16_bf16 v[96:111], v[220:223], a[236:239], v[96:111]
 buffer_load_dwordx4 v209, s[8:11], s32 offen offset:1024 nt lds
 s_mov_b32 s32, 40960
 v_mfma_f32_32x32x16_bf16 v[112:127], v[220:223], a[252:255], v[112:127]
 ds_read_b64_tr_b16 v[220:221], v202 offset:0
 ds_read_b64_tr_b16 v[222:223], v202 offset:2048
 s_waitcnt lgkmcnt(6)
 v_mfma_f32_32x32x16_bf16 v[128:143], v[224:227], a[236:239], v[128:143]
 v_mfma_f32_32x32x16_bf16 v[144:159], v[224:227], a[252:255], v[144:159]
 ds_read_b64_tr_b16 v[224:225], v203 offset:0
 ds_read_b64_tr_b16 v[226:227], v203 offset:2048
 v_mfma_f32_32x32x16_bf16 v[160:175], v[228:231], a[236:239], v[160:175]
 v_mfma_f32_32x32x16_bf16 v[176:191], v[228:231], a[252:255], v[176:191]
 s_waitcnt vmcnt(18)
 s_barrier
 ds_read_b64_tr_b16 v[228:229], v200 offset:4096
 ds_read_b64_tr_b16 v[230:231], v200 offset:6144
 s_add_u32 m0, s28, 114688
 s_add_u32 s34, s73, 0
 s_add_u32 s35, s73, 64512
 s_waitcnt lgkmcnt(6)
 v_mfma_f32_32x32x16_bf16 a[0:15], v[232:235], a[128:131], a[0:15]
 buffer_load_dwordx4 v211, s[16:19], s34 offen lds
 v_mfma_f32_32x32x16_bf16 a[16:31], v[232:235], a[144:147], a[16:31]
 ds_read_b64_tr_b16 v[232:233], v201 offset:4096
 ds_read_b64_tr_b16 v[234:235], v201 offset:6144
 v_mfma_f32_32x32x16_bf16 a[32:47], v[236:239], a[128:131], a[32:47]
 buffer_load_dwordx4 v211, s[16:19], s35 offen offset:1024 lds
 s_add_u32 m0, s28, 122880
 s_add_u32 s34, s73, 262144
 s_add_u32 s35, s73, 326656
 v_mfma_f32_32x32x16_bf16 a[48:63], v[236:239], a[144:147], a[48:63]
 ds_read_b64_tr_b16 v[236:237], v202 offset:4096
 ds_read_b64_tr_b16 v[238:239], v202 offset:6144
 s_waitcnt lgkmcnt(6)
 v_mfma_f32_32x32x16_bf16 a[64:79], v[220:223], a[128:131], a[64:79]
 buffer_load_dwordx4 v211, s[16:19], s34 offen lds
 v_mfma_f32_32x32x16_bf16 a[80:95], v[220:223], a[144:147], a[80:95]
 ds_read_b64_tr_b16 v[220:221], v203 offset:4096
 ds_read_b64_tr_b16 v[222:223], v203 offset:6144
 v_mfma_f32_32x32x16_bf16 a[96:111], v[224:227], a[128:131], a[96:111]
 buffer_load_dwordx4 v211, s[16:19], s35 offen offset:1024 lds
 s_add_u32 m0, s28, 40960
 v_mfma_f32_32x32x16_bf16 a[112:127], v[224:227], a[144:147], a[112:127]
 ds_read_b64_tr_b16 v[224:225], v200 offset:8192
 ds_read_b64_tr_b16 v[226:227], v200 offset:10240
 s_waitcnt lgkmcnt(6)
 v_mfma_f32_32x32x16_bf16 a[0:15], v[228:231], a[132:135], a[0:15]
 buffer_load_dwordx4 v208, s[8:11], s32 offen nt lds
 v_mfma_f32_32x32x16_bf16 a[16:31], v[228:231], a[148:151], a[16:31]
 ds_read_b64_tr_b16 v[228:229], v201 offset:8192
 ds_read_b64_tr_b16 v[230:231], v201 offset:10240
 v_mfma_f32_32x32x16_bf16 a[32:47], v[232:235], a[132:135], a[32:47]
 buffer_load_dwordx4 v209, s[8:11], s32 offen offset:1024 nt lds
 s_mov_b32 s32, 49152
 v_mfma_f32_32x32x16_bf16 a[48:63], v[232:235], a[148:151], a[48:63]
 ds_read_b64_tr_b16 v[232:233], v202 offset:8192
 ds_read_b64_tr_b16 v[234:235], v202 offset:10240
 s_waitcnt lgkmcnt(6)
 v_mfma_f32_32x32x16_bf16 a[64:79], v[236:239], a[132:135], a[64:79]
 v_mfma_f32_32x32x16_bf16 a[80:95], v[236:239], a[148:151], a[80:95]
 ds_read_b64_tr_b16 v[236:237], v203 offset:8192
 ds_read_b64_tr_b16 v[238:239], v203 offset:10240
 v_mfma_f32_32x32x16_bf16 a[96:111], v[220:223], a[132:135], a[96:111]
 v_mfma_f32_32x32x16_bf16 a[112:127], v[220:223], a[148:151], a[112:127]
 ds_read_b64_tr_b16 v[220:221], v200 offset:12288
 ds_read_b64_tr_b16 v[222:223], v200 offset:14336
 s_waitcnt lgkmcnt(6)
 v_mfma_f32_32x32x16_bf16 a[0:15], v[224:227], a[136:139], a[0:15]
 v_mfma_f32_32x32x16_bf16 a[16:31], v[224:227], a[152:155], a[16:31]
 ds_read_b64_tr_b16 v[224:225], v201 offset:12288
 ds_read_b64_tr_b16 v[226:227], v201 offset:14336
 v_mfma_f32_32x32x16_bf16 a[32:47], v[228:231], a[136:139], a[32:47]
 v_mfma_f32_32x32x16_bf16 a[48:63], v[228:231], a[152:155], a[48:63]
 ds_read_b64_tr_b16 v[228:229], v202 offset:12288
 ds_read_b64_tr_b16 v[230:231], v202 offset:14336
 s_waitcnt lgkmcnt(6)
 v_mfma_f32_32x32x16_bf16 a[64:79], v[232:235], a[136:139], a[64:79]
 v_mfma_f32_32x32x16_bf16 a[80:95], v[232:235], a[152:155], a[80:95]
 ds_read_b64_tr_b16 v[232:233], v203 offset:12288
 ds_read_b64_tr_b16 v[234:235], v203 offset:14336
 v_mfma_f32_32x32x16_bf16 a[96:111], v[236:239], a[136:139], a[96:111]
 v_mfma_f32_32x32x16_bf16 a[112:127], v[236:239], a[152:155], a[112:127]
 ds_read_b64_tr_b16 v[236:237], v200 offset:16384
 ds_read_b64_tr_b16 v[238:239], v200 offset:18432
 s_waitcnt lgkmcnt(6)
 v_mfma_f32_32x32x16_bf16 a[0:15], v[220:223], a[140:143], a[0:15]
 v_mfma_f32_32x32x16_bf16 a[16:31], v[220:223], a[156:159], a[16:31]
 ds_read_b64_tr_b16 v[220:221], v201 offset:16384
 ds_read_b64_tr_b16 v[222:223], v201 offset:18432
 v_mfma_f32_32x32x16_bf16 a[32:47], v[224:227], a[140:143], a[32:47]
 v_mfma_f32_32x32x16_bf16 a[48:63], v[224:227], a[156:159], a[48:63]
 ds_read_b64_tr_b16 v[224:225], v202 offset:16384
 ds_read_b64_tr_b16 v[226:227], v202 offset:18432
 s_waitcnt lgkmcnt(6)
 v_mfma_f32_32x32x16_bf16 a[64:79], v[228:231], a[140:143], a[64:79]
 v_mfma_f32_32x32x16_bf16 a[80:95], v[228:231], a[156:159], a[80:95]
 ds_read_b64_tr_b16 v[228:229], v203 offset:16384
 ds_read_b64_tr_b16 v[230:231], v203 offset:18432
 v_mfma_f32_32x32x16_bf16 a[96:111], v[232:235], a[140:143], a[96:111]
 v_mfma_f32_32x32x16_bf16 a[112:127], v[232:235], a[156:159], a[112:127]
 s_waitcnt vmcnt(18)
 s_barrier
 ds_read_b64_tr_b16 v[232:233], v200 offset:20480
 ds_read_b64_tr_b16 v[234:235], v200 offset:22528
 s_add_u32 m0, s28, 65536
 s_add_u32 s34, s74, 256
 s_add_u32 s35, s74, 64768
 s_waitcnt lgkmcnt(6)
 v_mfma_f32_32x32x16_bf16 v[64:79], v[236:239], a[128:131], v[64:79]
 buffer_load_dwordx4 v211, s[16:19], s34 offen lds
 s_waitcnt vmcnt(13)
 ds_read_b128 a[160:163], v204 offset:0
 ds_read_b128 a[164:167], v205 offset:0
 ds_read_b128 a[168:171], v206 offset:0
 ds_read_b128 a[172:175], v207 offset:0
 v_mfma_f32_32x32x16_bf16 v[80:95], v[236:239], a[144:147], v[80:95]
 ds_read_b64_tr_b16 v[236:237], v201 offset:20480
 ds_read_b64_tr_b16 v[238:239], v201 offset:22528
 s_waitcnt vmcnt(9)
 ds_read_b128 a[176:179], v204 offset:4096
 ds_read_b128 a[180:183], v205 offset:4096
 ds_read_b128 a[184:187], v206 offset:4096
 ds_read_b128 a[188:191], v207 offset:4096
 v_mfma_f32_32x32x16_bf16 v[96:111], v[220:223], a[128:131], v[96:111]
 buffer_load_dwordx4 v211, s[16:19], s35 offen offset:1024 lds
 s_add_u32 m0, s28, 73728
 s_add_u32 s34, s74, 262400
 s_add_u32 s35, s74, 326912
 v_mfma_f32_32x32x16_bf16 v[112:127], v[220:223], a[144:147], v[112:127]
 ds_read_b64_tr_b16 v[220:221], v202 offset:20480
 ds_read_b64_tr_b16 v[222:223], v202 offset:22528
 s_waitcnt lgkmcnt(14)
 v_mfma_f32_32x32x16_bf16 v[128:143], v[224:227], a[128:131], v[128:143]
 buffer_load_dwordx4 v211, s[16:19], s34 offen lds
 v_mfma_f32_32x32x16_bf16 v[144:159], v[224:227], a[144:147], v[144:159]
 ds_read_b64_tr_b16 v[224:225], v203 offset:20480
 ds_read_b64_tr_b16 v[226:227], v203 offset:22528
 v_mfma_f32_32x32x16_bf16 v[160:175], v[228:231], a[128:131], v[160:175]
 buffer_load_dwordx4 v211, s[16:19], s35 offen offset:1024 lds
 s_waitcnt lgkmcnt(4)
 s_add_u32 m0, s31, 131072
 s_add_u32 s44, s66, 0
 s_add_u32 s45, s66, 7168
 s_add_u32 s46, s66, 14336
 v_mfma_f32_32x32x16_bf16 v[176:191], v[228:231], a[144:147], v[176:191]
 ds_read_b64_tr_b16 v[228:229], v200 offset:24576
 ds_read_b64_tr_b16 v[230:231], v200 offset:26624
 s_add_u32 s47, s66, 21504
 v_mfma_f32_32x32x16_bf16 v[64:79], v[232:235], a[132:135], v[64:79]
 buffer_load_dwordx4 v212, s[20:23], s44 offen offset:0 lds
 v_mfma_f32_32x32x16_bf16 v[80:95], v[232:235], a[148:151], v[80:95]
 ds_read_b64_tr_b16 v[232:233], v201 offset:24576
 ds_read_b64_tr_b16 v[234:235], v201 offset:26624
 v_mfma_f32_32x32x16_bf16 v[96:111], v[236:239], a[132:135], v[96:111]
 buffer_load_dwordx4 v213, s[20:23], s45 offen offset:1024 lds
 v_mfma_f32_32x32x16_bf16 v[112:127], v[236:239], a[148:151], v[112:127]
 ds_read_b64_tr_b16 v[236:237], v202 offset:24576
 ds_read_b64_tr_b16 v[238:239], v202 offset:26624
 s_waitcnt lgkmcnt(6)
 v_mfma_f32_32x32x16_bf16 v[128:143], v[220:223], a[132:135], v[128:143]
 buffer_load_dwordx4 v212, s[20:23], s46 offen offset:2048 lds
 v_mfma_f32_32x32x16_bf16 v[144:159], v[220:223], a[148:151], v[144:159]
 ds_read_b64_tr_b16 v[220:221], v203 offset:24576
 ds_read_b64_tr_b16 v[222:223], v203 offset:26624
 v_mfma_f32_32x32x16_bf16 v[160:175], v[224:227], a[132:135], v[160:175]
 buffer_load_dwordx4 v213, s[20:23], s47 offen offset:3072 lds
 s_add_u32 m0, s31, 135168
 s_add_u32 s44, s66, 32768
 s_add_u32 s45, s66, 39936
 s_add_u32 s46, s66, 47104
 v_mfma_f32_32x32x16_bf16 v[176:191], v[224:227], a[148:151], v[176:191]
 ds_read_b64_tr_b16 v[224:225], v200 offset:28672
 ds_read_b64_tr_b16 v[226:227], v200 offset:30720
 s_add_u32 s47, s66, 54272
 s_waitcnt lgkmcnt(6)
 v_mfma_f32_32x32x16_bf16 v[64:79], v[228:231], a[136:139], v[64:79]
 buffer_load_dwordx4 v212, s[20:23], s44 offen offset:0 lds
 v_mfma_f32_32x32x16_bf16 v[80:95], v[228:231], a[152:155], v[80:95]
 ds_read_b64_tr_b16 v[228:229], v201 offset:28672
 ds_read_b64_tr_b16 v[230:231], v201 offset:30720
 v_mfma_f32_32x32x16_bf16 v[96:111], v[232:235], a[136:139], v[96:111]
 buffer_load_dwordx4 v213, s[20:23], s45 offen offset:1024 lds
 v_mfma_f32_32x32x16_bf16 v[112:127], v[232:235], a[152:155], v[112:127]
 ds_read_b64_tr_b16 v[232:233], v202 offset:28672
 ds_read_b64_tr_b16 v[234:235], v202 offset:30720
 s_waitcnt lgkmcnt(6)
 v_mfma_f32_32x32x16_bf16 v[128:143], v[236:239], a[136:139], v[128:143]
 buffer_load_dwordx4 v212, s[20:23], s46 offen offset:2048 lds
 v_mfma_f32_32x32x16_bf16 v[144:159], v[236:239], a[152:155], v[144:159]
 ds_read_b64_tr_b16 v[236:237], v203 offset:28672
 ds_read_b64_tr_b16 v[238:239], v203 offset:30720
 v_mfma_f32_32x32x16_bf16 v[160:175], v[220:223], a[136:139], v[160:175]
 buffer_load_dwordx4 v213, s[20:23], s47 offen offset:3072 lds
 s_add_u32 m0, s28, 49152
 v_mfma_f32_32x32x16_bf16 v[176:191], v[220:223], a[152:155], v[176:191]
 ds_read_b64_tr_b16 v[220:221], v200 offset:32768
 ds_read_b64_tr_b16 v[222:223], v200 offset:34816
 s_waitcnt lgkmcnt(6)
 v_mfma_f32_32x32x16_bf16 v[64:79], v[224:227], a[140:143], v[64:79]
 buffer_load_dwordx4 v208, s[8:11], s32 offen nt lds
 v_mfma_f32_32x32x16_bf16 v[80:95], v[224:227], a[156:159], v[80:95]
 ds_read_b64_tr_b16 v[224:225], v201 offset:32768
 ds_read_b64_tr_b16 v[226:227], v201 offset:34816
 v_mfma_f32_32x32x16_bf16 v[96:111], v[228:231], a[140:143], v[96:111]
 buffer_load_dwordx4 v209, s[8:11], s32 offen offset:1024 nt lds
 s_mov_b32 s32, 57344
 v_mfma_f32_32x32x16_bf16 v[112:127], v[228:231], a[156:159], v[112:127]
 ds_read_b64_tr_b16 v[228:229], v202 offset:32768
 ds_read_b64_tr_b16 v[230:231], v202 offset:34816
 s_waitcnt lgkmcnt(6)
 v_mfma_f32_32x32x16_bf16 v[128:143], v[232:235], a[140:143], v[128:143]
 v_mfma_f32_32x32x16_bf16 v[144:159], v[232:235], a[156:159], v[144:159]
 ds_read_b64_tr_b16 v[232:233], v203 offset:32768
 ds_read_b64_tr_b16 v[234:235], v203 offset:34816
 v_mfma_f32_32x32x16_bf16 v[160:175], v[236:239], a[140:143], v[160:175]
 v_mfma_f32_32x32x16_bf16 v[176:191], v[236:239], a[156:159], v[176:191]
 s_waitcnt vmcnt(18)
 s_barrier
 ds_read_b64_tr_b16 v[236:237], v200 offset:36864
 ds_read_b64_tr_b16 v[238:239], v200 offset:38912
 s_add_u32 m0, s28, 81920
 s_add_u32 s34, s74, 0
 s_add_u32 s35, s74, 64512
 s_waitcnt lgkmcnt(6)
 v_mfma_f32_32x32x16_bf16 a[0:15], v[220:223], a[160:163], a[0:15]
 buffer_load_dwordx4 v211, s[16:19], s34 offen lds
 v_bfe_u32 v219, v214, 9, 1
 v_lshlrev_b32 v218, 3, v219
 v_lshrrev_b32 v219, 11, v214
 v_lshl_add_u32 v218, v219, 4, v218
 v_mfma_f32_32x32x16_bf16 a[16:31], v[220:223], a[176:179], a[16:31]
 ds_read_b64_tr_b16 v[220:221], v201 offset:36864
 ds_read_b64_tr_b16 v[222:223], v201 offset:38912
 v_bfe_u32 v219, v214, 7, 2
 v_add_u32 v218, v218, v219
 v_lshlrev_b32 v218, 10, v218
 v_bfe_u32 v219, v214, 8, 1
 v_mfma_f32_32x32x16_bf16 a[32:47], v[224:227], a[160:163], a[32:47]
 buffer_load_dwordx4 v211, s[16:19], s35 offen offset:1024 lds
 s_add_u32 m0, s28, 90112
 s_add_u32 s34, s74, 262144
 s_add_u32 s35, s74, 326656
 v_lshlrev_b32 v219, 6, v219
 v_mfma_f32_32x32x16_bf16 a[48:63], v[224:227], a[176:179], a[48:63]
 ds_read_b64_tr_b16 v[224:225], v202 offset:36864
 ds_read_b64_tr_b16 v[226:227], v202 offset:38912
 v_xor_b32 v219, v219, v214
 v_and_b32 v219, 112, v219
 v_add_u32 v218, v218, v219
 v_lshrrev_b32 v219, 11, v214
 s_waitcnt lgkmcnt(6)
 v_mfma_f32_32x32x16_bf16 a[64:79], v[228:231], a[160:163], a[64:79]
 buffer_load_dwordx4 v211, s[16:19], s34 offen lds
 v_mfma_f32_32x32x16_bf16 a[80:95], v[228:231], a[176:179], a[80:95]
 ds_read_b64_tr_b16 v[228:229], v203 offset:36864
 ds_read_b64_tr_b16 v[230:231], v203 offset:38912
 v_mfma_f32_32x32x16_bf16 a[96:111], v[232:235], a[160:163], a[96:111]
 buffer_load_dwordx4 v211, s[16:19], s35 offen offset:1024 lds
 s_add_u32 m0, s28, 57344
 s_lshr_b32 s90, s2, 5
 s_lshl_b32 s90, s90, 7
 s_and_b32 s92, s2, 31
 v_mfma_f32_32x32x16_bf16 a[112:127], v[232:235], a[176:179], a[112:127]
 ds_read_b64_tr_b16 v[232:233], v200 offset:40960
 ds_read_b64_tr_b16 v[234:235], v200 offset:43008
 s_lshl_b32 s92, s92, 17
 s_add_u32 s90, s90, s92
 s_lshl_b32 s92, s2, 14
 s_add_u32 s93, s90, 0
 s_waitcnt lgkmcnt(6)
 v_mfma_f32_32x32x16_bf16 a[0:15], v[236:239], a[164:167], a[0:15]
 buffer_load_dwordx4 v208, s[8:11], s32 offen nt lds
 v_mfma_f32_32x32x16_bf16 a[16:31], v[236:239], a[180:183], a[16:31]
 ds_read_b64_tr_b16 v[236:237], v201 offset:40960
 ds_read_b64_tr_b16 v[238:239], v201 offset:43008
 v_mfma_f32_32x32x16_bf16 a[32:47], v[220:223], a[164:167], a[32:47]
 buffer_load_dwordx4 v209, s[8:11], s32 offen offset:1024 nt lds
 s_mov_b32 s32, 65536
 v_mfma_f32_32x32x16_bf16 a[48:63], v[220:223], a[180:183], a[48:63]
 ds_read_b64_tr_b16 v[220:221], v202 offset:40960
 ds_read_b64_tr_b16 v[222:223], v202 offset:43008
 s_waitcnt lgkmcnt(6)
 v_mfma_f32_32x32x16_bf16 a[64:79], v[224:227], a[164:167], a[64:79]
 buffer_load_dwordx4 v[240:243], v218, s[84:87], s93 offen
 s_add_u32 s93, s90, 4096
 v_mfma_f32_32x32x16_bf16 a[80:95], v[224:227], a[180:183], a[80:95]
 ds_read_b64_tr_b16 v[224:225], v203 offset:40960
 ds_read_b64_tr_b16 v[226:227], v203 offset:43008
 v_mfma_f32_32x32x16_bf16 a[96:111], v[228:231], a[164:167], a[96:111]
 buffer_load_dwordx4 v[244:247], v218, s[84:87], s93 offen
 s_add_u32 s93, s90, 65536
 v_mfma_f32_32x32x16_bf16 a[112:127], v[228:231], a[180:183], a[112:127]
 ds_read_b64_tr_b16 v[228:229], v200 offset:45056
 ds_read_b64_tr_b16 v[230:231], v200 offset:47104
 s_waitcnt lgkmcnt(6)
 v_mfma_f32_32x32x16_bf16 a[0:15], v[232:235], a[168:171], a[0:15]
 buffer_load_dwordx4 v[248:251], v218, s[84:87], s93 offen
 s_add_u32 s93, s90, 69632
 v_mfma_f32_32x32x16_bf16 a[16:31], v[232:235], a[184:187], a[16:31]
 ds_read_b64_tr_b16 v[232:233], v201 offset:45056
 ds_read_b64_tr_b16 v[234:235], v201 offset:47104
 v_mfma_f32_32x32x16_bf16 a[32:47], v[236:239], a[168:171], a[32:47]
 buffer_load_dwordx4 v[252:255], v218, s[84:87], s93 offen
 v_mfma_f32_32x32x16_bf16 a[48:63], v[236:239], a[184:187], a[48:63]
 ds_read_b64_tr_b16 v[236:237], v202 offset:45056
 ds_read_b64_tr_b16 v[238:239], v202 offset:47104
 s_waitcnt lgkmcnt(6)
 v_mfma_f32_32x32x16_bf16 a[64:79], v[220:223], a[168:171], a[64:79]
 v_mfma_f32_32x32x16_bf16 a[80:95], v[220:223], a[184:187], a[80:95]
 ds_read_b64_tr_b16 v[220:221], v203 offset:45056
 ds_read_b64_tr_b16 v[222:223], v203 offset:47104
 v_mfma_f32_32x32x16_bf16 a[96:111], v[224:227], a[168:171], a[96:111]
 v_mfma_f32_32x32x16_bf16 a[112:127], v[224:227], a[184:187], a[112:127]
 ds_read_b64_tr_b16 v[224:225], v200 offset:49152
 ds_read_b64_tr_b16 v[226:227], v200 offset:51200
 s_waitcnt lgkmcnt(6)
 v_mfma_f32_32x32x16_bf16 a[0:15], v[228:231], a[172:175], a[0:15]
 v_mfma_f32_32x32x16_bf16 a[16:31], v[228:231], a[188:191], a[16:31]
 ds_read_b64_tr_b16 v[228:229], v201 offset:49152
 ds_read_b64_tr_b16 v[230:231], v201 offset:51200
 v_mfma_f32_32x32x16_bf16 a[32:47], v[232:235], a[172:175], a[32:47]
 v_mfma_f32_32x32x16_bf16 a[48:63], v[232:235], a[188:191], a[48:63]
 ds_read_b64_tr_b16 v[232:233], v202 offset:49152
 ds_read_b64_tr_b16 v[234:235], v202 offset:51200
 s_waitcnt lgkmcnt(6)
 v_mfma_f32_32x32x16_bf16 a[64:79], v[236:239], a[172:175], a[64:79]
 v_mfma_f32_32x32x16_bf16 a[80:95], v[236:239], a[188:191], a[80:95]
 ds_read_b64_tr_b16 v[236:237], v203 offset:49152
 ds_read_b64_tr_b16 v[238:239], v203 offset:51200
 v_mfma_f32_32x32x16_bf16 a[96:111], v[220:223], a[172:175], a[96:111]
 v_mfma_f32_32x32x16_bf16 a[112:127], v[220:223], a[188:191], a[112:127]
 s_waitcnt vmcnt(22)
 s_barrier
 ds_read_b64_tr_b16 v[220:221], v200 offset:53248
 ds_read_b64_tr_b16 v[222:223], v200 offset:55296
 s_add_u32 m0, s28, 98304
 s_add_u32 s34, s75, 256
 s_add_u32 s35, s75, 64768
 s_waitcnt lgkmcnt(6)
 v_mfma_f32_32x32x16_bf16 v[64:79], v[224:227], a[160:163], v[64:79]
 buffer_load_dwordx4 v211, s[16:19], s34 offen lds
 s_waitcnt vmcnt(17)
 ds_read_b128 a[192:195], v204 offset:0
 s_waitcnt vmcnt(13)
 ds_read_b128 a[208:211], v204 offset:4096
 ds_read_b128 a[196:199], v205 offset:0
 ds_read_b128 a[212:215], v205 offset:4096
 v_mfma_f32_32x32x16_bf16 v[80:95], v[224:227], a[176:179], v[80:95]
 ds_read_b64_tr_b16 v[224:225], v201 offset:53248
 ds_read_b64_tr_b16 v[226:227], v201 offset:55296
 ds_read_b128 a[200:203], v206 offset:0
 ds_read_b128 a[216:219], v206 offset:4096
 ds_read_b128 a[204:207], v207 offset:0
 ds_read_b128 a[220:223], v207 offset:4096
 v_mfma_f32_32x32x16_bf16 v[96:111], v[228:231], a[160:163], v[96:111]
 buffer_load_dwordx4 v211, s[16:19], s35 offen offset:1024 lds
 s_add_u32 m0, s28, 106496
 s_add_u32 s34, s75, 262400
 s_add_u32 s35, s75, 326912
 v_mfma_f32_32x32x16_bf16 v[112:127], v[228:231], a[176:179], v[112:127]
 ds_read_b64_tr_b16 v[228:229], v202 offset:53248
 ds_read_b64_tr_b16 v[230:231], v202 offset:55296
 s_waitcnt lgkmcnt(14)
 v_mfma_f32_32x32x16_bf16 v[128:143], v[232:235], a[160:163], v[128:143]
 buffer_load_dwordx4 v211, s[16:19], s34 offen lds
 v_mfma_f32_32x32x16_bf16 v[144:159], v[232:235], a[176:179], v[144:159]
 ds_read_b64_tr_b16 v[232:233], v203 offset:53248
 ds_read_b64_tr_b16 v[234:235], v203 offset:55296
 v_mfma_f32_32x32x16_bf16 v[160:175], v[236:239], a[160:163], v[160:175]
 buffer_load_dwordx4 v211, s[16:19], s35 offen offset:1024 lds
 s_waitcnt lgkmcnt(4)
 s_add_u32 m0, s31, 131072
 s_add_u32 s44, s67, 0
 s_add_u32 s45, s67, 7168
 s_add_u32 s46, s67, 14336
 v_mfma_f32_32x32x16_bf16 v[176:191], v[236:239], a[176:179], v[176:191]
 ds_read_b64_tr_b16 v[236:237], v200 offset:57344
 ds_read_b64_tr_b16 v[238:239], v200 offset:59392
 s_add_u32 s47, s67, 21504
 v_mfma_f32_32x32x16_bf16 v[64:79], v[220:223], a[164:167], v[64:79]
 buffer_load_dwordx4 v212, s[20:23], s44 offen offset:0 lds
 v_mfma_f32_32x32x16_bf16 v[80:95], v[220:223], a[180:183], v[80:95]
 ds_read_b64_tr_b16 v[220:221], v201 offset:57344
 ds_read_b64_tr_b16 v[222:223], v201 offset:59392
 v_mfma_f32_32x32x16_bf16 v[96:111], v[224:227], a[164:167], v[96:111]
 buffer_load_dwordx4 v213, s[20:23], s45 offen offset:1024 lds
 v_mfma_f32_32x32x16_bf16 v[112:127], v[224:227], a[180:183], v[112:127]
 ds_read_b64_tr_b16 v[224:225], v202 offset:57344
 ds_read_b64_tr_b16 v[226:227], v202 offset:59392
 s_waitcnt lgkmcnt(6)
 v_mfma_f32_32x32x16_bf16 v[128:143], v[228:231], a[164:167], v[128:143]
 buffer_load_dwordx4 v212, s[20:23], s46 offen offset:2048 lds
 v_mfma_f32_32x32x16_bf16 v[144:159], v[228:231], a[180:183], v[144:159]
 ds_read_b64_tr_b16 v[228:229], v203 offset:57344
 ds_read_b64_tr_b16 v[230:231], v203 offset:59392
 v_mfma_f32_32x32x16_bf16 v[160:175], v[232:235], a[164:167], v[160:175]
 buffer_load_dwordx4 v213, s[20:23], s47 offen offset:3072 lds
 s_add_u32 m0, s31, 135168
 s_add_u32 s44, s67, 32768
 s_add_u32 s45, s67, 39936
 s_add_u32 s46, s67, 47104
 v_mfma_f32_32x32x16_bf16 v[176:191], v[232:235], a[180:183], v[176:191]
 ds_read_b64_tr_b16 v[232:233], v200 offset:61440
 ds_read_b64_tr_b16 v[234:235], v200 offset:63488
 s_add_u32 s47, s67, 54272
 s_waitcnt lgkmcnt(6)
 v_mfma_f32_32x32x16_bf16 v[64:79], v[236:239], a[168:171], v[64:79]
 buffer_load_dwordx4 v212, s[20:23], s44 offen offset:0 lds
 v_mfma_f32_32x32x16_bf16 v[80:95], v[236:239], a[184:187], v[80:95]
 ds_read_b64_tr_b16 v[236:237], v201 offset:61440
 ds_read_b64_tr_b16 v[238:239], v201 offset:63488
 v_mfma_f32_32x32x16_bf16 v[96:111], v[220:223], a[168:171], v[96:111]
 buffer_load_dwordx4 v213, s[20:23], s45 offen offset:1024 lds
 v_mfma_f32_32x32x16_bf16 v[112:127], v[220:223], a[184:187], v[112:127]
 ds_read_b64_tr_b16 v[220:221], v202 offset:61440
 ds_read_b64_tr_b16 v[222:223], v202 offset:63488
 s_waitcnt lgkmcnt(6)
 v_mfma_f32_32x32x16_bf16 v[128:143], v[224:227], a[168:171], v[128:143]
 buffer_load_dwordx4 v212, s[20:23], s46 offen offset:2048 lds
 v_mfma_f32_32x32x16_bf16 v[144:159], v[224:227], a[184:187], v[144:159]
 ds_read_b64_tr_b16 v[224:225], v203 offset:61440
 ds_read_b64_tr_b16 v[226:227], v203 offset:63488
 v_mfma_f32_32x32x16_bf16 v[160:175], v[228:231], a[168:171], v[160:175]
 buffer_load_dwordx4 v213, s[20:23], s47 offen offset:3072 lds
 v_mfma_f32_32x32x16_bf16 v[176:191], v[228:231], a[184:187], v[176:191]
 ds_read_b64_tr_b16 v[228:229], v200 offset:0
 ds_read_b64_tr_b16 v[230:231], v200 offset:2048
 s_waitcnt lgkmcnt(6)
 v_mfma_f32_32x32x16_bf16 v[64:79], v[232:235], a[172:175], v[64:79]
 v_mfma_f32_32x32x16_bf16 v[80:95], v[232:235], a[188:191], v[80:95]
 ds_read_b64_tr_b16 v[232:233], v201 offset:0
 ds_read_b64_tr_b16 v[234:235], v201 offset:2048
 v_mfma_f32_32x32x16_bf16 v[96:111], v[236:239], a[172:175], v[96:111]
 v_mfma_f32_32x32x16_bf16 v[112:127], v[236:239], a[188:191], v[112:127]
 ds_read_b64_tr_b16 v[236:237], v202 offset:0
 ds_read_b64_tr_b16 v[238:239], v202 offset:2048
 s_waitcnt lgkmcnt(6)
 v_mfma_f32_32x32x16_bf16 v[128:143], v[220:223], a[172:175], v[128:143]
 v_mfma_f32_32x32x16_bf16 v[144:159], v[220:223], a[188:191], v[144:159]
 ds_read_b64_tr_b16 v[220:221], v203 offset:0
 ds_read_b64_tr_b16 v[222:223], v203 offset:2048
 v_mfma_f32_32x32x16_bf16 v[160:175], v[224:227], a[172:175], v[160:175]
 v_mfma_f32_32x32x16_bf16 v[176:191], v[224:227], a[188:191], v[176:191]
 s_waitcnt vmcnt(20)
 s_barrier
 ds_read_b64_tr_b16 v[224:225], v200 offset:4096
 ds_read_b64_tr_b16 v[226:227], v200 offset:6144
 s_add_u32 m0, s28, 114688
 s_add_u32 s34, s75, 0
 s_add_u32 s35, s75, 64512
 s_waitcnt lgkmcnt(6)
 v_mfma_f32_32x32x16_bf16 a[0:15], v[228:231], a[192:195], a[0:15]
 buffer_load_dwordx4 v211, s[16:19], s34 offen lds
 v_mfma_f32_32x32x16_bf16 a[16:31], v[228:231], a[208:211], a[16:31]
 ds_read_b64_tr_b16 v[228:229], v201 offset:4096
 ds_read_b64_tr_b16 v[230:231], v201 offset:6144
 v_mfma_f32_32x32x16_bf16 a[32:47], v[232:235], a[192:195], a[32:47]
 buffer_load_dwordx4 v211, s[16:19], s35 offen offset:1024 lds
 s_add_u32 m0, s28, 122880
 s_add_u32 s34, s75, 262144
 s_add_u32 s35, s75, 326656
 v_mfma_f32_32x32x16_bf16 a[48:63], v[232:235], a[208:211], a[48:63]
 ds_read_b64_tr_b16 v[232:233], v202 offset:4096
 ds_read_b64_tr_b16 v[234:235], v202 offset:6144
 s_waitcnt lgkmcnt(6)
 v_mfma_f32_32x32x16_bf16 a[64:79], v[236:239], a[192:195], a[64:79]
 buffer_load_dwordx4 v211, s[16:19], s34 offen lds
 s_mov_b32 s34, 0
 v_mfma_f32_32x32x16_bf16 a[80:95], v[236:239], a[208:211], a[80:95]
 ds_read_b64_tr_b16 v[236:237], v203 offset:4096
 ds_read_b64_tr_b16 v[238:239], v203 offset:6144
 v_mfma_f32_32x32x16_bf16 a[96:111], v[220:223], a[192:195], a[96:111]
 buffer_load_dwordx4 v211, s[16:19], s35 offen offset:1024 lds
 v_mfma_f32_32x32x16_bf16 a[112:127], v[220:223], a[208:211], a[112:127]
 ds_read_b64_tr_b16 v[220:221], v200 offset:8192
 ds_read_b64_tr_b16 v[222:223], v200 offset:10240
 s_waitcnt lgkmcnt(6)
 v_mfma_f32_32x32x16_bf16 a[0:15], v[224:227], a[196:199], a[0:15]
 v_mfma_f32_32x32x16_bf16 a[16:31], v[224:227], a[212:215], a[16:31]
 ds_read_b64_tr_b16 v[224:225], v201 offset:8192
 ds_read_b64_tr_b16 v[226:227], v201 offset:10240
 v_mfma_f32_32x32x16_bf16 a[32:47], v[228:231], a[196:199], a[32:47]
 v_mfma_f32_32x32x16_bf16 a[48:63], v[228:231], a[212:215], a[48:63]
 ds_read_b64_tr_b16 v[228:229], v202 offset:8192
 ds_read_b64_tr_b16 v[230:231], v202 offset:10240
 s_waitcnt lgkmcnt(6)
 v_mfma_f32_32x32x16_bf16 a[64:79], v[232:235], a[196:199], a[64:79]
 v_mfma_f32_32x32x16_bf16 a[80:95], v[232:235], a[212:215], a[80:95]
 ds_read_b64_tr_b16 v[232:233], v203 offset:8192
 ds_read_b64_tr_b16 v[234:235], v203 offset:10240
 v_mfma_f32_32x32x16_bf16 a[96:111], v[236:239], a[196:199], a[96:111]
 v_mfma_f32_32x32x16_bf16 a[112:127], v[236:239], a[212:215], a[112:127]
 ds_read_b64_tr_b16 v[236:237], v200 offset:12288
 ds_read_b64_tr_b16 v[238:239], v200 offset:14336
 s_waitcnt lgkmcnt(6)
 v_mfma_f32_32x32x16_bf16 a[0:15], v[220:223], a[200:203], a[0:15]
 v_mfma_f32_32x32x16_bf16 a[16:31], v[220:223], a[216:219], a[16:31]
 ds_read_b64_tr_b16 v[220:221], v201 offset:12288
 ds_read_b64_tr_b16 v[222:223], v201 offset:14336
 v_mfma_f32_32x32x16_bf16 a[32:47], v[224:227], a[200:203], a[32:47]
 v_mfma_f32_32x32x16_bf16 a[48:63], v[224:227], a[216:219], a[48:63]
 ds_read_b64_tr_b16 v[224:225], v202 offset:12288
 ds_read_b64_tr_b16 v[226:227], v202 offset:14336
 s_waitcnt lgkmcnt(6)
 v_mfma_f32_32x32x16_bf16 a[64:79], v[228:231], a[200:203], a[64:79]
 v_mfma_f32_32x32x16_bf16 a[80:95], v[228:231], a[216:219], a[80:95]
 ds_read_b64_tr_b16 v[228:229], v203 offset:12288
 ds_read_b64_tr_b16 v[230:231], v203 offset:14336
 v_mfma_f32_32x32x16_bf16 a[96:111], v[232:235], a[200:203], a[96:111]
 v_mfma_f32_32x32x16_bf16 a[112:127], v[232:235], a[216:219], a[112:127]
 ds_read_b64_tr_b16 v[232:233], v200 offset:16384
 ds_read_b64_tr_b16 v[234:235], v200 offset:18432
 s_waitcnt lgkmcnt(6)
 v_mfma_f32_32x32x16_bf16 a[0:15], v[236:239], a[204:207], a[0:15]
 v_mfma_f32_32x32x16_bf16 a[16:31], v[236:239], a[220:223], a[16:31]
 ds_read_b64_tr_b16 v[236:237], v201 offset:16384
 ds_read_b64_tr_b16 v[238:239], v201 offset:18432
 v_mfma_f32_32x32x16_bf16 a[32:47], v[220:223], a[204:207], a[32:47]
 v_mfma_f32_32x32x16_bf16 a[48:63], v[220:223], a[220:223], a[48:63]
 ds_read_b64_tr_b16 v[220:221], v202 offset:16384
 ds_read_b64_tr_b16 v[222:223], v202 offset:18432
 s_waitcnt lgkmcnt(6)
 v_mfma_f32_32x32x16_bf16 a[64:79], v[224:227], a[204:207], a[64:79]
 v_mfma_f32_32x32x16_bf16 a[80:95], v[224:227], a[220:223], a[80:95]
 ds_read_b64_tr_b16 v[224:225], v203 offset:16384
 ds_read_b64_tr_b16 v[226:227], v203 offset:18432
 v_mfma_f32_32x32x16_bf16 a[96:111], v[228:231], a[204:207], a[96:111]
 v_mfma_f32_32x32x16_bf16 a[112:127], v[228:231], a[220:223], a[112:127]
 s_waitcnt vmcnt(14)
 s_barrier
 ds_read_b64_tr_b16 v[228:229], v200 offset:20480
 ds_read_b64_tr_b16 v[230:231], v200 offset:22528
 s_add_u32 m0, s28, 65536
 s_nop 0
 buffer_load_dwordx4 v210, s[12:15], s34 offen nt lds
 s_waitcnt lgkmcnt(6)
 v_mfma_f32_32x32x16_bf16 v[64:79], v[232:235], a[192:195], v[64:79]
 s_waitcnt vmcnt(9)
 ds_read_b128 a[224:227], v204 offset:0
 s_waitcnt vmcnt(5)
 ds_read_b128 a[240:243], v204 offset:4096
 ds_read_b128 a[228:231], v205 offset:0
 ds_read_b128 a[244:247], v205 offset:4096
 ds_read_b128 a[232:235], v206 offset:0
 ds_read_b128 a[248:251], v206 offset:4096
 v_mfma_f32_32x32x16_bf16 v[80:95], v[232:235], a[208:211], v[80:95]
 ds_read_b64_tr_b16 v[232:233], v201 offset:20480
 ds_read_b64_tr_b16 v[234:235], v201 offset:22528
 ds_read_b128 a[236:239], v207 offset:0
 ds_read_b128 a[252:255], v207 offset:4096
 buffer_load_dwordx4 v210, s[12:15], s34 offen offset:1024 nt lds
 v_mfma_f32_32x32x16_bf16 v[96:111], v[236:239], a[192:195], v[96:111]
 s_add_u32 m0, s28, 73728
 s_add_u32 s93, s92, 0
 s_mov_b32 s34, 8192
 v_mfma_f32_32x32x16_bf16 v[112:127], v[236:239], a[208:211], v[112:127]
 ds_read_b64_tr_b16 v[236:237], v202 offset:20480
 ds_read_b64_tr_b16 v[238:239], v202 offset:22528
 s_waitcnt lgkmcnt(14)
 v_mfma_f32_32x32x16_bf16 v[128:143], v[220:223], a[192:195], v[128:143]
 buffer_store_dwordx4 v[240:243], v214, s[96:99], s93 offen offset:0 sc1
 v_mfma_f32_32x32x16_bf16 v[144:159], v[220:223], a[208:211], v[144:159]
 ds_read_b64_tr_b16 v[220:221], v203 offset:20480
 ds_read_b64_tr_b16 v[222:223], v203 offset:22528
 v_mfma_f32_32x32x16_bf16 v[160:175], v[224:227], a[192:195], v[160:175]
 buffer_store_dwordx4 v[244:247], v214, s[96:99], s93 offen offset:1024 sc1
 s_add_u32 s93, s92, 8192
 v_mfma_f32_32x32x16_bf16 v[176:191], v[224:227], a[208:211], v[176:191]
 ds_read_b64_tr_b16 v[224:225], v200 offset:24576
 ds_read_b64_tr_b16 v[226:227], v200 offset:26624
 s_waitcnt lgkmcnt(6)
 v_mfma_f32_32x32x16_bf16 v[64:79], v[228:231], a[196:199], v[64:79]
 buffer_store_dwordx4 v[248:251], v214, s[96:99], s93 offen offset:0 sc1
 v_mfma_f32_32x32x16_bf16 v[80:95], v[228:231], a[212:215], v[80:95]
 ds_read_b64_tr_b16 v[228:229], v201 offset:24576
 ds_read_b64_tr_b16 v[230:231], v201 offset:26624
 v_mfma_f32_32x32x16_bf16 v[96:111], v[232:235], a[196:199], v[96:111]
 buffer_store_dwordx4 v[252:255], v214, s[96:99], s93 offen offset:1024 sc1
 v_mfma_f32_32x32x16_bf16 v[112:127], v[232:235], a[212:215], v[112:127]
 ds_read_b64_tr_b16 v[232:233], v202 offset:24576
 ds_read_b64_tr_b16 v[234:235], v202 offset:26624
 s_waitcnt lgkmcnt(6)
 v_mfma_f32_32x32x16_bf16 v[128:143], v[236:239], a[196:199], v[128:143]
 buffer_load_dwordx4 v210, s[12:15], s34 offen nt lds
 v_mfma_f32_32x32x16_bf16 v[144:159], v[236:239], a[212:215], v[144:159]
 ds_read_b64_tr_b16 v[236:237], v203 offset:24576
 ds_read_b64_tr_b16 v[238:239], v203 offset:26624
 v_mfma_f32_32x32x16_bf16 v[160:175], v[220:223], a[196:199], v[160:175]
 buffer_load_dwordx4 v210, s[12:15], s34 offen offset:1024 nt lds
 s_mov_b32 s34, 16384
 v_mfma_f32_32x32x16_bf16 v[176:191], v[220:223], a[212:215], v[176:191]
 ds_read_b64_tr_b16 v[220:221], v200 offset:28672
 ds_read_b64_tr_b16 v[222:223], v200 offset:30720
 s_waitcnt lgkmcnt(6)
 v_mfma_f32_32x32x16_bf16 v[64:79], v[224:227], a[200:203], v[64:79]
 v_mfma_f32_32x32x16_bf16 v[80:95], v[224:227], a[216:219], v[80:95]
 ds_read_b64_tr_b16 v[224:225], v201 offset:28672
 ds_read_b64_tr_b16 v[226:227], v201 offset:30720
 v_mfma_f32_32x32x16_bf16 v[96:111], v[228:231], a[200:203], v[96:111]
 v_mfma_f32_32x32x16_bf16 v[112:127], v[228:231], a[216:219], v[112:127]
 ds_read_b64_tr_b16 v[228:229], v202 offset:28672
 ds_read_b64_tr_b16 v[230:231], v202 offset:30720
 s_waitcnt lgkmcnt(6)
 v_mfma_f32_32x32x16_bf16 v[128:143], v[232:235], a[200:203], v[128:143]
 v_mfma_f32_32x32x16_bf16 v[144:159], v[232:235], a[216:219], v[144:159]
 ds_read_b64_tr_b16 v[232:233], v203 offset:28672
 ds_read_b64_tr_b16 v[234:235], v203 offset:30720
 v_mfma_f32_32x32x16_bf16 v[160:175], v[236:239], a[200:203], v[160:175]
 v_mfma_f32_32x32x16_bf16 v[176:191], v[236:239], a[216:219], v[176:191]
 ds_read_b64_tr_b16 v[236:237], v200 offset:32768
 ds_read_b64_tr_b16 v[238:239], v200 offset:34816
 s_waitcnt lgkmcnt(6)
 v_mfma_f32_32x32x16_bf16 v[64:79], v[220:223], a[204:207], v[64:79]
 v_mfma_f32_32x32x16_bf16 v[80:95], v[220:223], a[220:223], v[80:95]
 ds_read_b64_tr_b16 v[220:221], v200 offset:36864
 ds_read_b64_tr_b16 v[222:223], v200 offset:38912
 v_mfma_f32_32x32x16_bf16 v[96:111], v[224:227], a[204:207], v[96:111]
 v_mfma_f32_32x32x16_bf16 v[112:127], v[224:227], a[220:223], v[112:127]
 s_waitcnt lgkmcnt(4)
 v_mfma_f32_32x32x16_bf16 v[128:143], v[228:231], a[204:207], v[128:143]
 v_mfma_f32_32x32x16_bf16 v[144:159], v[228:231], a[220:223], v[144:159]
 v_mfma_f32_32x32x16_bf16 v[160:175], v[232:235], a[204:207], v[160:175]
 v_mfma_f32_32x32x16_bf16 v[176:191], v[232:235], a[220:223], v[176:191]
 s_waitcnt vmcnt(10)
 s_barrier
 ds_read_b64_tr_b16 v[224:225], v200 offset:40960
 ds_read_b64_tr_b16 v[226:227], v200 offset:43008
 ds_read_b64_tr_b16 v[228:229], v200 offset:45056
 ds_read_b64_tr_b16 v[230:231], v200 offset:47104
 ds_read_b64_tr_b16 v[232:233], v201 offset:32768
 s_waitcnt lgkmcnt(5)
 v_mfma_f32_32x32x16_bf16 a[0:15], v[236:239], a[224:227], a[0:15]
 ds_read_b64_tr_b16 v[234:235], v201 offset:34816
 s_add_u32 m0, s28, 81920
 s_nop 0
 buffer_load_dwordx4 v210, s[12:15], s34 offen nt lds
 v_bfe_u32 v218, v214, 4, 5
 v_lshl_add_u32 v218, v219, 5, v218
 v_mfma_f32_32x32x16_bf16 a[16:31], v[236:239], a[240:243], a[16:31]
 ds_read_b64_tr_b16 v[236:237], v201 offset:36864
 ds_read_b64_tr_b16 v[238:239], v201 offset:38912
 v_lshlrev_b32 v218, 2, v218
 v_mov_b32 v219, 0
 v_mfma_f32_32x32x16_bf16 a[0:15], v[220:223], a[228:231], a[0:15]
 v_mfma_f32_32x32x16_bf16 a[16:31], v[220:223], a[244:247], a[16:31]
 ds_read_b64_tr_b16 v[220:221], v201 offset:40960
 ds_read_b64_tr_b16 v[222:223], v201 offset:43008
 buffer_load_dwordx4 v210, s[12:15], s34 offen offset:1024 nt lds
 s_add_u32 m0, s28, 90112
 s_mov_b32 s34, 24576
 s_waitcnt lgkmcnt(8)
 v_mfma_f32_32x32x16_bf16 a[0:15], v[224:227], a[232:235], a[0:15]
 s_lshl_b32 s90, s2, 9
 s_add_u32 s90, s90, 33554432
 v_mfma_f32_32x32x16_bf16 a[16:31], v[224:227], a[248:251], a[16:31]
 ds_read_b64_tr_b16 v[224:225], v201 offset:45056
 ds_read_b64_tr_b16 v[226:227], v201 offset:47104
 buffer_load_dwordx4 v210, s[12:15], s34 offen nt lds
 s_waitcnt lgkmcnt(6)
 v_mfma_f32_32x32x16_bf16 a[0:15], v[228:231], a[236:239], a[0:15]
 v_mfma_f32_32x32x16_bf16 a[16:31], v[228:231], a[252:255], a[16:31]
 ds_read_b64_tr_b16 v[228:229], v202 offset:32768
 ds_read_b64_tr_b16 v[230:231], v202 offset:34816
 buffer_load_dwordx4 v210, s[12:15], s34 offen offset:1024 nt lds
 s_mov_b32 s34, 32768
 v_mfma_f32_32x32x16_bf16 a[32:47], v[232:235], a[224:227], a[32:47]
 v_mfma_f32_32x32x16_bf16 a[48:63], v[232:235], a[240:243], a[48:63]
 ds_read_b64_tr_b16 v[232:233], v202 offset:36864
 ds_read_b64_tr_b16 v[234:235], v202 offset:38912
 buffer_store_dword v219, v218, s[96:99], s90 offen
 s_waitcnt lgkmcnt(6)
 v_mfma_f32_32x32x16_bf16 a[32:47], v[236:239], a[228:231], a[32:47]
 v_mfma_f32_32x32x16_bf16 a[48:63], v[236:239], a[244:247], a[48:63]
 ds_read_b64_tr_b16 v[236:237], v202 offset:40960
 ds_read_b64_tr_b16 v[238:239], v202 offset:43008
 v_mfma_f32_32x32x16_bf16 a[32:47], v[220:223], a[232:235], a[32:47]
 v_mfma_f32_32x32x16_bf16 a[48:63], v[220:223], a[248:251], a[48:63]
 ds_read_b64_tr_b16 v[220:221], v202 offset:45056
 ds_read_b64_tr_b16 v[222:223], v202 offset:47104
 s_waitcnt lgkmcnt(6)
 v_mfma_f32_32x32x16_bf16 a[32:47], v[224:227], a[236:239], a[32:47]
 v_mfma_f32_32x32x16_bf16 a[48:63], v[224:227], a[252:255], a[48:63]
 ds_read_b64_tr_b16 v[224:225], v203 offset:32768
 ds_read_b64_tr_b16 v[226:227], v203 offset:34816
 v_mfma_f32_32x32x16_bf16 a[64:79], v[228:231], a[224:227], a[64:79]
 v_mfma_f32_32x32x16_bf16 a[80:95], v[228:231], a[240:243], a[80:95]
 ds_read_b64_tr_b16 v[228:229], v203 offset:36864
 ds_read_b64_tr_b16 v[230:231], v203 offset:38912
 s_waitcnt lgkmcnt(6)
 v_mfma_f32_32x32x16_bf16 a[64:79], v[232:235], a[228:231], a[64:79]
 v_mfma_f32_32x32x16_bf16 a[80:95], v[232:235], a[244:247], a[80:95]
 ds_read_b64_tr_b16 v[232:233], v203 offset:40960
 ds_read_b64_tr_b16 v[234:235], v203 offset:43008
 v_mfma_f32_32x32x16_bf16 a[64:79], v[236:239], a[232:235], a[64:79]
 v_mfma_f32_32x32x16_bf16 a[80:95], v[236:239], a[248:251], a[80:95]
 ds_read_b64_tr_b16 v[236:237], v203 offset:45056
 ds_read_b64_tr_b16 v[238:239], v203 offset:47104
 s_waitcnt lgkmcnt(6)
 v_mfma_f32_32x32x16_bf16 a[64:79], v[220:223], a[236:239], a[64:79]
 v_mfma_f32_32x32x16_bf16 a[80:95], v[220:223], a[252:255], a[80:95]
 ds_read_b64_tr_b16 v[220:221], v200 offset:49152
 ds_read_b64_tr_b16 v[222:223], v200 offset:51200
 v_mfma_f32_32x32x16_bf16 a[96:111], v[224:227], a[224:227], a[96:111]
 v_mfma_f32_32x32x16_bf16 a[112:127], v[224:227], a[240:243], a[112:127]
 ds_read_b64_tr_b16 v[224:225], v200 offset:53248
 ds_read_b64_tr_b16 v[226:227], v200 offset:55296
 s_waitcnt lgkmcnt(6)
 v_mfma_f32_32x32x16_bf16 a[96:111], v[228:231], a[228:231], a[96:111]
 v_mfma_f32_32x32x16_bf16 a[112:127], v[228:231], a[244:247], a[112:127]
 v_mfma_f32_32x32x16_bf16 a[96:111], v[232:235], a[232:235], a[96:111]
 v_mfma_f32_32x32x16_bf16 a[112:127], v[232:235], a[248:251], a[112:127]
 s_waitcnt lgkmcnt(2)
 v_mfma_f32_32x32x16_bf16 a[96:111], v[236:239], a[236:239], a[96:111]
 v_mfma_f32_32x32x16_bf16 a[112:127], v[236:239], a[252:255], a[112:127]
 s_waitcnt vmcnt(13)
 s_barrier
 ds_read_b64_tr_b16 v[228:229], v200 offset:57344
 ds_read_b64_tr_b16 v[230:231], v200 offset:59392
 ds_read_b64_tr_b16 v[232:233], v200 offset:61440
 ds_read_b64_tr_b16 v[234:235], v200 offset:63488
 ds_read_b64_tr_b16 v[236:237], v201 offset:49152
 v_mfma_f32_32x32x16_bf16 v[64:79], v[220:223], a[224:227], v[64:79]
 ds_read_b64_tr_b16 v[238:239], v201 offset:51200
 s_add_u32 m0, s28, 98304
 s_nop 0
 buffer_load_dwordx4 v210, s[12:15], s34 offen nt lds
 v_mfma_f32_32x32x16_bf16 v[80:95], v[220:223], a[240:243], v[80:95]
 ds_read_b64_tr_b16 v[220:221], v201 offset:53248
 ds_read_b64_tr_b16 v[222:223], v201 offset:55296
 s_waitcnt lgkmcnt(8)
 v_mfma_f32_32x32x16_bf16 v[64:79], v[224:227], a[228:231], v[64:79]
 v_mfma_f32_32x32x16_bf16 v[80:95], v[224:227], a[244:247], v[80:95]
 ds_read_b64_tr_b16 v[224:225], v201 offset:57344
 ds_read_b64_tr_b16 v[226:227], v201 offset:59392
 buffer_load_dwordx4 v210, s[12:15], s34 offen offset:1024 nt lds
 s_add_u32 m0, s28, 106496
 s_mov_b32 s34, 40960
 s_waitcnt lgkmcnt(8)
 v_mfma_f32_32x32x16_bf16 v[64:79], v[228:231], a[232:235], v[64:79]
 v_mfma_f32_32x32x16_bf16 v[80:95], v[228:231], a[248:251], v[80:95]
 ds_read_b64_tr_b16 v[228:229], v201 offset:61440
 ds_read_b64_tr_b16 v[230:231], v201 offset:63488
 buffer_load_dwordx4 v210, s[12:15], s34 offen nt lds
 s_waitcnt lgkmcnt(6)
 v_mfma_f32_32x32x16_bf16 v[64:79], v[232:235], a[236:239], v[64:79]
 v_mfma_f32_32x32x16_bf16 v[80:95], v[232:235], a[252:255], v[80:95]
 ds_read_b64_tr_b16 v[232:233], v202 offset:49152
 ds_read_b64_tr_b16 v[234:235], v202 offset:51200
 buffer_load_dwordx4 v210, s[12:15], s34 offen offset:1024 nt lds
 s_mov_b32 s34, 49152
 v_mfma_f32_32x32x16_bf16 v[96:111], v[236:239], a[224:227], v[96:111]
 s_nop 5
 v_mul_f32 v64, s29, v64
 v_mul_f32 v65, s29, v65
 v_mul_f32 v66, s29, v66
 v_mul_f32 v67, s29, v67
 v_mul_f32 v68, s29, v68
 v_mul_f32 v69, s29, v69
 v_mfma_f32_32x32x16_bf16 v[112:127], v[236:239], a[240:243], v[112:127]
 ds_read_b64_tr_b16 v[236:237], v202 offset:53248
 ds_read_b64_tr_b16 v[238:239], v202 offset:55296
 v_mul_f32 v70, s29, v70
 v_mul_f32 v71, s29, v71
 v_mul_f32 v72, s29, v72
 v_mul_f32 v73, s29, v73
 s_waitcnt lgkmcnt(6)
 v_mfma_f32_32x32x16_bf16 v[96:111], v[220:223], a[228:231], v[96:111]
 v_mul_f32 v74, s29, v74
 v_mul_f32 v75, s29, v75
 v_mul_f32 v76, s29, v76
 v_mul_f32 v77, s29, v77
 v_mul_f32 v78, s29, v78
 v_mul_f32 v79, s29, v79
 v_mfma_f32_32x32x16_bf16 v[112:127], v[220:223], a[244:247], v[112:127]
 ds_read_b64_tr_b16 v[220:221], v202 offset:57344
 ds_read_b64_tr_b16 v[222:223], v202 offset:59392
 v_cvt_pk_bf16_f32 v0, v64, v65
 v_cvt_pk_bf16_f32 v1, v66, v67
 v_cvt_pk_bf16_f32 v2, v68, v69
 v_cvt_pk_bf16_f32 v3, v70, v71
 v_mfma_f32_32x32x16_bf16 v[96:111], v[224:227], a[232:235], v[96:111]
 v_cvt_pk_bf16_f32 v4, v72, v73
 v_cvt_pk_bf16_f32 v5, v74, v75
 v_cvt_pk_bf16_f32 v6, v76, v77
 v_cvt_pk_bf16_f32 v7, v78, v79
 v_mul_f32 v80, s29, v80
 v_mul_f32 v81, s29, v81
 v_mfma_f32_32x32x16_bf16 v[112:127], v[224:227], a[248:251], v[112:127]
 ds_read_b64_tr_b16 v[224:225], v202 offset:61440
 ds_read_b64_tr_b16 v[226:227], v202 offset:63488
 v_mul_f32 v82, s29, v82
 v_mul_f32 v83, s29, v83
 v_mul_f32 v84, s29, v84
 v_mul_f32 v85, s29, v85
 s_waitcnt lgkmcnt(6)
 v_mfma_f32_32x32x16_bf16 v[96:111], v[228:231], a[236:239], v[96:111]
 v_mul_f32 v86, s29, v86
 v_mul_f32 v87, s29, v87
 v_mul_f32 v88, s29, v88
 v_mul_f32 v89, s29, v89
 v_mul_f32 v90, s29, v90
 v_mul_f32 v91, s29, v91
 v_mfma_f32_32x32x16_bf16 v[112:127], v[228:231], a[252:255], v[112:127]
 ds_read_b64_tr_b16 v[228:229], v203 offset:49152
 ds_read_b64_tr_b16 v[230:231], v203 offset:51200
 v_mul_f32 v92, s29, v92
 v_mul_f32 v93, s29, v93
 v_mul_f32 v94, s29, v94
 v_mul_f32 v95, s29, v95
 v_mfma_f32_32x32x16_bf16 v[128:143], v[232:235], a[224:227], v[128:143]
 v_cvt_pk_bf16_f32 v32, v80, v81
 v_cvt_pk_bf16_f32 v33, v82, v83
 v_cvt_pk_bf16_f32 v34, v84, v85
 v_cvt_pk_bf16_f32 v35, v86, v87
 v_cvt_pk_bf16_f32 v36, v88, v89
 v_cvt_pk_bf16_f32 v37, v90, v91
 v_mfma_f32_32x32x16_bf16 v[144:159], v[232:235], a[240:243], v[144:159]
 ds_read_b64_tr_b16 v[232:233], v203 offset:53248
 ds_read_b64_tr_b16 v[234:235], v203 offset:55296
 v_cvt_pk_bf16_f32 v38, v92, v93
 v_cvt_pk_bf16_f32 v39, v94, v95
 v_mul_f32 v96, s29, v96
 v_mul_f32 v97, s29, v97
 s_waitcnt lgkmcnt(6)
 v_mfma_f32_32x32x16_bf16 v[128:143], v[236:239], a[228:231], v[128:143]
 v_mul_f32 v98, s29, v98
 v_mul_f32 v99, s29, v99
 v_mul_f32 v100, s29, v100
 v_mul_f32 v101, s29, v101
 v_mul_f32 v102, s29, v102
 v_mul_f32 v103, s29, v103
 v_mfma_f32_32x32x16_bf16 v[144:159], v[236:239], a[244:247], v[144:159]
 ds_read_b64_tr_b16 v[236:237], v203 offset:57344
 ds_read_b64_tr_b16 v[238:239], v203 offset:59392
 v_cvt_pk_bf16_f32 v8, v96, v97
 v_cvt_pk_bf16_f32 v9, v98, v99
 v_cvt_pk_bf16_f32 v10, v100, v101
 v_cvt_pk_bf16_f32 v11, v102, v103
 v_mfma_f32_32x32x16_bf16 v[128:143], v[220:223], a[232:235], v[128:143]
 v_mul_f32 v112, s29, v112
 v_mul_f32 v113, s29, v113
 v_mul_f32 v114, s29, v114
 v_mul_f32 v115, s29, v115
 v_mul_f32 v116, s29, v116
 v_mul_f32 v117, s29, v117
 v_mfma_f32_32x32x16_bf16 v[144:159], v[220:223], a[248:251], v[144:159]
 ds_read_b64_tr_b16 v[220:221], v203 offset:61440
 ds_read_b64_tr_b16 v[222:223], v203 offset:63488
 v_mul_f32 v118, s29, v118
 v_mul_f32 v119, s29, v119
 v_cvt_pk_bf16_f32 v40, v112, v113
 v_cvt_pk_bf16_f32 v41, v114, v115
 s_waitcnt lgkmcnt(6)
 v_mfma_f32_32x32x16_bf16 v[128:143], v[224:227], a[236:239], v[128:143]
 v_cvt_pk_bf16_f32 v42, v116, v117
 v_cvt_pk_bf16_f32 v43, v118, v119
 v_mul_f32 v104, s29, v104
 v_mul_f32 v105, s29, v105
 v_mul_f32 v106, s29, v106
 v_mul_f32 v107, s29, v107
 v_mfma_f32_32x32x16_bf16 v[144:159], v[224:227], a[252:255], v[144:159]
 ds_read_b128 v[224:227], v192 offset:0
 v_mul_f32 v108, s29, v108
 v_mul_f32 v109, s29, v109
 v_mul_f32 v110, s29, v110
 v_mul_f32 v111, s29, v111
 v_cvt_pk_bf16_f32 v12, v104, v105
 v_mfma_f32_32x32x16_bf16 v[160:175], v[228:231], a[224:227], v[160:175]
 v_cvt_pk_bf16_f32 v13, v106, v107
 v_cvt_pk_bf16_f32 v14, v108, v109
 v_cvt_pk_bf16_f32 v15, v110, v111
 v_mul_f32 v120, s29, v120
 v_mul_f32 v121, s29, v121
 v_mul_f32 v122, s29, v122
 v_mfma_f32_32x32x16_bf16 v[176:191], v[228:231], a[240:243], v[176:191]
 ds_read_b128 v[228:231], v193 offset:0
 v_mul_f32 v123, s29, v123
 v_mul_f32 v124, s29, v124
 v_mul_f32 v125, s29, v125
 v_mul_f32 v126, s29, v126
 v_mul_f32 v127, s29, v127
 s_waitcnt lgkmcnt(4)
 v_mfma_f32_32x32x16_bf16 v[160:175], v[232:235], a[228:231], v[160:175]
 v_cvt_pk_bf16_f32 v44, v120, v121
 v_cvt_pk_bf16_f32 v45, v122, v123
 v_cvt_pk_bf16_f32 v46, v124, v125
 v_cvt_pk_bf16_f32 v47, v126, v127
 v_mul_f32 v128, s29, v128
 v_mul_f32 v129, s29, v129
 v_mfma_f32_32x32x16_bf16 v[176:191], v[232:235], a[244:247], v[176:191]
 ds_read_b128 v[232:235], v194 offset:0
 v_mul_f32 v130, s29, v130
 v_mul_f32 v131, s29, v131
 v_mul_f32 v132, s29, v132
 v_mul_f32 v133, s29, v133
 v_mul_f32 v134, s29, v134
 v_mfma_f32_32x32x16_bf16 v[160:175], v[236:239], a[232:235], v[160:175]
 v_mul_f32 v135, s29, v135
 v_cvt_pk_bf16_f32 v16, v128, v129
 v_cvt_pk_bf16_f32 v17, v130, v131
 v_cvt_pk_bf16_f32 v18, v132, v133
 v_cvt_pk_bf16_f32 v19, v134, v135
 v_mul_f32 v144, s29, v144
 v_mfma_f32_32x32x16_bf16 v[176:191], v[236:239], a[248:251], v[176:191]
 ds_read_b128 v[236:239], v195 offset:0
 v_mul_f32 v145, s29, v145
 v_mul_f32 v146, s29, v146
 v_mul_f32 v147, s29, v147
 v_mul_f32 v148, s29, v148
 v_mul_f32 v149, s29, v149
 s_waitcnt lgkmcnt(3)
 v_mfma_f32_32x32x16_bf16 v[160:175], v[220:223], a[236:239], v[160:175]
 v_mul_f32 v150, s29, v150
 v_mul_f32 v151, s29, v151
 v_cvt_pk_bf16_f32 v48, v144, v145
 v_cvt_pk_bf16_f32 v49, v146, v147
 v_cvt_pk_bf16_f32 v50, v148, v149
 v_cvt_pk_bf16_f32 v51, v150, v151
 v_mfma_f32_32x32x16_bf16 v[176:191], v[220:223], a[252:255], v[176:191]
 s_barrier
 ds_read_b128 v[220:223], v196 offset:0
 s_add_u32 m0, s28, 114688
 s_nop 0
 buffer_load_dwordx4 v210, s[12:15], s34 offen nt lds
 v_mul_f32 v136, s29, v136
 v_mfma_f32_32x32x16_bf16 v[64:79], v[224:227], v[0:3], 0
 v_mul_f32 v137, s29, v137
 v_mul_f32 v138, s29, v138
 v_mul_f32 v139, s29, v139
 v_mul_f32 v140, s29, v140
 v_mul_f32 v141, s29, v141
 v_mul_f32 v142, s29, v142
 v_mfma_f32_32x32x16_bf16 v[80:95], v[224:227], v[32:35], 0
 ds_read_b128 v[224:227], v197 offset:0
 v_mul_f32 v143, s29, v143
 v_cvt_pk_bf16_f32 v20, v136, v137
 buffer_load_dwordx4 v210, s[12:15], s34 offen offset:1024 nt lds
 s_add_u32 m0, s28, 122880
 s_waitcnt lgkmcnt(3)
 v_mfma_f32_32x32x16_bf16 v[64:79], v[228:231], v[4:7], v[64:79]
 s_mov_b32 s34, 57344
 v_cvt_pk_bf16_f32 v21, v138, v139
 v_cvt_pk_bf16_f32 v22, v140, v141
 v_cvt_pk_bf16_f32 v23, v142, v143
 v_mul_f32 v152, s29, v152
 v_mul_f32 v153, s29, v153
 v_mfma_f32_32x32x16_bf16 v[80:95], v[228:231], v[36:39], v[80:95]
 ds_read_b128 v[228:231], v198 offset:0
 v_mul_f32 v154, s29, v154
 v_mul_f32 v155, s29, v155
 buffer_load_dwordx4 v210, s[12:15], s34 offen nt lds
 v_mul_f32 v156, s29, v156
 v_mfma_f32_32x32x16_bf16 v[64:79], v[232:235], v[8:11], v[64:79]
 v_mul_f32 v157, s29, v157
 v_mul_f32 v158, s29, v158
 v_mul_f32 v159, s29, v159
 v_cvt_pk_bf16_f32 v52, v152, v153
 v_cvt_pk_bf16_f32 v53, v154, v155
 v_cvt_pk_bf16_f32 v54, v156, v157
 v_mfma_f32_32x32x16_bf16 v[80:95], v[232:235], v[40:43], v[80:95]
 ds_read_b128 v[232:235], v199 offset:0
 v_cvt_pk_bf16_f32 v55, v158, v159
 v_mul_f32 v160, s29, v160
 buffer_load_dwordx4 v210, s[12:15], s34 offen offset:1024 nt lds
 s_mov_b32 s34, 65536
 s_waitcnt lgkmcnt(3)
 v_mfma_f32_32x32x16_bf16 v[64:79], v[236:239], v[12:15], v[64:79]
 v_mul_f32 v161, s29, v161
 v_mul_f32 v162, s29, v162
 v_mul_f32 v163, s29, v163
 v_mul_f32 v164, s29, v164
 v_mul_f32 v165, s29, v165
 v_mul_f32 v166, s29, v166
 v_mfma_f32_32x32x16_bf16 v[80:95], v[236:239], v[44:47], v[80:95]
 ds_read_b128 v[236:239], v192 offset:8192
 v_mul_f32 v167, s29, v167
 v_cvt_pk_bf16_f32 v24, v160, v161
 v_cvt_pk_bf16_f32 v25, v162, v163
 v_cvt_pk_bf16_f32 v26, v164, v165
 v_cvt_pk_bf16_f32 v27, v166, v167
 v_mfma_f32_32x32x16_bf16 v[64:79], v[220:223], v[16:19], v[64:79]
 v_mul_f32 v176, s29, v176
 v_mul_f32 v177, s29, v177
 v_mul_f32 v178, s29, v178
 v_mul_f32 v179, s29, v179
 v_mul_f32 v180, s29, v180
 v_mul_f32 v181, s29, v181
 v_mfma_f32_32x32x16_bf16 v[80:95], v[220:223], v[48:51], v[80:95]
 ds_read_b128 v[220:223], v193 offset:8192
 v_mul_f32 v182, s29, v182
 v_mul_f32 v183, s29, v183
 v_cvt_pk_bf16_f32 v56, v176, v177
 v_cvt_pk_bf16_f32 v57, v178, v179
 v_cvt_pk_bf16_f32 v58, v180, v181
 s_waitcnt lgkmcnt(3)
 v_mfma_f32_32x32x16_bf16 v[64:79], v[224:227], v[20:23], v[64:79]
 v_cvt_pk_bf16_f32 v59, v182, v183
 v_mul_f32 v168, s29, v168
 v_mul_f32 v169, s29, v169
 v_mul_f32 v170, s29, v170
 v_mul_f32 v171, s29, v171
 v_mul_f32 v172, s29, v172
 v_mfma_f32_32x32x16_bf16 v[80:95], v[224:227], v[52:55], v[80:95]
 ds_read_b128 v[224:227], v194 offset:8192
 v_mul_f32 v173, s29, v173
 v_mul_f32 v174, s29, v174
 v_mul_f32 v175, s29, v175
 v_cvt_pk_bf16_f32 v28, v168, v169
 v_cvt_pk_bf16_f32 v29, v170, v171
 v_mfma_f32_32x32x16_bf16 v[64:79], v[228:231], v[24:27], v[64:79]
 v_cvt_pk_bf16_f32 v30, v172, v173
 v_cvt_pk_bf16_f32 v31, v174, v175
 v_mul_f32 v184, s29, v184
 v_mul_f32 v185, s29, v185
 v_mul_f32 v186, s29, v186
 v_mul_f32 v187, s29, v187
 v_mfma_f32_32x32x16_bf16 v[80:95], v[228:231], v[56:59], v[80:95]
 ds_read_b128 v[228:231], v195 offset:8192
 v_mul_f32 v188, s29, v188
 v_mul_f32 v189, s29, v189
 v_mul_f32 v190, s29, v190
 v_mul_f32 v191, s29, v191
 v_cvt_pk_bf16_f32 v60, v184, v185
 s_waitcnt lgkmcnt(3)
 v_mfma_f32_32x32x16_bf16 v[64:79], v[232:235], v[28:31], v[64:79]
 v_cvt_pk_bf16_f32 v61, v186, v187
 v_cvt_pk_bf16_f32 v62, v188, v189
 v_cvt_pk_bf16_f32 v63, v190, v191
 s_nop 1
 v_mfma_f32_32x32x16_bf16 v[80:95], v[232:235], v[60:63], v[80:95]
 ds_read_b128 v[232:235], v196 offset:8192
 v_mfma_f32_32x32x16_bf16 v[96:111], v[236:239], v[0:3], 0
 s_nop 3
 v_max3_f32 v250, v64, v65, v66
 v_max3_f32 v250, v250, v67, v68
 v_max3_f32 v250, v250, v69, v70
 v_max3_f32 v250, v250, v71, v72
 v_max3_f32 v250, v250, v73, v74
 v_max3_f32 v250, v250, v75, v76
 v_mfma_f32_32x32x16_bf16 v[112:127], v[236:239], v[32:35], 0
 ds_read_b128 v[236:239], v197 offset:8192
 v_max3_f32 v250, v250, v77, v78
 v_max_f32 v250, v79, v250
 v_mov_b32 v251, v250
 s_nop 1
 v_permlane32_swap_b32 v250, v251
 v_max_f32 v250, v250, v251
 s_waitcnt lgkmcnt(3)
 v_mfma_f32_32x32x16_bf16 v[96:111], v[220:223], v[4:7], v[96:111]
 v_sub_f32 v64, v64, v250
 v_sub_f32 v65, v65, v250
 v_sub_f32 v66, v66, v250
 v_sub_f32 v67, v67, v250
 v_sub_f32 v68, v68, v250
 v_sub_f32 v69, v69, v250
 v_mfma_f32_32x32x16_bf16 v[112:127], v[220:223], v[36:39], v[112:127]
 ds_read_b128 v[220:223], v198 offset:8192
 v_sub_f32 v70, v70, v250
 v_sub_f32 v71, v71, v250
 v_sub_f32 v72, v72, v250
 v_sub_f32 v73, v73, v250
 v_sub_f32 v74, v74, v250
 v_mfma_f32_32x32x16_bf16 v[96:111], v[224:227], v[8:11], v[96:111]
 v_sub_f32 v75, v75, v250
 v_sub_f32 v76, v76, v250
 v_sub_f32 v77, v77, v250
 v_sub_f32 v78, v78, v250
 v_sub_f32 v79, v79, v250
 v_sub_f32 v160, 0, v250
 v_mfma_f32_32x32x16_bf16 v[112:127], v[224:227], v[40:43], v[112:127]
 ds_read_b128 v[224:227], v199 offset:8192
 v_sub_f32 v161, 0, v250
 v_sub_f32 v162, 0, v250
 v_sub_f32 v163, 0, v250
 v_sub_f32 v164, 0, v250
 v_sub_f32 v165, 0, v250
 s_waitcnt lgkmcnt(3)
 v_mfma_f32_32x32x16_bf16 v[96:111], v[228:231], v[12:15], v[96:111]
 v_sub_f32 v166, 0, v250
 v_sub_f32 v167, 0, v250
 v_sub_f32 v168, 0, v250
 v_sub_f32 v169, 0, v250
 v_sub_f32 v170, 0, v250
 v_sub_f32 v171, 0, v250
 v_mfma_f32_32x32x16_bf16 v[112:127], v[228:231], v[44:47], v[112:127]
 ds_read_b128 v[228:231], v192 offset:16384
 v_sub_f32 v172, 0, v250
 v_sub_f32 v173, 0, v250
 v_sub_f32 v174, 0, v250
 v_sub_f32 v175, 0, v250
 v_max3_f32 v252, v80, v81, v82
 v_mfma_f32_32x32x16_bf16 v[96:111], v[232:235], v[16:19], v[96:111]
 v_exp_f32 v242, v64
 v_exp_f32 v243, v65
 v_exp_f32 v244, v66
 v_mfma_f32_32x32x16_bf16 v[112:127], v[232:235], v[48:51], v[112:127]
 ds_read_b128 v[232:235], v193 offset:16384
 v_add_f32 v240, v242, v243
 v_cvt_pk_bf16_f32 v128, v242, v243
 v_exp_f32 v245, v67
 v_add_f32 v240, v244, v240
 s_waitcnt lgkmcnt(3)
 v_mfma_f32_32x32x16_bf16 v[96:111], v[236:239], v[20:23], v[96:111]
 v_add_f32 v240, v245, v240
 v_cvt_pk_bf16_f32 v129, v244, v245
 v_exp_f32 v242, v68
 v_exp_f32 v243, v69
 v_mfma_f32_32x32x16_bf16 v[112:127], v[236:239], v[52:55], v[112:127]
 ds_read_b128 v[236:239], v194 offset:16384
 v_add_f32 v240, v242, v240
 v_add_f32 v240, v243, v240
 v_cvt_pk_bf16_f32 v130, v242, v243
 v_exp_f32 v244, v70
 v_mfma_f32_32x32x16_bf16 v[96:111], v[220:223], v[24:27], v[96:111]
 v_exp_f32 v245, v71
 v_add_f32 v240, v244, v240
 v_add_f32 v240, v245, v240
 v_cvt_pk_bf16_f32 v131, v244, v245
 v_max3_f32 v252, v252, v83, v84
 v_mfma_f32_32x32x16_bf16 v[112:127], v[220:223], v[56:59], v[112:127]
 ds_read_b128 v[220:223], v195 offset:16384
 v_exp_f32 v242, v72
 v_exp_f32 v243, v73
 v_add_f32 v240, v242, v240
 s_waitcnt lgkmcnt(3)
 v_mfma_f32_32x32x16_bf16 v[96:111], v[224:227], v[28:31], v[96:111]
 v_add_f32 v240, v243, v240
 v_cvt_pk_bf16_f32 v132, v242, v243
 v_exp_f32 v244, v74
 v_exp_f32 v245, v75
 v_mfma_f32_32x32x16_bf16 v[112:127], v[224:227], v[60:63], v[112:127]
 s_waitcnt vmcnt(19)
 s_barrier
 ds_read_b128 v[224:227], v196 offset:16384
 s_add_u32 m0, s28, 0
 s_nop 0
 buffer_load_dwordx4 v208, s[8:11], s32 offen nt lds
 v_add_f32 v240, v244, v240
 v_add_f32 v240, v245, v240
 v_cvt_pk_bf16_f32 v133, v244, v245
 v_exp_f32 v242, v76
 v_exp_f32 v243, v77
 v_exp_f32 v244, v78
 v_exp_f32 v245, v79
 v_mfma_f32_32x32x16_bf16 v[64:79], v[228:231], v[0:3], v[160:175]
 v_max3_f32 v252, v252, v85, v86
 buffer_load_dwordx4 v209, s[8:11], s32 offen offset:1024 nt lds
 s_add_u32 m0, s28, 8192
 s_mov_b32 s32, 73728
 v_max3_f32 v252, v252, v87, v88
 v_max3_f32 v252, v252, v89, v90
 v_max3_f32 v252, v252, v91, v92
 v_max3_f32 v252, v252, v93, v94
 v_max_f32 v252, v95, v252
 v_mov_b32 v253, v252
 s_nop 1
 v_permlane32_swap_b32 v252, v253
 v_max_f32 v252, v252, v253
 v_and_b32 v253, 6400, v214
 v_cmp_eq_u32 vcc, 0x1900, v253
 v_mov_b32 v253, 1900671690
 s_nop 0
 v_cndmask_b32 v252, v252, v253, vcc
 v_sub_f32 v80, v80, v252
 v_sub_f32 v81, v81, v252
 v_sub_f32 v82, v82, v252
 v_sub_f32 v83, v83, v252
 v_sub_f32 v84, v84, v252
 v_sub_f32 v85, v85, v252
 v_sub_f32 v86, v86, v252
 v_sub_f32 v87, v87, v252
 v_sub_f32 v88, v88, v252
 v_sub_f32 v89, v89, v252
 v_sub_f32 v90, v90, v252
 v_sub_f32 v91, v91, v252
 v_sub_f32 v92, v92, v252
 v_sub_f32 v93, v93, v252
 v_sub_f32 v94, v94, v252
 v_sub_f32 v95, v95, v252
 v_sub_f32 v176, 0, v252
 v_sub_f32 v177, 0, v252
 v_sub_f32 v178, 0, v252
 v_sub_f32 v179, 0, v252
 v_sub_f32 v180, 0, v252
 v_sub_f32 v181, 0, v252
 v_sub_f32 v182, 0, v252
 v_sub_f32 v183, 0, v252
 v_sub_f32 v184, 0, v252
 v_sub_f32 v185, 0, v252
 v_sub_f32 v186, 0, v252
 v_sub_f32 v187, 0, v252
 v_sub_f32 v188, 0, v252
 v_sub_f32 v189, 0, v252
 v_sub_f32 v190, 0, v252
 v_sub_f32 v191, 0, v252
 v_add_f32 v240, v242, v240
 v_add_f32 v240, v243, v240
 v_cvt_pk_bf16_f32 v134, v242, v243
 v_add_f32 v240, v244, v240
 v_add_f32 v240, v245, v240
 v_cvt_pk_bf16_f32 v135, v244, v245
 v_exp_f32 v242, v80
 v_exp_f32 v243, v81
 s_nop 0
 v_add_f32 v241, v242, v243
 v_cvt_pk_bf16_f32 v136, v242, v243
 v_exp_f32 v244, v82
 v_exp_f32 v245, v83
 v_add_f32 v241, v244, v241
 v_add_f32 v241, v245, v241
 v_cvt_pk_bf16_f32 v137, v244, v245
 v_exp_f32 v242, v84
 v_exp_f32 v243, v85
 v_add_f32 v241, v242, v241
 v_add_f32 v241, v243, v241
 v_cvt_pk_bf16_f32 v138, v242, v243
 v_exp_f32 v244, v86
 v_exp_f32 v245, v87
 v_add_f32 v241, v244, v241
 v_add_f32 v241, v245, v241
 v_cvt_pk_bf16_f32 v139, v244, v245
 v_exp_f32 v242, v88
 v_exp_f32 v243, v89
 v_add_f32 v241, v242, v241
 v_add_f32 v241, v243, v241
 v_cvt_pk_bf16_f32 v140, v242, v243
 v_exp_f32 v244, v90
 v_exp_f32 v245, v91
 v_add_f32 v241, v244, v241
 v_add_f32 v241, v245, v241
 v_cvt_pk_bf16_f32 v141, v244, v245
 v_exp_f32 v242, v92
 v_exp_f32 v243, v93
 v_exp_f32 v244, v94
 v_exp_f32 v245, v95
 v_mfma_f32_32x32x16_bf16 v[80:95], v[228:231], v[32:35], v[176:191]
 ds_read_b128 v[228:231], v197 offset:16384
 buffer_load_dwordx4 v208, s[8:11], s32 offen nt lds
 v_cvt_pk_bf16_f32 v142, v242, v243
 v_cvt_pk_bf16_f32 v143, v244, v245
 v_add_f32 v241, v242, v241
 s_waitcnt lgkmcnt(1)
 v_mfma_f32_32x32x16_bf16 v[64:79], v[232:235], v[4:7], v[64:79]
 v_add_f32 v241, v243, v241
 v_add_f32 v241, v244, v241
 v_add_f32 v241, v245, v241
 v_add_f32 v216, v240, v216
 v_add_f32 v217, v241, v217
 v_add_f32 v96, v160, v96
 v_mfma_f32_32x32x16_bf16 v[80:95], v[232:235], v[36:39], v[80:95]
 ds_read_b128 v[232:235], v198 offset:16384
 buffer_load_dwordx4 v209, s[8:11], s32 offen offset:1024 nt lds
 s_mov_b32 s32, 81920
 v_add_f32 v97, v161, v97
 v_add_f32 v98, v162, v98
 v_mfma_f32_32x32x16_bf16 v[64:79], v[236:239], v[8:11], v[64:79]
 v_add_f32 v99, v163, v99
 v_add_f32 v100, v164, v100
 v_add_f32 v101, v165, v101
 v_add_f32 v102, v166, v102
 v_add_f32 v103, v167, v103
 v_add_f32 v104, v168, v104
 v_mfma_f32_32x32x16_bf16 v[80:95], v[236:239], v[40:43], v[80:95]
 ds_read_b128 v[236:239], v199 offset:16384
 v_add_f32 v105, v169, v105
 v_add_f32 v106, v170, v106
 v_add_f32 v107, v171, v107
 v_add_f32 v108, v172, v108
 v_add_f32 v109, v173, v109
 v_mfma_f32_32x32x16_bf16 v[64:79], v[220:223], v[12:15], v[64:79]
 v_add_f32 v110, v174, v110
 v_add_f32 v111, v175, v111
 v_add_f32 v112, v176, v112
 v_add_f32 v113, v177, v113
 v_add_f32 v114, v178, v114
 v_add_f32 v115, v179, v115
 v_mfma_f32_32x32x16_bf16 v[80:95], v[220:223], v[44:47], v[80:95]
 ds_read_b64_tr_b16 v[220:221], v200 offset:0
 ds_read_b64_tr_b16 v[222:223], v200 offset:2048
 v_add_f32 v116, v180, v116
 v_add_f32 v117, v181, v117
 v_add_f32 v118, v182, v118
 v_add_f32 v119, v183, v119
 v_mfma_f32_32x32x16_bf16 v[64:79], v[224:227], v[16:19], v[64:79]
 v_add_f32 v120, v184, v120
 v_add_f32 v121, v185, v121
 v_add_f32 v122, v186, v122
 v_add_f32 v123, v187, v123
 v_add_f32 v124, v188, v124
 v_add_f32 v125, v189, v125
 v_mfma_f32_32x32x16_bf16 v[80:95], v[224:227], v[48:51], v[80:95]
 ds_read_b64_tr_b16 v[224:225], v201 offset:0
 ds_read_b64_tr_b16 v[226:227], v201 offset:2048
 v_add_f32 v126, v190, v126
 v_add_f32 v127, v191, v127
 v_exp_f32 v242, v96
 s_waitcnt lgkmcnt(5)
 v_mfma_f32_32x32x16_bf16 v[64:79], v[228:231], v[20:23], v[64:79]
 v_exp_f32 v243, v97
 v_exp_f32 v244, v98
 v_add_f32 v240, v242, v243
 v_cvt_pk_bf16_f32 v144, v242, v243
 v_mfma_f32_32x32x16_bf16 v[80:95], v[228:231], v[52:55], v[80:95]
 ds_read_b64_tr_b16 v[228:229], v202 offset:0
 ds_read_b64_tr_b16 v[230:231], v202 offset:2048
 v_exp_f32 v245, v99
 v_add_f32 v240, v244, v240
 v_add_f32 v240, v245, v240
 v_mfma_f32_32x32x16_bf16 v[64:79], v[232:235], v[24:27], v[64:79]
 v_cvt_pk_bf16_f32 v145, v244, v245
 v_exp_f32 v242, v100
 v_exp_f32 v243, v101
 v_add_f32 v240, v242, v240
 v_mfma_f32_32x32x16_bf16 v[80:95], v[232:235], v[56:59], v[80:95]
 ds_read_b64_tr_b16 v[232:233], v203 offset:0
 ds_read_b64_tr_b16 v[234:235], v203 offset:2048
 v_add_f32 v240, v243, v240
 v_cvt_pk_bf16_f32 v146, v242, v243
 v_exp_f32 v244, v102
 s_waitcnt lgkmcnt(6)
 v_mfma_f32_32x32x16_bf16 v[64:79], v[236:239], v[28:31], v[64:79]
 v_exp_f32 v245, v103
 v_add_f32 v240, v244, v240
 v_add_f32 v240, v245, v240
 v_cvt_pk_bf16_f32 v147, v244, v245
 v_mfma_f32_32x32x16_bf16 v[80:95], v[236:239], v[60:63], v[80:95]
 ds_read_b64_tr_b16 v[236:237], v200 offset:4096
 ds_read_b64_tr_b16 v[238:239], v200 offset:6144
 v_exp_f32 v242, v104
 v_exp_f32 v243, v105
 v_mfma_f32_32x32x16_bf16 a[128:143], v[220:223], v[128:131], 0
 v_add_f32 v240, v242, v240
 v_add_f32 v240, v243, v240
 v_cvt_pk_bf16_f32 v148, v242, v243
 v_exp_f32 v244, v106
 v_mfma_f32_32x32x16_bf16 a[144:159], v[220:223], v[136:139], 0
 ds_read_b64_tr_b16 v[220:221], v201 offset:4096
 ds_read_b64_tr_b16 v[222:223], v201 offset:6144
 v_exp_f32 v245, v107
 v_add_f32 v240, v244, v240
 v_add_f32 v240, v245, v240
 s_waitcnt lgkmcnt(6)
 v_mfma_f32_32x32x16_bf16 a[160:175], v[224:227], v[128:131], 0
 v_cvt_pk_bf16_f32 v149, v244, v245
 v_exp_f32 v242, v108
 v_exp_f32 v243, v109
 v_add_f32 v240, v242, v240
 v_mfma_f32_32x32x16_bf16 a[176:191], v[224:227], v[136:139], 0
 ds_read_b64_tr_b16 v[224:225], v202 offset:4096
 ds_read_b64_tr_b16 v[226:227], v202 offset:6144
 v_add_f32 v240, v243, v240
 v_cvt_pk_bf16_f32 v150, v242, v243
 v_exp_f32 v244, v110
 v_mfma_f32_32x32x16_bf16 a[192:207], v[228:231], v[128:131], 0
 v_exp_f32 v245, v111
 v_add_f32 v240, v244, v240
 v_add_f32 v240, v245, v240
 v_cvt_pk_bf16_f32 v151, v244, v245
 v_mfma_f32_32x32x16_bf16 a[208:223], v[228:231], v[136:139], 0
 ds_read_b64_tr_b16 v[228:229], v203 offset:4096
 ds_read_b64_tr_b16 v[230:231], v203 offset:6144
 v_exp_f32 v242, v112
 v_exp_f32 v243, v113
 s_waitcnt lgkmcnt(6)
 v_mfma_f32_32x32x16_bf16 a[224:239], v[232:235], v[128:131], 0
 v_add_f32 v241, v242, v243
 v_cvt_pk_bf16_f32 v152, v242, v243
 v_exp_f32 v244, v114
 v_exp_f32 v245, v115
 v_mfma_f32_32x32x16_bf16 a[240:255], v[232:235], v[136:139], 0
 ds_read_b128 v[232:235], v192 offset:24576
 v_add_f32 v241, v244, v241
 v_add_f32 v241, v245, v241
 v_cvt_pk_bf16_f32 v153, v244, v245
 v_exp_f32 v242, v116
 v_mfma_f32_32x32x16_bf16 a[128:143], v[236:239], v[132:135], a[128:143]
 v_exp_f32 v243, v117
 v_add_f32 v241, v242, v241
 v_add_f32 v241, v243, v241
 v_cvt_pk_bf16_f32 v154, v242, v243
 v_mfma_f32_32x32x16_bf16 a[144:159], v[236:239], v[140:143], a[144:159]
 ds_read_b128 v[236:239], v193 offset:24576
 v_exp_f32 v244, v118
 v_exp_f32 v245, v119
 v_add_f32 v241, v244, v241
 s_waitcnt lgkmcnt(4)
 v_mfma_f32_32x32x16_bf16 a[160:175], v[220:223], v[132:135], a[160:175]
 v_add_f32 v241, v245, v241
 v_cvt_pk_bf16_f32 v155, v244, v245
 v_exp_f32 v242, v120
 v_exp_f32 v243, v121
 v_mfma_f32_32x32x16_bf16 a[176:191], v[220:223], v[140:143], a[176:191]
 ds_read_b128 v[220:223], v194 offset:24576
 v_add_f32 v241, v242, v241
 v_add_f32 v241, v243, v241
 v_cvt_pk_bf16_f32 v156, v242, v243
 v_exp_f32 v244, v122
 v_mfma_f32_32x32x16_bf16 a[192:207], v[224:227], v[132:135], a[192:207]
 v_exp_f32 v245, v123
 v_add_f32 v241, v244, v241
 v_add_f32 v241, v245, v241
 v_cvt_pk_bf16_f32 v157, v244, v245
 v_mfma_f32_32x32x16_bf16 a[208:223], v[224:227], v[140:143], a[208:223]
 ds_read_b128 v[224:227], v195 offset:24576
 v_exp_f32 v242, v124
 v_exp_f32 v243, v125
 v_add_f32 v241, v242, v241
 s_waitcnt lgkmcnt(3)
 v_mfma_f32_32x32x16_bf16 a[224:239], v[228:231], v[132:135], a[224:239]
 v_add_f32 v241, v243, v241
 v_cvt_pk_bf16_f32 v158, v242, v243
 v_exp_f32 v244, v126
 v_exp_f32 v245, v127
 v_mfma_f32_32x32x16_bf16 a[240:255], v[228:231], v[140:143], a[240:255]
 v_add_f32 v241, v244, v241
 v_add_f32 v241, v245, v241
 v_cvt_pk_bf16_f32 v159, v244, v245
 v_add_f32 v254, v240, v241
 v_cmp_nge_f32 vcc, s30, v254
 s_cbranch_vccnz LR0_1
BR0_1:
 s_waitcnt vmcnt(17)
 s_barrier
 v_mfma_f32_32x32x16_bf16 v[96:111], v[232:235], v[0:3], v[160:175]
 ds_read_b128 v[228:231], v196 offset:24576
 s_add_u32 m0, s28, 65536
 s_nop 0
 buffer_load_dwordx4 v210, s[12:15], s34 offen nt lds
 v_add_f32 v216, v240, v216
 v_add_f32 v217, v241, v217
 v_mfma_f32_32x32x16_bf16 v[112:127], v[232:235], v[32:35], v[176:191]
 ds_read_b128 v[232:235], v197 offset:24576
 v_exp_f32 v242, v64
 v_exp_f32 v243, v65
 s_waitcnt lgkmcnt(3)
 v_mfma_f32_32x32x16_bf16 v[96:111], v[236:239], v[4:7], v[96:111]
 v_add_f32 v240, v242, v243
 v_cvt_pk_bf16_f32 v128, v242, v243
 buffer_load_dwordx4 v210, s[12:15], s34 offen offset:1024 nt lds
 s_add_u32 m0, s28, 16384
 s_mov_b32 s34, 73728
 v_mfma_f32_32x32x16_bf16 v[112:127], v[236:239], v[36:39], v[112:127]
 ds_read_b128 v[236:239], v198 offset:24576
 v_exp_f32 v244, v66
 v_exp_f32 v245, v67
 v_add_f32 v240, v244, v240
 v_mfma_f32_32x32x16_bf16 v[96:111], v[220:223], v[8:11], v[96:111]
 v_add_f32 v240, v245, v240
 v_cvt_pk_bf16_f32 v129, v244, v245
 buffer_load_dwordx4 v208, s[8:11], s32 offen nt lds
 v_exp_f32 v242, v68
 v_mfma_f32_32x32x16_bf16 v[112:127], v[220:223], v[40:43], v[112:127]
 ds_read_b128 v[220:223], v199 offset:24576
 v_exp_f32 v243, v69
 v_add_f32 v240, v242, v240
 v_add_f32 v240, v243, v240
 v_cvt_pk_bf16_f32 v130, v242, v243
 s_waitcnt lgkmcnt(3)
 v_mfma_f32_32x32x16_bf16 v[96:111], v[224:227], v[12:15], v[96:111]
 v_exp_f32 v244, v70
 buffer_load_dwordx4 v209, s[8:11], s32 offen offset:1024 nt lds
 s_mov_b32 s32, 90112
 v_add_f32 v240, v244, v240
 v_mfma_f32_32x32x16_bf16 v[112:127], v[224:227], v[44:47], v[112:127]
 ds_read_b64_tr_b16 v[224:225], v200 offset:8192
 ds_read_b64_tr_b16 v[226:227], v200 offset:10240
 v_exp_f32 v245, v71
 v_exp_f32 v242, v72
 v_mfma_f32_32x32x16_bf16 v[96:111], v[228:231], v[16:19], v[96:111]
 v_add_f32 v240, v245, v240
 v_cvt_pk_bf16_f32 v131, v244, v245
 v_exp_f32 v243, v73
 v_add_f32 v240, v242, v240
 v_add_f32 v240, v243, v240
 v_mfma_f32_32x32x16_bf16 v[112:127], v[228:231], v[48:51], v[112:127]
 ds_read_b64_tr_b16 v[228:229], v201 offset:8192
 ds_read_b64_tr_b16 v[230:231], v201 offset:10240
 v_cvt_pk_bf16_f32 v132, v242, v243
 v_exp_f32 v244, v74
 s_waitcnt lgkmcnt(5)
 v_mfma_f32_32x32x16_bf16 v[96:111], v[232:235], v[20:23], v[96:111]
 v_exp_f32 v245, v75
 v_add_f32 v240, v244, v240
 v_add_f32 v240, v245, v240
 v_cvt_pk_bf16_f32 v133, v244, v245
 v_mfma_f32_32x32x16_bf16 v[112:127], v[232:235], v[52:55], v[112:127]
 ds_read_b64_tr_b16 v[232:233], v202 offset:8192
 ds_read_b64_tr_b16 v[234:235], v202 offset:10240
 v_exp_f32 v242, v76
 v_exp_f32 v243, v77
 v_mfma_f32_32x32x16_bf16 v[96:111], v[236:239], v[24:27], v[96:111]
 v_add_f32 v240, v242, v240
 v_add_f32 v240, v243, v240
 v_cvt_pk_bf16_f32 v134, v242, v243
 v_exp_f32 v244, v78
 v_mfma_f32_32x32x16_bf16 v[112:127], v[236:239], v[56:59], v[112:127]
 ds_read_b64_tr_b16 v[236:237], v203 offset:8192
 ds_read_b64_tr_b16 v[238:239], v203 offset:10240
 v_exp_f32 v245, v79
 v_add_f32 v240, v244, v240
 v_add_f32 v240, v245, v240
 s_waitcnt lgkmcnt(6)
 v_mfma_f32_32x32x16_bf16 v[96:111], v[220:223], v[28:31], v[96:111]
 v_cvt_pk_bf16_f32 v135, v244, v245
 v_exp_f32 v242, v80
 v_exp_f32 v243, v81
 v_mfma_f32_32x32x16_bf16 v[112:127], v[220:223], v[60:63], v[112:127]
 ds_read_b64_tr_b16 v[220:221], v200 offset:12288
 ds_read_b64_tr_b16 v[222:223], v200 offset:14336
 v_add_f32 v241, v242, v243
 v_cvt_pk_bf16_f32 v136, v242, v243
 v_exp_f32 v244, v82
 v_mfma_f32_32x32x16_bf16 a[128:143], v[224:227], v[144:147], a[128:143]
 v_exp_f32 v245, v83
 v_add_f32 v241, v244, v241
 v_add_f32 v241, v245, v241
 v_cvt_pk_bf16_f32 v137, v244, v245
 v_mfma_f32_32x32x16_bf16 a[144:159], v[224:227], v[152:155], a[144:159]
 ds_read_b64_tr_b16 v[224:225], v201 offset:12288
 ds_read_b64_tr_b16 v[226:227], v201 offset:14336
 v_exp_f32 v242, v84
 v_exp_f32 v243, v85
 s_waitcnt lgkmcnt(6)
 v_mfma_f32_32x32x16_bf16 a[160:175], v[228:231], v[144:147], a[160:175]
 v_add_f32 v241, v242, v241
 v_add_f32 v241, v243, v241
 v_cvt_pk_bf16_f32 v138, v242, v243
 v_exp_f32 v244, v86
 v_mfma_f32_32x32x16_bf16 a[176:191], v[228:231], v[152:155], a[176:191]
 ds_read_b64_tr_b16 v[228:229], v202 offset:12288
 ds_read_b64_tr_b16 v[230:231], v202 offset:14336
 v_exp_f32 v245, v87
 v_add_f32 v241, v244, v241
 v_add_f32 v241, v245, v241
 v_mfma_f32_32x32x16_bf16 a[192:207], v[232:235], v[144:147], a[192:207]
 v_cvt_pk_bf16_f32 v139, v244, v245
 v_exp_f32 v242, v88
 v_exp_f32 v243, v89
 v_add_f32 v241, v242, v241
 v_mfma_f32_32x32x16_bf16 a[208:223], v[232:235], v[152:155], a[208:223]
 ds_read_b64_tr_b16 v[232:233], v203 offset:12288
 ds_read_b64_tr_b16 v[234:235], v203 offset:14336
 v_add_f32 v241, v243, v241
 v_cvt_pk_bf16_f32 v140, v242, v243
 v_exp_f32 v244, v90
 s_waitcnt lgkmcnt(6)
 v_mfma_f32_32x32x16_bf16 a[224:239], v[236:239], v[144:147], a[224:239]
 v_exp_f32 v245, v91
 v_add_f32 v241, v244, v241
 v_add_f32 v241, v245, v241
 v_cvt_pk_bf16_f32 v141, v244, v245
 v_mfma_f32_32x32x16_bf16 a[240:255], v[236:239], v[152:155], a[240:255]
 ds_read_b128 v[236:239], v192 offset:32768
 v_exp_f32 v242, v92
 v_exp_f32 v243, v93
 v_add_f32 v241, v242, v241
 v_mfma_f32_32x32x16_bf16 a[128:143], v[220:223], v[148:151], a[128:143]
 v_add_f32 v241, v243, v241
 v_cvt_pk_bf16_f32 v142, v242, v243
 v_exp_f32 v244, v94
 v_exp_f32 v245, v95
 v_mfma_f32_32x32x16_bf16 a[144:159], v[220:223], v[156:159], a[144:159]
 ds_read_b128 v[220:223], v193 offset:32768
 v_add_f32 v241, v244, v241
 v_add_f32 v241, v245, v241
 v_cvt_pk_bf16_f32 v143, v244, v245
 v_add_f32 v254, v240, v241
 v_cmp_nge_f32 vcc, s30, v254
 s_waitcnt lgkmcnt(4)
 v_mfma_f32_32x32x16_bf16 a[160:175], v[224:227], v[148:151], a[160:175]
 v_mfma_f32_32x32x16_bf16 a[176:191], v[224:227], v[156:159], a[176:191]
 ds_read_b128 v[224:227], v194 offset:32768
 v_mfma_f32_32x32x16_bf16 a[192:207], v[228:231], v[148:151], a[192:207]
 v_mfma_f32_32x32x16_bf16 a[208:223], v[228:231], v[156:159], a[208:223]
 ds_read_b128 v[228:231], v195 offset:32768
 s_waitcnt lgkmcnt(3)
 v_mfma_f32_32x32x16_bf16 a[224:239], v[232:235], v[148:151], a[224:239]
 v_mfma_f32_32x32x16_bf16 a[240:255], v[232:235], v[156:159], a[240:255]
 s_cbranch_vccnz LR0_2
BR0_2:
 s_waitcnt vmcnt(19)
 s_barrier
 ds_read_b128 v[232:235], v196 offset:32768
 s_add_u32 m0, s28, 73728
 s_nop 0
 buffer_load_dwordx4 v210, s[12:15], s34 offen nt lds
 v_mfma_f32_32x32x16_bf16 v[64:79], v[236:239], v[0:3], v[160:175]
 v_add_f32 v216, v240, v216
 v_add_f32 v217, v241, v217
 v_exp_f32 v242, v96
 v_exp_f32 v243, v97
 v_mfma_f32_32x32x16_bf16 v[80:95], v[236:239], v[32:35], v[176:191]
 ds_read_b128 v[236:239], v197 offset:32768
 v_add_f32 v240, v242, v243
 v_cvt_pk_bf16_f32 v144, v242, v243
 v_exp_f32 v244, v98
 v_accvgpr_read_b32 v250, a0
 s_waitcnt lgkmcnt(3)
 v_mfma_f32_32x32x16_bf16 v[64:79], v[220:223], v[4:7], v[64:79]
 buffer_load_dwordx4 v210, s[12:15], s34 offen offset:1024 nt lds
 s_add_u32 m0, s28, 24576
 s_mov_b32 s34, 81920
 v_exp_f32 v245, v99
 v_mfma_f32_32x32x16_bf16 v[80:95], v[220:223], v[36:39], v[80:95]
 ds_read_b128 v[220:223], v198 offset:32768
 v_add_f32 v240, v244, v240
 v_add_f32 v240, v245, v240
 v_cvt_pk_bf16_f32 v145, v244, v245
 v_exp_f32 v242, v100
 v_mfma_f32_32x32x16_bf16 v[64:79], v[224:227], v[8:11], v[64:79]
 buffer_load_dwordx4 v208, s[8:11], s32 offen nt lds
 v_exp_f32 v243, v101
 v_add_f32 v240, v242, v240
 v_add_f32 v240, v243, v240
 v_mfma_f32_32x32x16_bf16 v[80:95], v[224:227], v[40:43], v[80:95]
 ds_read_b128 v[224:227], v199 offset:32768
 v_cvt_pk_bf16_f32 v146, v242, v243
 v_exp_f32 v244, v102
 v_exp_f32 v245, v103
 s_waitcnt lgkmcnt(3)
 v_mfma_f32_32x32x16_bf16 v[64:79], v[228:231], v[12:15], v[64:79]
 buffer_load_dwordx4 v209, s[8:11], s32 offen offset:1024 nt lds
 s_mov_b32 s32, 98304
 v_add_f32 v240, v244, v240
 v_add_f32 v240, v245, v240
 v_cvt_pk_bf16_f32 v147, v244, v245
 v_mfma_f32_32x32x16_bf16 v[80:95], v[228:231], v[44:47], v[80:95]
 ds_read_b64_tr_b16 v[228:229], v200 offset:16384
 ds_read_b64_tr_b16 v[230:231], v200 offset:18432
 v_exp_f32 v242, v104
 v_exp_f32 v243, v105
 v_mfma_f32_32x32x16_bf16 v[64:79], v[232:235], v[16:19], v[64:79]
 v_add_f32 v240, v242, v240
 v_add_f32 v240, v243, v240
 v_cvt_pk_bf16_f32 v148, v242, v243
 v_exp_f32 v244, v106
 v_accvgpr_read_b32 v251, a1
 v_mfma_f32_32x32x16_bf16 v[80:95], v[232:235], v[48:51], v[80:95]
 ds_read_b64_tr_b16 v[232:233], v201 offset:16384
 ds_read_b64_tr_b16 v[234:235], v201 offset:18432
 v_exp_f32 v245, v107
 v_add_f32 v240, v244, v240
 v_add_f32 v240, v245, v240
 s_waitcnt lgkmcnt(5)
 v_mfma_f32_32x32x16_bf16 v[64:79], v[236:239], v[20:23], v[64:79]
 v_cvt_pk_bf16_f32 v149, v244, v245
 v_exp_f32 v242, v108
 v_exp_f32 v243, v109
 v_add_f32 v240, v242, v240
 v_mfma_f32_32x32x16_bf16 v[80:95], v[236:239], v[52:55], v[80:95]
 ds_read_b64_tr_b16 v[236:237], v202 offset:16384
 ds_read_b64_tr_b16 v[238:239], v202 offset:18432
 v_add_f32 v240, v243, v240
 v_cvt_pk_bf16_f32 v150, v242, v243
 v_exp_f32 v244, v110
 v_mfma_f32_32x32x16_bf16 v[64:79], v[220:223], v[24:27], v[64:79]
 v_exp_f32 v245, v111
 v_add_f32 v240, v244, v240
 v_add_f32 v240, v245, v240
 v_cvt_pk_bf16_f32 v151, v244, v245
 v_accvgpr_read_b32 v252, a2
 v_mfma_f32_32x32x16_bf16 v[80:95], v[220:223], v[56:59], v[80:95]
 ds_read_b64_tr_b16 v[220:221], v203 offset:16384
 ds_read_b64_tr_b16 v[222:223], v203 offset:18432
 v_exp_f32 v242, v112
 v_exp_f32 v243, v113
 s_waitcnt lgkmcnt(6)
 v_mfma_f32_32x32x16_bf16 v[64:79], v[224:227], v[28:31], v[64:79]
 v_add_f32 v241, v242, v243
 v_cvt_pk_bf16_f32 v152, v242, v243
 v_exp_f32 v244, v114
 v_exp_f32 v245, v115
 v_mfma_f32_32x32x16_bf16 v[80:95], v[224:227], v[60:63], v[80:95]
 ds_read_b64_tr_b16 v[224:225], v200 offset:20480
 ds_read_b64_tr_b16 v[226:227], v200 offset:22528
 v_add_f32 v241, v244, v241
 v_add_f32 v241, v245, v241
 v_cvt_pk_bf16_f32 v153, v244, v245
 v_accvgpr_read_b32 v253, a3
 v_mfma_f32_32x32x16_bf16 a[128:143], v[228:231], v[128:131], a[128:143]
 v_exp_f32 v242, v116
 v_exp_f32 v243, v117
 v_add_f32 v241, v242, v241
 v_add_f32 v241, v243, v241
 v_mfma_f32_32x32x16_bf16 a[144:159], v[228:231], v[136:139], a[144:159]
 ds_read_b64_tr_b16 v[228:229], v201 offset:20480
 ds_read_b64_tr_b16 v[230:231], v201 offset:22528
 v_cvt_pk_bf16_f32 v154, v242, v243
 v_exp_f32 v244, v118
 v_mul_f32 v250, s29, v250
 s_waitcnt lgkmcnt(6)
 v_mfma_f32_32x32x16_bf16 a[160:175], v[232:235], v[128:131], a[160:175]
 v_exp_f32 v245, v119
 v_add_f32 v241, v244, v241
 v_add_f32 v241, v245, v241
 v_cvt_pk_bf16_f32 v155, v244, v245
 v_mul_f32 v251, s29, v251
 v_mfma_f32_32x32x16_bf16 a[176:191], v[232:235], v[136:139], a[176:191]
 ds_read_b64_tr_b16 v[232:233], v202 offset:20480
 ds_read_b64_tr_b16 v[234:235], v202 offset:22528
 v_exp_f32 v242, v120
 v_exp_f32 v243, v121
 v_mfma_f32_32x32x16_bf16 a[192:207], v[236:239], v[128:131], a[192:207]
 v_add_f32 v241, v242, v241
 v_add_f32 v241, v243, v241
 v_cvt_pk_bf16_f32 v156, v242, v243
 v_exp_f32 v244, v122
 v_mul_f32 v252, s29, v252
 v_mfma_f32_32x32x16_bf16 a[208:223], v[236:239], v[136:139], a[208:223]
 ds_read_b64_tr_b16 v[236:237], v203 offset:20480
 ds_read_b64_tr_b16 v[238:239], v203 offset:22528
 v_exp_f32 v245, v123
 v_add_f32 v241, v244, v241
 v_add_f32 v241, v245, v241
 s_waitcnt lgkmcnt(6)
 v_mfma_f32_32x32x16_bf16 a[224:239], v[220:223], v[128:131], a[224:239]
 v_cvt_pk_bf16_f32 v157, v244, v245
 v_exp_f32 v242, v124
 v_exp_f32 v243, v125
 v_add_f32 v241, v242, v241
 v_mfma_f32_32x32x16_bf16 a[240:255], v[220:223], v[136:139], a[240:255]
 ds_read_b128 v[220:223], v192 offset:40960
 v_add_f32 v241, v243, v241
 v_cvt_pk_bf16_f32 v158, v242, v243
 v_exp_f32 v244, v126
 v_mul_f32 v253, s29, v253
 v_mfma_f32_32x32x16_bf16 a[128:143], v[224:227], v[132:135], a[128:143]
 v_exp_f32 v245, v127
 v_add_f32 v241, v244, v241
 v_add_f32 v241, v245, v241
 v_cvt_pk_bf16_f32 v159, v244, v245
 v_cvt_pk_bf16_f32 v250, v250, v251
 v_mfma_f32_32x32x16_bf16 a[144:159], v[224:227], v[140:143], a[144:159]
 ds_read_b128 v[224:227], v193 offset:40960
 v_cvt_pk_bf16_f32 v251, v252, v253
 v_accvgpr_write_b32 a0, v250
 v_accvgpr_write_b32 a1, v251
 v_accvgpr_read_b32 v250, a4
 v_accvgpr_read_b32 v251, a5
 s_waitcnt lgkmcnt(4)
 v_mfma_f32_32x32x16_bf16 a[160:175], v[228:231], v[132:135], a[160:175]
 v_accvgpr_read_b32 v252, a6
 v_accvgpr_read_b32 v253, a7
 v_mul_f32 v250, s29, v250
 v_mul_f32 v251, s29, v251
 v_mul_f32 v252, s29, v252
 v_mul_f32 v253, s29, v253
 v_mfma_f32_32x32x16_bf16 a[176:191], v[228:231], v[140:143], a[176:191]
 ds_read_b128 v[228:231], v194 offset:40960
 v_cvt_pk_bf16_f32 v250, v250, v251
 v_cvt_pk_bf16_f32 v251, v252, v253
 v_accvgpr_write_b32 a2, v250
 v_accvgpr_write_b32 a3, v251
 v_accvgpr_read_b32 v250, a8
 v_mfma_f32_32x32x16_bf16 a[192:207], v[232:235], v[132:135], a[192:207]
 v_accvgpr_read_b32 v251, a9
 v_accvgpr_read_b32 v252, a10
 v_accvgpr_read_b32 v253, a11
 v_mul_f32 v250, s29, v250
 v_mul_f32 v251, s29, v251
 v_mul_f32 v252, s29, v252
 v_mfma_f32_32x32x16_bf16 a[208:223], v[232:235], v[140:143], a[208:223]
 ds_read_b128 v[232:235], v195 offset:40960
 v_mul_f32 v253, s29, v253
 v_cvt_pk_bf16_f32 v250, v250, v251
 v_cvt_pk_bf16_f32 v251, v252, v253
 v_accvgpr_write_b32 a4, v250
 v_accvgpr_write_b32 a5, v251
 s_waitcnt lgkmcnt(3)
 v_mfma_f32_32x32x16_bf16 a[224:239], v[236:239], v[132:135], a[224:239]
 v_accvgpr_read_b32 v250, a12
 v_accvgpr_read_b32 v251, a13
 v_accvgpr_read_b32 v252, a14
 v_accvgpr_read_b32 v253, a15
 v_mul_f32 v250, s29, v250
 v_mul_f32 v251, s29, v251
 v_mfma_f32_32x32x16_bf16 a[240:255], v[236:239], v[140:143], a[240:255]
 v_mul_f32 v252, s29, v252
 v_mul_f32 v253, s29, v253
 v_cvt_pk_bf16_f32 v250, v250, v251
 v_cvt_pk_bf16_f32 v251, v252, v253
 v_accvgpr_write_b32 a6, v250
 v_accvgpr_write_b32 a7, v251
 v_add_f32 v254, v240, v241
 v_cmp_nge_f32 vcc, s30, v254
 s_cbranch_vccnz LR0_3
BR0_3:
 s_waitcnt vmcnt(21)
 s_barrier
 v_mfma_f32_32x32x16_bf16 v[96:111], v[220:223], v[0:3], v[160:175]
 ds_read_b128 v[236:239], v196 offset:40960
 s_add_u32 m0, s28, 81920
 s_nop 0
 buffer_load_dwordx4 v210, s[12:15], s34 offen nt lds
 v_add_f32 v216, v240, v216
 v_add_f32 v217, v241, v217
 v_mfma_f32_32x32x16_bf16 v[112:127], v[220:223], v[32:35], v[176:191]
 ds_read_b128 v[220:223], v197 offset:40960
 v_exp_f32 v242, v64
 v_exp_f32 v243, v65
 v_accvgpr_read_b32 v250, a16
 s_waitcnt lgkmcnt(2)
 v_mfma_f32_32x32x16_bf16 v[96:111], v[224:227], v[4:7], v[96:111]
 v_add_f32 v240, v242, v243
 v_cvt_pk_bf16_f32 v128, v242, v243
 buffer_load_dwordx4 v210, s[12:15], s34 offen offset:1024 nt lds
 s_add_u32 m0, s28, 32768
 s_mov_b32 s34, 90112
 v_mfma_f32_32x32x16_bf16 v[112:127], v[224:227], v[36:39], v[112:127]
 ds_read_b128 v[224:227], v198 offset:40960
 v_exp_f32 v244, v66
 v_exp_f32 v245, v67
 v_add_f32 v240, v244, v240
 v_mfma_f32_32x32x16_bf16 v[96:111], v[228:231], v[8:11], v[96:111]
 v_add_f32 v240, v245, v240
 v_cvt_pk_bf16_f32 v129, v244, v245
 buffer_load_dwordx4 v208, s[8:11], s32 offen nt lds
 v_exp_f32 v242, v68
 v_mfma_f32_32x32x16_bf16 v[112:127], v[228:231], v[40:43], v[112:127]
 ds_read_b128 v[228:231], v199 offset:40960
 v_exp_f32 v243, v69
 v_add_f32 v240, v242, v240
 v_add_f32 v240, v243, v240
 v_cvt_pk_bf16_f32 v130, v242, v243
 v_mfma_f32_32x32x16_bf16 v[96:111], v[232:235], v[12:15], v[96:111]
 v_exp_f32 v244, v70
 buffer_load_dwordx4 v209, s[8:11], s32 offen offset:1024 nt lds
 s_mov_b32 s32, 106496
 v_add_f32 v240, v244, v240
 v_mfma_f32_32x32x16_bf16 v[112:127], v[232:235], v[44:47], v[112:127]
 ds_read_b64_tr_b16 v[232:233], v200 offset:24576
 ds_read_b64_tr_b16 v[234:235], v200 offset:26624
 v_exp_f32 v245, v71
 v_exp_f32 v242, v72
 s_waitcnt lgkmcnt(4)
 v_mfma_f32_32x32x16_bf16 v[96:111], v[236:239], v[16:19], v[96:111]
 v_add_f32 v240, v245, v240
 v_cvt_pk_bf16_f32 v131, v244, v245
 v_exp_f32 v243, v73
 v_add_f32 v240, v242, v240
 v_add_f32 v240, v243, v240
 v_mfma_f32_32x32x16_bf16 v[112:127], v[236:239], v[48:51], v[112:127]
 ds_read_b64_tr_b16 v[236:237], v201 offset:24576
 ds_read_b64_tr_b16 v[238:239], v201 offset:26624
 v_cvt_pk_bf16_f32 v132, v242, v243
 v_exp_f32 v244, v74
 v_accvgpr_read_b32 v251, a17
 v_mfma_f32_32x32x16_bf16 v[96:111], v[220:223], v[20:23], v[96:111]
 v_exp_f32 v245, v75
 v_add_f32 v240, v244, v240
 v_add_f32 v240, v245, v240
 v_cvt_pk_bf16_f32 v133, v244, v245
 v_accvgpr_read_b32 v252, a18
 v_mfma_f32_32x32x16_bf16 v[112:127], v[220:223], v[52:55], v[112:127]
 ds_read_b64_tr_b16 v[220:221], v202 offset:24576
 ds_read_b64_tr_b16 v[222:223], v202 offset:26624
 v_exp_f32 v242, v76
 v_exp_f32 v243, v77
 s_waitcnt lgkmcnt(6)
 v_mfma_f32_32x32x16_bf16 v[96:111], v[224:227], v[24:27], v[96:111]
 v_add_f32 v240, v242, v240
 v_add_f32 v240, v243, v240
 v_cvt_pk_bf16_f32 v134, v242, v243
 v_exp_f32 v244, v78
 v_accvgpr_read_b32 v253, a19
 v_mfma_f32_32x32x16_bf16 v[112:127], v[224:227], v[56:59], v[112:127]
 ds_read_b64_tr_b16 v[224:225], v203 offset:24576
 ds_read_b64_tr_b16 v[226:227], v203 offset:26624
 v_exp_f32 v245, v79
 v_add_f32 v240, v244, v240
 v_add_f32 v240, v245, v240
 v_mfma_f32_32x32x16_bf16 v[96:111], v[228:231], v[28:31], v[96:111]
 v_cvt_pk_bf16_f32 v135, v244, v245
 v_exp_f32 v242, v80
 v_exp_f32 v243, v81
 v_mul_f32 v250, s29, v250
 v_mfma_f32_32x32x16_bf16 v[112:127], v[228:231], v[60:63], v[112:127]
 ds_read_b64_tr_b16 v[228:229], v200 offset:28672
 ds_read_b64_tr_b16 v[230:231], v200 offset:30720
 v_add_f32 v241, v242, v243
 v_cvt_pk_bf16_f32 v136, v242, v243
 v_exp_f32 v244, v82
 s_waitcnt lgkmcnt(6)
 v_mfma_f32_32x32x16_bf16 a[128:143], v[232:235], v[144:147], a[128:143]
 v_exp_f32 v245, v83
 v_add_f32 v241, v244, v241
 v_add_f32 v241, v245, v241
 v_cvt_pk_bf16_f32 v137, v244, v245
 v_mul_f32 v251, s29, v251
 v_mfma_f32_32x32x16_bf16 a[144:159], v[232:235], v[152:155], a[144:159]
 ds_read_b64_tr_b16 v[232:233], v201 offset:28672
 ds_read_b64_tr_b16 v[234:235], v201 offset:30720
 v_exp_f32 v242, v84
 v_exp_f32 v243, v85
 v_mfma_f32_32x32x16_bf16 a[160:175], v[236:239], v[144:147], a[160:175]
 v_add_f32 v241, v242, v241
 v_add_f32 v241, v243, v241
 v_cvt_pk_bf16_f32 v138, v242, v243
 v_exp_f32 v244, v86
 v_mul_f32 v252, s29, v252
 v_mfma_f32_32x32x16_bf16 a[176:191], v[236:239], v[152:155], a[176:191]
 ds_read_b64_tr_b16 v[236:237], v202 offset:28672
 ds_read_b64_tr_b16 v[238:239], v202 offset:30720
 v_exp_f32 v245, v87
 v_add_f32 v241, v244, v241
 v_add_f32 v241, v245, v241
 s_waitcnt lgkmcnt(6)
 v_mfma_f32_32x32x16_bf16 a[192:207], v[220:223], v[144:147], a[192:207]
 v_cvt_pk_bf16_f32 v139, v244, v245
 v_exp_f32 v242, v88
 v_exp_f32 v243, v89
 v_add_f32 v241, v242, v241
 v_mfma_f32_32x32x16_bf16 a[208:223], v[220:223], v[152:155], a[208:223]
 ds_read_b64_tr_b16 v[220:221], v203 offset:28672
 ds_read_b64_tr_b16 v[222:223], v203 offset:30720
 v_add_f32 v241, v243, v241
 v_cvt_pk_bf16_f32 v140, v242, v243
 v_exp_f32 v244, v90
 v_mfma_f32_32x32x16_bf16 a[224:239], v[224:227], v[144:147], a[224:239]
 v_exp_f32 v245, v91
 v_add_f32 v241, v244, v241
 v_add_f32 v241, v245, v241
 v_cvt_pk_bf16_f32 v141, v244, v245
 v_mul_f32 v253, s29, v253
 v_mfma_f32_32x32x16_bf16 a[240:255], v[224:227], v[152:155], a[240:255]
 ds_read_b128 v[224:227], v192 offset:49152
 v_exp_f32 v242, v92
 v_exp_f32 v243, v93
 v_add_f32 v241, v242, v241
 s_waitcnt lgkmcnt(5)
 v_mfma_f32_32x32x16_bf16 a[128:143], v[228:231], v[148:151], a[128:143]
 v_add_f32 v241, v243, v241
 v_cvt_pk_bf16_f32 v142, v242, v243
 v_exp_f32 v244, v94
 v_exp_f32 v245, v95
 v_mfma_f32_32x32x16_bf16 a[144:159], v[228:231], v[156:159], a[144:159]
 ds_read_b128 v[228:231], v193 offset:49152
 v_add_f32 v241, v244, v241
 v_add_f32 v241, v245, v241
 v_cvt_pk_bf16_f32 v143, v244, v245
 v_cvt_pk_bf16_f32 v250, v250, v251
 v_cvt_pk_bf16_f32 v251, v252, v253
 v_mfma_f32_32x32x16_bf16 a[160:175], v[232:235], v[148:151], a[160:175]
 v_accvgpr_write_b32 a8, v250
 v_accvgpr_write_b32 a9, v251
 v_accvgpr_read_b32 v250, a20
 v_accvgpr_read_b32 v251, a21
 v_accvgpr_read_b32 v252, a22
 v_accvgpr_read_b32 v253, a23
 v_mfma_f32_32x32x16_bf16 a[176:191], v[232:235], v[156:159], a[176:191]
 ds_read_b128 v[232:235], v194 offset:49152
 v_mul_f32 v250, s29, v250
 v_mul_f32 v251, s29, v251
 v_mul_f32 v252, s29, v252
 v_mul_f32 v253, s29, v253
 v_cvt_pk_bf16_f32 v250, v250, v251
 s_waitcnt lgkmcnt(3)
 v_mfma_f32_32x32x16_bf16 a[192:207], v[236:239], v[148:151], a[192:207]
 v_cvt_pk_bf16_f32 v251, v252, v253
 v_accvgpr_write_b32 a10, v250
 v_accvgpr_write_b32 a11, v251
 v_accvgpr_read_b32 v250, a24
 v_accvgpr_read_b32 v251, a25
 v_accvgpr_read_b32 v252, a26
 v_mfma_f32_32x32x16_bf16 a[208:223], v[236:239], v[156:159], a[208:223]
 ds_read_b128 v[236:239], v195 offset:49152
 v_accvgpr_read_b32 v253, a27
 v_mul_f32 v250, s29, v250
 v_mul_f32 v251, s29, v251
 v_mul_f32 v252, s29, v252
 v_mul_f32 v253, s29, v253
 v_mfma_f32_32x32x16_bf16 a[224:239], v[220:223], v[148:151], a[224:239]
 v_cvt_pk_bf16_f32 v250, v250, v251
 v_cvt_pk_bf16_f32 v251, v252, v253
 v_accvgpr_write_b32 a12, v250
 v_accvgpr_write_b32 a13, v251
 v_accvgpr_read_b32 v250, a28
 v_accvgpr_read_b32 v251, a29
 v_mfma_f32_32x32x16_bf16 a[240:255], v[220:223], v[156:159], a[240:255]
 v_accvgpr_read_b32 v252, a30
 v_accvgpr_read_b32 v253, a31
 v_mul_f32 v250, s29, v250
 v_mul_f32 v251, s29, v251
 v_mul_f32 v252, s29, v252
 v_mul_f32 v253, s29, v253
 v_cvt_pk_bf16_f32 v250, v250, v251
 v_cvt_pk_bf16_f32 v251, v252, v253
 v_accvgpr_write_b32 a14, v250
 v_accvgpr_write_b32 a15, v251
 v_add_f32 v254, v240, v241
 v_cmp_nge_f32 vcc, s30, v254
 s_cbranch_vccnz LR0_4
BR0_4:
 s_waitcnt vmcnt(22)
 s_barrier
 s_waitcnt lgkmcnt(1)
 v_mfma_f32_32x32x16_bf16 v[64:79], v[224:227], v[0:3], v[160:175]
 ds_read_b128 v[220:223], v196 offset:49152
 s_add_u32 m0, s28, 90112
 s_nop 0
 buffer_load_dwordx4 v210, s[12:15], s34 offen nt lds
 v_add_f32 v216, v240, v216
 v_add_f32 v217, v241, v217
 v_mfma_f32_32x32x16_bf16 v[80:95], v[224:227], v[32:35], v[176:191]
 ds_read_b128 v[224:227], v197 offset:49152
 v_exp_f32 v242, v96
 v_exp_f32 v243, v97
 v_accvgpr_read_b32 v250, a32
 v_mfma_f32_32x32x16_bf16 v[64:79], v[228:231], v[4:7], v[64:79]
 v_add_f32 v240, v242, v243
 v_cvt_pk_bf16_f32 v144, v242, v243
 buffer_load_dwordx4 v210, s[12:15], s34 offen offset:1024 nt lds
 s_add_u32 m0, s28, 40960
 s_mov_b32 s34, 98304
 v_mfma_f32_32x32x16_bf16 v[80:95], v[228:231], v[36:39], v[80:95]
 ds_read_b128 v[228:231], v198 offset:49152
 v_exp_f32 v244, v98
 v_exp_f32 v245, v99
 v_add_f32 v240, v244, v240
 v_mfma_f32_32x32x16_bf16 v[64:79], v[232:235], v[8:11], v[64:79]
 v_add_f32 v240, v245, v240
 v_cvt_pk_bf16_f32 v145, v244, v245
 buffer_load_dwordx4 v208, s[8:11], s32 offen nt lds
 v_exp_f32 v242, v100
 v_mfma_f32_32x32x16_bf16 v[80:95], v[232:235], v[40:43], v[80:95]
 ds_read_b128 v[232:235], v199 offset:49152
 v_exp_f32 v243, v101
 v_add_f32 v240, v242, v240
 v_add_f32 v240, v243, v240
 v_cvt_pk_bf16_f32 v146, v242, v243
 s_waitcnt lgkmcnt(3)
 v_mfma_f32_32x32x16_bf16 v[64:79], v[236:239], v[12:15], v[64:79]
 v_exp_f32 v244, v102
 buffer_load_dwordx4 v209, s[8:11], s32 offen offset:1024 nt lds
 s_mov_b32 s32, 114688
 v_add_f32 v240, v244, v240
 v_mfma_f32_32x32x16_bf16 v[80:95], v[236:239], v[44:47], v[80:95]
 ds_read_b64_tr_b16 v[236:237], v200 offset:32768
 ds_read_b64_tr_b16 v[238:239], v200 offset:34816
 v_exp_f32 v245, v103
 v_exp_f32 v242, v104
 v_mfma_f32_32x32x16_bf16 v[64:79], v[220:223], v[16:19], v[64:79]
 v_add_f32 v240, v245, v240
 v_cvt_pk_bf16_f32 v147, v244, v245
 v_exp_f32 v243, v105
 v_add_f32 v240, v242, v240
 v_add_f32 v240, v243, v240
 v_mfma_f32_32x32x16_bf16 v[80:95], v[220:223], v[48:51], v[80:95]
 ds_read_b64_tr_b16 v[220:221], v201 offset:32768
 ds_read_b64_tr_b16 v[222:223], v201 offset:34816
 v_cvt_pk_bf16_f32 v148, v242, v243
 v_exp_f32 v244, v106
 v_accvgpr_read_b32 v251, a33
 s_waitcnt lgkmcnt(5)
 v_mfma_f32_32x32x16_bf16 v[64:79], v[224:227], v[20:23], v[64:79]
 v_exp_f32 v245, v107
 v_add_f32 v240, v244, v240
 v_add_f32 v240, v245, v240
 v_cvt_pk_bf16_f32 v149, v244, v245
 v_accvgpr_read_b32 v252, a34
 v_mfma_f32_32x32x16_bf16 v[80:95], v[224:227], v[52:55], v[80:95]
 ds_read_b64_tr_b16 v[224:225], v202 offset:32768
 ds_read_b64_tr_b16 v[226:227], v202 offset:34816
 v_exp_f32 v242, v108
 v_exp_f32 v243, v109
 v_mfma_f32_32x32x16_bf16 v[64:79], v[228:231], v[24:27], v[64:79]
 v_add_f32 v240, v242, v240
 v_add_f32 v240, v243, v240
 v_cvt_pk_bf16_f32 v150, v242, v243
 v_exp_f32 v244, v110
 v_accvgpr_read_b32 v253, a35
 v_mfma_f32_32x32x16_bf16 v[80:95], v[228:231], v[56:59], v[80:95]
 ds_read_b64_tr_b16 v[228:229], v203 offset:32768
 ds_read_b64_tr_b16 v[230:231], v203 offset:34816
 v_exp_f32 v245, v111
 v_add_f32 v240, v244, v240
 v_add_f32 v240, v245, v240
 s_waitcnt lgkmcnt(6)
 v_mfma_f32_32x32x16_bf16 v[64:79], v[232:235], v[28:31], v[64:79]
 v_cvt_pk_bf16_f32 v151, v244, v245
 v_exp_f32 v242, v112
 v_exp_f32 v243, v113
 v_mul_f32 v250, s29, v250
 v_mfma_f32_32x32x16_bf16 v[80:95], v[232:235], v[60:63], v[80:95]
 ds_read_b64_tr_b16 v[232:233], v200 offset:36864
 ds_read_b64_tr_b16 v[234:235], v200 offset:38912
 v_add_f32 v241, v242, v243
 v_cvt_pk_bf16_f32 v152, v242, v243
 v_exp_f32 v244, v114
 v_mfma_f32_32x32x16_bf16 a[128:143], v[236:239], v[128:131], a[128:143]
 v_exp_f32 v245, v115
 v_add_f32 v241, v244, v241
 v_add_f32 v241, v245, v241
 v_cvt_pk_bf16_f32 v153, v244, v245
 v_mul_f32 v251, s29, v251
 v_mfma_f32_32x32x16_bf16 a[144:159], v[236:239], v[136:139], a[144:159]
 ds_read_b64_tr_b16 v[236:237], v201 offset:36864
 ds_read_b64_tr_b16 v[238:239], v201 offset:38912
 v_exp_f32 v242, v116
 v_exp_f32 v243, v117
 s_waitcnt lgkmcnt(6)
 v_mfma_f32_32x32x16_bf16 a[160:175], v[220:223], v[128:131], a[160:175]
 v_add_f32 v241, v242, v241
 v_add_f32 v241, v243, v241
 v_cvt_pk_bf16_f32 v154, v242, v243
 v_exp_f32 v244, v118
 v_mul_f32 v252, s29, v252
 v_mfma_f32_32x32x16_bf16 a[176:191], v[220:223], v[136:139], a[176:191]
 ds_read_b64_tr_b16 v[220:221], v202 offset:36864
 ds_read_b64_tr_b16 v[222:223], v202 offset:38912
 v_exp_f32 v245, v119
 v_add_f32 v241, v244, v241
 v_add_f32 v241, v245, v241
 v_mfma_f32_32x32x16_bf16 a[192:207], v[224:227], v[128:131], a[192:207]
 v_cvt_pk_bf16_f32 v155, v244, v245
 v_exp_f32 v242, v120
 v_exp_f32 v243, v121
 v_add_f32 v241, v242, v241
 v_mfma_f32_32x32x16_bf16 a[208:223], v[224:227], v[136:139], a[208:223]
 ds_read_b64_tr_b16 v[224:225], v203 offset:36864
 ds_read_b64_tr_b16 v[226:227], v203 offset:38912
 v_add_f32 v241, v243, v241
 v_cvt_pk_bf16_f32 v156, v242, v243
 v_exp_f32 v244, v122
 s_waitcnt lgkmcnt(6)
 v_mfma_f32_32x32x16_bf16 a[224:239], v[228:231], v[128:131], a[224:239]
 v_exp_f32 v245, v123
 v_add_f32 v241, v244, v241
 v_add_f32 v241, v245, v241
 v_cvt_pk_bf16_f32 v157, v244, v245
 v_mul_f32 v253, s29, v253
 v_mfma_f32_32x32x16_bf16 a[240:255], v[228:231], v[136:139], a[240:255]
 ds_read_b128 v[228:231], v192 offset:57344
 v_exp_f32 v242, v124
 v_exp_f32 v243, v125
 v_add_f32 v241, v242, v241
 v_mfma_f32_32x32x16_bf16 a[128:143], v[232:235], v[132:135], a[128:143]
 v_add_f32 v241, v243, v241
 v_cvt_pk_bf16_f32 v158, v242, v243
 v_exp_f32 v244, v126
 v_exp_f32 v245, v127
 v_mfma_f32_32x32x16_bf16 a[144:159], v[232:235], v[140:143], a[144:159]
 ds_read_b128 v[232:235], v193 offset:57344
 v_add_f32 v241, v244, v241
 v_add_f32 v241, v245, v241
 v_cvt_pk_bf16_f32 v159, v244, v245
 v_cvt_pk_bf16_f32 v250, v250, v251
 v_cvt_pk_bf16_f32 v251, v252, v253
 s_waitcnt lgkmcnt(4)
 v_mfma_f32_32x32x16_bf16 a[160:175], v[236:239], v[132:135], a[160:175]
 v_accvgpr_write_b32 a16, v250
 v_accvgpr_write_b32 a17, v251
 v_accvgpr_read_b32 v250, a36
 v_accvgpr_read_b32 v251, a37
 v_accvgpr_read_b32 v252, a38
 v_accvgpr_read_b32 v253, a39
 v_mfma_f32_32x32x16_bf16 a[176:191], v[236:239], v[140:143], a[176:191]
 ds_read_b128 v[236:239], v194 offset:57344
 v_mul_f32 v250, s29, v250
 v_mul_f32 v251, s29, v251
 v_mul_f32 v252, s29, v252
 v_mul_f32 v253, s29, v253
 v_cvt_pk_bf16_f32 v250, v250, v251
 v_mfma_f32_32x32x16_bf16 a[192:207], v[220:223], v[132:135], a[192:207]
 v_cvt_pk_bf16_f32 v251, v252, v253
 v_accvgpr_write_b32 a18, v250
 v_accvgpr_write_b32 a19, v251
 v_accvgpr_read_b32 v250, a40
 v_accvgpr_read_b32 v251, a41
 v_accvgpr_read_b32 v252, a42
 v_mfma_f32_32x32x16_bf16 a[208:223], v[220:223], v[140:143], a[208:223]
 ds_read_b128 v[220:223], v195 offset:57344
 v_accvgpr_read_b32 v253, a43
 v_mul_f32 v250, s29, v250
 v_mul_f32 v251, s29, v251
 v_mul_f32 v252, s29, v252
 v_mul_f32 v253, s29, v253
 s_waitcnt lgkmcnt(3)
 v_mfma_f32_32x32x16_bf16 a[224:239], v[224:227], v[132:135], a[224:239]
 v_cvt_pk_bf16_f32 v250, v250, v251
 v_cvt_pk_bf16_f32 v251, v252, v253
 v_accvgpr_write_b32 a20, v250
 v_accvgpr_write_b32 a21, v251
 v_accvgpr_read_b32 v250, a44
 v_accvgpr_read_b32 v251, a45
 v_mfma_f32_32x32x16_bf16 a[240:255], v[224:227], v[140:143], a[240:255]
 v_accvgpr_read_b32 v252, a46
 v_accvgpr_read_b32 v253, a47
 v_mul_f32 v250, s29, v250
 v_mul_f32 v251, s29, v251
 v_mul_f32 v252, s29, v252
 v_mul_f32 v253, s29, v253
 v_cvt_pk_bf16_f32 v250, v250, v251
 v_cvt_pk_bf16_f32 v251, v252, v253
 v_accvgpr_write_b32 a22, v250
 v_accvgpr_write_b32 a23, v251
 v_add_f32 v254, v240, v241
 v_cmp_nge_f32 vcc, s30, v254
 s_cbranch_vccnz LR0_5
BR0_5:
 s_waitcnt vmcnt(18)
 s_barrier
 v_mfma_f32_32x32x16_bf16 v[96:111], v[228:231], v[0:3], v[160:175]
 ds_read_b128 v[224:227], v196 offset:57344
 s_add_u32 m0, s28, 98304
 s_nop 0
 buffer_load_dwordx4 v210, s[12:15], s34 offen nt lds
 v_add_f32 v216, v240, v216
 v_add_f32 v217, v241, v217
 v_mfma_f32_32x32x16_bf16 v[112:127], v[228:231], v[32:35], v[176:191]
 ds_read_b128 v[228:231], v197 offset:57344
 v_exp_f32 v242, v64
 v_exp_f32 v243, v65
 v_accvgpr_read_b32 v250, a48
 s_waitcnt lgkmcnt(2)
 v_mfma_f32_32x32x16_bf16 v[96:111], v[232:235], v[4:7], v[96:111]
 v_add_f32 v240, v242, v243
 v_cvt_pk_bf16_f32 v128, v242, v243
 buffer_load_dwordx4 v210, s[12:15], s34 offen offset:1024 nt lds
 s_add_u32 m0, s28, 49152
 s_mov_b32 s34, 106496
 v_mfma_f32_32x32x16_bf16 v[112:127], v[232:235], v[36:39], v[112:127]
 ds_read_b128 v[232:235], v198 offset:57344
 v_exp_f32 v244, v66
 v_exp_f32 v245, v67
 v_add_f32 v240, v244, v240
 v_mfma_f32_32x32x16_bf16 v[96:111], v[236:239], v[8:11], v[96:111]
 v_add_f32 v240, v245, v240
 v_cvt_pk_bf16_f32 v129, v244, v245
 buffer_load_dwordx4 v208, s[8:11], s32 offen nt lds
 v_exp_f32 v242, v68
 v_mfma_f32_32x32x16_bf16 v[112:127], v[236:239], v[40:43], v[112:127]
 ds_read_b128 v[236:239], v199 offset:57344
 v_exp_f32 v243, v69
 v_add_f32 v240, v242, v240
 v_add_f32 v240, v243, v240
 v_cvt_pk_bf16_f32 v130, v242, v243
 v_mfma_f32_32x32x16_bf16 v[96:111], v[220:223], v[12:15], v[96:111]
 v_exp_f32 v244, v70
 buffer_load_dwordx4 v209, s[8:11], s32 offen offset:1024 nt lds
 s_mov_b32 s32, 122880
 v_add_f32 v240, v244, v240
 v_mfma_f32_32x32x16_bf16 v[112:127], v[220:223], v[44:47], v[112:127]
 ds_read_b64_tr_b16 v[220:221], v200 offset:40960
 ds_read_b64_tr_b16 v[222:223], v200 offset:43008
 v_exp_f32 v245, v71
 v_exp_f32 v242, v72
 s_waitcnt lgkmcnt(4)
 v_mfma_f32_32x32x16_bf16 v[96:111], v[224:227], v[16:19], v[96:111]
 v_add_f32 v240, v245, v240
 v_cvt_pk_bf16_f32 v131, v244, v245
 v_exp_f32 v243, v73
 v_add_f32 v240, v242, v240
 v_add_f32 v240, v243, v240
 v_mfma_f32_32x32x16_bf16 v[112:127], v[224:227], v[48:51], v[112:127]
 ds_read_b64_tr_b16 v[224:225], v201 offset:40960
 ds_read_b64_tr_b16 v[226:227], v201 offset:43008
 v_cvt_pk_bf16_f32 v132, v242, v243
 v_exp_f32 v244, v74
 v_accvgpr_read_b32 v251, a49
 v_mfma_f32_32x32x16_bf16 v[96:111], v[228:231], v[20:23], v[96:111]
 v_exp_f32 v245, v75
 v_add_f32 v240, v244, v240
 v_add_f32 v240, v245, v240
 v_cvt_pk_bf16_f32 v133, v244, v245
 v_accvgpr_read_b32 v252, a50
 v_mfma_f32_32x32x16_bf16 v[112:127], v[228:231], v[52:55], v[112:127]
 ds_read_b64_tr_b16 v[228:229], v202 offset:40960
 ds_read_b64_tr_b16 v[230:231], v202 offset:43008
 v_exp_f32 v242, v76
 v_exp_f32 v243, v77
 s_waitcnt lgkmcnt(6)
 v_mfma_f32_32x32x16_bf16 v[96:111], v[232:235], v[24:27], v[96:111]
 v_add_f32 v240, v242, v240
 v_add_f32 v240, v243, v240
 v_cvt_pk_bf16_f32 v134, v242, v243
 v_exp_f32 v244, v78
 v_accvgpr_read_b32 v253, a51
 v_mfma_f32_32x32x16_bf16 v[112:127], v[232:235], v[56:59], v[112:127]
 ds_read_b64_tr_b16 v[232:233], v203 offset:40960
 ds_read_b64_tr_b16 v[234:235], v203 offset:43008
 v_exp_f32 v245, v79
 v_add_f32 v240, v244, v240
 v_add_f32 v240, v245, v240
 v_mfma_f32_32x32x16_bf16 v[96:111], v[236:239], v[28:31], v[96:111]
 v_cvt_pk_bf16_f32 v135, v244, v245
 v_exp_f32 v242, v80
 v_exp_f32 v243, v81
 v_mul_f32 v250, s29, v250
 v_mfma_f32_32x32x16_bf16 v[112:127], v[236:239], v[60:63], v[112:127]
 ds_read_b64_tr_b16 v[236:237], v200 offset:45056
 ds_read_b64_tr_b16 v[238:239], v200 offset:47104
 v_add_f32 v241, v242, v243
 v_cvt_pk_bf16_f32 v136, v242, v243
 v_exp_f32 v244, v82
 s_waitcnt lgkmcnt(6)
 v_mfma_f32_32x32x16_bf16 a[128:143], v[220:223], v[144:147], a[128:143]
 v_exp_f32 v245, v83
 v_add_f32 v241, v244, v241
 v_add_f32 v241, v245, v241
 v_cvt_pk_bf16_f32 v137, v244, v245
 v_mul_f32 v251, s29, v251
 v_mfma_f32_32x32x16_bf16 a[144:159], v[220:223], v[152:155], a[144:159]
 ds_read_b64_tr_b16 v[220:221], v201 offset:45056
 ds_read_b64_tr_b16 v[222:223], v201 offset:47104
 v_exp_f32 v242, v84
 v_exp_f32 v243, v85
 v_mfma_f32_32x32x16_bf16 a[160:175], v[224:227], v[144:147], a[160:175]
 v_add_f32 v241, v242, v241
 v_add_f32 v241, v243, v241
 v_cvt_pk_bf16_f32 v138, v242, v243
 v_exp_f32 v244, v86
 v_mul_f32 v252, s29, v252
 v_mfma_f32_32x32x16_bf16 a[176:191], v[224:227], v[152:155], a[176:191]
 ds_read_b64_tr_b16 v[224:225], v202 offset:45056
 ds_read_b64_tr_b16 v[226:227], v202 offset:47104
 v_exp_f32 v245, v87
 v_add_f32 v241, v244, v241
 v_add_f32 v241, v245, v241
 s_waitcnt lgkmcnt(6)
 v_mfma_f32_32x32x16_bf16 a[192:207], v[228:231], v[144:147], a[192:207]
 v_cvt_pk_bf16_f32 v139, v244, v245
 v_exp_f32 v242, v88
 v_exp_f32 v243, v89
 v_add_f32 v241, v242, v241
 v_mfma_f32_32x32x16_bf16 a[208:223], v[228:231], v[152:155], a[208:223]
 ds_read_b64_tr_b16 v[228:229], v203 offset:45056
 ds_read_b64_tr_b16 v[230:231], v203 offset:47104
 v_add_f32 v241, v243, v241
 v_cvt_pk_bf16_f32 v140, v242, v243
 v_exp_f32 v244, v90
 v_mfma_f32_32x32x16_bf16 a[224:239], v[232:235], v[144:147], a[224:239]
 v_exp_f32 v245, v91
 v_add_f32 v241, v244, v241
 v_add_f32 v241, v245, v241
 v_cvt_pk_bf16_f32 v141, v244, v245
 v_mul_f32 v253, s29, v253
 v_mfma_f32_32x32x16_bf16 a[240:255], v[232:235], v[152:155], a[240:255]
 ds_read_b128 v[232:235], v192 offset:0
 v_exp_f32 v242, v92
 v_exp_f32 v243, v93
 v_add_f32 v241, v242, v241
 s_waitcnt lgkmcnt(5)
 v_mfma_f32_32x32x16_bf16 a[128:143], v[236:239], v[148:151], a[128:143]
 v_add_f32 v241, v243, v241
 v_cvt_pk_bf16_f32 v142, v242, v243
 v_exp_f32 v244, v94
 v_exp_f32 v245, v95
 v_mfma_f32_32x32x16_bf16 a[144:159], v[236:239], v[156:159], a[144:159]
 ds_read_b128 v[236:239], v193 offset:0
 v_add_f32 v241, v244, v241
 v_add_f32 v241, v245, v241
 v_cvt_pk_bf16_f32 v143, v244, v245
 v_cvt_pk_bf16_f32 v250, v250, v251
 v_cvt_pk_bf16_f32 v251, v252, v253
 v_mfma_f32_32x32x16_bf16 a[160:175], v[220:223], v[148:151], a[160:175]
 v_accvgpr_write_b32 a24, v250
 v_accvgpr_write_b32 a25, v251
 v_accvgpr_read_b32 v250, a52
 v_accvgpr_read_b32 v251, a53
 v_accvgpr_read_b32 v252, a54
 v_accvgpr_read_b32 v253, a55
 v_mfma_f32_32x32x16_bf16 a[176:191], v[220:223], v[156:159], a[176:191]
 ds_read_b128 v[220:223], v194 offset:0
 v_mul_f32 v250, s29, v250
 v_mul_f32 v251, s29, v251
 v_mul_f32 v252, s29, v252
 v_mul_f32 v253, s29, v253
 v_cvt_pk_bf16_f32 v250, v250, v251
 s_waitcnt lgkmcnt(3)
 v_mfma_f32_32x32x16_bf16 a[192:207], v[224:227], v[148:151], a[192:207]
 v_cvt_pk_bf16_f32 v251, v252, v253
 v_accvgpr_write_b32 a26, v250
 v_accvgpr_write_b32 a27, v251
 v_accvgpr_read_b32 v250, a56
 v_accvgpr_read_b32 v251, a57
 v_accvgpr_read_b32 v252, a58
 v_mfma_f32_32x32x16_bf16 a[208:223], v[224:227], v[156:159], a[208:223]
 ds_read_b128 v[224:227], v195 offset:0
 v_accvgpr_read_b32 v253, a59
 v_mul_f32 v250, s29, v250
 v_mul_f32 v251, s29, v251
 v_mul_f32 v252, s29, v252
 v_mul_f32 v253, s29, v253
 v_mfma_f32_32x32x16_bf16 a[224:239], v[228:231], v[148:151], a[224:239]
 v_cvt_pk_bf16_f32 v250, v250, v251
 v_cvt_pk_bf16_f32 v251, v252, v253
 v_accvgpr_write_b32 a28, v250
 v_accvgpr_write_b32 a29, v251
 v_accvgpr_read_b32 v250, a60
 v_accvgpr_read_b32 v251, a61
 v_mfma_f32_32x32x16_bf16 a[240:255], v[228:231], v[156:159], a[240:255]
 v_accvgpr_read_b32 v252, a62
 v_accvgpr_read_b32 v253, a63
 v_mul_f32 v250, s29, v250
 v_mul_f32 v251, s29, v251
 v_mul_f32 v252, s29, v252
 v_mul_f32 v253, s29, v253
 v_cvt_pk_bf16_f32 v250, v250, v251
 v_cvt_pk_bf16_f32 v251, v252, v253
 v_accvgpr_write_b32 a30, v250
 v_accvgpr_write_b32 a31, v251
 v_add_f32 v254, v240, v241
 v_cmp_nge_f32 vcc, s30, v254
 s_cbranch_vccnz LR0_6
BR0_6:
 s_waitcnt vmcnt(20)
 s_barrier
 s_waitcnt lgkmcnt(1)
 v_mfma_f32_32x32x16_bf16 v[64:79], v[232:235], v[0:3], v[160:175]
 ds_read_b128 v[228:231], v196 offset:0
 s_add_u32 m0, s28, 106496
 s_nop 0
 buffer_load_dwordx4 v210, s[12:15], s34 offen nt lds
 v_add_f32 v216, v240, v216
 v_add_f32 v217, v241, v217
 v_mfma_f32_32x32x16_bf16 v[80:95], v[232:235], v[32:35], v[176:191]
 ds_read_b128 v[232:235], v197 offset:0
 v_exp_f32 v242, v96
 v_exp_f32 v243, v97
 v_accvgpr_read_b32 v250, a64
 v_mfma_f32_32x32x16_bf16 v[64:79], v[236:239], v[4:7], v[64:79]
 v_add_f32 v240, v242, v243
 v_cvt_pk_bf16_f32 v144, v242, v243
 buffer_load_dwordx4 v210, s[12:15], s34 offen offset:1024 nt lds
 s_add_u32 m0, s28, 57344
 s_mov_b32 s34, 114688
 v_mfma_f32_32x32x16_bf16 v[80:95], v[236:239], v[36:39], v[80:95]
 ds_read_b128 v[236:239], v198 offset:0
 v_exp_f32 v244, v98
 v_exp_f32 v245, v99
 v_add_f32 v240, v244, v240
 v_mfma_f32_32x32x16_bf16 v[64:79], v[220:223], v[8:11], v[64:79]
 v_add_f32 v240, v245, v240
 v_cvt_pk_bf16_f32 v145, v244, v245
 buffer_load_dwordx4 v208, s[8:11], s32 offen nt lds
 v_exp_f32 v242, v100
 v_mfma_f32_32x32x16_bf16 v[80:95], v[220:223], v[40:43], v[80:95]
 ds_read_b128 v[220:223], v199 offset:0
 v_exp_f32 v243, v101
 v_add_f32 v240, v242, v240
 v_add_f32 v240, v243, v240
 v_cvt_pk_bf16_f32 v146, v242, v243
 s_waitcnt lgkmcnt(3)
 v_mfma_f32_32x32x16_bf16 v[64:79], v[224:227], v[12:15], v[64:79]
 v_exp_f32 v244, v102
 buffer_load_dwordx4 v209, s[8:11], s32 offen offset:1024 nt lds
 s_mov_b32 s32, 131072
 v_add_f32 v240, v244, v240
 v_mfma_f32_32x32x16_bf16 v[80:95], v[224:227], v[44:47], v[80:95]
 ds_read_b64_tr_b16 v[224:225], v200 offset:49152
 ds_read_b64_tr_b16 v[226:227], v200 offset:51200
 v_exp_f32 v245, v103
 v_exp_f32 v242, v104
 v_mfma_f32_32x32x16_bf16 v[64:79], v[228:231], v[16:19], v[64:79]
 v_add_f32 v240, v245, v240
 v_cvt_pk_bf16_f32 v147, v244, v245
 v_exp_f32 v243, v105
 v_add_f32 v240, v242, v240
 v_add_f32 v240, v243, v240
 v_mfma_f32_32x32x16_bf16 v[80:95], v[228:231], v[48:51], v[80:95]
 ds_read_b64_tr_b16 v[228:229], v201 offset:49152
 ds_read_b64_tr_b16 v[230:231], v201 offset:51200
 v_cvt_pk_bf16_f32 v148, v242, v243
 v_exp_f32 v244, v106
 v_accvgpr_read_b32 v251, a65
 s_waitcnt lgkmcnt(5)
 v_mfma_f32_32x32x16_bf16 v[64:79], v[232:235], v[20:23], v[64:79]
 v_exp_f32 v245, v107
 v_add_f32 v240, v244, v240
 v_add_f32 v240, v245, v240
 v_cvt_pk_bf16_f32 v149, v244, v245
 v_accvgpr_read_b32 v252, a66
 v_mfma_f32_32x32x16_bf16 v[80:95], v[232:235], v[52:55], v[80:95]
 ds_read_b64_tr_b16 v[232:233], v202 offset:49152
 ds_read_b64_tr_b16 v[234:235], v202 offset:51200
 v_exp_f32 v242, v108
 v_exp_f32 v243, v109
 v_mfma_f32_32x32x16_bf16 v[64:79], v[236:239], v[24:27], v[64:79]
 v_add_f32 v240, v242, v240
 v_add_f32 v240, v243, v240
 v_cvt_pk_bf16_f32 v150, v242, v243
 v_exp_f32 v244, v110
 v_accvgpr_read_b32 v253, a67
 v_mfma_f32_32x32x16_bf16 v[80:95], v[236:239], v[56:59], v[80:95]
 ds_read_b64_tr_b16 v[236:237], v203 offset:49152
 ds_read_b64_tr_b16 v[238:239], v203 offset:51200
 v_exp_f32 v245, v111
 v_add_f32 v240, v244, v240
 v_add_f32 v240, v245, v240
 s_waitcnt lgkmcnt(6)
 v_mfma_f32_32x32x16_bf16 v[64:79], v[220:223], v[28:31], v[64:79]
 v_cvt_pk_bf16_f32 v151, v244, v245
 v_exp_f32 v242, v112
 v_exp_f32 v243, v113
 v_mul_f32 v250, s29, v250
 v_mfma_f32_32x32x16_bf16 v[80:95], v[220:223], v[60:63], v[80:95]
 ds_read_b64_tr_b16 v[220:221], v200 offset:53248
 ds_read_b64_tr_b16 v[222:223], v200 offset:55296
 v_add_f32 v241, v242, v243
 v_cvt_pk_bf16_f32 v152, v242, v243
 v_exp_f32 v244, v114
 v_mfma_f32_32x32x16_bf16 a[128:143], v[224:227], v[128:131], a[128:143]
 v_exp_f32 v245, v115
 v_add_f32 v241, v244, v241
 v_add_f32 v241, v245, v241
 v_cvt_pk_bf16_f32 v153, v244, v245
 v_mul_f32 v251, s29, v251
 v_mfma_f32_32x32x16_bf16 a[144:159], v[224:227], v[136:139], a[144:159]
 ds_read_b64_tr_b16 v[224:225], v201 offset:53248
 ds_read_b64_tr_b16 v[226:227], v201 offset:55296
 v_exp_f32 v242, v116
 v_exp_f32 v243, v117
 s_waitcnt lgkmcnt(6)
 v_mfma_f32_32x32x16_bf16 a[160:175], v[228:231], v[128:131], a[160:175]
 v_add_f32 v241, v242, v241
 v_add_f32 v241, v243, v241
 v_cvt_pk_bf16_f32 v154, v242, v243
 v_exp_f32 v244, v118
 v_mul_f32 v252, s29, v252
 v_mfma_f32_32x32x16_bf16 a[176:191], v[228:231], v[136:139], a[176:191]
 ds_read_b64_tr_b16 v[228:229], v202 offset:53248
 ds_read_b64_tr_b16 v[230:231], v202 offset:55296
 v_exp_f32 v245, v119
 v_add_f32 v241, v244, v241
 v_add_f32 v241, v245, v241
 v_mfma_f32_32x32x16_bf16 a[192:207], v[232:235], v[128:131], a[192:207]
 v_cvt_pk_bf16_f32 v155, v244, v245
 v_exp_f32 v242, v120
 v_exp_f32 v243, v121
 v_add_f32 v241, v242, v241
 v_mfma_f32_32x32x16_bf16 a[208:223], v[232:235], v[136:139], a[208:223]
 ds_read_b64_tr_b16 v[232:233], v203 offset:53248
 ds_read_b64_tr_b16 v[234:235], v203 offset:55296
 v_add_f32 v241, v243, v241
 v_cvt_pk_bf16_f32 v156, v242, v243
 v_exp_f32 v244, v122
 s_waitcnt lgkmcnt(6)
 v_mfma_f32_32x32x16_bf16 a[224:239], v[236:239], v[128:131], a[224:239]
 v_exp_f32 v245, v123
 v_add_f32 v241, v244, v241
 v_add_f32 v241, v245, v241
 v_cvt_pk_bf16_f32 v157, v244, v245
 v_mul_f32 v253, s29, v253
 v_mfma_f32_32x32x16_bf16 a[240:255], v[236:239], v[136:139], a[240:255]
 ds_read_b128 v[236:239], v192 offset:8192
 v_exp_f32 v242, v124
 v_exp_f32 v243, v125
 v_add_f32 v241, v242, v241
 v_mfma_f32_32x32x16_bf16 a[128:143], v[220:223], v[132:135], a[128:143]
 v_add_f32 v241, v243, v241
 v_cvt_pk_bf16_f32 v158, v242, v243
 v_exp_f32 v244, v126
 v_exp_f32 v245, v127
 v_mfma_f32_32x32x16_bf16 a[144:159], v[220:223], v[140:143], a[144:159]
 ds_read_b128 v[220:223], v193 offset:8192
 v_add_f32 v241, v244, v241
 v_add_f32 v241, v245, v241
 v_cvt_pk_bf16_f32 v159, v244, v245
 v_cvt_pk_bf16_f32 v250, v250, v251
 v_cvt_pk_bf16_f32 v251, v252, v253
 s_waitcnt lgkmcnt(4)
 v_mfma_f32_32x32x16_bf16 a[160:175], v[224:227], v[132:135], a[160:175]
 v_accvgpr_write_b32 a32, v250
 v_accvgpr_write_b32 a33, v251
 v_accvgpr_read_b32 v250, a68
 v_accvgpr_read_b32 v251, a69
 v_accvgpr_read_b32 v252, a70
 v_accvgpr_read_b32 v253, a71
 v_mfma_f32_32x32x16_bf16 a[176:191], v[224:227], v[140:143], a[176:191]
 ds_read_b128 v[224:227], v194 offset:8192
 v_mul_f32 v250, s29, v250
 v_mul_f32 v251, s29, v251
 v_mul_f32 v252, s29, v252
 v_mul_f32 v253, s29, v253
 v_cvt_pk_bf16_f32 v250, v250, v251
 v_mfma_f32_32x32x16_bf16 a[192:207], v[228:231], v[132:135], a[192:207]
 v_cvt_pk_bf16_f32 v251, v252, v253
 v_accvgpr_write_b32 a34, v250
 v_accvgpr_write_b32 a35, v251
 v_accvgpr_read_b32 v250, a72
 v_accvgpr_read_b32 v251, a73
 v_accvgpr_read_b32 v252, a74
 v_mfma_f32_32x32x16_bf16 a[208:223], v[228:231], v[140:143], a[208:223]
 ds_read_b128 v[228:231], v195 offset:8192
 v_accvgpr_read_b32 v253, a75
 v_mul_f32 v250, s29, v250
 v_mul_f32 v251, s29, v251
 v_mul_f32 v252, s29, v252
 v_mul_f32 v253, s29, v253
 s_waitcnt lgkmcnt(3)
 v_mfma_f32_32x32x16_bf16 a[224:239], v[232:235], v[132:135], a[224:239]
 v_cvt_pk_bf16_f32 v250, v250, v251
 v_cvt_pk_bf16_f32 v251, v252, v253
 v_accvgpr_write_b32 a36, v250
 v_accvgpr_write_b32 a37, v251
 v_accvgpr_read_b32 v250, a76
 v_accvgpr_read_b32 v251, a77
 v_mfma_f32_32x32x16_bf16 a[240:255], v[232:235], v[140:143], a[240:255]
 v_accvgpr_read_b32 v252, a78
 v_accvgpr_read_b32 v253, a79
 v_mul_f32 v250, s29, v250
 v_mul_f32 v251, s29, v251
 v_mul_f32 v252, s29, v252
 v_mul_f32 v253, s29, v253
 v_cvt_pk_bf16_f32 v250, v250, v251
 v_cvt_pk_bf16_f32 v251, v252, v253
 v_accvgpr_write_b32 a38, v250
 v_accvgpr_write_b32 a39, v251
 v_add_f32 v254, v240, v241
 v_cmp_nge_f32 vcc, s30, v254
 s_cbranch_vccnz LR0_7
BR0_7:
 s_waitcnt vmcnt(20)
 s_barrier
 v_mfma_f32_32x32x16_bf16 v[96:111], v[236:239], v[0:3], v[160:175]
 ds_read_b128 v[232:235], v196 offset:8192
 s_add_u32 m0, s28, 114688
 s_nop 0
 buffer_load_dwordx4 v210, s[12:15], s34 offen nt lds
 v_add_f32 v216, v240, v216
 v_add_f32 v217, v241, v217
 v_mfma_f32_32x32x16_bf16 v[112:127], v[236:239], v[32:35], v[176:191]
 ds_read_b128 v[236:239], v197 offset:8192
 v_exp_f32 v242, v64
 v_exp_f32 v243, v65
 v_accvgpr_read_b32 v250, a80
 s_waitcnt lgkmcnt(2)
 v_mfma_f32_32x32x16_bf16 v[96:111], v[220:223], v[4:7], v[96:111]
 v_add_f32 v240, v242, v243
 v_cvt_pk_bf16_f32 v128, v242, v243
 buffer_load_dwordx4 v210, s[12:15], s34 offen offset:1024 nt lds
 s_add_u32 m0, s28, 0
 s_mov_b32 s34, 122880
 v_mfma_f32_32x32x16_bf16 v[112:127], v[220:223], v[36:39], v[112:127]
 ds_read_b128 v[220:223], v198 offset:8192
 v_exp_f32 v244, v66
 v_exp_f32 v245, v67
 v_add_f32 v240, v244, v240
 v_mfma_f32_32x32x16_bf16 v[96:111], v[224:227], v[8:11], v[96:111]
 v_add_f32 v240, v245, v240
 v_cvt_pk_bf16_f32 v129, v244, v245
 buffer_load_dwordx4 v208, s[8:11], s32 offen nt lds
 v_exp_f32 v242, v68
 v_mfma_f32_32x32x16_bf16 v[112:127], v[224:227], v[40:43], v[112:127]
 ds_read_b128 v[224:227], v199 offset:8192
 v_exp_f32 v243, v69
 v_add_f32 v240, v242, v240
 v_add_f32 v240, v243, v240
 v_cvt_pk_bf16_f32 v130, v242, v243
 v_mfma_f32_32x32x16_bf16 v[96:111], v[228:231], v[12:15], v[96:111]
 v_exp_f32 v244, v70
 buffer_load_dwordx4 v209, s[8:11], s32 offen offset:1024 nt lds
 s_mov_b32 s32, 139264
 v_add_f32 v240, v244, v240
 v_mfma_f32_32x32x16_bf16 v[112:127], v[228:231], v[44:47], v[112:127]
 ds_read_b64_tr_b16 v[228:229], v200 offset:57344
 ds_read_b64_tr_b16 v[230:231], v200 offset:59392
 v_exp_f32 v245, v71
 v_exp_f32 v242, v72
 s_waitcnt lgkmcnt(4)
 v_mfma_f32_32x32x16_bf16 v[96:111], v[232:235], v[16:19], v[96:111]
 v_add_f32 v240, v245, v240
 v_cvt_pk_bf16_f32 v131, v244, v245
 v_exp_f32 v243, v73
 v_add_f32 v240, v242, v240
 v_add_f32 v240, v243, v240
 v_mfma_f32_32x32x16_bf16 v[112:127], v[232:235], v[48:51], v[112:127]
 ds_read_b64_tr_b16 v[232:233], v201 offset:57344
 ds_read_b64_tr_b16 v[234:235], v201 offset:59392
 v_cvt_pk_bf16_f32 v132, v242, v243
 v_exp_f32 v244, v74
 v_accvgpr_read_b32 v251, a81
 v_mfma_f32_32x32x16_bf16 v[96:111], v[236:239], v[20:23], v[96:111]
 v_exp_f32 v245, v75
 v_add_f32 v240, v244, v240
 v_add_f32 v240, v245, v240
 v_cvt_pk_bf16_f32 v133, v244, v245
 v_accvgpr_read_b32 v252, a82
 v_mfma_f32_32x32x16_bf16 v[112:127], v[236:239], v[52:55], v[112:127]
 ds_read_b64_tr_b16 v[236:237], v202 offset:57344
 ds_read_b64_tr_b16 v[238:239], v202 offset:59392
 v_exp_f32 v242, v76
 v_exp_f32 v243, v77
 s_waitcnt lgkmcnt(6)
 v_mfma_f32_32x32x16_bf16 v[96:111], v[220:223], v[24:27], v[96:111]
 v_add_f32 v240, v242, v240
 v_add_f32 v240, v243, v240
 v_cvt_pk_bf16_f32 v134, v242, v243
 v_exp_f32 v244, v78
 v_accvgpr_read_b32 v253, a83
 v_mfma_f32_32x32x16_bf16 v[112:127], v[220:223], v[56:59], v[112:127]
 ds_read_b64_tr_b16 v[220:221], v203 offset:57344
 ds_read_b64_tr_b16 v[222:223], v203 offset:59392
 v_exp_f32 v245, v79
 v_add_f32 v240, v244, v240
 v_add_f32 v240, v245, v240
 v_mfma_f32_32x32x16_bf16 v[96:111], v[224:227], v[28:31], v[96:111]
 v_cvt_pk_bf16_f32 v135, v244, v245
 v_exp_f32 v242, v80
 v_exp_f32 v243, v81
 v_mul_f32 v250, s29, v250
 v_mfma_f32_32x32x16_bf16 v[112:127], v[224:227], v[60:63], v[112:127]
 ds_read_b64_tr_b16 v[224:225], v200 offset:61440
 ds_read_b64_tr_b16 v[226:227], v200 offset:63488
 v_add_f32 v241, v242, v243
 v_cvt_pk_bf16_f32 v136, v242, v243
 v_exp_f32 v244, v82
 s_waitcnt lgkmcnt(6)
 v_mfma_f32_32x32x16_bf16 a[128:143], v[228:231], v[144:147], a[128:143]
 v_exp_f32 v245, v83
 v_add_f32 v241, v244, v241
 v_add_f32 v241, v245, v241
 v_cvt_pk_bf16_f32 v137, v244, v245
 v_mul_f32 v251, s29, v251
 v_mfma_f32_32x32x16_bf16 a[144:159], v[228:231], v[152:155], a[144:159]
 ds_read_b64_tr_b16 v[228:229], v201 offset:61440
 ds_read_b64_tr_b16 v[230:231], v201 offset:63488
 v_exp_f32 v242, v84
 v_exp_f32 v243, v85
 v_mfma_f32_32x32x16_bf16 a[160:175], v[232:235], v[144:147], a[160:175]
 v_add_f32 v241, v242, v241
 v_add_f32 v241, v243, v241
 v_cvt_pk_bf16_f32 v138, v242, v243
 v_exp_f32 v244, v86
 v_mul_f32 v252, s29, v252
 v_mfma_f32_32x32x16_bf16 a[176:191], v[232:235], v[152:155], a[176:191]
 ds_read_b64_tr_b16 v[232:233], v202 offset:61440
 ds_read_b64_tr_b16 v[234:235], v202 offset:63488
 v_exp_f32 v245, v87
 v_add_f32 v241, v244, v241
 v_add_f32 v241, v245, v241
 s_waitcnt lgkmcnt(6)
 v_mfma_f32_32x32x16_bf16 a[192:207], v[236:239], v[144:147], a[192:207]
 v_cvt_pk_bf16_f32 v139, v244, v245
 v_exp_f32 v242, v88
 v_exp_f32 v243, v89
 v_add_f32 v241, v242, v241
 v_mfma_f32_32x32x16_bf16 a[208:223], v[236:239], v[152:155], a[208:223]
 ds_read_b64_tr_b16 v[236:237], v203 offset:61440
 ds_read_b64_tr_b16 v[238:239], v203 offset:63488
 v_add_f32 v241, v243, v241
 v_cvt_pk_bf16_f32 v140, v242, v243
 v_exp_f32 v244, v90
 v_mfma_f32_32x32x16_bf16 a[224:239], v[220:223], v[144:147], a[224:239]
 v_exp_f32 v245, v91
 v_add_f32 v241, v244, v241
 v_add_f32 v241, v245, v241
 v_cvt_pk_bf16_f32 v141, v244, v245
 v_mul_f32 v253, s29, v253
 v_mfma_f32_32x32x16_bf16 a[240:255], v[220:223], v[152:155], a[240:255]
 ds_read_b128 v[220:223], v192 offset:16384
 v_exp_f32 v242, v92
 v_exp_f32 v243, v93
 v_add_f32 v241, v242, v241
 s_waitcnt lgkmcnt(5)
 v_mfma_f32_32x32x16_bf16 a[128:143], v[224:227], v[148:151], a[128:143]
 v_add_f32 v241, v243, v241
 v_cvt_pk_bf16_f32 v142, v242, v243
 v_exp_f32 v244, v94
 v_exp_f32 v245, v95
 v_mfma_f32_32x32x16_bf16 a[144:159], v[224:227], v[156:159], a[144:159]
 ds_read_b128 v[224:227], v193 offset:16384
 v_add_f32 v241, v244, v241
 v_add_f32 v241, v245, v241
 v_cvt_pk_bf16_f32 v143, v244, v245
 v_cvt_pk_bf16_f32 v250, v250, v251
 v_cvt_pk_bf16_f32 v251, v252, v253
 v_mfma_f32_32x32x16_bf16 a[160:175], v[228:231], v[148:151], a[160:175]
 v_accvgpr_write_b32 a40, v250
 v_accvgpr_write_b32 a41, v251
 v_accvgpr_read_b32 v250, a84
 v_accvgpr_read_b32 v251, a85
 v_accvgpr_read_b32 v252, a86
 v_accvgpr_read_b32 v253, a87
 v_mfma_f32_32x32x16_bf16 a[176:191], v[228:231], v[156:159], a[176:191]
 ds_read_b128 v[228:231], v194 offset:16384
 v_mul_f32 v250, s29, v250
 v_mul_f32 v251, s29, v251
 v_mul_f32 v252, s29, v252
 v_mul_f32 v253, s29, v253
 v_cvt_pk_bf16_f32 v250, v250, v251
 s_waitcnt lgkmcnt(3)
 v_mfma_f32_32x32x16_bf16 a[192:207], v[232:235], v[148:151], a[192:207]
 v_cvt_pk_bf16_f32 v251, v252, v253
 v_accvgpr_write_b32 a42, v250
 v_accvgpr_write_b32 a43, v251
 v_accvgpr_read_b32 v250, a88
 v_accvgpr_read_b32 v251, a89
 v_accvgpr_read_b32 v252, a90
 v_mfma_f32_32x32x16_bf16 a[208:223], v[232:235], v[156:159], a[208:223]
 ds_read_b128 v[232:235], v195 offset:16384
 v_accvgpr_read_b32 v253, a91
 v_mul_f32 v250, s29, v250
 v_mul_f32 v251, s29, v251
 v_mul_f32 v252, s29, v252
 v_mul_f32 v253, s29, v253
 v_mfma_f32_32x32x16_bf16 a[224:239], v[236:239], v[148:151], a[224:239]
 v_cvt_pk_bf16_f32 v250, v250, v251
 v_cvt_pk_bf16_f32 v251, v252, v253
 v_accvgpr_write_b32 a44, v250
 v_accvgpr_write_b32 a45, v251
 v_accvgpr_read_b32 v250, a92
 v_accvgpr_read_b32 v251, a93
 v_mfma_f32_32x32x16_bf16 a[240:255], v[236:239], v[156:159], a[240:255]
 v_accvgpr_read_b32 v252, a94
 v_accvgpr_read_b32 v253, a95
 v_mul_f32 v250, s29, v250
 v_mul_f32 v251, s29, v251
 v_mul_f32 v252, s29, v252
 v_mul_f32 v253, s29, v253
 v_cvt_pk_bf16_f32 v250, v250, v251
 v_cvt_pk_bf16_f32 v251, v252, v253
 v_accvgpr_write_b32 a46, v250
 v_accvgpr_write_b32 a47, v251
 v_add_f32 v254, v240, v241
 v_cmp_nge_f32 vcc, s30, v254
 s_cbranch_vccnz LR0_8
BR0_8:
 s_waitcnt vmcnt(20)
 s_barrier
 s_waitcnt lgkmcnt(1)
 v_mfma_f32_32x32x16_bf16 v[64:79], v[220:223], v[0:3], v[160:175]
 ds_read_b128 v[236:239], v196 offset:16384
 s_add_u32 m0, s28, 122880
 s_nop 0
 buffer_load_dwordx4 v210, s[12:15], s34 offen nt lds
 v_add_f32 v216, v240, v216
 v_add_f32 v217, v241, v217
 v_mfma_f32_32x32x16_bf16 v[80:95], v[220:223], v[32:35], v[176:191]
 ds_read_b128 v[220:223], v197 offset:16384
 v_exp_f32 v242, v96
 v_exp_f32 v243, v97
 v_accvgpr_read_b32 v250, a96
 v_mfma_f32_32x32x16_bf16 v[64:79], v[224:227], v[4:7], v[64:79]
 v_add_f32 v240, v242, v243
 v_cvt_pk_bf16_f32 v144, v242, v243
 buffer_load_dwordx4 v210, s[12:15], s34 offen offset:1024 nt lds
 s_add_u32 m0, s28, 8192
 s_mov_b32 s34, 131072
 v_mfma_f32_32x32x16_bf16 v[80:95], v[224:227], v[36:39], v[80:95]
 ds_read_b128 v[224:227], v198 offset:16384
 v_exp_f32 v244, v98
 v_exp_f32 v245, v99
 v_add_f32 v240, v244, v240
 v_mfma_f32_32x32x16_bf16 v[64:79], v[228:231], v[8:11], v[64:79]
 v_add_f32 v240, v245, v240
 v_cvt_pk_bf16_f32 v145, v244, v245
 buffer_load_dwordx4 v208, s[8:11], s32 offen nt lds
 v_exp_f32 v242, v100
 v_mfma_f32_32x32x16_bf16 v[80:95], v[228:231], v[40:43], v[80:95]
 ds_read_b128 v[228:231], v199 offset:16384
 v_exp_f32 v243, v101
 v_add_f32 v240, v242, v240
 v_add_f32 v240, v243, v240
 v_cvt_pk_bf16_f32 v146, v242, v243
 s_waitcnt lgkmcnt(3)
 v_mfma_f32_32x32x16_bf16 v[64:79], v[232:235], v[12:15], v[64:79]
 v_exp_f32 v244, v102
 buffer_load_dwordx4 v209, s[8:11], s32 offen offset:1024 nt lds
 s_mov_b32 s32, 147456
 v_add_f32 v240, v244, v240
 v_mfma_f32_32x32x16_bf16 v[80:95], v[232:235], v[44:47], v[80:95]
 ds_read_b64_tr_b16 v[232:233], v200 offset:0
 ds_read_b64_tr_b16 v[234:235], v200 offset:2048
 v_exp_f32 v245, v103
 v_exp_f32 v242, v104
 v_mfma_f32_32x32x16_bf16 v[64:79], v[236:239], v[16:19], v[64:79]
 v_add_f32 v240, v245, v240
 v_cvt_pk_bf16_f32 v147, v244, v245
 v_exp_f32 v243, v105
 v_add_f32 v240, v242, v240
 v_add_f32 v240, v243, v240
 v_mfma_f32_32x32x16_bf16 v[80:95], v[236:239], v[48:51], v[80:95]
 ds_read_b64_tr_b16 v[236:237], v201 offset:0
 ds_read_b64_tr_b16 v[238:239], v201 offset:2048
 v_cvt_pk_bf16_f32 v148, v242, v243
 v_exp_f32 v244, v106
 v_accvgpr_read_b32 v251, a97
 s_waitcnt lgkmcnt(5)
 v_mfma_f32_32x32x16_bf16 v[64:79], v[220:223], v[20:23], v[64:79]
 v_exp_f32 v245, v107
 v_add_f32 v240, v244, v240
 v_add_f32 v240, v245, v240
 v_cvt_pk_bf16_f32 v149, v244, v245
 v_accvgpr_read_b32 v252, a98
 v_mfma_f32_32x32x16_bf16 v[80:95], v[220:223], v[52:55], v[80:95]
 ds_read_b64_tr_b16 v[220:221], v202 offset:0
 ds_read_b64_tr_b16 v[222:223], v202 offset:2048
 v_exp_f32 v242, v108
 v_exp_f32 v243, v109
 v_mfma_f32_32x32x16_bf16 v[64:79], v[224:227], v[24:27], v[64:79]
 v_add_f32 v240, v242, v240
 v_add_f32 v240, v243, v240
 v_cvt_pk_bf16_f32 v150, v242, v243
 v_exp_f32 v244, v110
 v_accvgpr_read_b32 v253, a99
 v_mfma_f32_32x32x16_bf16 v[80:95], v[224:227], v[56:59], v[80:95]
 ds_read_b64_tr_b16 v[224:225], v203 offset:0
 ds_read_b64_tr_b16 v[226:227], v203 offset:2048
 v_exp_f32 v245, v111
 v_add_f32 v240, v244, v240
 v_add_f32 v240, v245, v240
 s_waitcnt lgkmcnt(6)
 v_mfma_f32_32x32x16_bf16 v[64:79], v[228:231], v[28:31], v[64:79]
 v_cvt_pk_bf16_f32 v151, v244, v245
 v_exp_f32 v242, v112
 v_exp_f32 v243, v113
 v_mul_f32 v250, s29, v250
 v_mfma_f32_32x32x16_bf16 v[80:95], v[228:231], v[60:63], v[80:95]
 ds_read_b64_tr_b16 v[228:229], v200 offset:4096
 ds_read_b64_tr_b16 v[230:231], v200 offset:6144
 v_add_f32 v241, v242, v243
 v_cvt_pk_bf16_f32 v152, v242, v243
 v_exp_f32 v244, v114
 v_mfma_f32_32x32x16_bf16 a[128:143], v[232:235], v[128:131], a[128:143]
 v_exp_f32 v245, v115
 v_add_f32 v241, v244, v241
 v_add_f32 v241, v245, v241
 v_cvt_pk_bf16_f32 v153, v244, v245
 v_mul_f32 v251, s29, v251
 v_mfma_f32_32x32x16_bf16 a[144:159], v[232:235], v[136:139], a[144:159]
 ds_read_b64_tr_b16 v[232:233], v201 offset:4096
 ds_read_b64_tr_b16 v[234:235], v201 offset:6144
 v_exp_f32 v242, v116
 v_exp_f32 v243, v117
 s_waitcnt lgkmcnt(6)
 v_mfma_f32_32x32x16_bf16 a[160:175], v[236:239], v[128:131], a[160:175]
 v_add_f32 v241, v242, v241
 v_add_f32 v241, v243, v241
 v_cvt_pk_bf16_f32 v154, v242, v243
 v_exp_f32 v244, v118
 v_mul_f32 v252, s29, v252
 v_mfma_f32_32x32x16_bf16 a[176:191], v[236:239], v[136:139], a[176:191]
 ds_read_b64_tr_b16 v[236:237], v202 offset:4096
 ds_read_b64_tr_b16 v[238:239], v202 offset:6144
 v_exp_f32 v245, v119
 v_add_f32 v241, v244, v241
 v_add_f32 v241, v245, v241
 v_mfma_f32_32x32x16_bf16 a[192:207], v[220:223], v[128:131], a[192:207]
 v_cvt_pk_bf16_f32 v155, v244, v245
 v_exp_f32 v242, v120
 v_exp_f32 v243, v121
 v_add_f32 v241, v242, v241
 v_mfma_f32_32x32x16_bf16 a[208:223], v[220:223], v[136:139], a[208:223]
 ds_read_b64_tr_b16 v[220:221], v203 offset:4096
 ds_read_b64_tr_b16 v[222:223], v203 offset:6144
 v_add_f32 v241, v243, v241
 v_cvt_pk_bf16_f32 v156, v242, v243
 v_exp_f32 v244, v122
 s_waitcnt lgkmcnt(6)
 v_mfma_f32_32x32x16_bf16 a[224:239], v[224:227], v[128:131], a[224:239]
 v_exp_f32 v245, v123
 v_add_f32 v241, v244, v241
 v_add_f32 v241, v245, v241
 v_cvt_pk_bf16_f32 v157, v244, v245
 v_mul_f32 v253, s29, v253
 v_mfma_f32_32x32x16_bf16 a[240:255], v[224:227], v[136:139], a[240:255]
 ds_read_b128 v[224:227], v192 offset:24576
 v_exp_f32 v242, v124
 v_exp_f32 v243, v125
 v_add_f32 v241, v242, v241
 v_mfma_f32_32x32x16_bf16 a[128:143], v[228:231], v[132:135], a[128:143]
 v_add_f32 v241, v243, v241
 v_cvt_pk_bf16_f32 v158, v242, v243
 v_exp_f32 v244, v126
 v_exp_f32 v245, v127
 v_mfma_f32_32x32x16_bf16 a[144:159], v[228:231], v[140:143], a[144:159]
 ds_read_b128 v[228:231], v193 offset:24576
 v_add_f32 v241, v244, v241
 v_add_f32 v241, v245, v241
 v_cvt_pk_bf16_f32 v159, v244, v245
 v_cvt_pk_bf16_f32 v250, v250, v251
 v_cvt_pk_bf16_f32 v251, v252, v253
 s_waitcnt lgkmcnt(4)
 v_mfma_f32_32x32x16_bf16 a[160:175], v[232:235], v[132:135], a[160:175]
 v_accvgpr_write_b32 a48, v250
 v_accvgpr_write_b32 a49, v251
 v_accvgpr_read_b32 v250, a100
 v_accvgpr_read_b32 v251, a101
 v_accvgpr_read_b32 v252, a102
 v_accvgpr_read_b32 v253, a103
 v_mfma_f32_32x32x16_bf16 a[176:191], v[232:235], v[140:143], a[176:191]
 ds_read_b128 v[232:235], v194 offset:24576
 v_mul_f32 v250, s29, v250
 v_mul_f32 v251, s29, v251
 v_mul_f32 v252, s29, v252
 v_mul_f32 v253, s29, v253
 v_cvt_pk_bf16_f32 v250, v250, v251
 v_mfma_f32_32x32x16_bf16 a[192:207], v[236:239], v[132:135], a[192:207]
 v_cvt_pk_bf16_f32 v251, v252, v253
 v_accvgpr_write_b32 a50, v250
 v_accvgpr_write_b32 a51, v251
 v_accvgpr_read_b32 v250, a104
 v_accvgpr_read_b32 v251, a105
 v_accvgpr_read_b32 v252, a106
 v_mfma_f32_32x32x16_bf16 a[208:223], v[236:239], v[140:143], a[208:223]
 ds_read_b128 v[236:239], v195 offset:24576
 v_accvgpr_read_b32 v253, a107
 v_mul_f32 v250, s29, v250
 v_mul_f32 v251, s29, v251
 v_mul_f32 v252, s29, v252
 v_mul_f32 v253, s29, v253
 s_waitcnt lgkmcnt(3)
 v_mfma_f32_32x32x16_bf16 a[224:239], v[220:223], v[132:135], a[224:239]
 v_cvt_pk_bf16_f32 v250, v250, v251
 v_cvt_pk_bf16_f32 v251, v252, v253
 v_accvgpr_write_b32 a52, v250
 v_accvgpr_write_b32 a53, v251
 v_accvgpr_read_b32 v250, a108
 v_accvgpr_read_b32 v251, a109
 v_mfma_f32_32x32x16_bf16 a[240:255], v[220:223], v[140:143], a[240:255]
 v_accvgpr_read_b32 v252, a110
 v_accvgpr_read_b32 v253, a111
 v_mul_f32 v250, s29, v250
 v_mul_f32 v251, s29, v251
 v_mul_f32 v252, s29, v252
 v_mul_f32 v253, s29, v253
 v_cvt_pk_bf16_f32 v250, v250, v251
 v_cvt_pk_bf16_f32 v251, v252, v253
 v_accvgpr_write_b32 a54, v250
 v_accvgpr_write_b32 a55, v251
 v_add_f32 v254, v240, v241
 v_cmp_nge_f32 vcc, s30, v254
 s_cbranch_vccnz LR0_9
BR0_9:
 s_waitcnt vmcnt(20)
 s_barrier
 v_mfma_f32_32x32x16_bf16 v[96:111], v[224:227], v[0:3], v[160:175]
 ds_read_b128 v[220:223], v196 offset:24576
 s_add_u32 m0, s28, 65536
 s_nop 0
 buffer_load_dwordx4 v210, s[12:15], s34 offen nt lds
 v_add_f32 v216, v240, v216
 v_add_f32 v217, v241, v217
 v_mfma_f32_32x32x16_bf16 v[112:127], v[224:227], v[32:35], v[176:191]
 ds_read_b128 v[224:227], v197 offset:24576
 v_exp_f32 v242, v64
 v_exp_f32 v243, v65
 v_accvgpr_read_b32 v250, a112
 s_waitcnt lgkmcnt(2)
 v_mfma_f32_32x32x16_bf16 v[96:111], v[228:231], v[4:7], v[96:111]
 v_add_f32 v240, v242, v243
 v_cvt_pk_bf16_f32 v128, v242, v243
 buffer_load_dwordx4 v210, s[12:15], s34 offen offset:1024 nt lds
 s_add_u32 m0, s28, 16384
 s_mov_b32 s34, 139264
 v_mfma_f32_32x32x16_bf16 v[112:127], v[228:231], v[36:39], v[112:127]
 ds_read_b128 v[228:231], v198 offset:24576
 v_exp_f32 v244, v66
 v_exp_f32 v245, v67
 v_add_f32 v240, v244, v240
 v_mfma_f32_32x32x16_bf16 v[96:111], v[232:235], v[8:11], v[96:111]
 v_add_f32 v240, v245, v240
 v_cvt_pk_bf16_f32 v129, v244, v245
 buffer_load_dwordx4 v208, s[8:11], s32 offen nt lds
 v_exp_f32 v242, v68
 v_mfma_f32_32x32x16_bf16 v[112:127], v[232:235], v[40:43], v[112:127]
 ds_read_b128 v[232:235], v199 offset:24576
 v_exp_f32 v243, v69
 v_add_f32 v240, v242, v240
 v_add_f32 v240, v243, v240
 v_cvt_pk_bf16_f32 v130, v242, v243
 v_mfma_f32_32x32x16_bf16 v[96:111], v[236:239], v[12:15], v[96:111]
 v_exp_f32 v244, v70
 buffer_load_dwordx4 v209, s[8:11], s32 offen offset:1024 nt lds
 s_mov_b32 s32, 155648
 v_add_f32 v240, v244, v240
 v_mfma_f32_32x32x16_bf16 v[112:127], v[236:239], v[44:47], v[112:127]
 ds_read_b64_tr_b16 v[236:237], v200 offset:8192
 ds_read_b64_tr_b16 v[238:239], v200 offset:10240
 v_exp_f32 v245, v71
 v_exp_f32 v242, v72
 s_waitcnt lgkmcnt(4)
 v_mfma_f32_32x32x16_bf16 v[96:111], v[220:223], v[16:19], v[96:111]
 v_add_f32 v240, v245, v240
 v_cvt_pk_bf16_f32 v131, v244, v245
 v_exp_f32 v243, v73
 v_add_f32 v240, v242, v240
 v_add_f32 v240, v243, v240
 v_mfma_f32_32x32x16_bf16 v[112:127], v[220:223], v[48:51], v[112:127]
 ds_read_b64_tr_b16 v[220:221], v201 offset:8192
 ds_read_b64_tr_b16 v[222:223], v201 offset:10240
 v_cvt_pk_bf16_f32 v132, v242, v243
 v_exp_f32 v244, v74
 v_accvgpr_read_b32 v251, a113
 v_mfma_f32_32x32x16_bf16 v[96:111], v[224:227], v[20:23], v[96:111]
 v_exp_f32 v245, v75
 v_add_f32 v240, v244, v240
 v_add_f32 v240, v245, v240
 v_cvt_pk_bf16_f32 v133, v244, v245
 v_accvgpr_read_b32 v252, a114
 v_mfma_f32_32x32x16_bf16 v[112:127], v[224:227], v[52:55], v[112:127]
 ds_read_b64_tr_b16 v[224:225], v202 offset:8192
 ds_read_b64_tr_b16 v[226:227], v202 offset:10240
 v_exp_f32 v242, v76
 v_exp_f32 v243, v77
 s_waitcnt lgkmcnt(6)
 v_mfma_f32_32x32x16_bf16 v[96:111], v[228:231], v[24:27], v[96:111]
 v_add_f32 v240, v242, v240
 v_add_f32 v240, v243, v240
 v_cvt_pk_bf16_f32 v134, v242, v243
 v_exp_f32 v244, v78
 v_accvgpr_read_b32 v253, a115
 v_mfma_f32_32x32x16_bf16 v[112:127], v[228:231], v[56:59], v[112:127]
 ds_read_b64_tr_b16 v[228:229], v203 offset:8192
 ds_read_b64_tr_b16 v[230:231], v203 offset:10240
 v_exp_f32 v245, v79
 v_add_f32 v240, v244, v240
 v_add_f32 v240, v245, v240
 v_mfma_f32_32x32x16_bf16 v[96:111], v[232:235], v[28:31], v[96:111]
 v_cvt_pk_bf16_f32 v135, v244, v245
 v_exp_f32 v242, v80
 v_exp_f32 v243, v81
 v_mul_f32 v250, s29, v250
 v_mfma_f32_32x32x16_bf16 v[112:127], v[232:235], v[60:63], v[112:127]
 ds_read_b64_tr_b16 v[232:233], v200 offset:12288
 ds_read_b64_tr_b16 v[234:235], v200 offset:14336
 v_add_f32 v241, v242, v243
 v_cvt_pk_bf16_f32 v136, v242, v243
 v_exp_f32 v244, v82
 s_waitcnt lgkmcnt(6)
 v_mfma_f32_32x32x16_bf16 a[128:143], v[236:239], v[144:147], a[128:143]
 v_exp_f32 v245, v83
 v_add_f32 v241, v244, v241
 v_add_f32 v241, v245, v241
 v_cvt_pk_bf16_f32 v137, v244, v245
 v_mul_f32 v251, s29, v251
 v_mfma_f32_32x32x16_bf16 a[144:159], v[236:239], v[152:155], a[144:159]
 ds_read_b64_tr_b16 v[236:237], v201 offset:12288
 ds_read_b64_tr_b16 v[238:239], v201 offset:14336
 v_exp_f32 v242, v84
 v_exp_f32 v243, v85
 v_mfma_f32_32x32x16_bf16 a[160:175], v[220:223], v[144:147], a[160:175]
 v_add_f32 v241, v242, v241
 v_add_f32 v241, v243, v241
 v_cvt_pk_bf16_f32 v138, v242, v243
 v_exp_f32 v244, v86
 v_mul_f32 v252, s29, v252
 v_mfma_f32_32x32x16_bf16 a[176:191], v[220:223], v[152:155], a[176:191]
 ds_read_b64_tr_b16 v[220:221], v202 offset:12288
 ds_read_b64_tr_b16 v[222:223], v202 offset:14336
 v_exp_f32 v245, v87
 v_add_f32 v241, v244, v241
 v_add_f32 v241, v245, v241
 s_waitcnt lgkmcnt(6)
 v_mfma_f32_32x32x16_bf16 a[192:207], v[224:227], v[144:147], a[192:207]
 v_cvt_pk_bf16_f32 v139, v244, v245
 v_exp_f32 v242, v88
 v_exp_f32 v243, v89
 v_add_f32 v241, v242, v241
 v_mfma_f32_32x32x16_bf16 a[208:223], v[224:227], v[152:155], a[208:223]
 ds_read_b64_tr_b16 v[224:225], v203 offset:12288
 ds_read_b64_tr_b16 v[226:227], v203 offset:14336
 v_add_f32 v241, v243, v241
 v_cvt_pk_bf16_f32 v140, v242, v243
 v_exp_f32 v244, v90
 v_mfma_f32_32x32x16_bf16 a[224:239], v[228:231], v[144:147], a[224:239]
 v_exp_f32 v245, v91
 v_add_f32 v241, v244, v241
 v_add_f32 v241, v245, v241
 v_cvt_pk_bf16_f32 v141, v244, v245
 v_mul_f32 v253, s29, v253
 v_mfma_f32_32x32x16_bf16 a[240:255], v[228:231], v[152:155], a[240:255]
 ds_read_b128 v[228:231], v192 offset:32768
 v_exp_f32 v242, v92
 v_exp_f32 v243, v93
 v_add_f32 v241, v242, v241
 s_waitcnt lgkmcnt(5)
 v_mfma_f32_32x32x16_bf16 a[128:143], v[232:235], v[148:151], a[128:143]
 v_add_f32 v241, v243, v241
 v_cvt_pk_bf16_f32 v142, v242, v243
 v_exp_f32 v244, v94
 v_exp_f32 v245, v95
 v_mfma_f32_32x32x16_bf16 a[144:159], v[232:235], v[156:159], a[144:159]
 ds_read_b128 v[232:235], v193 offset:32768
 v_add_f32 v241, v244, v241
 v_add_f32 v241, v245, v241
 v_cvt_pk_bf16_f32 v143, v244, v245
 v_cvt_pk_bf16_f32 v250, v250, v251
 v_cvt_pk_bf16_f32 v251, v252, v253
 v_mfma_f32_32x32x16_bf16 a[160:175], v[236:239], v[148:151], a[160:175]
 v_accvgpr_write_b32 a56, v250
 v_accvgpr_write_b32 a57, v251
 v_accvgpr_read_b32 v250, a116
 v_accvgpr_read_b32 v251, a117
 v_accvgpr_read_b32 v252, a118
 v_accvgpr_read_b32 v253, a119
 v_mfma_f32_32x32x16_bf16 a[176:191], v[236:239], v[156:159], a[176:191]
 ds_read_b128 v[236:239], v194 offset:32768
 v_mul_f32 v250, s29, v250
 v_mul_f32 v251, s29, v251
 v_mul_f32 v252, s29, v252
 v_mul_f32 v253, s29, v253
 v_cvt_pk_bf16_f32 v250, v250, v251
 s_waitcnt lgkmcnt(3)
 v_mfma_f32_32x32x16_bf16 a[192:207], v[220:223], v[148:151], a[192:207]
 v_cvt_pk_bf16_f32 v251, v252, v253
 v_accvgpr_write_b32 a58, v250
 v_accvgpr_write_b32 a59, v251
 v_accvgpr_read_b32 v250, a120
 v_accvgpr_read_b32 v251, a121
 v_accvgpr_read_b32 v252, a122
 v_mfma_f32_32x32x16_bf16 a[208:223], v[220:223], v[156:159], a[208:223]
 ds_read_b128 v[220:223], v195 offset:32768
 v_accvgpr_read_b32 v253, a123
 v_mul_f32 v250, s29, v250
 v_mul_f32 v251, s29, v251
 v_mul_f32 v252, s29, v252
 v_mul_f32 v253, s29, v253
 v_mfma_f32_32x32x16_bf16 a[224:239], v[224:227], v[148:151], a[224:239]
 v_cvt_pk_bf16_f32 v250, v250, v251
 v_cvt_pk_bf16_f32 v251, v252, v253
 v_accvgpr_write_b32 a60, v250
 v_accvgpr_write_b32 a61, v251
 v_accvgpr_read_b32 v250, a124
 v_accvgpr_read_b32 v251, a125
 v_mfma_f32_32x32x16_bf16 a[240:255], v[224:227], v[156:159], a[240:255]
 v_accvgpr_read_b32 v252, a126
 v_accvgpr_read_b32 v253, a127
 v_mul_f32 v250, s29, v250
 v_mul_f32 v251, s29, v251
 v_mul_f32 v252, s29, v252
 v_mul_f32 v253, s29, v253
 v_cvt_pk_bf16_f32 v250, v250, v251
 v_cvt_pk_bf16_f32 v251, v252, v253
 v_accvgpr_write_b32 a62, v250
 v_accvgpr_write_b32 a63, v251
 v_add_f32 v254, v240, v241
 v_cmp_nge_f32 vcc, s30, v254
 s_cbranch_vccnz LR0_10
BR0_10:
 s_waitcnt vmcnt(20)
 s_barrier
 s_waitcnt lgkmcnt(1)
 v_mfma_f32_32x32x16_bf16 v[64:79], v[228:231], v[0:3], v[160:175]
 ds_read_b128 v[224:227], v196 offset:32768
 s_add_u32 m0, s28, 73728
 s_nop 0
 buffer_load_dwordx4 v210, s[12:15], s34 offen nt lds
 v_add_f32 v216, v240, v216
 v_add_f32 v217, v241, v217
 v_mfma_f32_32x32x16_bf16 v[80:95], v[228:231], v[32:35], v[176:191]
 ds_read_b128 v[228:231], v197 offset:32768
 v_exp_f32 v242, v96
 v_exp_f32 v243, v97
 v_mfma_f32_32x32x16_bf16 v[64:79], v[232:235], v[4:7], v[64:79]
 v_add_f32 v240, v242, v243
 v_cvt_pk_bf16_f32 v144, v242, v243
 buffer_load_dwordx4 v210, s[12:15], s34 offen offset:1024 nt lds
 s_add_u32 m0, s28, 24576
 s_mov_b32 s34, 147456
 v_mfma_f32_32x32x16_bf16 v[80:95], v[232:235], v[36:39], v[80:95]
 ds_read_b128 v[232:235], v198 offset:32768
 v_exp_f32 v244, v98
 v_exp_f32 v245, v99
 v_add_f32 v240, v244, v240
 v_mfma_f32_32x32x16_bf16 v[64:79], v[236:239], v[8:11], v[64:79]
 v_add_f32 v240, v245, v240
 v_cvt_pk_bf16_f32 v145, v244, v245
 buffer_load_dwordx4 v208, s[8:11], s32 offen nt lds
 v_exp_f32 v242, v100
 v_mfma_f32_32x32x16_bf16 v[80:95], v[236:239], v[40:43], v[80:95]
 ds_read_b128 v[236:239], v199 offset:32768
 v_exp_f32 v243, v101
 v_add_f32 v240, v242, v240
 v_add_f32 v240, v243, v240
 v_cvt_pk_bf16_f32 v146, v242, v243
 s_waitcnt lgkmcnt(3)
 v_mfma_f32_32x32x16_bf16 v[64:79], v[220:223], v[12:15], v[64:79]
 v_exp_f32 v244, v102
 buffer_load_dwordx4 v209, s[8:11], s32 offen offset:1024 nt lds
 s_mov_b32 s32, 163840
 v_add_f32 v240, v244, v240
 v_mfma_f32_32x32x16_bf16 v[80:95], v[220:223], v[44:47], v[80:95]
 ds_read_b64_tr_b16 v[220:221], v200 offset:16384
 ds_read_b64_tr_b16 v[222:223], v200 offset:18432
 v_exp_f32 v245, v103
 v_exp_f32 v242, v104
 v_mfma_f32_32x32x16_bf16 v[64:79], v[224:227], v[16:19], v[64:79]
 v_add_f32 v240, v245, v240
 v_cvt_pk_bf16_f32 v147, v244, v245
 v_exp_f32 v243, v105
 v_add_f32 v240, v242, v240
 v_add_f32 v240, v243, v240
 v_mfma_f32_32x32x16_bf16 v[80:95], v[224:227], v[48:51], v[80:95]
 ds_read_b64_tr_b16 v[224:225], v201 offset:16384
 ds_read_b64_tr_b16 v[226:227], v201 offset:18432
 v_cvt_pk_bf16_f32 v148, v242, v243
 v_exp_f32 v244, v106
 s_waitcnt lgkmcnt(5)
 v_mfma_f32_32x32x16_bf16 v[64:79], v[228:231], v[20:23], v[64:79]
 v_exp_f32 v245, v107
 v_add_f32 v240, v244, v240
 v_add_f32 v240, v245, v240
 v_cvt_pk_bf16_f32 v149, v244, v245
 v_mfma_f32_32x32x16_bf16 v[80:95], v[228:231], v[52:55], v[80:95]
 ds_read_b64_tr_b16 v[228:229], v202 offset:16384
 ds_read_b64_tr_b16 v[230:231], v202 offset:18432
 v_exp_f32 v242, v108
 v_exp_f32 v243, v109
 v_mfma_f32_32x32x16_bf16 v[64:79], v[232:235], v[24:27], v[64:79]
 v_add_f32 v240, v242, v240
 v_add_f32 v240, v243, v240
 v_cvt_pk_bf16_f32 v150, v242, v243
 v_exp_f32 v244, v110
 v_mfma_f32_32x32x16_bf16 v[80:95], v[232:235], v[56:59], v[80:95]
 ds_read_b64_tr_b16 v[232:233], v203 offset:16384
 ds_read_b64_tr_b16 v[234:235], v203 offset:18432
 v_exp_f32 v245, v111
 v_add_f32 v240, v244, v240
 v_add_f32 v240, v245, v240
 s_waitcnt lgkmcnt(6)
 v_mfma_f32_32x32x16_bf16 v[64:79], v[236:239], v[28:31], v[64:79]
 v_cvt_pk_bf16_f32 v151, v244, v245
 v_exp_f32 v242, v112
 v_exp_f32 v243, v113
 v_mfma_f32_32x32x16_bf16 v[80:95], v[236:239], v[60:63], v[80:95]
 ds_read_b64_tr_b16 v[236:237], v200 offset:20480
 ds_read_b64_tr_b16 v[238:239], v200 offset:22528
 v_add_f32 v241, v242, v243
 v_cvt_pk_bf16_f32 v152, v242, v243
 v_exp_f32 v244, v114
 v_mfma_f32_32x32x16_bf16 a[128:143], v[220:223], v[128:131], a[128:143]
 v_exp_f32 v245, v115
 v_add_f32 v241, v244, v241
 v_add_f32 v241, v245, v241
 v_cvt_pk_bf16_f32 v153, v244, v245
 v_mfma_f32_32x32x16_bf16 a[144:159], v[220:223], v[136:139], a[144:159]
 ds_read_b64_tr_b16 v[220:221], v201 offset:20480
 ds_read_b64_tr_b16 v[222:223], v201 offset:22528
 v_exp_f32 v242, v116
 v_exp_f32 v243, v117
 s_waitcnt lgkmcnt(6)
 v_mfma_f32_32x32x16_bf16 a[160:175], v[224:227], v[128:131], a[160:175]
 v_add_f32 v241, v242, v241
 v_add_f32 v241, v243, v241
 v_cvt_pk_bf16_f32 v154, v242, v243
 v_exp_f32 v244, v118
 v_mfma_f32_32x32x16_bf16 a[176:191], v[224:227], v[136:139], a[176:191]
 ds_read_b64_tr_b16 v[224:225], v202 offset:20480
 ds_read_b64_tr_b16 v[226:227], v202 offset:22528
 v_exp_f32 v245, v119
 v_add_f32 v241, v244, v241
 v_add_f32 v241, v245, v241
 v_mfma_f32_32x32x16_bf16 a[192:207], v[228:231], v[128:131], a[192:207]
 v_cvt_pk_bf16_f32 v155, v244, v245
 v_exp_f32 v242, v120
 v_exp_f32 v243, v121
 v_add_f32 v241, v242, v241
 v_mfma_f32_32x32x16_bf16 a[208:223], v[228:231], v[136:139], a[208:223]
 ds_read_b64_tr_b16 v[228:229], v203 offset:20480
 ds_read_b64_tr_b16 v[230:231], v203 offset:22528
 v_add_f32 v241, v243, v241
 v_cvt_pk_bf16_f32 v156, v242, v243
 v_exp_f32 v244, v122
 s_waitcnt lgkmcnt(6)
 v_mfma_f32_32x32x16_bf16 a[224:239], v[232:235], v[128:131], a[224:239]
 v_exp_f32 v245, v123
 v_add_f32 v241, v244, v241
 v_add_f32 v241, v245, v241
 v_cvt_pk_bf16_f32 v157, v244, v245
 v_mfma_f32_32x32x16_bf16 a[240:255], v[232:235], v[136:139], a[240:255]
 ds_read_b128 v[232:235], v192 offset:40960
 v_exp_f32 v242, v124
 v_exp_f32 v243, v125
 v_add_f32 v241, v242, v241
 v_mfma_f32_32x32x16_bf16 a[128:143], v[236:239], v[132:135], a[128:143]
 v_add_f32 v241, v243, v241
 v_cvt_pk_bf16_f32 v158, v242, v243
 v_exp_f32 v244, v126
 v_exp_f32 v245, v127
 v_mfma_f32_32x32x16_bf16 a[144:159], v[236:239], v[140:143], a[144:159]
 ds_read_b128 v[236:239], v193 offset:40960
 v_add_f32 v241, v244, v241
 v_add_f32 v241, v245, v241
 v_cvt_pk_bf16_f32 v159, v244, v245
 v_add_f32 v254, v240, v241
 v_cmp_nge_f32 vcc, s30, v254
 s_waitcnt lgkmcnt(4)
 v_mfma_f32_32x32x16_bf16 a[160:175], v[220:223], v[132:135], a[160:175]
 v_mfma_f32_32x32x16_bf16 a[176:191], v[220:223], v[140:143], a[176:191]
 ds_read_b128 v[220:223], v194 offset:40960
 v_mfma_f32_32x32x16_bf16 a[192:207], v[224:227], v[132:135], a[192:207]
 v_mfma_f32_32x32x16_bf16 a[208:223], v[224:227], v[140:143], a[208:223]
 ds_read_b128 v[224:227], v195 offset:40960
 s_waitcnt lgkmcnt(3)
 v_mfma_f32_32x32x16_bf16 a[224:239], v[228:231], v[132:135], a[224:239]
 v_mfma_f32_32x32x16_bf16 a[240:255], v[228:231], v[140:143], a[240:255]
 s_cbranch_vccnz LR0_11
BR0_11:
 s_waitcnt vmcnt(20)
 s_barrier
 ds_read_b128 v[228:231], v196 offset:40960
 s_add_u32 m0, s28, 81920
 s_nop 0
 buffer_load_dwordx4 v210, s[12:15], s34 offen nt lds
 v_mfma_f32_32x32x16_bf16 v[96:111], v[232:235], v[0:3], v[160:175]
 v_add_f32 v216, v240, v216
 v_add_f32 v217, v241, v217
 v_exp_f32 v242, v64
 v_exp_f32 v243, v65
 v_mfma_f32_32x32x16_bf16 v[112:127], v[232:235], v[32:35], v[176:191]
 ds_read_b128 v[232:235], v197 offset:40960
 v_add_f32 v240, v242, v243
 v_cvt_pk_bf16_f32 v128, v242, v243
 v_exp_f32 v244, v66
 s_waitcnt lgkmcnt(3)
 v_mfma_f32_32x32x16_bf16 v[96:111], v[236:239], v[4:7], v[96:111]
 buffer_load_dwordx4 v210, s[12:15], s34 offen offset:1024 nt lds
 s_add_u32 m0, s28, 32768
 s_mov_b32 s34, 155648
 v_exp_f32 v245, v67
 v_mfma_f32_32x32x16_bf16 v[112:127], v[236:239], v[36:39], v[112:127]
 ds_read_b128 v[236:239], v198 offset:40960
 v_add_f32 v240, v244, v240
 v_add_f32 v240, v245, v240
 v_cvt_pk_bf16_f32 v129, v244, v245
 v_exp_f32 v242, v68
 v_mfma_f32_32x32x16_bf16 v[96:111], v[220:223], v[8:11], v[96:111]
 buffer_load_dwordx4 v208, s[8:11], s32 offen nt lds
 v_exp_f32 v243, v69
 v_add_f32 v240, v242, v240
 v_add_f32 v240, v243, v240
 v_mfma_f32_32x32x16_bf16 v[112:127], v[220:223], v[40:43], v[112:127]
 ds_read_b128 v[220:223], v199 offset:40960
 v_cvt_pk_bf16_f32 v130, v242, v243
 v_exp_f32 v244, v70
 v_exp_f32 v245, v71
 s_waitcnt lgkmcnt(3)
 v_mfma_f32_32x32x16_bf16 v[96:111], v[224:227], v[12:15], v[96:111]
 buffer_load_dwordx4 v209, s[8:11], s32 offen offset:1024 nt lds
 s_mov_b32 s32, 172032
 v_add_f32 v240, v244, v240
 v_add_f32 v240, v245, v240
 v_cvt_pk_bf16_f32 v131, v244, v245
 v_mfma_f32_32x32x16_bf16 v[112:127], v[224:227], v[44:47], v[112:127]
 ds_read_b64_tr_b16 v[224:225], v200 offset:24576
 ds_read_b64_tr_b16 v[226:227], v200 offset:26624
 v_exp_f32 v242, v72
 v_exp_f32 v243, v73
 v_mfma_f32_32x32x16_bf16 v[96:111], v[228:231], v[16:19], v[96:111]
 v_add_f32 v240, v242, v240
 v_add_f32 v240, v243, v240
 v_cvt_pk_bf16_f32 v132, v242, v243
 v_exp_f32 v244, v74
 v_mfma_f32_32x32x16_bf16 v[112:127], v[228:231], v[48:51], v[112:127]
 ds_read_b64_tr_b16 v[228:229], v201 offset:24576
 ds_read_b64_tr_b16 v[230:231], v201 offset:26624
 v_exp_f32 v245, v75
 v_add_f32 v240, v244, v240
 v_add_f32 v240, v245, v240
 s_waitcnt lgkmcnt(5)
 v_mfma_f32_32x32x16_bf16 v[96:111], v[232:235], v[20:23], v[96:111]
 v_cvt_pk_bf16_f32 v133, v244, v245
 v_exp_f32 v242, v76
 v_exp_f32 v243, v77
 v_add_f32 v240, v242, v240
 v_mfma_f32_32x32x16_bf16 v[112:127], v[232:235], v[52:55], v[112:127]
 ds_read_b64_tr_b16 v[232:233], v202 offset:24576
 ds_read_b64_tr_b16 v[234:235], v202 offset:26624
 v_add_f32 v240, v243, v240
 v_cvt_pk_bf16_f32 v134, v242, v243
 v_exp_f32 v244, v78
 v_mfma_f32_32x32x16_bf16 v[96:111], v[236:239], v[24:27], v[96:111]
 v_exp_f32 v245, v79
 v_add_f32 v240, v244, v240
 v_add_f32 v240, v245, v240
 v_cvt_pk_bf16_f32 v135, v244, v245
 v_mfma_f32_32x32x16_bf16 v[112:127], v[236:239], v[56:59], v[112:127]
 ds_read_b64_tr_b16 v[236:237], v203 offset:24576
 ds_read_b64_tr_b16 v[238:239], v203 offset:26624
 v_exp_f32 v242, v80
 v_exp_f32 v243, v81
 s_waitcnt lgkmcnt(6)
 v_mfma_f32_32x32x16_bf16 v[96:111], v[220:223], v[28:31], v[96:111]
 v_add_f32 v241, v242, v243
 v_cvt_pk_bf16_f32 v136, v242, v243
 v_exp_f32 v244, v82
 v_exp_f32 v245, v83
 v_mfma_f32_32x32x16_bf16 v[112:127], v[220:223], v[60:63], v[112:127]
 ds_read_b64_tr_b16 v[220:221], v200 offset:28672
 ds_read_b64_tr_b16 v[222:223], v200 offset:30720
 v_add_f32 v241, v244, v241
 v_add_f32 v241, v245, v241
 v_cvt_pk_bf16_f32 v137, v244, v245
 v_mfma_f32_32x32x16_bf16 a[128:143], v[224:227], v[144:147], a[128:143]
 v_exp_f32 v242, v84
 v_exp_f32 v243, v85
 v_add_f32 v241, v242, v241
 v_add_f32 v241, v243, v241
 v_mfma_f32_32x32x16_bf16 a[144:159], v[224:227], v[152:155], a[144:159]
 ds_read_b64_tr_b16 v[224:225], v201 offset:28672
 ds_read_b64_tr_b16 v[226:227], v201 offset:30720
 v_cvt_pk_bf16_f32 v138, v242, v243
 v_exp_f32 v244, v86
 s_waitcnt lgkmcnt(6)
 v_mfma_f32_32x32x16_bf16 a[160:175], v[228:231], v[144:147], a[160:175]
 v_exp_f32 v245, v87
 v_add_f32 v241, v244, v241
 v_add_f32 v241, v245, v241
 v_cvt_pk_bf16_f32 v139, v244, v245
 v_mfma_f32_32x32x16_bf16 a[176:191], v[228:231], v[152:155], a[176:191]
 ds_read_b64_tr_b16 v[228:229], v202 offset:28672
 ds_read_b64_tr_b16 v[230:231], v202 offset:30720
 v_exp_f32 v242, v88
 v_exp_f32 v243, v89
 v_mfma_f32_32x32x16_bf16 a[192:207], v[232:235], v[144:147], a[192:207]
 v_add_f32 v241, v242, v241
 v_add_f32 v241, v243, v241
 v_cvt_pk_bf16_f32 v140, v242, v243
 v_exp_f32 v244, v90
 v_mfma_f32_32x32x16_bf16 a[208:223], v[232:235], v[152:155], a[208:223]
 ds_read_b64_tr_b16 v[232:233], v203 offset:28672
 ds_read_b64_tr_b16 v[234:235], v203 offset:30720
 v_exp_f32 v245, v91
 v_add_f32 v241, v244, v241
 v_add_f32 v241, v245, v241
 s_waitcnt lgkmcnt(6)
 v_mfma_f32_32x32x16_bf16 a[224:239], v[236:239], v[144:147], a[224:239]
 v_cvt_pk_bf16_f32 v141, v244, v245
 v_exp_f32 v242, v92
 v_exp_f32 v243, v93
 v_add_f32 v241, v242, v241
 v_mfma_f32_32x32x16_bf16 a[240:255], v[236:239], v[152:155], a[240:255]
 ds_read_b128 v[236:239], v192 offset:49152
 v_add_f32 v241, v243, v241
 v_cvt_pk_bf16_f32 v142, v242, v243
 v_exp_f32 v244, v94
 v_mfma_f32_32x32x16_bf16 a[128:143], v[220:223], v[148:151], a[128:143]
 v_exp_f32 v245, v95
 v_add_f32 v241, v244, v241
 v_add_f32 v241, v245, v241
 v_cvt_pk_bf16_f32 v143, v244, v245
 v_add_f32 v254, v240, v241
 v_mfma_f32_32x32x16_bf16 a[144:159], v[220:223], v[156:159], a[144:159]
 ds_read_b128 v[220:223], v193 offset:49152
 v_cmp_nge_f32 vcc, s30, v254
 s_waitcnt lgkmcnt(4)
 v_mfma_f32_32x32x16_bf16 a[160:175], v[224:227], v[148:151], a[160:175]
 v_mfma_f32_32x32x16_bf16 a[176:191], v[224:227], v[156:159], a[176:191]
 ds_read_b128 v[224:227], v194 offset:49152
 v_mfma_f32_32x32x16_bf16 a[192:207], v[228:231], v[148:151], a[192:207]
 v_mfma_f32_32x32x16_bf16 a[208:223], v[228:231], v[156:159], a[208:223]
 ds_read_b128 v[228:231], v195 offset:49152
 s_waitcnt lgkmcnt(3)
 v_mfma_f32_32x32x16_bf16 a[224:239], v[232:235], v[148:151], a[224:239]
 v_mfma_f32_32x32x16_bf16 a[240:255], v[232:235], v[156:159], a[240:255]
 s_cbranch_vccnz LR0_12
BR0_12:
 s_waitcnt vmcnt(20)
 s_barrier
 ds_read_b128 v[232:235], v196 offset:49152
 s_add_u32 m0, s28, 90112
 s_nop 0
 buffer_load_dwordx4 v210, s[12:15], s34 offen nt lds
 v_mfma_f32_32x32x16_bf16 v[64:79], v[236:239], v[0:3], v[160:175]
 v_add_f32 v216, v240, v216
 v_add_f32 v217, v241, v217
 v_exp_f32 v242, v96
 v_exp_f32 v243, v97
 v_mfma_f32_32x32x16_bf16 v[80:95], v[236:239], v[32:35], v[176:191]
 ds_read_b128 v[236:239], v197 offset:49152
 v_add_f32 v240, v242, v243
 v_cvt_pk_bf16_f32 v144, v242, v243
 v_exp_f32 v244, v98
 s_waitcnt lgkmcnt(3)
 v_mfma_f32_32x32x16_bf16 v[64:79], v[220:223], v[4:7], v[64:79]
 buffer_load_dwordx4 v210, s[12:15], s34 offen offset:1024 nt lds
 s_add_u32 m0, s28, 40960
 s_mov_b32 s34, 163840
 v_exp_f32 v245, v99
 v_mfma_f32_32x32x16_bf16 v[80:95], v[220:223], v[36:39], v[80:95]
 ds_read_b128 v[220:223], v198 offset:49152
 v_add_f32 v240, v244, v240
 v_add_f32 v240, v245, v240
 v_cvt_pk_bf16_f32 v145, v244, v245
 v_exp_f32 v242, v100
 v_mfma_f32_32x32x16_bf16 v[64:79], v[224:227], v[8:11], v[64:79]
 buffer_load_dwordx4 v208, s[8:11], s32 offen nt lds
 v_exp_f32 v243, v101
 v_add_f32 v240, v242, v240
 v_add_f32 v240, v243, v240
 v_mfma_f32_32x32x16_bf16 v[80:95], v[224:227], v[40:43], v[80:95]
 ds_read_b128 v[224:227], v199 offset:49152
 v_cvt_pk_bf16_f32 v146, v242, v243
 v_exp_f32 v244, v102
 v_exp_f32 v245, v103
 s_waitcnt lgkmcnt(3)
 v_mfma_f32_32x32x16_bf16 v[64:79], v[228:231], v[12:15], v[64:79]
 buffer_load_dwordx4 v209, s[8:11], s32 offen offset:1024 nt lds
 s_mov_b32 s32, 180224
 v_add_f32 v240, v244, v240
 v_add_f32 v240, v245, v240
 v_cvt_pk_bf16_f32 v147, v244, v245
 v_mfma_f32_32x32x16_bf16 v[80:95], v[228:231], v[44:47], v[80:95]
 ds_read_b64_tr_b16 v[228:229], v200 offset:32768
 ds_read_b64_tr_b16 v[230:231], v200 offset:34816
 v_exp_f32 v242, v104
 v_exp_f32 v243, v105
 v_mfma_f32_32x32x16_bf16 v[64:79], v[232:235], v[16:19], v[64:79]
 v_add_f32 v240, v242, v240
 v_add_f32 v240, v243, v240
 v_cvt_pk_bf16_f32 v148, v242, v243
 v_exp_f32 v244, v106
 v_mfma_f32_32x32x16_bf16 v[80:95], v[232:235], v[48:51], v[80:95]
 ds_read_b64_tr_b16 v[232:233], v201 offset:32768
 ds_read_b64_tr_b16 v[234:235], v201 offset:34816
 v_exp_f32 v245, v107
 v_add_f32 v240, v244, v240
 v_add_f32 v240, v245, v240
 s_waitcnt lgkmcnt(5)
 v_mfma_f32_32x32x16_bf16 v[64:79], v[236:239], v[20:23], v[64:79]
 v_cvt_pk_bf16_f32 v149, v244, v245
 v_exp_f32 v242, v108
 v_exp_f32 v243, v109
 v_add_f32 v240, v242, v240
 v_mfma_f32_32x32x16_bf16 v[80:95], v[236:239], v[52:55], v[80:95]
 ds_read_b64_tr_b16 v[236:237], v202 offset:32768
 ds_read_b64_tr_b16 v[238:239], v202 offset:34816
 v_add_f32 v240, v243, v240
 v_cvt_pk_bf16_f32 v150, v242, v243
 v_exp_f32 v244, v110
 v_mfma_f32_32x32x16_bf16 v[64:79], v[220:223], v[24:27], v[64:79]
 v_exp_f32 v245, v111
 v_add_f32 v240, v244, v240
 v_add_f32 v240, v245, v240
 v_cvt_pk_bf16_f32 v151, v244, v245
 v_mfma_f32_32x32x16_bf16 v[80:95], v[220:223], v[56:59], v[80:95]
 ds_read_b64_tr_b16 v[220:221], v203 offset:32768
 ds_read_b64_tr_b16 v[222:223], v203 offset:34816
 v_exp_f32 v242, v112
 v_exp_f32 v243, v113
 s_waitcnt lgkmcnt(6)
 v_mfma_f32_32x32x16_bf16 v[64:79], v[224:227], v[28:31], v[64:79]
 v_add_f32 v241, v242, v243
 v_cvt_pk_bf16_f32 v152, v242, v243
 v_exp_f32 v244, v114
 v_exp_f32 v245, v115
 v_mfma_f32_32x32x16_bf16 v[80:95], v[224:227], v[60:63], v[80:95]
 ds_read_b64_tr_b16 v[224:225], v200 offset:36864
 ds_read_b64_tr_b16 v[226:227], v200 offset:38912
 v_add_f32 v241, v244, v241
 v_add_f32 v241, v245, v241
 v_cvt_pk_bf16_f32 v153, v244, v245
 v_mfma_f32_32x32x16_bf16 a[128:143], v[228:231], v[128:131], a[128:143]
 v_exp_f32 v242, v116
 v_exp_f32 v243, v117
 v_add_f32 v241, v242, v241
 v_add_f32 v241, v243, v241
 v_mfma_f32_32x32x16_bf16 a[144:159], v[228:231], v[136:139], a[144:159]
 ds_read_b64_tr_b16 v[228:229], v201 offset:36864
 ds_read_b64_tr_b16 v[230:231], v201 offset:38912
 v_cvt_pk_bf16_f32 v154, v242, v243
 v_exp_f32 v244, v118
 s_waitcnt lgkmcnt(6)
 v_mfma_f32_32x32x16_bf16 a[160:175], v[232:235], v[128:131], a[160:175]
 v_exp_f32 v245, v119
 v_add_f32 v241, v244, v241
 v_add_f32 v241, v245, v241
 v_cvt_pk_bf16_f32 v155, v244, v245
 v_mfma_f32_32x32x16_bf16 a[176:191], v[232:235], v[136:139], a[176:191]
 ds_read_b64_tr_b16 v[232:233], v202 offset:36864
 ds_read_b64_tr_b16 v[234:235], v202 offset:38912
 v_exp_f32 v242, v120
 v_exp_f32 v243, v121
 v_mfma_f32_32x32x16_bf16 a[192:207], v[236:239], v[128:131], a[192:207]
 v_add_f32 v241, v242, v241
 v_add_f32 v241, v243, v241
 v_cvt_pk_bf16_f32 v156, v242, v243
 v_exp_f32 v244, v122
 v_mfma_f32_32x32x16_bf16 a[208:223], v[236:239], v[136:139], a[208:223]
 ds_read_b64_tr_b16 v[236:237], v203 offset:36864
 ds_read_b64_tr_b16 v[238:239], v203 offset:38912
 v_exp_f32 v245, v123
 v_add_f32 v241, v244, v241
 v_add_f32 v241, v245, v241
 s_waitcnt lgkmcnt(6)
 v_mfma_f32_32x32x16_bf16 a[224:239], v[220:223], v[128:131], a[224:239]
 v_cvt_pk_bf16_f32 v157, v244, v245
 v_exp_f32 v242, v124
 v_exp_f32 v243, v125
 v_add_f32 v241, v242, v241
 v_mfma_f32_32x32x16_bf16 a[240:255], v[220:223], v[136:139], a[240:255]
 ds_read_b128 v[220:223], v192 offset:57344
 v_add_f32 v241, v243, v241
 v_cvt_pk_bf16_f32 v158, v242, v243
 v_exp_f32 v244, v126
 v_mfma_f32_32x32x16_bf16 a[128:143], v[224:227], v[132:135], a[128:143]
 v_exp_f32 v245, v127
 v_add_f32 v241, v244, v241
 v_add_f32 v241, v245, v241
 v_cvt_pk_bf16_f32 v159, v244, v245
 v_add_f32 v254, v240, v241
 v_mfma_f32_32x32x16_bf16 a[144:159], v[224:227], v[140:143], a[144:159]
 ds_read_b128 v[224:227], v193 offset:57344
 v_cmp_nge_f32 vcc, s30, v254
 s_waitcnt lgkmcnt(4)
 v_mfma_f32_32x32x16_bf16 a[160:175], v[228:231], v[132:135], a[160:175]
 v_mfma_f32_32x32x16_bf16 a[176:191], v[228:231], v[140:143], a[176:191]
 ds_read_b128 v[228:231], v194 offset:57344
 v_mfma_f32_32x32x16_bf16 a[192:207], v[232:235], v[132:135], a[192:207]
 v_mfma_f32_32x32x16_bf16 a[208:223], v[232:235], v[140:143], a[208:223]
 ds_read_b128 v[232:235], v195 offset:57344
 s_waitcnt lgkmcnt(3)
 v_mfma_f32_32x32x16_bf16 a[224:239], v[236:239], v[132:135], a[224:239]
 v_mfma_f32_32x32x16_bf16 a[240:255], v[236:239], v[140:143], a[240:255]
 s_cbranch_vccnz LR0_13
BR0_13:
 s_waitcnt vmcnt(22)
 s_barrier
 ds_read_b128 v[236:239], v196 offset:57344
 s_add_u32 m0, s28, 98304
 s_nop 0
 buffer_load_dwordx4 v210, s[12:15], s34 offen nt lds
 v_mfma_f32_32x32x16_bf16 v[96:111], v[220:223], v[0:3], v[160:175]
 v_add_f32 v216, v240, v216
 v_add_f32 v217, v241, v217
 v_exp_f32 v242, v64
 v_exp_f32 v243, v65
 v_mfma_f32_32x32x16_bf16 v[112:127], v[220:223], v[32:35], v[176:191]
 ds_read_b128 v[220:223], v197 offset:57344
 v_add_f32 v240, v242, v243
 v_cvt_pk_bf16_f32 v128, v242, v243
 v_exp_f32 v244, v66
 s_waitcnt lgkmcnt(3)
 v_mfma_f32_32x32x16_bf16 v[96:111], v[224:227], v[4:7], v[96:111]
 buffer_load_dwordx4 v210, s[12:15], s34 offen offset:1024 nt lds
 s_add_u32 m0, s28, 49152
 s_mov_b32 s34, 172032
 v_exp_f32 v245, v67
 v_mfma_f32_32x32x16_bf16 v[112:127], v[224:227], v[36:39], v[112:127]
 ds_read_b128 v[224:227], v198 offset:57344
 v_add_f32 v240, v244, v240
 v_add_f32 v240, v245, v240
 v_cvt_pk_bf16_f32 v129, v244, v245
 v_exp_f32 v242, v68
 v_mfma_f32_32x32x16_bf16 v[96:111], v[228:231], v[8:11], v[96:111]
 buffer_load_dwordx4 v208, s[8:11], s32 offen nt lds
 v_exp_f32 v243, v69
 v_add_f32 v240, v242, v240
 v_add_f32 v240, v243, v240
 v_mfma_f32_32x32x16_bf16 v[112:127], v[228:231], v[40:43], v[112:127]
 ds_read_b128 v[228:231], v199 offset:57344
 v_cvt_pk_bf16_f32 v130, v242, v243
 v_exp_f32 v244, v70
 v_exp_f32 v245, v71
 s_waitcnt lgkmcnt(3)
 v_mfma_f32_32x32x16_bf16 v[96:111], v[232:235], v[12:15], v[96:111]
 buffer_load_dwordx4 v209, s[8:11], s32 offen offset:1024 nt lds
 s_mov_b32 s32, 188416
 v_add_f32 v240, v244, v240
 v_add_f32 v240, v245, v240
 v_cvt_pk_bf16_f32 v131, v244, v245
 v_mfma_f32_32x32x16_bf16 v[112:127], v[232:235], v[44:47], v[112:127]
 ds_read_b64_tr_b16 v[232:233], v200 offset:40960
 ds_read_b64_tr_b16 v[234:235], v200 offset:43008
 v_exp_f32 v242, v72
 v_exp_f32 v243, v73
 v_mfma_f32_32x32x16_bf16 v[96:111], v[236:239], v[16:19], v[96:111]
 v_add_f32 v240, v242, v240
 v_add_f32 v240, v243, v240
 v_cvt_pk_bf16_f32 v132, v242, v243
 v_exp_f32 v244, v74
 v_mfma_f32_32x32x16_bf16 v[112:127], v[236:239], v[48:51], v[112:127]
 ds_read_b64_tr_b16 v[236:237], v201 offset:40960
 ds_read_b64_tr_b16 v[238:239], v201 offset:43008
 v_exp_f32 v245, v75
 v_add_f32 v240, v244, v240
 v_add_f32 v240, v245, v240
 s_waitcnt lgkmcnt(5)
 v_mfma_f32_32x32x16_bf16 v[96:111], v[220:223], v[20:23], v[96:111]
 v_cvt_pk_bf16_f32 v133, v244, v245
 v_exp_f32 v242, v76
 v_exp_f32 v243, v77
 v_add_f32 v240, v242, v240
 v_mfma_f32_32x32x16_bf16 v[112:127], v[220:223], v[52:55], v[112:127]
 ds_read_b64_tr_b16 v[220:221], v202 offset:40960
 ds_read_b64_tr_b16 v[222:223], v202 offset:43008
 v_add_f32 v240, v243, v240
 v_cvt_pk_bf16_f32 v134, v242, v243
 v_exp_f32 v244, v78
 v_mfma_f32_32x32x16_bf16 v[96:111], v[224:227], v[24:27], v[96:111]
 v_exp_f32 v245, v79
 v_add_f32 v240, v244, v240
 v_add_f32 v240, v245, v240
 v_cvt_pk_bf16_f32 v135, v244, v245
 v_mfma_f32_32x32x16_bf16 v[112:127], v[224:227], v[56:59], v[112:127]
 ds_read_b64_tr_b16 v[224:225], v203 offset:40960
 ds_read_b64_tr_b16 v[226:227], v203 offset:43008
 v_exp_f32 v242, v80
 v_exp_f32 v243, v81
 s_waitcnt lgkmcnt(6)
 v_mfma_f32_32x32x16_bf16 v[96:111], v[228:231], v[28:31], v[96:111]
 v_add_f32 v241, v242, v243
 v_cvt_pk_bf16_f32 v136, v242, v243
 v_exp_f32 v244, v82
 v_exp_f32 v245, v83
 v_mfma_f32_32x32x16_bf16 v[112:127], v[228:231], v[60:63], v[112:127]
 ds_read_b64_tr_b16 v[228:229], v200 offset:45056
 ds_read_b64_tr_b16 v[230:231], v200 offset:47104
 v_add_f32 v241, v244, v241
 v_add_f32 v241, v245, v241
 v_cvt_pk_bf16_f32 v137, v244, v245
 v_mfma_f32_32x32x16_bf16 a[128:143], v[232:235], v[144:147], a[128:143]
 v_exp_f32 v242, v84
 v_exp_f32 v243, v85
 v_add_f32 v241, v242, v241
 v_add_f32 v241, v243, v241
 v_mfma_f32_32x32x16_bf16 a[144:159], v[232:235], v[152:155], a[144:159]
 ds_read_b64_tr_b16 v[232:233], v201 offset:45056
 ds_read_b64_tr_b16 v[234:235], v201 offset:47104
 v_cvt_pk_bf16_f32 v138, v242, v243
 v_exp_f32 v244, v86
 s_waitcnt lgkmcnt(6)
 v_mfma_f32_32x32x16_bf16 a[160:175], v[236:239], v[144:147], a[160:175]
 v_exp_f32 v245, v87
 v_add_f32 v241, v244, v241
 v_add_f32 v241, v245, v241
 v_cvt_pk_bf16_f32 v139, v244, v245
 v_mfma_f32_32x32x16_bf16 a[176:191], v[236:239], v[152:155], a[176:191]
 ds_read_b64_tr_b16 v[236:237], v202 offset:45056
 ds_read_b64_tr_b16 v[238:239], v202 offset:47104
 v_exp_f32 v242, v88
 v_exp_f32 v243, v89
 v_mfma_f32_32x32x16_bf16 a[192:207], v[220:223], v[144:147], a[192:207]
 v_add_f32 v241, v242, v241
 v_add_f32 v241, v243, v241
 v_cvt_pk_bf16_f32 v140, v242, v243
 v_exp_f32 v244, v90
 v_mfma_f32_32x32x16_bf16 a[208:223], v[220:223], v[152:155], a[208:223]
 ds_read_b64_tr_b16 v[220:221], v203 offset:45056
 ds_read_b64_tr_b16 v[222:223], v203 offset:47104
 v_exp_f32 v245, v91
 v_add_f32 v241, v244, v241
 v_add_f32 v241, v245, v241
 s_waitcnt lgkmcnt(6)
 v_mfma_f32_32x32x16_bf16 a[224:239], v[224:227], v[144:147], a[224:239]
 v_cvt_pk_bf16_f32 v141, v244, v245
 v_exp_f32 v242, v92
 v_exp_f32 v243, v93
 v_add_f32 v241, v242, v241
 v_mfma_f32_32x32x16_bf16 a[240:255], v[224:227], v[152:155], a[240:255]
 ds_read_b64_tr_b16 v[224:225], v200 offset:49152
 ds_read_b64_tr_b16 v[226:227], v200 offset:51200
 v_add_f32 v241, v243, v241
 v_cvt_pk_bf16_f32 v142, v242, v243
 v_exp_f32 v244, v94
 v_mfma_f32_32x32x16_bf16 a[128:143], v[228:231], v[148:151], a[128:143]
 v_exp_f32 v245, v95
 v_add_f32 v241, v244, v241
 v_add_f32 v241, v245, v241
 v_cvt_pk_bf16_f32 v143, v244, v245
 v_add_f32 v254, v240, v241
 v_mfma_f32_32x32x16_bf16 a[144:159], v[228:231], v[156:159], a[144:159]
 ds_read_b64_tr_b16 v[228:229], v201 offset:49152
 ds_read_b64_tr_b16 v[230:231], v201 offset:51200
 v_cmp_nge_f32 vcc, s30, v254
 s_waitcnt lgkmcnt(6)
 v_mfma_f32_32x32x16_bf16 a[160:175], v[232:235], v[148:151], a[160:175]
 v_mfma_f32_32x32x16_bf16 a[176:191], v[232:235], v[156:159], a[176:191]
 ds_read_b64_tr_b16 v[232:233], v202 offset:49152
 ds_read_b64_tr_b16 v[234:235], v202 offset:51200
 v_mfma_f32_32x32x16_bf16 a[192:207], v[236:239], v[148:151], a[192:207]
 v_mfma_f32_32x32x16_bf16 a[208:223], v[236:239], v[156:159], a[208:223]
 ds_read_b64_tr_b16 v[236:237], v203 offset:49152
 ds_read_b64_tr_b16 v[238:239], v203 offset:51200
 s_waitcnt lgkmcnt(6)
 v_mfma_f32_32x32x16_bf16 a[224:239], v[220:223], v[148:151], a[224:239]
 v_mfma_f32_32x32x16_bf16 a[240:255], v[220:223], v[156:159], a[240:255]
 s_cbranch_vccnz LR0_14
BR0_14:
 s_waitcnt vmcnt(22)
 s_barrier
 ds_read_b64_tr_b16 v[220:221], v200 offset:53248
 ds_read_b64_tr_b16 v[222:223], v200 offset:55296
 s_add_u32 m0, s28, 106496
 v_add_f32 v216, v240, v216
 v_mfma_f32_32x32x16_bf16 a[128:143], v[224:227], v[128:131], a[128:143]
 buffer_load_dwordx4 v210, s[12:15], s34 offen nt lds
 v_add_f32 v217, v241, v217
 v_exp_f32 v242, v96
 v_mfma_f32_32x32x16_bf16 a[144:159], v[224:227], v[136:139], a[144:159]
 ds_read_b64_tr_b16 v[224:225], v201 offset:53248
 ds_read_b64_tr_b16 v[226:227], v201 offset:55296
 v_exp_f32 v243, v97
 v_exp_f32 v244, v98
 s_waitcnt lgkmcnt(6)
 v_mfma_f32_32x32x16_bf16 a[160:175], v[228:231], v[128:131], a[160:175]
 buffer_load_dwordx4 v210, s[12:15], s34 offen offset:1024 nt lds
 s_add_u32 m0, s28, 57344
 s_add_u32 s76, s36, 0
 s_add_u32 s77, s36, 8192
 s_add_u32 s78, s36, 16384
 v_mfma_f32_32x32x16_bf16 a[176:191], v[228:231], v[136:139], a[176:191]
 ds_read_b64_tr_b16 v[228:229], v202 offset:53248
 ds_read_b64_tr_b16 v[230:231], v202 offset:55296
 s_add_u32 s79, s36, 24576
 s_add_u32 s80, s36, 32768
 s_add_u32 s81, s36, 40960
 s_add_u32 s82, s36, 49152
 v_mfma_f32_32x32x16_bf16 a[192:207], v[232:235], v[128:131], a[192:207]
 buffer_load_dwordx4 v208, s[8:11], s32 offen nt lds
 s_add_u32 s83, s36, 57344
 s_mov_b32 s34, 180224
 v_add_f32 v240, v242, v243
 v_cvt_pk_bf16_f32 v144, v242, v243
 v_mfma_f32_32x32x16_bf16 a[208:223], v[232:235], v[136:139], a[208:223]
 ds_read_b64_tr_b16 v[232:233], v203 offset:53248
 ds_read_b64_tr_b16 v[234:235], v203 offset:55296
 v_exp_f32 v245, v99
 v_add_f32 v240, v244, v240
 v_add_f32 v240, v245, v240
 s_waitcnt lgkmcnt(6)
 v_mfma_f32_32x32x16_bf16 a[224:239], v[236:239], v[128:131], a[224:239]
 buffer_load_dwordx4 v209, s[8:11], s32 offen offset:1024 nt lds
 s_mov_b32 s32, 196608
 v_cvt_pk_bf16_f32 v145, v244, v245
 v_exp_f32 v242, v100
 v_mfma_f32_32x32x16_bf16 a[240:255], v[236:239], v[136:139], a[240:255]
 ds_read_b64_tr_b16 v[236:237], v200 offset:57344
 ds_read_b64_tr_b16 v[238:239], v200 offset:59392
 v_exp_f32 v243, v101
 v_add_f32 v240, v242, v240
 v_add_f32 v240, v243, v240
 v_mfma_f32_32x32x16_bf16 a[128:143], v[220:223], v[132:135], a[128:143]
 v_cvt_pk_bf16_f32 v146, v242, v243
 v_exp_f32 v244, v102
 v_exp_f32 v245, v103
 v_add_f32 v240, v244, v240
 v_mfma_f32_32x32x16_bf16 a[144:159], v[220:223], v[140:143], a[144:159]
 ds_read_b64_tr_b16 v[220:221], v201 offset:57344
 ds_read_b64_tr_b16 v[222:223], v201 offset:59392
 v_add_f32 v240, v245, v240
 v_cvt_pk_bf16_f32 v147, v244, v245
 v_exp_f32 v242, v104
 s_waitcnt lgkmcnt(6)
 v_mfma_f32_32x32x16_bf16 a[160:175], v[224:227], v[132:135], a[160:175]
 v_exp_f32 v243, v105
 v_add_f32 v240, v242, v240
 v_add_f32 v240, v243, v240
 v_cvt_pk_bf16_f32 v148, v242, v243
 v_mfma_f32_32x32x16_bf16 a[176:191], v[224:227], v[140:143], a[176:191]
 ds_read_b64_tr_b16 v[224:225], v202 offset:57344
 ds_read_b64_tr_b16 v[226:227], v202 offset:59392
 v_exp_f32 v244, v106
 v_exp_f32 v245, v107
 v_mfma_f32_32x32x16_bf16 a[192:207], v[228:231], v[132:135], a[192:207]
 v_add_f32 v240, v244, v240
 v_add_f32 v240, v245, v240
 v_cvt_pk_bf16_f32 v149, v244, v245
 v_exp_f32 v242, v108
 v_mfma_f32_32x32x16_bf16 a[208:223], v[228:231], v[140:143], a[208:223]
 ds_read_b64_tr_b16 v[228:229], v203 offset:57344
 ds_read_b64_tr_b16 v[230:231], v203 offset:59392
 v_exp_f32 v243, v109
 v_add_f32 v240, v242, v240
 v_add_f32 v240, v243, v240
 s_waitcnt lgkmcnt(6)
 v_mfma_f32_32x32x16_bf16 a[224:239], v[232:235], v[132:135], a[224:239]
 v_cvt_pk_bf16_f32 v150, v242, v243
 v_exp_f32 v244, v110
 v_exp_f32 v245, v111
 v_add_f32 v240, v244, v240
 v_mfma_f32_32x32x16_bf16 a[240:255], v[232:235], v[140:143], a[240:255]
 v_add_f32 v240, v245, v240
 v_cvt_pk_bf16_f32 v151, v244, v245
 v_exp_f32 v242, v112
 v_exp_f32 v243, v113
 s_nop 0
 v_add_f32 v241, v242, v243
 v_cvt_pk_bf16_f32 v152, v242, v243
 v_exp_f32 v244, v114
 v_exp_f32 v245, v115
 v_add_f32 v241, v244, v241
 v_add_f32 v241, v245, v241
 v_cvt_pk_bf16_f32 v153, v244, v245
 v_exp_f32 v242, v116
 v_exp_f32 v243, v117
 v_add_f32 v241, v242, v241
 v_add_f32 v241, v243, v241
 v_cvt_pk_bf16_f32 v154, v242, v243
 v_exp_f32 v244, v118
 v_exp_f32 v245, v119
 v_add_f32 v241, v244, v241
 v_add_f32 v241, v245, v241
 v_cvt_pk_bf16_f32 v155, v244, v245
 v_exp_f32 v242, v120
 v_exp_f32 v243, v121
 v_add_f32 v241, v242, v241
 v_add_f32 v241, v243, v241
 v_cvt_pk_bf16_f32 v156, v242, v243
 v_exp_f32 v244, v122
 v_exp_f32 v245, v123
 v_add_f32 v241, v244, v241
 v_add_f32 v241, v245, v241
 v_cvt_pk_bf16_f32 v157, v244, v245
 v_exp_f32 v242, v124
 v_exp_f32 v243, v125
 v_add_f32 v241, v242, v241
 v_add_f32 v241, v243, v241
 v_cvt_pk_bf16_f32 v158, v242, v243
 v_exp_f32 v244, v126
 v_exp_f32 v245, v127
 v_add_f32 v241, v244, v241
 v_add_f32 v241, v245, v241
 v_cvt_pk_bf16_f32 v159, v244, v245
 v_add_f32 v254, v240, v241
 v_cmp_nge_f32 vcc, s30, v254
 s_cbranch_vccnz LR0_15
BR0_15:
 v_mfma_f32_32x32x16_bf16 a[128:143], v[236:239], v[144:147], a[128:143]
 ds_read_b64_tr_b16 v[232:233], v200 offset:61440
 ds_read_b64_tr_b16 v[234:235], v200 offset:63488
 v_add_f32 v216, v240, v216
 v_add_f32 v217, v241, v217
 v_mov_b32 v254, v216
 s_nop 1
 v_permlane32_swap_b32 v216, v254
 v_mfma_f32_32x32x16_bf16 a[144:159], v[236:239], v[152:155], a[144:159]
 ds_read_b64_tr_b16 v[236:237], v201 offset:61440
 ds_read_b64_tr_b16 v[238:239], v201 offset:63488
 v_add_f32 v216, v216, v254
 v_rcp_f32 v218, v216
 v_mov_b32 v255, v217
 s_waitcnt lgkmcnt(4)
 v_mfma_f32_32x32x16_bf16 a[160:175], v[220:223], v[144:147], a[160:175]
 v_permlane32_swap_b32 v217, v255
 v_add_f32 v217, v217, v255
 v_max_f32 v217, 8388608, v217
 v_rcp_f32 v219, v217
 v_mov_b32 v216, 0
 v_mfma_f32_32x32x16_bf16 a[176:191], v[220:223], v[152:155], a[176:191]
 ds_read_b64_tr_b16 v[220:221], v202 offset:61440
 ds_read_b64_tr_b16 v[222:223], v202 offset:63488
 v_mov_b32 v217, 0
 v_mfma_f32_32x32x16_bf16 a[192:207], v[224:227], v[144:147], a[192:207]
 v_mfma_f32_32x32x16_bf16 a[208:223], v[224:227], v[152:155], a[208:223]
 ds_read_b64_tr_b16 v[224:225], v203 offset:61440
 ds_read_b64_tr_b16 v[226:227], v203 offset:63488
 v_mfma_f32_32x32x16_bf16 a[224:239], v[228:231], v[144:147], a[224:239]
 v_mfma_f32_32x32x16_bf16 a[240:255], v[228:231], v[152:155], a[240:255]
 ds_read_b128 v[228:231], v192 offset:0
 s_waitcnt lgkmcnt(5)
 v_mfma_f32_32x32x16_bf16 a[128:143], v[232:235], v[148:151], a[128:143]
 v_mfma_f32_32x32x16_bf16 a[144:159], v[232:235], v[156:159], a[144:159]
 ds_read_b128 v[232:235], v193 offset:0
 v_mfma_f32_32x32x16_bf16 a[160:175], v[236:239], v[148:151], a[160:175]
 v_mfma_f32_32x32x16_bf16 a[176:191], v[236:239], v[156:159], a[176:191]
 ds_read_b128 v[236:239], v194 offset:0
 s_waitcnt lgkmcnt(3)
 v_mfma_f32_32x32x16_bf16 a[192:207], v[220:223], v[148:151], a[192:207]
 v_mfma_f32_32x32x16_bf16 a[208:223], v[220:223], v[156:159], a[208:223]
 ds_read_b128 v[220:223], v195 offset:0
 v_mfma_f32_32x32x16_bf16 a[224:239], v[224:227], v[148:151], a[224:239]
 v_mfma_f32_32x32x16_bf16 a[240:255], v[224:227], v[156:159], a[240:255]
 s_waitcnt vmcnt(20)
 s_barrier
 ds_read_b128 v[224:227], v196 offset:0
 s_add_u32 m0, s28, 114688
 s_nop 0
 buffer_load_dwordx4 v210, s[12:15], s34 offen nt lds
 s_waitcnt lgkmcnt(3)
 v_mfma_f32_32x32x16_bf16 v[64:79], v[228:231], a[0:3], 0
 v_mfma_f32_32x32x16_bf16 v[80:95], v[228:231], a[8:11], 0
 ds_read_b128 v[228:231], v197 offset:0
 v_mfma_f32_32x32x16_bf16 v[64:79], v[232:235], a[4:7], v[64:79]
 buffer_load_dwordx4 v210, s[12:15], s34 offen offset:1024 nt lds
 s_add_u32 m0, s28, 122880
 s_mov_b32 s34, 188416
 v_mfma_f32_32x32x16_bf16 v[80:95], v[232:235], a[12:15], v[80:95]
 ds_read_b128 v[232:235], v198 offset:0
 s_waitcnt lgkmcnt(3)
 v_mfma_f32_32x32x16_bf16 v[64:79], v[236:239], a[16:19], v[64:79]
 buffer_load_dwordx4 v210, s[12:15], s34 offen nt lds
 v_mfma_f32_32x32x16_bf16 v[80:95], v[236:239], a[24:27], v[80:95]
 ds_read_b128 v[236:239], v199 offset:0
 v_mfma_f32_32x32x16_bf16 v[64:79], v[220:223], a[20:23], v[64:79]
 buffer_load_dwordx4 v210, s[12:15], s34 offen offset:1024 nt lds
 s_mov_b32 s34, 196608
 v_mfma_f32_32x32x16_bf16 v[80:95], v[220:223], a[28:31], v[80:95]
 ds_read_b128 v[220:223], v192 offset:8192
 s_waitcnt lgkmcnt(3)
 v_mfma_f32_32x32x16_bf16 v[64:79], v[224:227], a[32:35], v[64:79]
 v_mfma_f32_32x32x16_bf16 v[80:95], v[224:227], a[40:43], v[80:95]
 ds_read_b128 v[224:227], v193 offset:8192
 v_mfma_f32_32x32x16_bf16 v[64:79], v[228:231], a[36:39], v[64:79]
 v_mfma_f32_32x32x16_bf16 v[80:95], v[228:231], a[44:47], v[80:95]
 ds_read_b128 v[228:231], v194 offset:8192
 s_waitcnt lgkmcnt(3)
 v_mfma_f32_32x32x16_bf16 v[64:79], v[232:235], a[48:51], v[64:79]
 v_mfma_f32_32x32x16_bf16 v[80:95], v[232:235], a[56:59], v[80:95]
 ds_read_b128 v[232:235], v195 offset:8192
 v_mfma_f32_32x32x16_bf16 v[64:79], v[236:239], a[52:55], v[64:79]
 v_mfma_f32_32x32x16_bf16 v[80:95], v[236:239], a[60:63], v[80:95]
 ds_read_b128 v[236:239], v196 offset:8192
 s_waitcnt lgkmcnt(3)
 v_mfma_f32_32x32x16_bf16 v[96:111], v[220:223], a[0:3], 0
 s_nop 7
 v_max3_f32 v250, v64, v65, v66
 v_max3_f32 v250, v250, v67, v68
 v_max3_f32 v250, v250, v69, v70
 v_max3_f32 v250, v250, v71, v72
 v_max3_f32 v250, v250, v73, v74
 v_max3_f32 v250, v250, v75, v76
 v_mfma_f32_32x32x16_bf16 v[112:127], v[220:223], a[8:11], 0
 ds_read_b128 v[220:223], v197 offset:8192
 v_max3_f32 v250, v250, v77, v78
 v_max_f32 v250, v79, v250
 v_mov_b32 v251, v250
 s_nop 1
 v_permlane32_swap_b32 v250, v251
 v_max_f32 v250, v250, v251
 v_mfma_f32_32x32x16_bf16 v[96:111], v[224:227], a[4:7], v[96:111]
 v_sub_f32 v64, v64, v250
 v_sub_f32 v65, v65, v250
 v_sub_f32 v66, v66, v250
 v_sub_f32 v67, v67, v250
 v_sub_f32 v68, v68, v250
 v_sub_f32 v69, v69, v250
 v_mfma_f32_32x32x16_bf16 v[112:127], v[224:227], a[12:15], v[112:127]
 ds_read_b128 v[224:227], v198 offset:8192
 v_sub_f32 v70, v70, v250
 v_sub_f32 v71, v71, v250
 v_sub_f32 v72, v72, v250
 v_sub_f32 v73, v73, v250
 v_sub_f32 v74, v74, v250
 s_waitcnt lgkmcnt(3)
 v_mfma_f32_32x32x16_bf16 v[96:111], v[228:231], a[16:19], v[96:111]
 v_sub_f32 v75, v75, v250
 v_sub_f32 v76, v76, v250
 v_sub_f32 v77, v77, v250
 v_sub_f32 v78, v78, v250
 v_sub_f32 v79, v79, v250
 v_sub_f32 v160, 0, v250
 v_mfma_f32_32x32x16_bf16 v[112:127], v[228:231], a[24:27], v[112:127]
 ds_read_b128 v[228:231], v199 offset:8192
 v_sub_f32 v161, 0, v250
 v_sub_f32 v162, 0, v250
 v_sub_f32 v163, 0, v250
 v_sub_f32 v164, 0, v250
 v_sub_f32 v165, 0, v250
 v_mfma_f32_32x32x16_bf16 v[96:111], v[232:235], a[20:23], v[96:111]
 v_sub_f32 v166, 0, v250
 v_sub_f32 v167, 0, v250
 v_sub_f32 v168, 0, v250
 v_sub_f32 v169, 0, v250
 v_sub_f32 v170, 0, v250
 v_sub_f32 v171, 0, v250
 v_mfma_f32_32x32x16_bf16 v[112:127], v[232:235], a[28:31], v[112:127]
 ds_read_b128 v[232:235], v192 offset:16384
 v_sub_f32 v172, 0, v250
 v_sub_f32 v173, 0, v250
 v_sub_f32 v174, 0, v250
 v_sub_f32 v175, 0, v250
 v_max3_f32 v252, v80, v81, v82
 s_waitcnt lgkmcnt(3)
 v_mfma_f32_32x32x16_bf16 v[96:111], v[236:239], a[32:35], v[96:111]
 v_exp_f32 v242, v64
 v_exp_f32 v243, v65
 v_exp_f32 v244, v66
 v_mfma_f32_32x32x16_bf16 v[112:127], v[236:239], a[40:43], v[112:127]
 ds_read_b128 v[236:239], v193 offset:16384
 v_add_f32 v240, v242, v243
 v_cvt_pk_bf16_f32 v128, v242, v243
 v_exp_f32 v245, v67
 v_add_f32 v240, v244, v240
 v_mfma_f32_32x32x16_bf16 v[96:111], v[220:223], a[36:39], v[96:111]
 v_add_f32 v240, v245, v240
 v_cvt_pk_bf16_f32 v129, v244, v245
 v_exp_f32 v242, v68
 v_exp_f32 v243, v69
 v_mfma_f32_32x32x16_bf16 v[112:127], v[220:223], a[44:47], v[112:127]
 ds_read_b128 v[220:223], v194 offset:16384
 v_add_f32 v240, v242, v240
 v_add_f32 v240, v243, v240
 v_cvt_pk_bf16_f32 v130, v242, v243
 v_exp_f32 v244, v70
 s_waitcnt lgkmcnt(3)
 v_mfma_f32_32x32x16_bf16 v[96:111], v[224:227], a[48:51], v[96:111]
 v_exp_f32 v245, v71
 v_add_f32 v240, v244, v240
 v_add_f32 v240, v245, v240
 v_cvt_pk_bf16_f32 v131, v244, v245
 v_max3_f32 v252, v252, v83, v84
 v_mfma_f32_32x32x16_bf16 v[112:127], v[224:227], a[56:59], v[112:127]
 ds_read_b128 v[224:227], v195 offset:16384
 v_exp_f32 v242, v72
 v_exp_f32 v243, v73
 v_add_f32 v240, v242, v240
 v_mfma_f32_32x32x16_bf16 v[96:111], v[228:231], a[52:55], v[96:111]
 v_add_f32 v240, v243, v240
 v_cvt_pk_bf16_f32 v132, v242, v243
 v_exp_f32 v244, v74
 v_exp_f32 v245, v75
 v_mfma_f32_32x32x16_bf16 v[112:127], v[228:231], a[60:63], v[112:127]
 s_waitcnt vmcnt(20)
 s_barrier
 ds_read_b128 v[228:231], v196 offset:16384
 s_add_u32 m0, s28, 0
 s_nop 0
 buffer_load_dwordx4 v208, s[8:11], s32 offen nt lds
 v_add_f32 v240, v244, v240
 v_add_f32 v240, v245, v240
 v_cvt_pk_bf16_f32 v133, v244, v245
 v_exp_f32 v242, v76
 v_exp_f32 v243, v77
 v_exp_f32 v244, v78
 v_exp_f32 v245, v79
 s_waitcnt lgkmcnt(2)
 v_mfma_f32_32x32x16_bf16 v[64:79], v[232:235], a[0:3], v[160:175]
 v_max3_f32 v252, v252, v85, v86
 buffer_load_dwordx4 v209, s[8:11], s32 offen offset:1024 nt lds
 s_add_u32 m0, s28, 8192
 s_mov_b32 s32, 204800
 v_max3_f32 v252, v252, v87, v88
 v_max3_f32 v252, v252, v89, v90
 v_max3_f32 v252, v252, v91, v92
 v_max3_f32 v252, v252, v93, v94
 v_max_f32 v252, v95, v252
 v_mov_b32 v253, v252
 s_nop 1
 v_permlane32_swap_b32 v252, v253
 v_max_f32 v252, v252, v253
 v_and_b32 v253, 6400, v214
 v_cmp_eq_u32 vcc, 0x1900, v253
 v_mov_b32 v253, 1900671690
 s_nop 0
 v_cndmask_b32 v252, v252, v253, vcc
 v_sub_f32 v80, v80, v252
 v_sub_f32 v81, v81, v252
 v_sub_f32 v82, v82, v252
 v_sub_f32 v83, v83, v252
 v_sub_f32 v84, v84, v252
 v_sub_f32 v85, v85, v252
 v_sub_f32 v86, v86, v252
 v_sub_f32 v87, v87, v252
 v_sub_f32 v88, v88, v252
 v_sub_f32 v89, v89, v252
 v_sub_f32 v90, v90, v252
 v_sub_f32 v91, v91, v252
 v_sub_f32 v92, v92, v252
 v_sub_f32 v93, v93, v252
 v_sub_f32 v94, v94, v252
 v_sub_f32 v95, v95, v252
 v_sub_f32 v176, 0, v252
 v_sub_f32 v177, 0, v252
 v_sub_f32 v178, 0, v252
 v_sub_f32 v179, 0, v252
 v_sub_f32 v180, 0, v252
 v_sub_f32 v181, 0, v252
 v_sub_f32 v182, 0, v252
 v_sub_f32 v183, 0, v252
 v_sub_f32 v184, 0, v252
 v_sub_f32 v185, 0, v252
 v_sub_f32 v186, 0, v252
 v_sub_f32 v187, 0, v252
 v_sub_f32 v188, 0, v252
 v_sub_f32 v189, 0, v252
 v_sub_f32 v190, 0, v252
 v_sub_f32 v191, 0, v252
 v_add_f32 v240, v242, v240
 v_add_f32 v240, v243, v240
 v_cvt_pk_bf16_f32 v134, v242, v243
 v_add_f32 v240, v244, v240
 v_add_f32 v240, v245, v240
 v_cvt_pk_bf16_f32 v135, v244, v245
 v_exp_f32 v242, v80
 v_exp_f32 v243, v81
 s_nop 0
 v_add_f32 v241, v242, v243
 v_cvt_pk_bf16_f32 v136, v242, v243
 v_exp_f32 v244, v82
 v_exp_f32 v245, v83
 v_add_f32 v241, v244, v241
 v_add_f32 v241, v245, v241
 v_cvt_pk_bf16_f32 v137, v244, v245
 v_exp_f32 v242, v84
 v_exp_f32 v243, v85
 v_add_f32 v241, v242, v241
 v_add_f32 v241, v243, v241
 v_cvt_pk_bf16_f32 v138, v242, v243
 v_exp_f32 v244, v86
 v_exp_f32 v245, v87
 v_add_f32 v241, v244, v241
 v_add_f32 v241, v245, v241
 v_cvt_pk_bf16_f32 v139, v244, v245
 v_exp_f32 v242, v88
 v_exp_f32 v243, v89
 v_add_f32 v241, v242, v241
 v_add_f32 v241, v243, v241
 v_cvt_pk_bf16_f32 v140, v242, v243
 v_exp_f32 v244, v90
 v_exp_f32 v245, v91
 v_add_f32 v241, v244, v241
 v_add_f32 v241, v245, v241
 v_cvt_pk_bf16_f32 v141, v244, v245
 v_exp_f32 v242, v92
 v_exp_f32 v243, v93
 v_exp_f32 v244, v94
 v_exp_f32 v245, v95
 v_mfma_f32_32x32x16_bf16 v[80:95], v[232:235], a[8:11], v[176:191]
 ds_read_b128 v[232:235], v197 offset:16384
 buffer_load_dwordx4 v208, s[8:11], s32 offen nt lds
 v_cvt_pk_bf16_f32 v142, v242, v243
 v_cvt_pk_bf16_f32 v143, v244, v245
 v_add_f32 v241, v242, v241
 v_mfma_f32_32x32x16_bf16 v[64:79], v[236:239], a[4:7], v[64:79]
 v_add_f32 v241, v243, v241
 v_add_f32 v241, v244, v241
 v_add_f32 v241, v245, v241
 v_add_f32 v216, v240, v216
 v_add_f32 v217, v241, v217
 v_add_f32 v96, v160, v96
 v_mfma_f32_32x32x16_bf16 v[80:95], v[236:239], a[12:15], v[80:95]
 ds_read_b128 v[236:239], v198 offset:16384
 buffer_load_dwordx4 v209, s[8:11], s32 offen offset:1024 nt lds
 s_mov_b32 s32, 212992
 v_add_f32 v97, v161, v97
 v_add_f32 v98, v162, v98
 v_mfma_f32_32x32x16_bf16 v[64:79], v[220:223], a[16:19], v[64:79]
 v_add_f32 v99, v163, v99
 v_add_f32 v100, v164, v100
 v_add_f32 v101, v165, v101
 v_add_f32 v102, v166, v102
 v_add_f32 v103, v167, v103
 v_add_f32 v104, v168, v104
 v_mfma_f32_32x32x16_bf16 v[80:95], v[220:223], a[24:27], v[80:95]
 ds_read_b128 v[220:223], v199 offset:16384
 v_add_f32 v105, v169, v105
 v_add_f32 v106, v170, v106
 v_add_f32 v107, v171, v107
 v_add_f32 v108, v172, v108
 v_add_f32 v109, v173, v109
 s_waitcnt lgkmcnt(3)
 v_mfma_f32_32x32x16_bf16 v[64:79], v[224:227], a[20:23], v[64:79]
 v_add_f32 v110, v174, v110
 v_add_f32 v111, v175, v111
 v_add_f32 v112, v176, v112
 v_add_f32 v113, v177, v113
 v_add_f32 v114, v178, v114
 v_add_f32 v115, v179, v115
 v_mfma_f32_32x32x16_bf16 v[80:95], v[224:227], a[28:31], v[80:95]
 ds_read_b64_tr_b16 v[224:225], v200 offset:0
 ds_read_b64_tr_b16 v[226:227], v200 offset:2048
 v_add_f32 v116, v180, v116
 v_add_f32 v117, v181, v117
 v_add_f32 v118, v182, v118
 v_add_f32 v119, v183, v119
 v_mfma_f32_32x32x16_bf16 v[64:79], v[228:231], a[32:35], v[64:79]
 v_add_f32 v120, v184, v120
 v_add_f32 v121, v185, v121
 v_add_f32 v122, v186, v122
 v_add_f32 v123, v187, v123
 v_add_f32 v124, v188, v124
 v_add_f32 v125, v189, v125
 v_mfma_f32_32x32x16_bf16 v[80:95], v[228:231], a[40:43], v[80:95]
 ds_read_b64_tr_b16 v[228:229], v201 offset:0
 ds_read_b64_tr_b16 v[230:231], v201 offset:2048
 v_add_f32 v126, v190, v126
 v_add_f32 v127, v191, v127
 v_exp_f32 v242, v96
 s_waitcnt lgkmcnt(5)
 v_mfma_f32_32x32x16_bf16 v[64:79], v[232:235], a[36:39], v[64:79]
 v_exp_f32 v243, v97
 v_exp_f32 v244, v98
 v_add_f32 v240, v242, v243
 v_cvt_pk_bf16_f32 v144, v242, v243
 v_mfma_f32_32x32x16_bf16 v[80:95], v[232:235], a[44:47], v[80:95]
 ds_read_b64_tr_b16 v[232:233], v202 offset:0
 ds_read_b64_tr_b16 v[234:235], v202 offset:2048
 v_exp_f32 v245, v99
 v_add_f32 v240, v244, v240
 v_add_f32 v240, v245, v240
 v_mfma_f32_32x32x16_bf16 v[64:79], v[236:239], a[48:51], v[64:79]
 v_cvt_pk_bf16_f32 v145, v244, v245
 v_exp_f32 v242, v100
 v_exp_f32 v243, v101
 v_add_f32 v240, v242, v240
 v_mfma_f32_32x32x16_bf16 v[80:95], v[236:239], a[56:59], v[80:95]
 ds_read_b64_tr_b16 v[236:237], v203 offset:0
 ds_read_b64_tr_b16 v[238:239], v203 offset:2048
 v_add_f32 v240, v243, v240
 v_cvt_pk_bf16_f32 v146, v242, v243
 v_exp_f32 v244, v102
 s_waitcnt lgkmcnt(6)
 v_mfma_f32_32x32x16_bf16 v[64:79], v[220:223], a[52:55], v[64:79]
 v_exp_f32 v245, v103
 v_add_f32 v240, v244, v240
 v_add_f32 v240, v245, v240
 v_cvt_pk_bf16_f32 v147, v244, v245
 v_mfma_f32_32x32x16_bf16 v[80:95], v[220:223], a[60:63], v[80:95]
 ds_read_b64_tr_b16 v[220:221], v200 offset:4096
 ds_read_b64_tr_b16 v[222:223], v200 offset:6144
 v_exp_f32 v242, v104
 v_exp_f32 v243, v105
 v_mfma_f32_32x32x16_bf16 a[64:79], v[224:227], v[128:131], 0
 v_add_f32 v240, v242, v240
 v_add_f32 v240, v243, v240
 v_cvt_pk_bf16_f32 v148, v242, v243
 v_exp_f32 v244, v106
 v_mfma_f32_32x32x16_bf16 a[80:95], v[224:227], v[136:139], 0
 ds_read_b64_tr_b16 v[224:225], v201 offset:4096
 ds_read_b64_tr_b16 v[226:227], v201 offset:6144
 v_exp_f32 v245, v107
 v_add_f32 v240, v244, v240
 v_add_f32 v240, v245, v240
 s_waitcnt lgkmcnt(6)
 v_mfma_f32_32x32x16_bf16 a[96:111], v[228:231], v[128:131], 0
 v_cvt_pk_bf16_f32 v149, v244, v245
 v_exp_f32 v242, v108
 v_exp_f32 v243, v109
 v_add_f32 v240, v242, v240
 v_mfma_f32_32x32x16_bf16 a[112:127], v[228:231], v[136:139], 0
 ds_read_b64_tr_b16 v[228:229], v202 offset:4096
 ds_read_b64_tr_b16 v[230:231], v202 offset:6144
 v_add_f32 v240, v243, v240
 v_cvt_pk_bf16_f32 v150, v242, v243
 v_exp_f32 v244, v110
 v_mfma_f32_32x32x16_bf16 v[0:15], v[232:235], v[128:131], 0
 v_exp_f32 v245, v111
 v_add_f32 v240, v244, v240
 v_add_f32 v240, v245, v240
 v_cvt_pk_bf16_f32 v151, v244, v245
 v_mfma_f32_32x32x16_bf16 v[16:31], v[232:235], v[136:139], 0
 ds_read_b64_tr_b16 v[232:233], v203 offset:4096
 ds_read_b64_tr_b16 v[234:235], v203 offset:6144
 v_exp_f32 v242, v112
 v_exp_f32 v243, v113
 s_waitcnt lgkmcnt(6)
 v_mfma_f32_32x32x16_bf16 v[32:47], v[236:239], v[128:131], 0
 v_add_f32 v241, v242, v243
 v_cvt_pk_bf16_f32 v152, v242, v243
 v_exp_f32 v244, v114
 v_exp_f32 v245, v115
 v_mfma_f32_32x32x16_bf16 v[48:63], v[236:239], v[136:139], 0
 ds_read_b128 v[236:239], v192 offset:24576
 v_add_f32 v241, v244, v241
 v_add_f32 v241, v245, v241
 v_cvt_pk_bf16_f32 v153, v244, v245
 v_exp_f32 v242, v116
 v_mfma_f32_32x32x16_bf16 a[64:79], v[220:223], v[132:135], a[64:79]
 v_exp_f32 v243, v117
 v_add_f32 v241, v242, v241
 v_add_f32 v241, v243, v241
 v_cvt_pk_bf16_f32 v154, v242, v243
 v_mfma_f32_32x32x16_bf16 a[80:95], v[220:223], v[140:143], a[80:95]
 ds_read_b128 v[220:223], v193 offset:24576
 v_exp_f32 v244, v118
 v_exp_f32 v245, v119
 v_add_f32 v241, v244, v241
 s_waitcnt lgkmcnt(4)
 v_mfma_f32_32x32x16_bf16 a[96:111], v[224:227], v[132:135], a[96:111]
 v_add_f32 v241, v245, v241
 v_cvt_pk_bf16_f32 v155, v244, v245
 v_exp_f32 v242, v120
 v_exp_f32 v243, v121
 v_mfma_f32_32x32x16_bf16 a[112:127], v[224:227], v[140:143], a[112:127]
 ds_read_b128 v[224:227], v194 offset:24576
 v_add_f32 v241, v242, v241
 v_add_f32 v241, v243, v241
 v_cvt_pk_bf16_f32 v156, v242, v243
 v_exp_f32 v244, v122
 v_mfma_f32_32x32x16_bf16 v[0:15], v[228:231], v[132:135], v[0:15]
 v_exp_f32 v245, v123
 v_add_f32 v241, v244, v241
 v_add_f32 v241, v245, v241
 v_cvt_pk_bf16_f32 v157, v244, v245
 v_mfma_f32_32x32x16_bf16 v[16:31], v[228:231], v[140:143], v[16:31]
 ds_read_b128 v[228:231], v195 offset:24576
 v_exp_f32 v242, v124
 v_exp_f32 v243, v125
 v_add_f32 v241, v242, v241
 s_waitcnt lgkmcnt(3)
 v_mfma_f32_32x32x16_bf16 v[32:47], v[232:235], v[132:135], v[32:47]
 v_add_f32 v241, v243, v241
 v_cvt_pk_bf16_f32 v158, v242, v243
 v_exp_f32 v244, v126
 v_exp_f32 v245, v127
 v_mfma_f32_32x32x16_bf16 v[48:63], v[232:235], v[140:143], v[48:63]
 v_add_f32 v241, v244, v241
 v_add_f32 v241, v245, v241
 v_cvt_pk_bf16_f32 v159, v244, v245
 v_add_f32 v254, v240, v241
 v_cmp_nge_f32 vcc, s30, v254
 s_cbranch_vccnz LR1_1
BR1_1:
 s_waitcnt vmcnt(20)
 s_barrier
 v_mfma_f32_32x32x16_bf16 v[96:111], v[236:239], a[0:3], v[160:175]
 ds_read_b128 v[232:235], v196 offset:24576
 s_add_u32 m0, s28, 65536
 s_nop 0
 buffer_load_dwordx4 v210, s[12:15], s34 offen nt lds
 v_add_f32 v216, v240, v216
 v_add_f32 v217, v241, v217
 v_mfma_f32_32x32x16_bf16 v[112:127], v[236:239], a[8:11], v[176:191]
 ds_read_b128 v[236:239], v197 offset:24576
 v_exp_f32 v242, v64
 v_exp_f32 v243, v65
 s_waitcnt lgkmcnt(3)
 v_mfma_f32_32x32x16_bf16 v[96:111], v[220:223], a[4:7], v[96:111]
 v_add_f32 v240, v242, v243
 v_cvt_pk_bf16_f32 v128, v242, v243
 buffer_load_dwordx4 v210, s[12:15], s34 offen offset:1024 nt lds
 s_add_u32 m0, s28, 16384
 s_mov_b32 s34, 204800
 v_mfma_f32_32x32x16_bf16 v[112:127], v[220:223], a[12:15], v[112:127]
 ds_read_b128 v[220:223], v198 offset:24576
 v_exp_f32 v244, v66
 v_exp_f32 v245, v67
 v_add_f32 v240, v244, v240
 v_mfma_f32_32x32x16_bf16 v[96:111], v[224:227], a[16:19], v[96:111]
 v_add_f32 v240, v245, v240
 v_cvt_pk_bf16_f32 v129, v244, v245
 buffer_load_dwordx4 v208, s[8:11], s32 offen nt lds
 v_exp_f32 v242, v68
 v_mfma_f32_32x32x16_bf16 v[112:127], v[224:227], a[24:27], v[112:127]
 ds_read_b128 v[224:227], v199 offset:24576
 v_exp_f32 v243, v69
 v_add_f32 v240, v242, v240
 v_add_f32 v240, v243, v240
 v_cvt_pk_bf16_f32 v130, v242, v243
 s_waitcnt lgkmcnt(3)
 v_mfma_f32_32x32x16_bf16 v[96:111], v[228:231], a[20:23], v[96:111]
 v_exp_f32 v244, v70
 buffer_load_dwordx4 v209, s[8:11], s32 offen offset:1024 nt lds
 s_mov_b32 s32, 221184
 v_add_f32 v240, v244, v240
 v_mfma_f32_32x32x16_bf16 v[112:127], v[228:231], a[28:31], v[112:127]
 ds_read_b64_tr_b16 v[228:229], v200 offset:8192
 ds_read_b64_tr_b16 v[230:231], v200 offset:10240
 v_exp_f32 v245, v71
 v_exp_f32 v242, v72
 v_mfma_f32_32x32x16_bf16 v[96:111], v[232:235], a[32:35], v[96:111]
 v_add_f32 v240, v245, v240
 v_cvt_pk_bf16_f32 v131, v244, v245
 v_exp_f32 v243, v73
 v_add_f32 v240, v242, v240
 v_add_f32 v240, v243, v240
 v_mfma_f32_32x32x16_bf16 v[112:127], v[232:235], a[40:43], v[112:127]
 ds_read_b64_tr_b16 v[232:233], v201 offset:8192
 ds_read_b64_tr_b16 v[234:235], v201 offset:10240
 v_cvt_pk_bf16_f32 v132, v242, v243
 v_exp_f32 v244, v74
 s_waitcnt lgkmcnt(5)
 v_mfma_f32_32x32x16_bf16 v[96:111], v[236:239], a[36:39], v[96:111]
 v_exp_f32 v245, v75
 v_add_f32 v240, v244, v240
 v_add_f32 v240, v245, v240
 v_cvt_pk_bf16_f32 v133, v244, v245
 v_mfma_f32_32x32x16_bf16 v[112:127], v[236:239], a[44:47], v[112:127]
 ds_read_b64_tr_b16 v[236:237], v202 offset:8192
 ds_read_b64_tr_b16 v[238:239], v202 offset:10240
 v_exp_f32 v242, v76
 v_exp_f32 v243, v77
 v_mfma_f32_32x32x16_bf16 v[96:111], v[220:223], a[48:51], v[96:111]
 v_add_f32 v240, v242, v240
 v_add_f32 v240, v243, v240
 v_cvt_pk_bf16_f32 v134, v242, v243
 v_exp_f32 v244, v78
 v_mfma_f32_32x32x16_bf16 v[112:127], v[220:223], a[56:59], v[112:127]
 ds_read_b64_tr_b16 v[220:221], v203 offset:8192
 ds_read_b64_tr_b16 v[222:223], v203 offset:10240
 v_exp_f32 v245, v79
 v_add_f32 v240, v244, v240
 v_add_f32 v240, v245, v240
 s_waitcnt lgkmcnt(6)
 v_mfma_f32_32x32x16_bf16 v[96:111], v[224:227], a[52:55], v[96:111]
 v_cvt_pk_bf16_f32 v135, v244, v245
 v_exp_f32 v242, v80
 v_exp_f32 v243, v81
 v_mfma_f32_32x32x16_bf16 v[112:127], v[224:227], a[60:63], v[112:127]
 ds_read_b64_tr_b16 v[224:225], v200 offset:12288
 ds_read_b64_tr_b16 v[226:227], v200 offset:14336
 v_add_f32 v241, v242, v243
 v_cvt_pk_bf16_f32 v136, v242, v243
 v_exp_f32 v244, v82
 v_mfma_f32_32x32x16_bf16 a[64:79], v[228:231], v[144:147], a[64:79]
 v_exp_f32 v245, v83
 v_add_f32 v241, v244, v241
 v_add_f32 v241, v245, v241
 v_cvt_pk_bf16_f32 v137, v244, v245
 v_mfma_f32_32x32x16_bf16 a[80:95], v[228:231], v[152:155], a[80:95]
 ds_read_b64_tr_b16 v[228:229], v201 offset:12288
 ds_read_b64_tr_b16 v[230:231], v201 offset:14336
 v_exp_f32 v242, v84
 v_exp_f32 v243, v85
 s_waitcnt lgkmcnt(6)
 v_mfma_f32_32x32x16_bf16 a[96:111], v[232:235], v[144:147], a[96:111]
 v_add_f32 v241, v242, v241
 v_add_f32 v241, v243, v241
 v_cvt_pk_bf16_f32 v138, v242, v243
 v_exp_f32 v244, v86
 v_mfma_f32_32x32x16_bf16 a[112:127], v[232:235], v[152:155], a[112:127]
 ds_read_b64_tr_b16 v[232:233], v202 offset:12288
 ds_read_b64_tr_b16 v[234:235], v202 offset:14336
 v_exp_f32 v245, v87
 v_add_f32 v241, v244, v241
 v_add_f32 v241, v245, v241
 v_mfma_f32_32x32x16_bf16 v[0:15], v[236:239], v[144:147], v[0:15]
 v_cvt_pk_bf16_f32 v139, v244, v245
 v_exp_f32 v242, v88
 v_exp_f32 v243, v89
 v_add_f32 v241, v242, v241
 v_mfma_f32_32x32x16_bf16 v[16:31], v[236:239], v[152:155], v[16:31]
 ds_read_b64_tr_b16 v[236:237], v203 offset:12288
 ds_read_b64_tr_b16 v[238:239], v203 offset:14336
 v_add_f32 v241, v243, v241
 v_cvt_pk_bf16_f32 v140, v242, v243
 v_exp_f32 v244, v90
 s_waitcnt lgkmcnt(6)
 v_mfma_f32_32x32x16_bf16 v[32:47], v[220:223], v[144:147], v[32:47]
 v_exp_f32 v245, v91
 v_add_f32 v241, v244, v241
 v_add_f32 v241, v245, v241
 v_cvt_pk_bf16_f32 v141, v244, v245
 v_mfma_f32_32x32x16_bf16 v[48:63], v[220:223], v[152:155], v[48:63]
 ds_read_b128 v[220:223], v192 offset:32768
 v_exp_f32 v242, v92
 v_exp_f32 v243, v93
 v_add_f32 v241, v242, v241
 v_mfma_f32_32x32x16_bf16 a[64:79], v[224:227], v[148:151], a[64:79]
 v_add_f32 v241, v243, v241
 v_cvt_pk_bf16_f32 v142, v242, v243
 v_exp_f32 v244, v94
 v_exp_f32 v245, v95
 v_mfma_f32_32x32x16_bf16 a[80:95], v[224:227], v[156:159], a[80:95]
 ds_read_b128 v[224:227], v193 offset:32768
 v_add_f32 v241, v244, v241
 v_add_f32 v241, v245, v241
 v_cvt_pk_bf16_f32 v143, v244, v245
 v_add_f32 v254, v240, v241
 v_cmp_nge_f32 vcc, s30, v254
 s_waitcnt lgkmcnt(4)
 v_mfma_f32_32x32x16_bf16 a[96:111], v[228:231], v[148:151], a[96:111]
 v_mfma_f32_32x32x16_bf16 a[112:127], v[228:231], v[156:159], a[112:127]
 ds_read_b128 v[228:231], v194 offset:32768
 v_mfma_f32_32x32x16_bf16 v[0:15], v[232:235], v[148:151], v[0:15]
 v_mfma_f32_32x32x16_bf16 v[16:31], v[232:235], v[156:159], v[16:31]
 ds_read_b128 v[232:235], v195 offset:32768
 s_waitcnt lgkmcnt(3)
 v_mfma_f32_32x32x16_bf16 v[32:47], v[236:239], v[148:151], v[32:47]
 v_mfma_f32_32x32x16_bf16 v[48:63], v[236:239], v[156:159], v[48:63]
 s_cbranch_vccnz LR1_2
BR1_2:
 s_waitcnt vmcnt(20)
 s_barrier
 ds_read_b128 v[236:239], v196 offset:32768
 s_add_u32 m0, s28, 73728
 s_nop 0
 buffer_load_dwordx4 v210, s[12:15], s34 offen nt lds
 v_mfma_f32_32x32x16_bf16 v[64:79], v[220:223], a[0:3], v[160:175]
 v_add_f32 v216, v240, v216
 v_add_f32 v217, v241, v217
 v_exp_f32 v242, v96
 v_exp_f32 v243, v97
 v_mfma_f32_32x32x16_bf16 v[80:95], v[220:223], a[8:11], v[176:191]
 ds_read_b128 v[220:223], v197 offset:32768
 v_add_f32 v240, v242, v243
 v_cvt_pk_bf16_f32 v144, v242, v243
 v_exp_f32 v244, v98
 v_accvgpr_read_b32 v250, a128
 s_waitcnt lgkmcnt(3)
 v_mfma_f32_32x32x16_bf16 v[64:79], v[224:227], a[4:7], v[64:79]
 buffer_load_dwordx4 v210, s[12:15], s34 offen offset:1024 nt lds
 s_add_u32 m0, s28, 24576
 s_mov_b32 s34, 212992
 v_exp_f32 v245, v99
 v_mfma_f32_32x32x16_bf16 v[80:95], v[224:227], a[12:15], v[80:95]
 ds_read_b128 v[224:227], v198 offset:32768
 v_add_f32 v240, v244, v240
 v_add_f32 v240, v245, v240
 v_cvt_pk_bf16_f32 v145, v244, v245
 v_exp_f32 v242, v100
 v_mfma_f32_32x32x16_bf16 v[64:79], v[228:231], a[16:19], v[64:79]
 buffer_load_dwordx4 v208, s[8:11], s32 offen nt lds
 v_exp_f32 v243, v101
 v_add_f32 v240, v242, v240
 v_add_f32 v240, v243, v240
 v_mfma_f32_32x32x16_bf16 v[80:95], v[228:231], a[24:27], v[80:95]
 ds_read_b128 v[228:231], v199 offset:32768
 v_cvt_pk_bf16_f32 v146, v242, v243
 v_exp_f32 v244, v102
 v_exp_f32 v245, v103
 s_waitcnt lgkmcnt(3)
 v_mfma_f32_32x32x16_bf16 v[64:79], v[232:235], a[20:23], v[64:79]
 buffer_load_dwordx4 v209, s[8:11], s32 offen offset:1024 nt lds
 s_mov_b32 s32, 229376
 v_add_f32 v240, v244, v240
 v_add_f32 v240, v245, v240
 v_cvt_pk_bf16_f32 v147, v244, v245
 v_mfma_f32_32x32x16_bf16 v[80:95], v[232:235], a[28:31], v[80:95]
 ds_read_b64_tr_b16 v[232:233], v200 offset:16384
 ds_read_b64_tr_b16 v[234:235], v200 offset:18432
 v_exp_f32 v242, v104
 v_exp_f32 v243, v105
 v_mfma_f32_32x32x16_bf16 v[64:79], v[236:239], a[32:35], v[64:79]
 v_add_f32 v240, v242, v240
 v_add_f32 v240, v243, v240
 v_cvt_pk_bf16_f32 v148, v242, v243
 v_exp_f32 v244, v106
 v_accvgpr_read_b32 v251, a129
 v_mfma_f32_32x32x16_bf16 v[80:95], v[236:239], a[40:43], v[80:95]
 ds_read_b64_tr_b16 v[236:237], v201 offset:16384
 ds_read_b64_tr_b16 v[238:239], v201 offset:18432
 v_exp_f32 v245, v107
 v_add_f32 v240, v244, v240
 v_add_f32 v240, v245, v240
 s_waitcnt lgkmcnt(5)
 v_mfma_f32_32x32x16_bf16 v[64:79], v[220:223], a[36:39], v[64:79]
 v_cvt_pk_bf16_f32 v149, v244, v245
 v_exp_f32 v242, v108
 v_exp_f32 v243, v109
 v_add_f32 v240, v242, v240
 v_mfma_f32_32x32x16_bf16 v[80:95], v[220:223], a[44:47], v[80:95]
 ds_read_b64_tr_b16 v[220:221], v202 offset:16384
 ds_read_b64_tr_b16 v[222:223], v202 offset:18432
 v_add_f32 v240, v243, v240
 v_cvt_pk_bf16_f32 v150, v242, v243
 v_exp_f32 v244, v110
 v_mfma_f32_32x32x16_bf16 v[64:79], v[224:227], a[48:51], v[64:79]
 v_exp_f32 v245, v111
 v_add_f32 v240, v244, v240
 v_add_f32 v240, v245, v240
 v_cvt_pk_bf16_f32 v151, v244, v245
 v_accvgpr_read_b32 v252, a130
 v_mfma_f32_32x32x16_bf16 v[80:95], v[224:227], a[56:59], v[80:95]
 ds_read_b64_tr_b16 v[224:225], v203 offset:16384
 ds_read_b64_tr_b16 v[226:227], v203 offset:18432
 v_exp_f32 v242, v112
 v_exp_f32 v243, v113
 s_waitcnt lgkmcnt(6)
 v_mfma_f32_32x32x16_bf16 v[64:79], v[228:231], a[52:55], v[64:79]
 v_add_f32 v241, v242, v243
 v_cvt_pk_bf16_f32 v152, v242, v243
 v_exp_f32 v244, v114
 v_exp_f32 v245, v115
 v_mfma_f32_32x32x16_bf16 v[80:95], v[228:231], a[60:63], v[80:95]
 ds_read_b64_tr_b16 v[228:229], v200 offset:20480
 ds_read_b64_tr_b16 v[230:231], v200 offset:22528
 v_add_f32 v241, v244, v241
 v_add_f32 v241, v245, v241
 v_cvt_pk_bf16_f32 v153, v244, v245
 v_accvgpr_read_b32 v253, a131
 v_mfma_f32_32x32x16_bf16 a[64:79], v[232:235], v[128:131], a[64:79]
 v_exp_f32 v242, v116
 v_exp_f32 v243, v117
 v_add_f32 v241, v242, v241
 v_add_f32 v241, v243, v241
 v_mfma_f32_32x32x16_bf16 a[80:95], v[232:235], v[136:139], a[80:95]
 ds_read_b64_tr_b16 v[232:233], v201 offset:20480
 ds_read_b64_tr_b16 v[234:235], v201 offset:22528
 v_cvt_pk_bf16_f32 v154, v242, v243
 v_exp_f32 v244, v118
 v_mul_f32 v250, v218, v250
 s_waitcnt lgkmcnt(6)
 v_mfma_f32_32x32x16_bf16 a[96:111], v[236:239], v[128:131], a[96:111]
 v_exp_f32 v245, v119
 v_add_f32 v241, v244, v241
 v_add_f32 v241, v245, v241
 v_cvt_pk_bf16_f32 v155, v244, v245
 v_mul_f32 v251, v218, v251
 v_mfma_f32_32x32x16_bf16 a[112:127], v[236:239], v[136:139], a[112:127]
 ds_read_b64_tr_b16 v[236:237], v202 offset:20480
 ds_read_b64_tr_b16 v[238:239], v202 offset:22528
 v_exp_f32 v242, v120
 v_exp_f32 v243, v121
 v_mfma_f32_32x32x16_bf16 v[0:15], v[220:223], v[128:131], v[0:15]
 v_add_f32 v241, v242, v241
 v_add_f32 v241, v243, v241
 v_cvt_pk_bf16_f32 v156, v242, v243
 v_exp_f32 v244, v122
 v_mul_f32 v252, v218, v252
 v_mfma_f32_32x32x16_bf16 v[16:31], v[220:223], v[136:139], v[16:31]
 ds_read_b64_tr_b16 v[220:221], v203 offset:20480
 ds_read_b64_tr_b16 v[222:223], v203 offset:22528
 v_exp_f32 v245, v123
 v_add_f32 v241, v244, v241
 v_add_f32 v241, v245, v241
 s_waitcnt lgkmcnt(6)
 v_mfma_f32_32x32x16_bf16 v[32:47], v[224:227], v[128:131], v[32:47]
 v_cvt_pk_bf16_f32 v157, v244, v245
 v_exp_f32 v242, v124
 v_exp_f32 v243, v125
 v_add_f32 v241, v242, v241
 v_mfma_f32_32x32x16_bf16 v[48:63], v[224:227], v[136:139], v[48:63]
 ds_read_b128 v[224:227], v192 offset:40960
 v_add_f32 v241, v243, v241
 v_cvt_pk_bf16_f32 v158, v242, v243
 v_exp_f32 v244, v126
 v_mul_f32 v253, v218, v253
 v_mfma_f32_32x32x16_bf16 a[64:79], v[228:231], v[132:135], a[64:79]
 v_exp_f32 v245, v127
 v_add_f32 v241, v244, v241
 v_add_f32 v241, v245, v241
 v_cvt_pk_bf16_f32 v159, v244, v245
 v_cvt_pk_bf16_f32 v246, v250, v251
 v_mfma_f32_32x32x16_bf16 a[80:95], v[228:231], v[140:143], a[80:95]
 ds_read_b128 v[228:231], v193 offset:40960
 v_cvt_pk_bf16_f32 v247, v252, v253
 v_accvgpr_read_b32 v250, a132
 v_accvgpr_read_b32 v251, a133
 v_accvgpr_read_b32 v252, a134
 v_accvgpr_read_b32 v253, a135
 s_waitcnt lgkmcnt(4)
 v_mfma_f32_32x32x16_bf16 a[96:111], v[232:235], v[132:135], a[96:111]
 v_mul_f32 v250, v218, v250
 v_mul_f32 v251, v218, v251
 v_mul_f32 v252, v218, v252
 v_mul_f32 v253, v218, v253
 v_cvt_pk_bf16_f32 v248, v250, v251
 v_cvt_pk_bf16_f32 v249, v252, v253
 v_mfma_f32_32x32x16_bf16 a[112:127], v[232:235], v[140:143], a[112:127]
 ds_read_b128 v[232:235], v194 offset:40960
 buffer_store_dwordx4 v[246:249], v214, s[24:27], s76 offen offset:0 sc1
 v_accvgpr_read_b32 v250, a136
 v_accvgpr_read_b32 v251, a137
 v_accvgpr_read_b32 v252, a138
 v_mfma_f32_32x32x16_bf16 v[0:15], v[236:239], v[132:135], v[0:15]
 v_accvgpr_read_b32 v253, a139
 v_mul_f32 v250, v218, v250
 v_mul_f32 v251, v218, v251
 v_mul_f32 v252, v218, v252
 v_mul_f32 v253, v218, v253
 v_cvt_pk_bf16_f32 v246, v250, v251
 v_mfma_f32_32x32x16_bf16 v[16:31], v[236:239], v[140:143], v[16:31]
 ds_read_b128 v[236:239], v195 offset:40960
 v_cvt_pk_bf16_f32 v247, v252, v253
 v_accvgpr_read_b32 v250, a140
 v_accvgpr_read_b32 v251, a141
 v_accvgpr_read_b32 v252, a142
 v_accvgpr_read_b32 v253, a143
 s_waitcnt lgkmcnt(3)
 v_mfma_f32_32x32x16_bf16 v[32:47], v[220:223], v[132:135], v[32:47]
 v_mul_f32 v250, v218, v250
 v_mul_f32 v251, v218, v251
 v_mul_f32 v252, v218, v252
 v_mul_f32 v253, v218, v253
 v_cvt_pk_bf16_f32 v248, v250, v251
 v_cvt_pk_bf16_f32 v249, v252, v253
 v_mfma_f32_32x32x16_bf16 v[48:63], v[220:223], v[140:143], v[48:63]
 buffer_store_dwordx4 v[246:249], v214, s[24:27], s77 offen offset:0 sc1
 v_add_f32 v254, v240, v241
 v_cmp_nge_f32 vcc, s30, v254
 s_cbranch_vccnz LR1_3
BR1_3:
 s_waitcnt vmcnt(22)
 s_barrier
 v_mfma_f32_32x32x16_bf16 v[96:111], v[224:227], a[0:3], v[160:175]
 ds_read_b128 v[220:223], v196 offset:40960
 s_add_u32 m0, s28, 81920
 v_add_f32 v216, v240, v216
 v_add_f32 v217, v241, v217
 v_exp_f32 v242, v64
 v_mfma_f32_32x32x16_bf16 v[112:127], v[224:227], a[8:11], v[176:191]
 ds_read_b128 v[224:227], v197 offset:40960
 buffer_load_dwordx4 v210, s[12:15], s34 offen nt lds
 v_exp_f32 v243, v65
 v_accvgpr_read_b32 v250, a144
 s_waitcnt lgkmcnt(3)
 v_mfma_f32_32x32x16_bf16 v[96:111], v[228:231], a[4:7], v[96:111]
 v_add_f32 v240, v242, v243
 v_cvt_pk_bf16_f32 v128, v242, v243
 v_exp_f32 v244, v66
 v_exp_f32 v245, v67
 v_mfma_f32_32x32x16_bf16 v[112:127], v[228:231], a[12:15], v[112:127]
 ds_read_b128 v[228:231], v198 offset:40960
 buffer_load_dwordx4 v210, s[12:15], s34 offen offset:1024 nt lds
 s_add_u32 m0, s28, 32768
 s_mov_b32 s34, 221184
 v_add_f32 v240, v244, v240
 v_mfma_f32_32x32x16_bf16 v[96:111], v[232:235], a[16:19], v[96:111]
 v_add_f32 v240, v245, v240
 v_cvt_pk_bf16_f32 v129, v244, v245
 v_exp_f32 v242, v68
 v_exp_f32 v243, v69
 v_mfma_f32_32x32x16_bf16 v[112:127], v[232:235], a[24:27], v[112:127]
 ds_read_b128 v[232:235], v199 offset:40960
 buffer_load_dwordx4 v208, s[8:11], s32 offen nt lds
 v_add_f32 v240, v242, v240
 v_add_f32 v240, v243, v240
 v_cvt_pk_bf16_f32 v130, v242, v243
 s_waitcnt lgkmcnt(3)
 v_mfma_f32_32x32x16_bf16 v[96:111], v[236:239], a[20:23], v[96:111]
 v_exp_f32 v244, v70
 v_exp_f32 v245, v71
 v_add_f32 v240, v244, v240
 v_add_f32 v240, v245, v240
 v_mfma_f32_32x32x16_bf16 v[112:127], v[236:239], a[28:31], v[112:127]
 ds_read_b64_tr_b16 v[236:237], v200 offset:24576
 ds_read_b64_tr_b16 v[238:239], v200 offset:26624
 buffer_load_dwordx4 v209, s[8:11], s32 offen offset:1024 nt lds
 s_mov_b32 s32, 237568
 v_cvt_pk_bf16_f32 v131, v244, v245
 v_mfma_f32_32x32x16_bf16 v[96:111], v[220:223], a[32:35], v[96:111]
 v_exp_f32 v242, v72
 v_exp_f32 v243, v73
 v_add_f32 v240, v242, v240
 v_add_f32 v240, v243, v240
 v_mfma_f32_32x32x16_bf16 v[112:127], v[220:223], a[40:43], v[112:127]
 ds_read_b64_tr_b16 v[220:221], v201 offset:24576
 ds_read_b64_tr_b16 v[222:223], v201 offset:26624
 v_cvt_pk_bf16_f32 v132, v242, v243
 v_exp_f32 v244, v74
 v_accvgpr_read_b32 v251, a145
 s_waitcnt lgkmcnt(5)
 v_mfma_f32_32x32x16_bf16 v[96:111], v[224:227], a[36:39], v[96:111]
 v_exp_f32 v245, v75
 v_add_f32 v240, v244, v240
 v_add_f32 v240, v245, v240
 v_cvt_pk_bf16_f32 v133, v244, v245
 v_accvgpr_read_b32 v252, a146
 v_mfma_f32_32x32x16_bf16 v[112:127], v[224:227], a[44:47], v[112:127]
 ds_read_b64_tr_b16 v[224:225], v202 offset:24576
 ds_read_b64_tr_b16 v[226:227], v202 offset:26624
 v_exp_f32 v242, v76
 v_exp_f32 v243, v77
 v_mfma_f32_32x32x16_bf16 v[96:111], v[228:231], a[48:51], v[96:111]
 v_add_f32 v240, v242, v240
 v_add_f32 v240, v243, v240
 v_cvt_pk_bf16_f32 v134, v242, v243
 v_exp_f32 v244, v78
 v_accvgpr_read_b32 v253, a147
 v_mfma_f32_32x32x16_bf16 v[112:127], v[228:231], a[56:59], v[112:127]
 ds_read_b64_tr_b16 v[228:229], v203 offset:24576
 ds_read_b64_tr_b16 v[230:231], v203 offset:26624
 v_exp_f32 v245, v79
 v_add_f32 v240, v244, v240
 v_add_f32 v240, v245, v240
 s_waitcnt lgkmcnt(6)
 v_mfma_f32_32x32x16_bf16 v[96:111], v[232:235], a[52:55], v[96:111]
 v_cvt_pk_bf16_f32 v135, v244, v245
 v_exp_f32 v242, v80
 v_exp_f32 v243, v81
 v_mul_f32 v250, v219, v250
 v_mfma_f32_32x32x16_bf16 v[112:127], v[232:235], a[60:63], v[112:127]
 ds_read_b64_tr_b16 v[232:233], v200 offset:28672
 ds_read_b64_tr_b16 v[234:235], v200 offset:30720
 v_add_f32 v241, v242, v243
 v_cvt_pk_bf16_f32 v136, v242, v243
 v_exp_f32 v244, v82
 v_mfma_f32_32x32x16_bf16 a[64:79], v[236:239], v[144:147], a[64:79]
 v_exp_f32 v245, v83
 v_add_f32 v241, v244, v241
 v_add_f32 v241, v245, v241
 v_cvt_pk_bf16_f32 v137, v244, v245
 v_mul_f32 v251, v219, v251
 v_mfma_f32_32x32x16_bf16 a[80:95], v[236:239], v[152:155], a[80:95]
 ds_read_b64_tr_b16 v[236:237], v201 offset:28672
 ds_read_b64_tr_b16 v[238:239], v201 offset:30720
 v_exp_f32 v242, v84
 v_exp_f32 v243, v85
 s_waitcnt lgkmcnt(6)
 v_mfma_f32_32x32x16_bf16 a[96:111], v[220:223], v[144:147], a[96:111]
 v_add_f32 v241, v242, v241
 v_add_f32 v241, v243, v241
 v_cvt_pk_bf16_f32 v138, v242, v243
 v_exp_f32 v244, v86
 v_mul_f32 v252, v219, v252
 v_mfma_f32_32x32x16_bf16 a[112:127], v[220:223], v[152:155], a[112:127]
 ds_read_b64_tr_b16 v[220:221], v202 offset:28672
 ds_read_b64_tr_b16 v[222:223], v202 offset:30720
 v_exp_f32 v245, v87
 v_add_f32 v241, v244, v241
 v_add_f32 v241, v245, v241
 v_mfma_f32_32x32x16_bf16 v[0:15], v[224:227], v[144:147], v[0:15]
 v_cvt_pk_bf16_f32 v139, v244, v245
 v_exp_f32 v242, v88
 v_exp_f32 v243, v89
 v_add_f32 v241, v242, v241
 v_mfma_f32_32x32x16_bf16 v[16:31], v[224:227], v[152:155], v[16:31]
 ds_read_b64_tr_b16 v[224:225], v203 offset:28672
 ds_read_b64_tr_b16 v[226:227], v203 offset:30720
 v_add_f32 v241, v243, v241
 v_cvt_pk_bf16_f32 v140, v242, v243
 v_exp_f32 v244, v90
 s_waitcnt lgkmcnt(6)
 v_mfma_f32_32x32x16_bf16 v[32:47], v[228:231], v[144:147], v[32:47]
 v_exp_f32 v245, v91
 v_add_f32 v241, v244, v241
 v_add_f32 v241, v245, v241
 v_cvt_pk_bf16_f32 v141, v244, v245
 v_mul_f32 v253, v219, v253
 v_mfma_f32_32x32x16_bf16 v[48:63], v[228:231], v[152:155], v[48:63]
 ds_read_b128 v[228:231], v192 offset:49152
 v_exp_f32 v242, v92
 v_exp_f32 v243, v93
 v_add_f32 v241, v242, v241
 v_mfma_f32_32x32x16_bf16 a[64:79], v[232:235], v[148:151], a[64:79]
 v_add_f32 v241, v243, v241
 v_cvt_pk_bf16_f32 v142, v242, v243
 v_exp_f32 v244, v94
 v_exp_f32 v245, v95
 v_mfma_f32_32x32x16_bf16 a[80:95], v[232:235], v[156:159], a[80:95]
 ds_read_b128 v[232:235], v193 offset:49152
 v_add_f32 v241, v244, v241
 v_add_f32 v241, v245, v241
 v_cvt_pk_bf16_f32 v143, v244, v245
 v_cvt_pk_bf16_f32 v246, v250, v251
 v_cvt_pk_bf16_f32 v247, v252, v253
 s_waitcnt lgkmcnt(4)
 v_mfma_f32_32x32x16_bf16 a[96:111], v[236:239], v[148:151], a[96:111]
 v_accvgpr_read_b32 v250, a148
 v_accvgpr_read_b32 v251, a149
 v_accvgpr_read_b32 v252, a150
 v_accvgpr_read_b32 v253, a151
 v_mul_f32 v250, v219, v250
 v_mul_f32 v251, v219, v251
 v_mfma_f32_32x32x16_bf16 a[112:127], v[236:239], v[156:159], a[112:127]
 ds_read_b128 v[236:239], v194 offset:49152
 v_mul_f32 v252, v219, v252
 v_mul_f32 v253, v219, v253
 v_cvt_pk_bf16_f32 v248, v250, v251
 v_cvt_pk_bf16_f32 v249, v252, v253
 v_accvgpr_read_b32 v250, a152
 v_mfma_f32_32x32x16_bf16 v[0:15], v[220:223], v[148:151], v[0:15]
 buffer_store_dwordx4 v[246:249], v214, s[24:27], s76 offen offset:1024 sc1
 v_accvgpr_read_b32 v251, a153
 v_accvgpr_read_b32 v252, a154
 v_accvgpr_read_b32 v253, a155
 v_mul_f32 v250, v219, v250
 v_mfma_f32_32x32x16_bf16 v[16:31], v[220:223], v[156:159], v[16:31]
 ds_read_b128 v[220:223], v195 offset:49152
 v_mul_f32 v251, v219, v251
 v_mul_f32 v252, v219, v252
 v_mul_f32 v253, v219, v253
 v_cvt_pk_bf16_f32 v246, v250, v251
 v_cvt_pk_bf16_f32 v247, v252, v253
 s_waitcnt lgkmcnt(3)
 v_mfma_f32_32x32x16_bf16 v[32:47], v[224:227], v[148:151], v[32:47]
 v_accvgpr_read_b32 v250, a156
 v_accvgpr_read_b32 v251, a157
 v_accvgpr_read_b32 v252, a158
 v_accvgpr_read_b32 v253, a159
 v_mul_f32 v250, v219, v250
 v_mul_f32 v251, v219, v251
 v_mfma_f32_32x32x16_bf16 v[48:63], v[224:227], v[156:159], v[48:63]
 v_mul_f32 v252, v219, v252
 v_mul_f32 v253, v219, v253
 v_cvt_pk_bf16_f32 v248, v250, v251
 v_cvt_pk_bf16_f32 v249, v252, v253
 buffer_store_dwordx4 v[246:249], v214, s[24:27], s77 offen offset:1024 sc1
 v_add_f32 v254, v240, v241
 v_cmp_nge_f32 vcc, s30, v254
 s_cbranch_vccnz LR1_4
BR1_4:
 s_waitcnt vmcnt(24)
 s_barrier
 v_mfma_f32_32x32x16_bf16 v[64:79], v[228:231], a[0:3], v[160:175]
 ds_read_b128 v[224:227], v196 offset:49152
 s_add_u32 m0, s28, 90112
 v_add_f32 v216, v240, v216
 v_add_f32 v217, v241, v217
 v_exp_f32 v242, v96
 v_mfma_f32_32x32x16_bf16 v[80:95], v[228:231], a[8:11], v[176:191]
 ds_read_b128 v[228:231], v197 offset:49152
 buffer_load_dwordx4 v210, s[12:15], s34 offen nt lds
 v_exp_f32 v243, v97
 v_accvgpr_read_b32 v250, a160
 s_waitcnt lgkmcnt(2)
 v_mfma_f32_32x32x16_bf16 v[64:79], v[232:235], a[4:7], v[64:79]
 v_add_f32 v240, v242, v243
 v_cvt_pk_bf16_f32 v144, v242, v243
 v_exp_f32 v244, v98
 v_exp_f32 v245, v99
 v_mfma_f32_32x32x16_bf16 v[80:95], v[232:235], a[12:15], v[80:95]
 ds_read_b128 v[232:235], v198 offset:49152
 buffer_load_dwordx4 v210, s[12:15], s34 offen offset:1024 nt lds
 s_add_u32 m0, s28, 40960
 s_mov_b32 s34, 229376
 v_add_f32 v240, v244, v240
 v_mfma_f32_32x32x16_bf16 v[64:79], v[236:239], a[16:19], v[64:79]
 v_add_f32 v240, v245, v240
 v_cvt_pk_bf16_f32 v145, v244, v245
 v_exp_f32 v242, v100
 v_exp_f32 v243, v101
 v_mfma_f32_32x32x16_bf16 v[80:95], v[236:239], a[24:27], v[80:95]
 ds_read_b128 v[236:239], v199 offset:49152
 buffer_load_dwordx4 v208, s[8:11], s32 offen nt lds
 v_add_f32 v240, v242, v240
 v_add_f32 v240, v243, v240
 v_cvt_pk_bf16_f32 v146, v242, v243
 v_mfma_f32_32x32x16_bf16 v[64:79], v[220:223], a[20:23], v[64:79]
 v_exp_f32 v244, v102
 v_exp_f32 v245, v103
 v_add_f32 v240, v244, v240
 v_add_f32 v240, v245, v240
 v_mfma_f32_32x32x16_bf16 v[80:95], v[220:223], a[28:31], v[80:95]
 ds_read_b64_tr_b16 v[220:221], v200 offset:32768
 ds_read_b64_tr_b16 v[222:223], v200 offset:34816
 buffer_load_dwordx4 v209, s[8:11], s32 offen offset:1024 nt lds
 s_mov_b32 s32, 245760
 v_cvt_pk_bf16_f32 v147, v244, v245
 s_waitcnt lgkmcnt(4)
 v_mfma_f32_32x32x16_bf16 v[64:79], v[224:227], a[32:35], v[64:79]
 v_exp_f32 v242, v104
 v_exp_f32 v243, v105
 v_add_f32 v240, v242, v240
 v_add_f32 v240, v243, v240
 v_mfma_f32_32x32x16_bf16 v[80:95], v[224:227], a[40:43], v[80:95]
 ds_read_b64_tr_b16 v[224:225], v201 offset:32768
 ds_read_b64_tr_b16 v[226:227], v201 offset:34816
 v_cvt_pk_bf16_f32 v148, v242, v243
 v_exp_f32 v244, v106
 v_accvgpr_read_b32 v251, a161
 v_mfma_f32_32x32x16_bf16 v[64:79], v[228:231], a[36:39], v[64:79]
 v_exp_f32 v245, v107
 v_add_f32 v240, v244, v240
 v_add_f32 v240, v245, v240
 v_cvt_pk_bf16_f32 v149, v244, v245
 v_accvgpr_read_b32 v252, a162
 v_mfma_f32_32x32x16_bf16 v[80:95], v[228:231], a[44:47], v[80:95]
 ds_read_b64_tr_b16 v[228:229], v202 offset:32768
 ds_read_b64_tr_b16 v[230:231], v202 offset:34816
 v_exp_f32 v242, v108
 v_exp_f32 v243, v109
 s_waitcnt lgkmcnt(6)
 v_mfma_f32_32x32x16_bf16 v[64:79], v[232:235], a[48:51], v[64:79]
 v_add_f32 v240, v242, v240
 v_add_f32 v240, v243, v240
 v_cvt_pk_bf16_f32 v150, v242, v243
 v_exp_f32 v244, v110
 v_accvgpr_read_b32 v253, a163
 v_mfma_f32_32x32x16_bf16 v[80:95], v[232:235], a[56:59], v[80:95]
 ds_read_b64_tr_b16 v[232:233], v203 offset:32768
 ds_read_b64_tr_b16 v[234:235], v203 offset:34816
 v_exp_f32 v245, v111
 v_add_f32 v240, v244, v240
 v_add_f32 v240, v245, v240
 v_mfma_f32_32x32x16_bf16 v[64:79], v[236:239], a[52:55], v[64:79]
 v_cvt_pk_bf16_f32 v151, v244, v245
 v_exp_f32 v242, v112
 v_exp_f32 v243, v113
 v_mul_f32 v250, v218, v250
 v_mfma_f32_32x32x16_bf16 v[80:95], v[236:239], a[60:63], v[80:95]
 ds_read_b64_tr_b16 v[236:237], v200 offset:36864
 ds_read_b64_tr_b16 v[238:239], v200 offset:38912
 v_add_f32 v241, v242, v243
 v_cvt_pk_bf16_f32 v152, v242, v243
 v_exp_f32 v244, v114
 s_waitcnt lgkmcnt(6)
 v_mfma_f32_32x32x16_bf16 a[64:79], v[220:223], v[128:131], a[64:79]
 v_exp_f32 v245, v115
 v_add_f32 v241, v244, v241
 v_add_f32 v241, v245, v241
 v_cvt_pk_bf16_f32 v153, v244, v245
 v_mul_f32 v251, v218, v251
 v_mfma_f32_32x32x16_bf16 a[80:95], v[220:223], v[136:139], a[80:95]
 ds_read_b64_tr_b16 v[220:221], v201 offset:36864
 ds_read_b64_tr_b16 v[222:223], v201 offset:38912
 v_exp_f32 v242, v116
 v_exp_f32 v243, v117
 v_mfma_f32_32x32x16_bf16 a[96:111], v[224:227], v[128:131], a[96:111]
 v_add_f32 v241, v242, v241
 v_add_f32 v241, v243, v241
 v_cvt_pk_bf16_f32 v154, v242, v243
 v_exp_f32 v244, v118
 v_mul_f32 v252, v218, v252
 v_mfma_f32_32x32x16_bf16 a[112:127], v[224:227], v[136:139], a[112:127]
 ds_read_b64_tr_b16 v[224:225], v202 offset:36864
 ds_read_b64_tr_b16 v[226:227], v202 offset:38912
 v_exp_f32 v245, v119
 v_add_f32 v241, v244, v241
 v_add_f32 v241, v245, v241
 s_waitcnt lgkmcnt(6)
 v_mfma_f32_32x32x16_bf16 v[0:15], v[228:231], v[128:131], v[0:15]
 v_cvt_pk_bf16_f32 v155, v244, v245
 v_exp_f32 v242, v120
 v_exp_f32 v243, v121
 v_add_f32 v241, v242, v241
 v_mfma_f32_32x32x16_bf16 v[16:31], v[228:231], v[136:139], v[16:31]
 ds_read_b64_tr_b16 v[228:229], v203 offset:36864
 ds_read_b64_tr_b16 v[230:231], v203 offset:38912
 v_add_f32 v241, v243, v241
 v_cvt_pk_bf16_f32 v156, v242, v243
 v_exp_f32 v244, v122
 v_mfma_f32_32x32x16_bf16 v[32:47], v[232:235], v[128:131], v[32:47]
 v_exp_f32 v245, v123
 v_add_f32 v241, v244, v241
 v_add_f32 v241, v245, v241
 v_cvt_pk_bf16_f32 v157, v244, v245
 v_mul_f32 v253, v218, v253
 v_mfma_f32_32x32x16_bf16 v[48:63], v[232:235], v[136:139], v[48:63]
 ds_read_b128 v[232:235], v192 offset:57344
 v_exp_f32 v242, v124
 v_exp_f32 v243, v125
 v_add_f32 v241, v242, v241
 s_waitcnt lgkmcnt(5)
 v_mfma_f32_32x32x16_bf16 a[64:79], v[236:239], v[132:135], a[64:79]
 v_add_f32 v241, v243, v241
 v_cvt_pk_bf16_f32 v158, v242, v243
 v_exp_f32 v244, v126
 v_exp_f32 v245, v127
 v_mfma_f32_32x32x16_bf16 a[80:95], v[236:239], v[140:143], a[80:95]
 ds_read_b128 v[236:239], v193 offset:57344
 v_add_f32 v241, v244, v241
 v_add_f32 v241, v245, v241
 v_cvt_pk_bf16_f32 v159, v244, v245
 v_cvt_pk_bf16_f32 v246, v250, v251
 v_cvt_pk_bf16_f32 v247, v252, v253
 v_mfma_f32_32x32x16_bf16 a[96:111], v[220:223], v[132:135], a[96:111]
 v_accvgpr_read_b32 v250, a164
 v_accvgpr_read_b32 v251, a165
 v_accvgpr_read_b32 v252, a166
 v_accvgpr_read_b32 v253, a167
 v_mul_f32 v250, v218, v250
 v_mul_f32 v251, v218, v251
 v_mfma_f32_32x32x16_bf16 a[112:127], v[220:223], v[140:143], a[112:127]
 ds_read_b128 v[220:223], v194 offset:57344
 v_mul_f32 v252, v218, v252
 v_mul_f32 v253, v218, v253
 v_cvt_pk_bf16_f32 v248, v250, v251
 v_cvt_pk_bf16_f32 v249, v252, v253
 v_accvgpr_read_b32 v250, a168
 s_waitcnt lgkmcnt(3)
 v_mfma_f32_32x32x16_bf16 v[0:15], v[224:227], v[132:135], v[0:15]
 buffer_store_dwordx4 v[246:249], v214, s[24:27], s78 offen offset:0 sc1
 v_accvgpr_read_b32 v251, a169
 v_accvgpr_read_b32 v252, a170
 v_accvgpr_read_b32 v253, a171
 v_mul_f32 v250, v218, v250
 v_mfma_f32_32x32x16_bf16 v[16:31], v[224:227], v[140:143], v[16:31]
 ds_read_b128 v[224:227], v195 offset:57344
 v_mul_f32 v251, v218, v251
 v_mul_f32 v252, v218, v252
 v_mul_f32 v253, v218, v253
 v_cvt_pk_bf16_f32 v246, v250, v251
 v_cvt_pk_bf16_f32 v247, v252, v253
 v_mfma_f32_32x32x16_bf16 v[32:47], v[228:231], v[132:135], v[32:47]
 v_accvgpr_read_b32 v250, a172
 v_accvgpr_read_b32 v251, a173
 v_accvgpr_read_b32 v252, a174
 v_accvgpr_read_b32 v253, a175
 v_mul_f32 v250, v218, v250
 v_mul_f32 v251, v218, v251
 v_mfma_f32_32x32x16_bf16 v[48:63], v[228:231], v[140:143], v[48:63]
 v_mul_f32 v252, v218, v252
 v_mul_f32 v253, v218, v253
 v_cvt_pk_bf16_f32 v248, v250, v251
 v_cvt_pk_bf16_f32 v249, v252, v253
 buffer_store_dwordx4 v[246:249], v214, s[24:27], s79 offen offset:0 sc1
 v_add_f32 v254, v240, v241
 v_cmp_nge_f32 vcc, s30, v254
 s_cbranch_vccnz LR1_5
BR1_5:
 s_waitcnt vmcnt(24)
 s_barrier
 s_waitcnt lgkmcnt(1)
 v_mfma_f32_32x32x16_bf16 v[96:111], v[232:235], a[0:3], v[160:175]
 ds_read_b128 v[228:231], v196 offset:57344
 s_add_u32 m0, s28, 98304
 v_add_f32 v216, v240, v216
 v_add_f32 v217, v241, v217
 v_exp_f32 v242, v64
 v_mfma_f32_32x32x16_bf16 v[112:127], v[232:235], a[8:11], v[176:191]
 ds_read_b128 v[232:235], v197 offset:57344
 buffer_load_dwordx4 v210, s[12:15], s34 offen nt lds
 v_exp_f32 v243, v65
 v_accvgpr_read_b32 v250, a176
 v_mfma_f32_32x32x16_bf16 v[96:111], v[236:239], a[4:7], v[96:111]
 v_add_f32 v240, v242, v243
 v_cvt_pk_bf16_f32 v128, v242, v243
 v_exp_f32 v244, v66
 v_exp_f32 v245, v67
 v_mfma_f32_32x32x16_bf16 v[112:127], v[236:239], a[12:15], v[112:127]
 ds_read_b128 v[236:239], v198 offset:57344
 buffer_load_dwordx4 v210, s[12:15], s34 offen offset:1024 nt lds
 s_add_u32 m0, s28, 49152
 s_mov_b32 s34, 237568
 v_add_f32 v240, v244, v240
 v_mfma_f32_32x32x16_bf16 v[96:111], v[220:223], a[16:19], v[96:111]
 v_add_f32 v240, v245, v240
 v_cvt_pk_bf16_f32 v129, v244, v245
 v_exp_f32 v242, v68
 v_exp_f32 v243, v69
 v_mfma_f32_32x32x16_bf16 v[112:127], v[220:223], a[24:27], v[112:127]
 ds_read_b128 v[220:223], v199 offset:57344
 buffer_load_dwordx4 v208, s[8:11], s32 offen nt lds
 v_add_f32 v240, v242, v240
 v_add_f32 v240, v243, v240
 v_cvt_pk_bf16_f32 v130, v242, v243
 s_waitcnt lgkmcnt(3)
 v_mfma_f32_32x32x16_bf16 v[96:111], v[224:227], a[20:23], v[96:111]
 v_exp_f32 v244, v70
 v_exp_f32 v245, v71
 v_add_f32 v240, v244, v240
 v_add_f32 v240, v245, v240
 v_mfma_f32_32x32x16_bf16 v[112:127], v[224:227], a[28:31], v[112:127]
 ds_read_b64_tr_b16 v[224:225], v200 offset:40960
 ds_read_b64_tr_b16 v[226:227], v200 offset:43008
 buffer_load_dwordx4 v209, s[8:11], s32 offen offset:1024 nt lds
 s_mov_b32 s32, 253952
 v_cvt_pk_bf16_f32 v131, v244, v245
 v_mfma_f32_32x32x16_bf16 v[96:111], v[228:231], a[32:35], v[96:111]
 v_exp_f32 v242, v72
 v_exp_f32 v243, v73
 v_add_f32 v240, v242, v240
 v_add_f32 v240, v243, v240
 v_mfma_f32_32x32x16_bf16 v[112:127], v[228:231], a[40:43], v[112:127]
 ds_read_b64_tr_b16 v[228:229], v201 offset:40960
 ds_read_b64_tr_b16 v[230:231], v201 offset:43008
 v_cvt_pk_bf16_f32 v132, v242, v243
 v_exp_f32 v244, v74
 v_accvgpr_read_b32 v251, a177
 s_waitcnt lgkmcnt(5)
 v_mfma_f32_32x32x16_bf16 v[96:111], v[232:235], a[36:39], v[96:111]
 v_exp_f32 v245, v75
 v_add_f32 v240, v244, v240
 v_add_f32 v240, v245, v240
 v_cvt_pk_bf16_f32 v133, v244, v245
 v_accvgpr_read_b32 v252, a178
 v_mfma_f32_32x32x16_bf16 v[112:127], v[232:235], a[44:47], v[112:127]
 ds_read_b64_tr_b16 v[232:233], v202 offset:40960
 ds_read_b64_tr_b16 v[234:235], v202 offset:43008
 v_exp_f32 v242, v76
 v_exp_f32 v243, v77
 v_mfma_f32_32x32x16_bf16 v[96:111], v[236:239], a[48:51], v[96:111]
 v_add_f32 v240, v242, v240
 v_add_f32 v240, v243, v240
 v_cvt_pk_bf16_f32 v134, v242, v243
 v_exp_f32 v244, v78
 v_accvgpr_read_b32 v253, a179
 v_mfma_f32_32x32x16_bf16 v[112:127], v[236:239], a[56:59], v[112:127]
 ds_read_b64_tr_b16 v[236:237], v203 offset:40960
 ds_read_b64_tr_b16 v[238:239], v203 offset:43008
 v_exp_f32 v245, v79
 v_add_f32 v240, v244, v240
 v_add_f32 v240, v245, v240
 s_waitcnt lgkmcnt(6)
 v_mfma_f32_32x32x16_bf16 v[96:111], v[220:223], a[52:55], v[96:111]
 v_cvt_pk_bf16_f32 v135, v244, v245
 v_exp_f32 v242, v80
 v_exp_f32 v243, v81
 v_mul_f32 v250, v219, v250
 v_mfma_f32_32x32x16_bf16 v[112:127], v[220:223], a[60:63], v[112:127]
 ds_read_b64_tr_b16 v[220:221], v200 offset:45056
 ds_read_b64_tr_b16 v[222:223], v200 offset:47104
 v_add_f32 v241, v242, v243
 v_cvt_pk_bf16_f32 v136, v242, v243
 v_exp_f32 v244, v82
 v_mfma_f32_32x32x16_bf16 a[64:79], v[224:227], v[144:147], a[64:79]
 v_exp_f32 v245, v83
 v_add_f32 v241, v244, v241
 v_add_f32 v241, v245, v241
 v_cvt_pk_bf16_f32 v137, v244, v245
 v_mul_f32 v251, v219, v251
 v_mfma_f32_32x32x16_bf16 a[80:95], v[224:227], v[152:155], a[80:95]
 ds_read_b64_tr_b16 v[224:225], v201 offset:45056
 ds_read_b64_tr_b16 v[226:227], v201 offset:47104
 v_exp_f32 v242, v84
 v_exp_f32 v243, v85
 s_waitcnt lgkmcnt(6)
 v_mfma_f32_32x32x16_bf16 a[96:111], v[228:231], v[144:147], a[96:111]
 v_add_f32 v241, v242, v241
 v_add_f32 v241, v243, v241
 v_cvt_pk_bf16_f32 v138, v242, v243
 v_exp_f32 v244, v86
 v_mul_f32 v252, v219, v252
 v_mfma_f32_32x32x16_bf16 a[112:127], v[228:231], v[152:155], a[112:127]
 ds_read_b64_tr_b16 v[228:229], v202 offset:45056
 ds_read_b64_tr_b16 v[230:231], v202 offset:47104
 v_exp_f32 v245, v87
 v_add_f32 v241, v244, v241
 v_add_f32 v241, v245, v241
 v_mfma_f32_32x32x16_bf16 v[0:15], v[232:235], v[144:147], v[0:15]
 v_cvt_pk_bf16_f32 v139, v244, v245
 v_exp_f32 v242, v88
 v_exp_f32 v243, v89
 v_add_f32 v241, v242, v241
 v_mfma_f32_32x32x16_bf16 v[16:31], v[232:235], v[152:155], v[16:31]
 ds_read_b64_tr_b16 v[232:233], v203 offset:45056
 ds_read_b64_tr_b16 v[234:235], v203 offset:47104
 v_add_f32 v241, v243, v241
 v_cvt_pk_bf16_f32 v140, v242, v243
 v_exp_f32 v244, v90
 s_waitcnt lgkmcnt(6)
 v_mfma_f32_32x32x16_bf16 v[32:47], v[236:239], v[144:147], v[32:47]
 v_exp_f32 v245, v91
 v_add_f32 v241, v244, v241
 v_add_f32 v241, v245, v241
 v_cvt_pk_bf16_f32 v141, v244, v245
 v_mul_f32 v253, v219, v253
 v_mfma_f32_32x32x16_bf16 v[48:63], v[236:239], v[152:155], v[48:63]
 ds_read_b128 v[236:239], v192 offset:0
 v_exp_f32 v242, v92
 v_exp_f32 v243, v93
 v_add_f32 v241, v242, v241
 v_mfma_f32_32x32x16_bf16 a[64:79], v[220:223], v[148:151], a[64:79]
 v_add_f32 v241, v243, v241
 v_cvt_pk_bf16_f32 v142, v242, v243
 v_exp_f32 v244, v94
 v_exp_f32 v245, v95
 v_mfma_f32_32x32x16_bf16 a[80:95], v[220:223], v[156:159], a[80:95]
 ds_read_b128 v[220:223], v193 offset:0
 v_add_f32 v241, v244, v241
 v_add_f32 v241, v245, v241
 v_cvt_pk_bf16_f32 v143, v244, v245
 v_cvt_pk_bf16_f32 v246, v250, v251
 v_cvt_pk_bf16_f32 v247, v252, v253
 s_waitcnt lgkmcnt(4)
 v_mfma_f32_32x32x16_bf16 a[96:111], v[224:227], v[148:151], a[96:111]
 v_accvgpr_read_b32 v250, a180
 v_accvgpr_read_b32 v251, a181
 v_accvgpr_read_b32 v252, a182
 v_accvgpr_read_b32 v253, a183
 v_mul_f32 v250, v219, v250
 v_mul_f32 v251, v219, v251
 v_mfma_f32_32x32x16_bf16 a[112:127], v[224:227], v[156:159], a[112:127]
 ds_read_b128 v[224:227], v194 offset:0
 v_mul_f32 v252, v219, v252
 v_mul_f32 v253, v219, v253
 v_cvt_pk_bf16_f32 v248, v250, v251
 v_cvt_pk_bf16_f32 v249, v252, v253
 v_accvgpr_read_b32 v250, a184
 v_mfma_f32_32x32x16_bf16 v[0:15], v[228:231], v[148:151], v[0:15]
 buffer_store_dwordx4 v[246:249], v214, s[24:27], s78 offen offset:1024 sc1
 v_accvgpr_read_b32 v251, a185
 v_accvgpr_read_b32 v252, a186
 v_accvgpr_read_b32 v253, a187
 v_mul_f32 v250, v219, v250
 v_mfma_f32_32x32x16_bf16 v[16:31], v[228:231], v[156:159], v[16:31]
 ds_read_b128 v[228:231], v195 offset:0
 v_mul_f32 v251, v219, v251
 v_mul_f32 v252, v219, v252
 v_mul_f32 v253, v219, v253
 v_cvt_pk_bf16_f32 v246, v250, v251
 v_cvt_pk_bf16_f32 v247, v252, v253
 s_waitcnt lgkmcnt(3)
 v_mfma_f32_32x32x16_bf16 v[32:47], v[232:235], v[148:151], v[32:47]
 v_accvgpr_read_b32 v250, a188
 v_accvgpr_read_b32 v251, a189
 v_accvgpr_read_b32 v252, a190
 v_accvgpr_read_b32 v253, a191
 v_mul_f32 v250, v219, v250
 v_mul_f32 v251, v219, v251
 v_mfma_f32_32x32x16_bf16 v[48:63], v[232:235], v[156:159], v[48:63]
 v_mul_f32 v252, v219, v252
 v_mul_f32 v253, v219, v253
 v_cvt_pk_bf16_f32 v248, v250, v251
 v_cvt_pk_bf16_f32 v249, v252, v253
 buffer_store_dwordx4 v[246:249], v214, s[24:27], s79 offen offset:1024 sc1
 v_add_f32 v254, v240, v241
 v_cmp_nge_f32 vcc, s30, v254
 s_cbranch_vccnz LR1_6
BR1_6:
 s_waitcnt vmcnt(28)
 s_barrier
 v_mfma_f32_32x32x16_bf16 v[64:79], v[236:239], a[0:3], v[160:175]
 ds_read_b128 v[232:235], v196 offset:0
 s_add_u32 m0, s28, 106496
 v_add_f32 v216, v240, v216
 v_add_f32 v217, v241, v217
 v_exp_f32 v242, v96
 v_mfma_f32_32x32x16_bf16 v[80:95], v[236:239], a[8:11], v[176:191]
 ds_read_b128 v[236:239], v197 offset:0
 buffer_load_dwordx4 v210, s[12:15], s34 offen nt lds
 v_exp_f32 v243, v97
 v_accvgpr_read_b32 v250, a192
 s_waitcnt lgkmcnt(2)
 v_mfma_f32_32x32x16_bf16 v[64:79], v[220:223], a[4:7], v[64:79]
 v_add_f32 v240, v242, v243
 v_cvt_pk_bf16_f32 v144, v242, v243
 v_exp_f32 v244, v98
 v_exp_f32 v245, v99
 v_mfma_f32_32x32x16_bf16 v[80:95], v[220:223], a[12:15], v[80:95]
 ds_read_b128 v[220:223], v198 offset:0
 buffer_load_dwordx4 v210, s[12:15], s34 offen offset:1024 nt lds
 s_add_u32 m0, s28, 57344
 s_mov_b32 s34, 245760
 v_add_f32 v240, v244, v240
 v_mfma_f32_32x32x16_bf16 v[64:79], v[224:227], a[16:19], v[64:79]
 v_add_f32 v240, v245, v240
 v_cvt_pk_bf16_f32 v145, v244, v245
 v_exp_f32 v242, v100
 v_exp_f32 v243, v101
 v_mfma_f32_32x32x16_bf16 v[80:95], v[224:227], a[24:27], v[80:95]
 ds_read_b128 v[224:227], v199 offset:0
 buffer_load_dwordx4 v208, s[8:11], s32 offen nt lds
 v_add_f32 v240, v242, v240
 v_add_f32 v240, v243, v240
 v_cvt_pk_bf16_f32 v146, v242, v243
 v_mfma_f32_32x32x16_bf16 v[64:79], v[228:231], a[20:23], v[64:79]
 v_exp_f32 v244, v102
 v_exp_f32 v245, v103
 v_add_f32 v240, v244, v240
 v_add_f32 v240, v245, v240
 v_mfma_f32_32x32x16_bf16 v[80:95], v[228:231], a[28:31], v[80:95]
 ds_read_b64_tr_b16 v[228:229], v200 offset:49152
 ds_read_b64_tr_b16 v[230:231], v200 offset:51200
 buffer_load_dwordx4 v209, s[8:11], s32 offen offset:1024 nt lds
 v_cvt_pk_bf16_f32 v147, v244, v245
 v_accvgpr_read_b32 v251, a193
 s_waitcnt lgkmcnt(4)
 v_mfma_f32_32x32x16_bf16 v[64:79], v[232:235], a[32:35], v[64:79]
 v_exp_f32 v242, v104
 v_exp_f32 v243, v105
 v_add_f32 v240, v242, v240
 v_add_f32 v240, v243, v240
 v_mfma_f32_32x32x16_bf16 v[80:95], v[232:235], a[40:43], v[80:95]
 ds_read_b64_tr_b16 v[232:233], v201 offset:49152
 ds_read_b64_tr_b16 v[234:235], v201 offset:51200
 v_cvt_pk_bf16_f32 v148, v242, v243
 v_exp_f32 v244, v106
 v_accvgpr_read_b32 v252, a194
 v_mfma_f32_32x32x16_bf16 v[64:79], v[236:239], a[36:39], v[64:79]
 v_exp_f32 v245, v107
 v_add_f32 v240, v244, v240
 v_add_f32 v240, v245, v240
 v_cvt_pk_bf16_f32 v149, v244, v245
 v_accvgpr_read_b32 v253, a195
 v_mfma_f32_32x32x16_bf16 v[80:95], v[236:239], a[44:47], v[80:95]
 ds_read_b64_tr_b16 v[236:237], v202 offset:49152
 ds_read_b64_tr_b16 v[238:239], v202 offset:51200
 v_exp_f32 v242, v108
 v_exp_f32 v243, v109
 s_waitcnt lgkmcnt(6)
 v_mfma_f32_32x32x16_bf16 v[64:79], v[220:223], a[48:51], v[64:79]
 v_add_f32 v240, v242, v240
 v_add_f32 v240, v243, v240
 v_cvt_pk_bf16_f32 v150, v242, v243
 v_exp_f32 v244, v110
 v_mul_f32 v250, v218, v250
 v_mfma_f32_32x32x16_bf16 v[80:95], v[220:223], a[56:59], v[80:95]
 ds_read_b64_tr_b16 v[220:221], v203 offset:49152
 ds_read_b64_tr_b16 v[222:223], v203 offset:51200
 v_exp_f32 v245, v111
 v_add_f32 v240, v244, v240
 v_add_f32 v240, v245, v240
 v_mfma_f32_32x32x16_bf16 v[64:79], v[224:227], a[52:55], v[64:79]
 v_cvt_pk_bf16_f32 v151, v244, v245
 v_exp_f32 v242, v112
 v_exp_f32 v243, v113
 v_mul_f32 v251, v218, v251
 v_mfma_f32_32x32x16_bf16 v[80:95], v[224:227], a[60:63], v[80:95]
 ds_read_b64_tr_b16 v[224:225], v200 offset:53248
 ds_read_b64_tr_b16 v[226:227], v200 offset:55296
 v_add_f32 v241, v242, v243
 v_cvt_pk_bf16_f32 v152, v242, v243
 v_exp_f32 v244, v114
 s_waitcnt lgkmcnt(6)
 v_mfma_f32_32x32x16_bf16 a[64:79], v[228:231], v[128:131], a[64:79]
 v_exp_f32 v245, v115
 v_add_f32 v241, v244, v241
 v_add_f32 v241, v245, v241
 v_cvt_pk_bf16_f32 v153, v244, v245
 v_mul_f32 v252, v218, v252
 v_mfma_f32_32x32x16_bf16 a[80:95], v[228:231], v[136:139], a[80:95]
 ds_read_b64_tr_b16 v[228:229], v201 offset:53248
 ds_read_b64_tr_b16 v[230:231], v201 offset:55296
 v_exp_f32 v242, v116
 v_exp_f32 v243, v117
 v_mfma_f32_32x32x16_bf16 a[96:111], v[232:235], v[128:131], a[96:111]
 v_add_f32 v241, v242, v241
 v_add_f32 v241, v243, v241
 v_cvt_pk_bf16_f32 v154, v242, v243
 v_exp_f32 v244, v118
 v_mul_f32 v253, v218, v253
 v_mfma_f32_32x32x16_bf16 a[112:127], v[232:235], v[136:139], a[112:127]
 ds_read_b64_tr_b16 v[232:233], v202 offset:53248
 ds_read_b64_tr_b16 v[234:235], v202 offset:55296
 v_exp_f32 v245, v119
 v_add_f32 v241, v244, v241
 v_add_f32 v241, v245, v241
 s_waitcnt lgkmcnt(6)
 v_mfma_f32_32x32x16_bf16 v[0:15], v[236:239], v[128:131], v[0:15]
 v_cvt_pk_bf16_f32 v155, v244, v245
 v_exp_f32 v242, v120
 v_exp_f32 v243, v121
 v_add_f32 v241, v242, v241
 v_mfma_f32_32x32x16_bf16 v[16:31], v[236:239], v[136:139], v[16:31]
 ds_read_b64_tr_b16 v[236:237], v203 offset:53248
 ds_read_b64_tr_b16 v[238:239], v203 offset:55296
 v_add_f32 v241, v243, v241
 v_cvt_pk_bf16_f32 v156, v242, v243
 v_exp_f32 v244, v122
 v_mfma_f32_32x32x16_bf16 v[32:47], v[220:223], v[128:131], v[32:47]
 v_exp_f32 v245, v123
 v_add_f32 v241, v244, v241
 v_add_f32 v241, v245, v241
 v_cvt_pk_bf16_f32 v157, v244, v245
 v_cvt_pk_bf16_f32 v246, v250, v251
 v_mfma_f32_32x32x16_bf16 v[48:63], v[220:223], v[136:139], v[48:63]
 ds_read_b128 v[220:223], v192 offset:8192
 v_exp_f32 v242, v124
 v_exp_f32 v243, v125
 v_add_f32 v241, v242, v241
 s_waitcnt lgkmcnt(5)
 v_mfma_f32_32x32x16_bf16 a[64:79], v[224:227], v[132:135], a[64:79]
 v_add_f32 v241, v243, v241
 v_cvt_pk_bf16_f32 v158, v242, v243
 v_exp_f32 v244, v126
 v_exp_f32 v245, v127
 v_mfma_f32_32x32x16_bf16 a[80:95], v[224:227], v[140:143], a[80:95]
 ds_read_b128 v[224:227], v193 offset:8192
 v_add_f32 v241, v244, v241
 v_add_f32 v241, v245, v241
 v_cvt_pk_bf16_f32 v159, v244, v245
 v_cvt_pk_bf16_f32 v247, v252, v253
 v_accvgpr_read_b32 v250, a196
 v_mfma_f32_32x32x16_bf16 a[96:111], v[228:231], v[132:135], a[96:111]
 v_accvgpr_read_b32 v251, a197
 v_accvgpr_read_b32 v252, a198
 v_accvgpr_read_b32 v253, a199
 v_mul_f32 v250, v218, v250
 v_mul_f32 v251, v218, v251
 v_mul_f32 v252, v218, v252
 v_mfma_f32_32x32x16_bf16 a[112:127], v[228:231], v[140:143], a[112:127]
 ds_read_b128 v[228:231], v194 offset:8192
 v_mul_f32 v253, v218, v253
 v_cvt_pk_bf16_f32 v248, v250, v251
 v_cvt_pk_bf16_f32 v249, v252, v253
 buffer_store_dwordx4 v[246:249], v214, s[24:27], s80 offen offset:0 sc1
 s_waitcnt lgkmcnt(3)
 v_mfma_f32_32x32x16_bf16 v[0:15], v[232:235], v[132:135], v[0:15]
 v_accvgpr_read_b32 v250, a200
 v_accvgpr_read_b32 v251, a201
 v_accvgpr_read_b32 v252, a202
 v_accvgpr_read_b32 v253, a203
 v_mul_f32 v250, v218, v250
 v_mul_f32 v251, v218, v251
 v_mfma_f32_32x32x16_bf16 v[16:31], v[232:235], v[140:143], v[16:31]
 ds_read_b128 v[232:235], v195 offset:8192
 v_mul_f32 v252, v218, v252
 v_mul_f32 v253, v218, v253
 v_cvt_pk_bf16_f32 v246, v250, v251
 v_cvt_pk_bf16_f32 v247, v252, v253
 v_accvgpr_read_b32 v250, a204
 v_mfma_f32_32x32x16_bf16 v[32:47], v[236:239], v[132:135], v[32:47]
 v_accvgpr_read_b32 v251, a205
 v_accvgpr_read_b32 v252, a206
 v_accvgpr_read_b32 v253, a207
 v_mul_f32 v250, v218, v250
 v_mul_f32 v251, v218, v251
 v_mul_f32 v252, v218, v252
 v_mfma_f32_32x32x16_bf16 v[48:63], v[236:239], v[140:143], v[48:63]
 v_mul_f32 v253, v218, v253
 v_cvt_pk_bf16_f32 v248, v250, v251
 v_cvt_pk_bf16_f32 v249, v252, v253
 buffer_store_dwordx4 v[246:249], v214, s[24:27], s81 offen offset:0 sc1
 v_add_f32 v254, v240, v241
 v_cmp_nge_f32 vcc, s30, v254
 s_cbranch_vccnz LR1_7
BR1_7:
 s_waitcnt vmcnt(30)
 s_barrier
 s_waitcnt lgkmcnt(1)
 v_mfma_f32_32x32x16_bf16 v[96:111], v[220:223], a[0:3], v[160:175]
 ds_read_b128 v[236:239], v196 offset:8192
 s_add_u32 m0, s28, 114688
 v_add_f32 v216, v240, v216
 v_add_f32 v217, v241, v217
 v_exp_f32 v242, v64
 v_mfma_f32_32x32x16_bf16 v[112:127], v[220:223], a[8:11], v[176:191]
 ds_read_b128 v[220:223], v197 offset:8192
 buffer_load_dwordx4 v210, s[12:15], s34 offen nt lds
 v_exp_f32 v243, v65
 v_accvgpr_read_b32 v250, a208
 v_mfma_f32_32x32x16_bf16 v[96:111], v[224:227], a[4:7], v[96:111]
 v_add_f32 v240, v242, v243
 v_cvt_pk_bf16_f32 v128, v242, v243
 v_exp_f32 v244, v66
 v_exp_f32 v245, v67
 v_mfma_f32_32x32x16_bf16 v[112:127], v[224:227], a[12:15], v[112:127]
 ds_read_b128 v[224:227], v198 offset:8192
 buffer_load_dwordx4 v210, s[12:15], s34 offen offset:1024 nt lds
 s_mov_b32 s34, 253952
 v_add_f32 v240, v244, v240
 v_add_f32 v240, v245, v240
 v_mfma_f32_32x32x16_bf16 v[96:111], v[228:231], a[16:19], v[96:111]
 v_cvt_pk_bf16_f32 v129, v244, v245
 v_exp_f32 v242, v68
 v_exp_f32 v243, v69
 v_add_f32 v240, v242, v240
 v_mfma_f32_32x32x16_bf16 v[112:127], v[228:231], a[24:27], v[112:127]
 ds_read_b128 v[228:231], v199 offset:8192
 v_add_f32 v240, v243, v240
 v_cvt_pk_bf16_f32 v130, v242, v243
 v_exp_f32 v244, v70
 v_accvgpr_read_b32 v251, a209
 s_waitcnt lgkmcnt(3)
 v_mfma_f32_32x32x16_bf16 v[96:111], v[232:235], a[20:23], v[96:111]
 v_exp_f32 v245, v71
 v_add_f32 v240, v244, v240
 v_add_f32 v240, v245, v240
 v_cvt_pk_bf16_f32 v131, v244, v245
 v_accvgpr_read_b32 v252, a210
 v_mfma_f32_32x32x16_bf16 v[112:127], v[232:235], a[28:31], v[112:127]
 ds_read_b64_tr_b16 v[232:233], v200 offset:57344
 ds_read_b64_tr_b16 v[234:235], v200 offset:59392
 v_exp_f32 v242, v72
 v_exp_f32 v243, v73
 v_mfma_f32_32x32x16_bf16 v[96:111], v[236:239], a[32:35], v[96:111]
 v_add_f32 v240, v242, v240
 v_add_f32 v240, v243, v240
 v_cvt_pk_bf16_f32 v132, v242, v243
 v_exp_f32 v244, v74
 v_accvgpr_read_b32 v253, a211
 v_mfma_f32_32x32x16_bf16 v[112:127], v[236:239], a[40:43], v[112:127]
 ds_read_b64_tr_b16 v[236:237], v201 offset:57344
 ds_read_b64_tr_b16 v[238:239], v201 offset:59392
 v_exp_f32 v245, v75
 v_add_f32 v240, v244, v240
 v_add_f32 v240, v245, v240
 s_waitcnt lgkmcnt(5)
 v_mfma_f32_32x32x16_bf16 v[96:111], v[220:223], a[36:39], v[96:111]
 v_cvt_pk_bf16_f32 v133, v244, v245
 v_exp_f32 v242, v76
 v_exp_f32 v243, v77
 v_add_f32 v240, v242, v240
 v_mfma_f32_32x32x16_bf16 v[112:127], v[220:223], a[44:47], v[112:127]
 ds_read_b64_tr_b16 v[220:221], v202 offset:57344
 ds_read_b64_tr_b16 v[222:223], v202 offset:59392
 v_add_f32 v240, v243, v240
 v_cvt_pk_bf16_f32 v134, v242, v243
 v_exp_f32 v244, v78
 v_mfma_f32_32x32x16_bf16 v[96:111], v[224:227], a[48:51], v[96:111]
 v_exp_f32 v245, v79
 v_add_f32 v240, v244, v240
 v_add_f32 v240, v245, v240
 v_cvt_pk_bf16_f32 v135, v244, v245
 v_mul_f32 v250, v219, v250
 v_mfma_f32_32x32x16_bf16 v[112:127], v[224:227], a[56:59], v[112:127]
 ds_read_b64_tr_b16 v[224:225], v203 offset:57344
 ds_read_b64_tr_b16 v[226:227], v203 offset:59392
 v_exp_f32 v242, v80
 v_exp_f32 v243, v81
 s_waitcnt lgkmcnt(6)
 v_mfma_f32_32x32x16_bf16 v[96:111], v[228:231], a[52:55], v[96:111]
 v_add_f32 v241, v242, v243
 v_cvt_pk_bf16_f32 v136, v242, v243
 v_exp_f32 v244, v82
 v_exp_f32 v245, v83
 v_mfma_f32_32x32x16_bf16 v[112:127], v[228:231], a[60:63], v[112:127]
 ds_read_b64_tr_b16 v[228:229], v200 offset:61440
 ds_read_b64_tr_b16 v[230:231], v200 offset:63488
 v_add_f32 v241, v244, v241
 v_add_f32 v241, v245, v241
 v_cvt_pk_bf16_f32 v137, v244, v245
 v_mul_f32 v251, v219, v251
 v_mfma_f32_32x32x16_bf16 a[64:79], v[232:235], v[144:147], a[64:79]
 v_exp_f32 v242, v84
 v_exp_f32 v243, v85
 v_add_f32 v241, v242, v241
 v_add_f32 v241, v243, v241
 v_mfma_f32_32x32x16_bf16 a[80:95], v[232:235], v[152:155], a[80:95]
 ds_read_b64_tr_b16 v[232:233], v201 offset:61440
 ds_read_b64_tr_b16 v[234:235], v201 offset:63488
 v_cvt_pk_bf16_f32 v138, v242, v243
 v_exp_f32 v244, v86
 v_mul_f32 v252, v219, v252
 s_waitcnt lgkmcnt(6)
 v_mfma_f32_32x32x16_bf16 a[96:111], v[236:239], v[144:147], a[96:111]
 v_exp_f32 v245, v87
 v_add_f32 v241, v244, v241
 v_add_f32 v241, v245, v241
 v_cvt_pk_bf16_f32 v139, v244, v245
 v_mul_f32 v253, v219, v253
 v_mfma_f32_32x32x16_bf16 a[112:127], v[236:239], v[152:155], a[112:127]
 ds_read_b64_tr_b16 v[236:237], v202 offset:61440
 ds_read_b64_tr_b16 v[238:239], v202 offset:63488
 v_exp_f32 v242, v88
 v_exp_f32 v243, v89
 v_mfma_f32_32x32x16_bf16 v[0:15], v[220:223], v[144:147], v[0:15]
 v_add_f32 v241, v242, v241
 v_add_f32 v241, v243, v241
 v_cvt_pk_bf16_f32 v140, v242, v243
 v_exp_f32 v244, v90
 v_cvt_pk_bf16_f32 v246, v250, v251
 v_mfma_f32_32x32x16_bf16 v[16:31], v[220:223], v[152:155], v[16:31]
 ds_read_b64_tr_b16 v[220:221], v203 offset:61440
 ds_read_b64_tr_b16 v[222:223], v203 offset:63488
 v_exp_f32 v245, v91
 v_add_f32 v241, v244, v241
 v_add_f32 v241, v245, v241
 s_waitcnt lgkmcnt(6)
 v_mfma_f32_32x32x16_bf16 v[32:47], v[224:227], v[144:147], v[32:47]
 v_cvt_pk_bf16_f32 v141, v244, v245
 v_exp_f32 v242, v92
 v_exp_f32 v243, v93
 v_add_f32 v241, v242, v241
 v_mfma_f32_32x32x16_bf16 v[48:63], v[224:227], v[152:155], v[48:63]
 ds_read_b128 v[224:227], v192 offset:16384
 v_add_f32 v241, v243, v241
 v_cvt_pk_bf16_f32 v142, v242, v243
 v_exp_f32 v244, v94
 v_cvt_pk_bf16_f32 v247, v252, v253
 v_mfma_f32_32x32x16_bf16 a[64:79], v[228:231], v[148:151], a[64:79]
 v_exp_f32 v245, v95
 v_add_f32 v241, v244, v241
 v_add_f32 v241, v245, v241
 v_cvt_pk_bf16_f32 v143, v244, v245
 v_accvgpr_read_b32 v250, a212
 v_mfma_f32_32x32x16_bf16 a[80:95], v[228:231], v[156:159], a[80:95]
 ds_read_b128 v[228:231], v193 offset:16384
 v_accvgpr_read_b32 v251, a213
 v_accvgpr_read_b32 v252, a214
 v_accvgpr_read_b32 v253, a215
 v_mul_f32 v250, v219, v250
 v_mul_f32 v251, v219, v251
 s_waitcnt lgkmcnt(4)
 v_mfma_f32_32x32x16_bf16 a[96:111], v[232:235], v[148:151], a[96:111]
 v_mul_f32 v252, v219, v252
 v_mul_f32 v253, v219, v253
 v_cvt_pk_bf16_f32 v248, v250, v251
 v_cvt_pk_bf16_f32 v249, v252, v253
 buffer_store_dwordx4 v[246:249], v214, s[24:27], s80 offen offset:1024 sc1
 v_mfma_f32_32x32x16_bf16 a[112:127], v[232:235], v[156:159], a[112:127]
 ds_read_b128 v[232:235], v194 offset:16384
 v_accvgpr_read_b32 v250, a216
 v_accvgpr_read_b32 v251, a217
 v_accvgpr_read_b32 v252, a218
 v_accvgpr_read_b32 v253, a219
 v_mul_f32 v250, v219, v250
 v_mfma_f32_32x32x16_bf16 v[0:15], v[236:239], v[148:151], v[0:15]
 v_mul_f32 v251, v219, v251
 v_mul_f32 v252, v219, v252
 v_mul_f32 v253, v219, v253
 v_cvt_pk_bf16_f32 v246, v250, v251
 v_cvt_pk_bf16_f32 v247, v252, v253
 v_accvgpr_read_b32 v250, a220
 v_mfma_f32_32x32x16_bf16 v[16:31], v[236:239], v[156:159], v[16:31]
 ds_read_b128 v[236:239], v195 offset:16384
 v_accvgpr_read_b32 v251, a221
 v_accvgpr_read_b32 v252, a222
 v_accvgpr_read_b32 v253, a223
 v_mul_f32 v250, v219, v250
 v_mul_f32 v251, v219, v251
 s_waitcnt lgkmcnt(3)
 v_mfma_f32_32x32x16_bf16 v[32:47], v[220:223], v[148:151], v[32:47]
 v_mul_f32 v252, v219, v252
 v_mul_f32 v253, v219, v253
 v_cvt_pk_bf16_f32 v248, v250, v251
 v_cvt_pk_bf16_f32 v249, v252, v253
 buffer_store_dwordx4 v[246:249], v214, s[24:27], s81 offen offset:1024 sc1
 v_mfma_f32_32x32x16_bf16 v[48:63], v[220:223], v[156:159], v[48:63]
 v_add_f32 v254, v240, v241
 v_cmp_nge_f32 vcc, s30, v254
 s_cbranch_vccnz LR1_8
BR1_8:
 s_waitcnt vmcnt(30)
 s_barrier
 ds_read_b128 v[220:223], v196 offset:16384
 s_add_u32 m0, s28, 122880
 v_mfma_f32_32x32x16_bf16 v[64:79], v[224:227], a[0:3], v[160:175]
 s_add_u32 s76, s36, 65536
 s_add_u32 s77, s36, 73728
 s_add_u32 s78, s36, 81920
 s_add_u32 s79, s36, 90112
 buffer_load_dwordx4 v210, s[12:15], s34 offen nt lds
 v_mfma_f32_32x32x16_bf16 v[80:95], v[224:227], a[8:11], v[176:191]
 ds_read_b128 v[224:227], v197 offset:16384
 s_add_u32 s80, s36, 98304
 s_add_u32 s81, s36, 106496
 v_add_f32 v216, v240, v216
 v_add_f32 v217, v241, v217
 v_accvgpr_read_b32 v250, a224
 s_waitcnt lgkmcnt(3)
 v_mfma_f32_32x32x16_bf16 v[64:79], v[228:231], a[4:7], v[64:79]
 v_exp_f32 v242, v96
 v_exp_f32 v243, v97
 buffer_load_dwordx4 v210, s[12:15], s34 offen offset:1024 nt lds
 v_mfma_f32_32x32x16_bf16 v[80:95], v[228:231], a[12:15], v[80:95]
 ds_read_b128 v[228:231], v198 offset:16384
 v_add_f32 v240, v242, v243
 v_cvt_pk_bf16_f32 v144, v242, v243
 v_exp_f32 v244, v98
 v_accvgpr_read_b32 v251, a225
 v_mfma_f32_32x32x16_bf16 v[64:79], v[232:235], a[16:19], v[64:79]
 v_exp_f32 v245, v99
 v_add_f32 v240, v244, v240
 v_add_f32 v240, v245, v240
 v_cvt_pk_bf16_f32 v145, v244, v245
 v_accvgpr_read_b32 v252, a226
 v_mfma_f32_32x32x16_bf16 v[80:95], v[232:235], a[24:27], v[80:95]
 ds_read_b128 v[232:235], v199 offset:16384
 v_exp_f32 v242, v100
 v_exp_f32 v243, v101
 v_add_f32 v240, v242, v240
 s_waitcnt lgkmcnt(3)
 v_mfma_f32_32x32x16_bf16 v[64:79], v[236:239], a[20:23], v[64:79]
 v_add_f32 v240, v243, v240
 v_cvt_pk_bf16_f32 v146, v242, v243
 v_exp_f32 v244, v102
 v_exp_f32 v245, v103
 v_mfma_f32_32x32x16_bf16 v[80:95], v[236:239], a[28:31], v[80:95]
 ds_read_b64_tr_b16 v[236:237], v200 offset:0
 ds_read_b64_tr_b16 v[238:239], v200 offset:2048
 v_add_f32 v240, v244, v240
 v_add_f32 v240, v245, v240
 v_cvt_pk_bf16_f32 v147, v244, v245
 v_accvgpr_read_b32 v253, a227
 v_mfma_f32_32x32x16_bf16 v[64:79], v[220:223], a[32:35], v[64:79]
 v_exp_f32 v242, v104
 v_exp_f32 v243, v105
 v_add_f32 v240, v242, v240
 v_add_f32 v240, v243, v240
 v_mfma_f32_32x32x16_bf16 v[80:95], v[220:223], a[40:43], v[80:95]
 ds_read_b64_tr_b16 v[220:221], v201 offset:0
 ds_read_b64_tr_b16 v[222:223], v201 offset:2048
 v_cvt_pk_bf16_f32 v148, v242, v243
 v_exp_f32 v244, v106
 v_mul_f32 v250, v218, v250
 s_waitcnt lgkmcnt(5)
 v_mfma_f32_32x32x16_bf16 v[64:79], v[224:227], a[36:39], v[64:79]
 v_exp_f32 v245, v107
 v_add_f32 v240, v244, v240
 v_add_f32 v240, v245, v240
 v_cvt_pk_bf16_f32 v149, v244, v245
 v_mul_f32 v251, v218, v251
 v_mfma_f32_32x32x16_bf16 v[80:95], v[224:227], a[44:47], v[80:95]
 ds_read_b64_tr_b16 v[224:225], v202 offset:0
 ds_read_b64_tr_b16 v[226:227], v202 offset:2048
 v_exp_f32 v242, v108
 v_exp_f32 v243, v109
 v_mfma_f32_32x32x16_bf16 v[64:79], v[228:231], a[48:51], v[64:79]
 v_add_f32 v240, v242, v240
 v_add_f32 v240, v243, v240
 v_cvt_pk_bf16_f32 v150, v242, v243
 v_exp_f32 v244, v110
 v_mul_f32 v252, v218, v252
 v_mfma_f32_32x32x16_bf16 v[80:95], v[228:231], a[56:59], v[80:95]
 ds_read_b64_tr_b16 v[228:229], v203 offset:0
 ds_read_b64_tr_b16 v[230:231], v203 offset:2048
 v_exp_f32 v245, v111
 v_add_f32 v240, v244, v240
 v_add_f32 v240, v245, v240
 s_waitcnt lgkmcnt(6)
 v_mfma_f32_32x32x16_bf16 v[64:79], v[232:235], a[52:55], v[64:79]
 v_cvt_pk_bf16_f32 v151, v244, v245
 v_exp_f32 v242, v112
 v_exp_f32 v243, v113
 v_mul_f32 v253, v218, v253
 v_mfma_f32_32x32x16_bf16 v[80:95], v[232:235], a[60:63], v[80:95]
 ds_read_b64_tr_b16 v[232:233], v200 offset:4096
 ds_read_b64_tr_b16 v[234:235], v200 offset:6144
 v_add_f32 v241, v242, v243
 v_cvt_pk_bf16_f32 v152, v242, v243
 v_exp_f32 v244, v114
 v_mfma_f32_32x32x16_bf16 a[64:79], v[236:239], v[128:131], a[64:79]
 v_exp_f32 v245, v115
 v_add_f32 v241, v244, v241
 v_add_f32 v241, v245, v241
 v_cvt_pk_bf16_f32 v153, v244, v245
 v_cvt_pk_bf16_f32 v246, v250, v251
 v_mfma_f32_32x32x16_bf16 a[80:95], v[236:239], v[136:139], a[80:95]
 ds_read_b64_tr_b16 v[236:237], v201 offset:4096
 ds_read_b64_tr_b16 v[238:239], v201 offset:6144
 v_exp_f32 v242, v116
 v_exp_f32 v243, v117
 s_waitcnt lgkmcnt(6)
 v_mfma_f32_32x32x16_bf16 a[96:111], v[220:223], v[128:131], a[96:111]
 v_add_f32 v241, v242, v241
 v_add_f32 v241, v243, v241
 v_cvt_pk_bf16_f32 v154, v242, v243
 v_exp_f32 v244, v118
 v_cvt_pk_bf16_f32 v247, v252, v253
 v_mfma_f32_32x32x16_bf16 a[112:127], v[220:223], v[136:139], a[112:127]
 ds_read_b64_tr_b16 v[220:221], v202 offset:4096
 ds_read_b64_tr_b16 v[222:223], v202 offset:6144
 v_exp_f32 v245, v119
 v_add_f32 v241, v244, v241
 v_add_f32 v241, v245, v241
 v_mfma_f32_32x32x16_bf16 v[0:15], v[224:227], v[128:131], v[0:15]
 v_cvt_pk_bf16_f32 v155, v244, v245
 v_exp_f32 v242, v120
 v_exp_f32 v243, v121
 v_add_f32 v241, v242, v241
 v_mfma_f32_32x32x16_bf16 v[16:31], v[224:227], v[136:139], v[16:31]
 ds_read_b64_tr_b16 v[224:225], v203 offset:4096
 ds_read_b64_tr_b16 v[226:227], v203 offset:6144
 v_add_f32 v241, v243, v241
 v_cvt_pk_bf16_f32 v156, v242, v243
 v_exp_f32 v244, v122
 s_waitcnt lgkmcnt(6)
 v_mfma_f32_32x32x16_bf16 v[32:47], v[228:231], v[128:131], v[32:47]
 v_exp_f32 v245, v123
 v_add_f32 v241, v244, v241
 v_add_f32 v241, v245, v241
 v_cvt_pk_bf16_f32 v157, v244, v245
 v_accvgpr_read_b32 v250, a228
 v_mfma_f32_32x32x16_bf16 v[48:63], v[228:231], v[136:139], v[48:63]
 ds_read_b128 v[228:231], v192 offset:24576
 v_exp_f32 v242, v124
 v_exp_f32 v243, v125
 v_add_f32 v241, v242, v241
 v_mfma_f32_32x32x16_bf16 a[64:79], v[232:235], v[132:135], a[64:79]
 v_add_f32 v241, v243, v241
 v_cvt_pk_bf16_f32 v158, v242, v243
 v_exp_f32 v244, v126
 v_exp_f32 v245, v127
 v_mfma_f32_32x32x16_bf16 a[80:95], v[232:235], v[140:143], a[80:95]
 ds_read_b128 v[232:235], v193 offset:24576
 v_add_f32 v241, v244, v241
 v_add_f32 v241, v245, v241
 v_cvt_pk_bf16_f32 v159, v244, v245
 v_accvgpr_read_b32 v251, a229
 v_accvgpr_read_b32 v252, a230
 s_waitcnt lgkmcnt(4)
 v_mfma_f32_32x32x16_bf16 a[96:111], v[236:239], v[132:135], a[96:111]
 v_accvgpr_read_b32 v253, a231
 v_mul_f32 v250, v218, v250
 v_mul_f32 v251, v218, v251
 v_mul_f32 v252, v218, v252
 v_mul_f32 v253, v218, v253
 v_cvt_pk_bf16_f32 v248, v250, v251
 v_mfma_f32_32x32x16_bf16 a[112:127], v[236:239], v[140:143], a[112:127]
 ds_read_b128 v[236:239], v194 offset:24576
 v_cvt_pk_bf16_f32 v249, v252, v253
 buffer_store_dwordx4 v[246:249], v214, s[24:27], s82 offen offset:0 sc1
 v_accvgpr_read_b32 v250, a232
 v_accvgpr_read_b32 v251, a233
 v_mfma_f32_32x32x16_bf16 v[0:15], v[220:223], v[132:135], v[0:15]
 v_accvgpr_read_b32 v252, a234
 v_accvgpr_read_b32 v253, a235
 v_mul_f32 v250, v218, v250
 v_mul_f32 v251, v218, v251
 v_mul_f32 v252, v218, v252
 v_mul_f32 v253, v218, v253
 v_mfma_f32_32x32x16_bf16 v[16:31], v[220:223], v[140:143], v[16:31]
 ds_read_b128 v[220:223], v195 offset:24576
 v_cvt_pk_bf16_f32 v246, v250, v251
 v_cvt_pk_bf16_f32 v247, v252, v253
 v_accvgpr_read_b32 v250, a236
 v_accvgpr_read_b32 v251, a237
 v_accvgpr_read_b32 v252, a238
 s_waitcnt lgkmcnt(3)
 v_mfma_f32_32x32x16_bf16 v[32:47], v[224:227], v[132:135], v[32:47]
 v_accvgpr_read_b32 v253, a239
 v_mul_f32 v250, v218, v250
 v_mul_f32 v251, v218, v251
 v_mul_f32 v252, v218, v252
 v_mul_f32 v253, v218, v253
 v_cvt_pk_bf16_f32 v248, v250, v251
 v_mfma_f32_32x32x16_bf16 v[48:63], v[224:227], v[140:143], v[48:63]
 v_cvt_pk_bf16_f32 v249, v252, v253
 buffer_store_dwordx4 v[246:249], v214, s[24:27], s83 offen offset:0 sc1
 v_add_f32 v254, v240, v241
 v_cmp_nge_f32 vcc, s30, v254
 s_cbranch_vccnz LR1_9
BR1_9:
 s_waitcnt vmcnt(28)
 s_barrier
 v_mfma_f32_32x32x16_bf16 v[96:111], v[228:231], a[0:3], v[160:175]
 ds_read_b128 v[224:227], v196 offset:24576
 v_add_f32 v216, v240, v216
 v_add_f32 v217, v241, v217
 v_exp_f32 v242, v64
 v_accvgpr_read_b32 v250, a240
 v_mfma_f32_32x32x16_bf16 v[112:127], v[228:231], a[8:11], v[176:191]
 ds_read_b128 v[228:231], v197 offset:24576
 v_exp_f32 v243, v65
 v_exp_f32 v244, v66
 v_add_f32 v240, v242, v243
 s_waitcnt lgkmcnt(3)
 v_mfma_f32_32x32x16_bf16 v[96:111], v[232:235], a[4:7], v[96:111]
 v_cvt_pk_bf16_f32 v128, v242, v243
 v_exp_f32 v245, v67
 v_add_f32 v240, v244, v240
 v_add_f32 v240, v245, v240
 v_cvt_pk_bf16_f32 v129, v244, v245
 v_mfma_f32_32x32x16_bf16 v[112:127], v[232:235], a[12:15], v[112:127]
 ds_read_b128 v[232:235], v198 offset:24576
 v_exp_f32 v242, v68
 v_exp_f32 v243, v69
 v_add_f32 v240, v242, v240
 v_mfma_f32_32x32x16_bf16 v[96:111], v[236:239], a[16:19], v[96:111]
 v_add_f32 v240, v243, v240
 v_cvt_pk_bf16_f32 v130, v242, v243
 v_exp_f32 v244, v70
 v_exp_f32 v245, v71
 v_mfma_f32_32x32x16_bf16 v[112:127], v[236:239], a[24:27], v[112:127]
 ds_read_b128 v[236:239], v199 offset:24576
 v_add_f32 v240, v244, v240
 v_add_f32 v240, v245, v240
 v_cvt_pk_bf16_f32 v131, v244, v245
 v_exp_f32 v242, v72
 s_waitcnt lgkmcnt(3)
 v_mfma_f32_32x32x16_bf16 v[96:111], v[220:223], a[20:23], v[96:111]
 v_exp_f32 v243, v73
 v_add_f32 v240, v242, v240
 v_add_f32 v240, v243, v240
 v_cvt_pk_bf16_f32 v132, v242, v243
 v_accvgpr_read_b32 v251, a241
 v_mfma_f32_32x32x16_bf16 v[112:127], v[220:223], a[28:31], v[112:127]
 ds_read_b64_tr_b16 v[220:221], v200 offset:8192
 ds_read_b64_tr_b16 v[222:223], v200 offset:10240
 v_exp_f32 v244, v74
 v_exp_f32 v245, v75
 v_mfma_f32_32x32x16_bf16 v[96:111], v[224:227], a[32:35], v[96:111]
 v_add_f32 v240, v244, v240
 v_add_f32 v240, v245, v240
 v_cvt_pk_bf16_f32 v133, v244, v245
 v_exp_f32 v242, v76
 v_accvgpr_read_b32 v252, a242
 v_mfma_f32_32x32x16_bf16 v[112:127], v[224:227], a[40:43], v[112:127]
 ds_read_b64_tr_b16 v[224:225], v201 offset:8192
 ds_read_b64_tr_b16 v[226:227], v201 offset:10240
 v_exp_f32 v243, v77
 v_add_f32 v240, v242, v240
 v_add_f32 v240, v243, v240
 s_waitcnt lgkmcnt(5)
 v_mfma_f32_32x32x16_bf16 v[96:111], v[228:231], a[36:39], v[96:111]
 v_cvt_pk_bf16_f32 v134, v242, v243
 v_exp_f32 v244, v78
 v_exp_f32 v245, v79
 v_add_f32 v240, v244, v240
 v_mfma_f32_32x32x16_bf16 v[112:127], v[228:231], a[44:47], v[112:127]
 ds_read_b64_tr_b16 v[228:229], v202 offset:8192
 ds_read_b64_tr_b16 v[230:231], v202 offset:10240
 v_add_f32 v240, v245, v240
 v_cvt_pk_bf16_f32 v135, v244, v245
 v_exp_f32 v242, v80
 v_mfma_f32_32x32x16_bf16 v[96:111], v[232:235], a[48:51], v[96:111]
 v_exp_f32 v243, v81
 v_exp_f32 v244, v82
 v_add_f32 v241, v242, v243
 v_cvt_pk_bf16_f32 v136, v242, v243
 v_mfma_f32_32x32x16_bf16 v[112:127], v[232:235], a[56:59], v[112:127]
 ds_read_b64_tr_b16 v[232:233], v203 offset:8192
 ds_read_b64_tr_b16 v[234:235], v203 offset:10240
 v_exp_f32 v245, v83
 v_add_f32 v241, v244, v241
 v_add_f32 v241, v245, v241
 s_waitcnt lgkmcnt(6)
 v_mfma_f32_32x32x16_bf16 v[96:111], v[236:239], a[52:55], v[96:111]
 v_cvt_pk_bf16_f32 v137, v244, v245
 v_exp_f32 v242, v84
 v_exp_f32 v243, v85
 v_add_f32 v241, v242, v241
 v_mfma_f32_32x32x16_bf16 v[112:127], v[236:239], a[60:63], v[112:127]
 ds_read_b64_tr_b16 v[236:237], v200 offset:12288
 ds_read_b64_tr_b16 v[238:239], v200 offset:14336
 v_add_f32 v241, v243, v241
 v_cvt_pk_bf16_f32 v138, v242, v243
 v_exp_f32 v244, v86
 v_mfma_f32_32x32x16_bf16 a[64:79], v[220:223], v[144:147], a[64:79]
 v_exp_f32 v245, v87
 v_add_f32 v241, v244, v241
 v_add_f32 v241, v245, v241
 v_cvt_pk_bf16_f32 v139, v244, v245
 v_accvgpr_read_b32 v253, a243
 v_mfma_f32_32x32x16_bf16 a[80:95], v[220:223], v[152:155], a[80:95]
 ds_read_b64_tr_b16 v[220:221], v201 offset:12288
 ds_read_b64_tr_b16 v[222:223], v201 offset:14336
 v_exp_f32 v242, v88
 v_exp_f32 v243, v89
 s_waitcnt lgkmcnt(6)
 v_mfma_f32_32x32x16_bf16 a[96:111], v[224:227], v[144:147], a[96:111]
 v_add_f32 v241, v242, v241
 v_add_f32 v241, v243, v241
 v_cvt_pk_bf16_f32 v140, v242, v243
 v_exp_f32 v244, v90
 v_mul_f32 v250, v219, v250
 v_mfma_f32_32x32x16_bf16 a[112:127], v[224:227], v[152:155], a[112:127]
 ds_read_b64_tr_b16 v[224:225], v202 offset:12288
 ds_read_b64_tr_b16 v[226:227], v202 offset:14336
 v_exp_f32 v245, v91
 v_add_f32 v241, v244, v241
 v_add_f32 v241, v245, v241
 v_mfma_f32_32x32x16_bf16 v[0:15], v[228:231], v[144:147], v[0:15]
 v_cvt_pk_bf16_f32 v141, v244, v245
 v_exp_f32 v242, v92
 v_exp_f32 v243, v93
 v_add_f32 v241, v242, v241
 v_mfma_f32_32x32x16_bf16 v[16:31], v[228:231], v[152:155], v[16:31]
 ds_read_b64_tr_b16 v[228:229], v203 offset:12288
 ds_read_b64_tr_b16 v[230:231], v203 offset:14336
 v_add_f32 v241, v243, v241
 v_cvt_pk_bf16_f32 v142, v242, v243
 v_exp_f32 v244, v94
 s_waitcnt lgkmcnt(6)
 v_mfma_f32_32x32x16_bf16 v[32:47], v[232:235], v[144:147], v[32:47]
 v_exp_f32 v245, v95
 v_add_f32 v241, v244, v241
 v_add_f32 v241, v245, v241
 v_cvt_pk_bf16_f32 v143, v244, v245
 v_mul_f32 v251, v219, v251
 v_mfma_f32_32x32x16_bf16 v[48:63], v[232:235], v[152:155], v[48:63]
 ds_read_b128 v[232:235], v192 offset:32768
 v_mul_f32 v252, v219, v252
 v_mul_f32 v253, v219, v253
 v_cvt_pk_bf16_f32 v246, v250, v251
 v_cvt_pk_bf16_f32 v247, v252, v253
 v_accvgpr_read_b32 v250, a244
 v_mfma_f32_32x32x16_bf16 a[64:79], v[236:239], v[148:151], a[64:79]
 v_accvgpr_read_b32 v251, a245
 v_accvgpr_read_b32 v252, a246
 v_accvgpr_read_b32 v253, a247
 v_mul_f32 v250, v219, v250
 v_mul_f32 v251, v219, v251
 v_mul_f32 v252, v219, v252
 v_mfma_f32_32x32x16_bf16 a[80:95], v[236:239], v[156:159], a[80:95]
 ds_read_b128 v[236:239], v193 offset:32768
 v_mul_f32 v253, v219, v253
 v_cvt_pk_bf16_f32 v248, v250, v251
 v_cvt_pk_bf16_f32 v249, v252, v253
 buffer_store_dwordx4 v[246:249], v214, s[24:27], s82 offen offset:1024 sc1
 s_waitcnt lgkmcnt(4)
 v_mfma_f32_32x32x16_bf16 a[96:111], v[220:223], v[148:151], a[96:111]
 s_add_u32 s82, s36, 114688
 v_accvgpr_read_b32 v250, a248
 v_accvgpr_read_b32 v251, a249
 v_accvgpr_read_b32 v252, a250
 v_accvgpr_read_b32 v253, a251
 v_mul_f32 v250, v219, v250
 v_mfma_f32_32x32x16_bf16 a[112:127], v[220:223], v[156:159], a[112:127]
 ds_read_b128 v[220:223], v194 offset:32768
 v_mul_f32 v251, v219, v251
 v_mul_f32 v252, v219, v252
 v_mul_f32 v253, v219, v253
 v_cvt_pk_bf16_f32 v246, v250, v251
 v_cvt_pk_bf16_f32 v247, v252, v253
 v_mfma_f32_32x32x16_bf16 v[0:15], v[224:227], v[148:151], v[0:15]
 v_accvgpr_read_b32 v250, a252
 v_accvgpr_read_b32 v251, a253
 v_accvgpr_read_b32 v252, a254
 v_accvgpr_read_b32 v253, a255
 v_mul_f32 v250, v219, v250
 v_mul_f32 v251, v219, v251
 v_mfma_f32_32x32x16_bf16 v[16:31], v[224:227], v[156:159], v[16:31]
 ds_read_b128 v[224:227], v195 offset:32768
 v_mul_f32 v252, v219, v252
 v_mul_f32 v253, v219, v253
 v_cvt_pk_bf16_f32 v248, v250, v251
 v_cvt_pk_bf16_f32 v249, v252, v253
 v_add_f32 v254, v240, v241
 s_waitcnt lgkmcnt(3)
 v_mfma_f32_32x32x16_bf16 v[32:47], v[228:231], v[148:151], v[32:47]
 buffer_store_dwordx4 v[246:249], v214, s[24:27], s83 offen offset:1024 sc1
 s_add_u32 s83, s36, 122880
 v_cmp_nge_f32 vcc, s30, v254
 v_mfma_f32_32x32x16_bf16 v[48:63], v[228:231], v[156:159], v[48:63]
 s_cbranch_vccnz LR1_10
BR1_10:
 s_waitcnt vmcnt(24)
 s_barrier
 ds_read_b128 v[228:231], v196 offset:32768
 v_add_f32 v216, v240, v216
 v_add_f32 v217, v241, v217
 v_mfma_f32_32x32x16_bf16 v[64:79], v[232:235], a[0:3], v[160:175]
 v_exp_f32 v242, v96
 v_exp_f32 v243, v97
 v_exp_f32 v244, v98
 v_mfma_f32_32x32x16_bf16 v[80:95], v[232:235], a[8:11], v[176:191]
 ds_read_b128 v[232:235], v197 offset:32768
 v_add_f32 v240, v242, v243
 v_cvt_pk_bf16_f32 v144, v242, v243
 v_exp_f32 v245, v99
 v_add_f32 v240, v244, v240
 s_waitcnt lgkmcnt(3)
 v_mfma_f32_32x32x16_bf16 v[64:79], v[236:239], a[4:7], v[64:79]
 v_add_f32 v240, v245, v240
 v_cvt_pk_bf16_f32 v145, v244, v245
 v_exp_f32 v242, v100
 v_exp_f32 v243, v101
 v_mfma_f32_32x32x16_bf16 v[80:95], v[236:239], a[12:15], v[80:95]
 ds_read_b128 v[236:239], v198 offset:32768
 v_add_f32 v240, v242, v240
 v_add_f32 v240, v243, v240
 v_cvt_pk_bf16_f32 v146, v242, v243
 v_exp_f32 v244, v102
 v_mfma_f32_32x32x16_bf16 v[64:79], v[220:223], a[16:19], v[64:79]
 v_exp_f32 v245, v103
 v_add_f32 v240, v244, v240
 v_add_f32 v240, v245, v240
 v_cvt_pk_bf16_f32 v147, v244, v245
 v_mfma_f32_32x32x16_bf16 v[80:95], v[220:223], a[24:27], v[80:95]
 ds_read_b128 v[220:223], v199 offset:32768
 v_exp_f32 v242, v104
 v_exp_f32 v243, v105
 v_add_f32 v240, v242, v240
 s_waitcnt lgkmcnt(3)
 v_mfma_f32_32x32x16_bf16 v[64:79], v[224:227], a[20:23], v[64:79]
 v_add_f32 v240, v243, v240
 v_cvt_pk_bf16_f32 v148, v242, v243
 v_exp_f32 v244, v106
 v_exp_f32 v245, v107
 v_mfma_f32_32x32x16_bf16 v[80:95], v[224:227], a[28:31], v[80:95]
 ds_read_b64_tr_b16 v[224:225], v200 offset:16384
 ds_read_b64_tr_b16 v[226:227], v200 offset:18432
 v_add_f32 v240, v244, v240
 v_add_f32 v240, v245, v240
 v_cvt_pk_bf16_f32 v149, v244, v245
 v_mfma_f32_32x32x16_bf16 v[64:79], v[228:231], a[32:35], v[64:79]
 v_exp_f32 v242, v108
 v_exp_f32 v243, v109
 v_add_f32 v240, v242, v240
 v_add_f32 v240, v243, v240
 v_mfma_f32_32x32x16_bf16 v[80:95], v[228:231], a[40:43], v[80:95]
 ds_read_b64_tr_b16 v[228:229], v201 offset:16384
 ds_read_b64_tr_b16 v[230:231], v201 offset:18432
 v_cvt_pk_bf16_f32 v150, v242, v243
 v_exp_f32 v244, v110
 s_waitcnt lgkmcnt(5)
 v_mfma_f32_32x32x16_bf16 v[64:79], v[232:235], a[36:39], v[64:79]
 v_exp_f32 v245, v111
 v_add_f32 v240, v244, v240
 v_add_f32 v240, v245, v240
 v_cvt_pk_bf16_f32 v151, v244, v245
 v_mfma_f32_32x32x16_bf16 v[80:95], v[232:235], a[44:47], v[80:95]
 ds_read_b64_tr_b16 v[232:233], v202 offset:16384
 ds_read_b64_tr_b16 v[234:235], v202 offset:18432
 v_exp_f32 v242, v112
 v_exp_f32 v243, v113
 v_mfma_f32_32x32x16_bf16 v[64:79], v[236:239], a[48:51], v[64:79]
 v_add_f32 v241, v242, v243
 v_cvt_pk_bf16_f32 v152, v242, v243
 v_exp_f32 v244, v114
 v_exp_f32 v245, v115
 v_mfma_f32_32x32x16_bf16 v[80:95], v[236:239], a[56:59], v[80:95]
 ds_read_b64_tr_b16 v[236:237], v203 offset:16384
 ds_read_b64_tr_b16 v[238:239], v203 offset:18432
 v_add_f32 v241, v244, v241
 v_add_f32 v241, v245, v241
 v_cvt_pk_bf16_f32 v153, v244, v245
 s_waitcnt lgkmcnt(6)
 v_mfma_f32_32x32x16_bf16 v[64:79], v[220:223], a[52:55], v[64:79]
 v_exp_f32 v242, v116
 v_exp_f32 v243, v117
 v_add_f32 v241, v242, v241
 v_add_f32 v241, v243, v241
 v_mfma_f32_32x32x16_bf16 v[80:95], v[220:223], a[60:63], v[80:95]
 ds_read_b64_tr_b16 v[220:221], v200 offset:20480
 ds_read_b64_tr_b16 v[222:223], v200 offset:22528
 v_cvt_pk_bf16_f32 v154, v242, v243
 v_exp_f32 v244, v118
 v_mfma_f32_32x32x16_bf16 a[64:79], v[224:227], v[128:131], a[64:79]
 v_exp_f32 v245, v119
 v_add_f32 v241, v244, v241
 v_add_f32 v241, v245, v241
 v_cvt_pk_bf16_f32 v155, v244, v245
 v_mfma_f32_32x32x16_bf16 a[80:95], v[224:227], v[136:139], a[80:95]
 ds_read_b64_tr_b16 v[224:225], v201 offset:20480
 ds_read_b64_tr_b16 v[226:227], v201 offset:22528
 v_exp_f32 v242, v120
 v_exp_f32 v243, v121
 s_waitcnt lgkmcnt(6)
 v_mfma_f32_32x32x16_bf16 a[96:111], v[228:231], v[128:131], a[96:111]
 v_add_f32 v241, v242, v241
 v_add_f32 v241, v243, v241
 v_cvt_pk_bf16_f32 v156, v242, v243
 v_exp_f32 v244, v122
 v_mfma_f32_32x32x16_bf16 a[112:127], v[228:231], v[136:139], a[112:127]
 ds_read_b64_tr_b16 v[228:229], v202 offset:20480
 ds_read_b64_tr_b16 v[230:231], v202 offset:22528
 v_exp_f32 v245, v123
 v_add_f32 v241, v244, v241
 v_add_f32 v241, v245, v241
 v_mfma_f32_32x32x16_bf16 v[0:15], v[232:235], v[128:131], v[0:15]
 v_cvt_pk_bf16_f32 v157, v244, v245
 v_exp_f32 v242, v124
 v_exp_f32 v243, v125
 v_add_f32 v241, v242, v241
 v_mfma_f32_32x32x16_bf16 v[16:31], v[232:235], v[136:139], v[16:31]
 ds_read_b64_tr_b16 v[232:233], v203 offset:20480
 ds_read_b64_tr_b16 v[234:235], v203 offset:22528
 v_add_f32 v241, v243, v241
 v_cvt_pk_bf16_f32 v158, v242, v243
 v_exp_f32 v244, v126
 s_waitcnt lgkmcnt(6)
 v_mfma_f32_32x32x16_bf16 v[32:47], v[236:239], v[128:131], v[32:47]
 v_exp_f32 v245, v127
 v_add_f32 v241, v244, v241
 v_add_f32 v241, v245, v241
 v_cvt_pk_bf16_f32 v159, v244, v245
 v_add_f32 v254, v240, v241
 v_mfma_f32_32x32x16_bf16 v[48:63], v[236:239], v[136:139], v[48:63]
 ds_read_b128 v[236:239], v192 offset:40960
 v_cmp_nge_f32 vcc, s30, v254
 v_mfma_f32_32x32x16_bf16 a[64:79], v[220:223], v[132:135], a[64:79]
 v_mfma_f32_32x32x16_bf16 a[80:95], v[220:223], v[140:143], a[80:95]
 ds_read_b128 v[220:223], v193 offset:40960
 s_waitcnt lgkmcnt(4)
 v_mfma_f32_32x32x16_bf16 a[96:111], v[224:227], v[132:135], a[96:111]
 v_mfma_f32_32x32x16_bf16 a[112:127], v[224:227], v[140:143], a[112:127]
 ds_read_b128 v[224:227], v194 offset:40960
 v_mfma_f32_32x32x16_bf16 v[0:15], v[228:231], v[132:135], v[0:15]
 v_mfma_f32_32x32x16_bf16 v[16:31], v[228:231], v[140:143], v[16:31]
 ds_read_b128 v[228:231], v195 offset:40960
 s_waitcnt lgkmcnt(3)
 v_mfma_f32_32x32x16_bf16 v[32:47], v[232:235], v[132:135], v[32:47]
 v_mfma_f32_32x32x16_bf16 v[48:63], v[232:235], v[140:143], v[48:63]
 s_cbranch_vccnz LR1_11
BR1_11:
 s_waitcnt vmcnt(18)
 s_barrier
 ds_read_b128 v[232:235], v196 offset:40960
 v_add_f32 v216, v240, v216
 v_add_f32 v217, v241, v217
 v_mfma_f32_32x32x16_bf16 v[96:111], v[236:239], a[0:3], v[160:175]
 v_exp_f32 v242, v64
 v_exp_f32 v243, v65
 v_exp_f32 v244, v66
 v_mfma_f32_32x32x16_bf16 v[112:127], v[236:239], a[8:11], v[176:191]
 ds_read_b128 v[236:239], v197 offset:40960
 v_add_f32 v240, v242, v243
 v_cvt_pk_bf16_f32 v128, v242, v243
 v_exp_f32 v245, v67
 v_add_f32 v240, v244, v240
 s_waitcnt lgkmcnt(3)
 v_mfma_f32_32x32x16_bf16 v[96:111], v[220:223], a[4:7], v[96:111]
 v_add_f32 v240, v245, v240
 v_cvt_pk_bf16_f32 v129, v244, v245
 v_exp_f32 v242, v68
 v_exp_f32 v243, v69
 v_mfma_f32_32x32x16_bf16 v[112:127], v[220:223], a[12:15], v[112:127]
 ds_read_b128 v[220:223], v198 offset:40960
 v_add_f32 v240, v242, v240
 v_add_f32 v240, v243, v240
 v_cvt_pk_bf16_f32 v130, v242, v243
 v_exp_f32 v244, v70
 v_mfma_f32_32x32x16_bf16 v[96:111], v[224:227], a[16:19], v[96:111]
 v_exp_f32 v245, v71
 v_add_f32 v240, v244, v240
 v_add_f32 v240, v245, v240
 v_cvt_pk_bf16_f32 v131, v244, v245
 v_mfma_f32_32x32x16_bf16 v[112:127], v[224:227], a[24:27], v[112:127]
 ds_read_b128 v[224:227], v199 offset:40960
 v_exp_f32 v242, v72
 v_exp_f32 v243, v73
 v_add_f32 v240, v242, v240
 s_waitcnt lgkmcnt(3)
 v_mfma_f32_32x32x16_bf16 v[96:111], v[228:231], a[20:23], v[96:111]
 v_add_f32 v240, v243, v240
 v_cvt_pk_bf16_f32 v132, v242, v243
 v_exp_f32 v244, v74
 v_exp_f32 v245, v75
 v_mfma_f32_32x32x16_bf16 v[112:127], v[228:231], a[28:31], v[112:127]
 ds_read_b64_tr_b16 v[228:229], v200 offset:24576
 ds_read_b64_tr_b16 v[230:231], v200 offset:26624
 v_add_f32 v240, v244, v240
 v_add_f32 v240, v245, v240
 v_cvt_pk_bf16_f32 v133, v244, v245
 v_mfma_f32_32x32x16_bf16 v[96:111], v[232:235], a[32:35], v[96:111]
 v_exp_f32 v242, v76
 v_exp_f32 v243, v77
 v_add_f32 v240, v242, v240
 v_add_f32 v240, v243, v240
 v_mfma_f32_32x32x16_bf16 v[112:127], v[232:235], a[40:43], v[112:127]
 ds_read_b64_tr_b16 v[232:233], v201 offset:24576
 ds_read_b64_tr_b16 v[234:235], v201 offset:26624
 v_cvt_pk_bf16_f32 v134, v242, v243
 v_exp_f32 v244, v78
 s_waitcnt lgkmcnt(5)
 v_mfma_f32_32x32x16_bf16 v[96:111], v[236:239], a[36:39], v[96:111]
 v_exp_f32 v245, v79
 v_add_f32 v240, v244, v240
 v_add_f32 v240, v245, v240
 v_cvt_pk_bf16_f32 v135, v244, v245
 v_mfma_f32_32x32x16_bf16 v[112:127], v[236:239], a[44:47], v[112:127]
 ds_read_b64_tr_b16 v[236:237], v202 offset:24576
 ds_read_b64_tr_b16 v[238:239], v202 offset:26624
 v_exp_f32 v242, v80
 v_exp_f32 v243, v81
 v_mfma_f32_32x32x16_bf16 v[96:111], v[220:223], a[48:51], v[96:111]
 v_add_f32 v241, v242, v243
 v_cvt_pk_bf16_f32 v136, v242, v243
 v_exp_f32 v244, v82
 v_exp_f32 v245, v83
 v_mfma_f32_32x32x16_bf16 v[112:127], v[220:223], a[56:59], v[112:127]
 ds_read_b64_tr_b16 v[220:221], v203 offset:24576
 ds_read_b64_tr_b16 v[222:223], v203 offset:26624
 v_add_f32 v241, v244, v241
 v_add_f32 v241, v245, v241
 v_cvt_pk_bf16_f32 v137, v244, v245
 s_waitcnt lgkmcnt(6)
 v_mfma_f32_32x32x16_bf16 v[96:111], v[224:227], a[52:55], v[96:111]
 v_exp_f32 v242, v84
 v_exp_f32 v243, v85
 v_add_f32 v241, v242, v241
 v_add_f32 v241, v243, v241
 v_mfma_f32_32x32x16_bf16 v[112:127], v[224:227], a[60:63], v[112:127]
 ds_read_b64_tr_b16 v[224:225], v200 offset:28672
 ds_read_b64_tr_b16 v[226:227], v200 offset:30720
 v_cvt_pk_bf16_f32 v138, v242, v243
 v_exp_f32 v244, v86
 v_mfma_f32_32x32x16_bf16 a[64:79], v[228:231], v[144:147], a[64:79]
 v_exp_f32 v245, v87
 v_add_f32 v241, v244, v241
 v_add_f32 v241, v245, v241
 v_cvt_pk_bf16_f32 v139, v244, v245
 v_mfma_f32_32x32x16_bf16 a[80:95], v[228:231], v[152:155], a[80:95]
 ds_read_b64_tr_b16 v[228:229], v201 offset:28672
 ds_read_b64_tr_b16 v[230:231], v201 offset:30720
 v_exp_f32 v242, v88
 v_exp_f32 v243, v89
 s_waitcnt lgkmcnt(6)
 v_mfma_f32_32x32x16_bf16 a[96:111], v[232:235], v[144:147], a[96:111]
 v_add_f32 v241, v242, v241
 v_add_f32 v241, v243, v241
 v_cvt_pk_bf16_f32 v140, v242, v243
 v_exp_f32 v244, v90
 v_mfma_f32_32x32x16_bf16 a[112:127], v[232:235], v[152:155], a[112:127]
 ds_read_b64_tr_b16 v[232:233], v202 offset:28672
 ds_read_b64_tr_b16 v[234:235], v202 offset:30720
 v_exp_f32 v245, v91
 v_add_f32 v241, v244, v241
 v_add_f32 v241, v245, v241
 v_mfma_f32_32x32x16_bf16 v[0:15], v[236:239], v[144:147], v[0:15]
 v_cvt_pk_bf16_f32 v141, v244, v245
 v_exp_f32 v242, v92
 v_exp_f32 v243, v93
 v_add_f32 v241, v242, v241
 v_mfma_f32_32x32x16_bf16 v[16:31], v[236:239], v[152:155], v[16:31]
 ds_read_b64_tr_b16 v[236:237], v203 offset:28672
 ds_read_b64_tr_b16 v[238:239], v203 offset:30720
 v_add_f32 v241, v243, v241
 v_cvt_pk_bf16_f32 v142, v242, v243
 v_exp_f32 v244, v94
 s_waitcnt lgkmcnt(6)
 v_mfma_f32_32x32x16_bf16 v[32:47], v[220:223], v[144:147], v[32:47]
 v_exp_f32 v245, v95
 v_add_f32 v241, v244, v241
 v_add_f32 v241, v245, v241
 v_cvt_pk_bf16_f32 v143, v244, v245
 v_add_f32 v254, v240, v241
 v_mfma_f32_32x32x16_bf16 v[48:63], v[220:223], v[152:155], v[48:63]
 ds_read_b128 v[220:223], v192 offset:49152
 v_cmp_nge_f32 vcc, s30, v254
 v_mfma_f32_32x32x16_bf16 a[64:79], v[224:227], v[148:151], a[64:79]
 v_mfma_f32_32x32x16_bf16 a[80:95], v[224:227], v[156:159], a[80:95]
 ds_read_b128 v[224:227], v193 offset:49152
 s_waitcnt lgkmcnt(4)
 v_mfma_f32_32x32x16_bf16 a[96:111], v[228:231], v[148:151], a[96:111]
 v_mfma_f32_32x32x16_bf16 a[112:127], v[228:231], v[156:159], a[112:127]
 ds_read_b128 v[228:231], v194 offset:49152
 v_mfma_f32_32x32x16_bf16 v[0:15], v[232:235], v[148:151], v[0:15]
 v_mfma_f32_32x32x16_bf16 v[16:31], v[232:235], v[156:159], v[16:31]
 ds_read_b128 v[232:235], v195 offset:49152
 s_waitcnt lgkmcnt(3)
 v_mfma_f32_32x32x16_bf16 v[32:47], v[236:239], v[148:151], v[32:47]
 v_mfma_f32_32x32x16_bf16 v[48:63], v[236:239], v[156:159], v[48:63]
 s_cbranch_vccnz LR1_12
BR1_12:
 s_waitcnt vmcnt(12)
 s_barrier
 ds_read_b128 v[236:239], v196 offset:49152
 v_add_f32 v216, v240, v216
 v_add_f32 v217, v241, v217
 v_mfma_f32_32x32x16_bf16 v[64:79], v[220:223], a[0:3], v[160:175]
 v_exp_f32 v242, v96
 v_exp_f32 v243, v97
 v_exp_f32 v244, v98
 v_mfma_f32_32x32x16_bf16 v[80:95], v[220:223], a[8:11], v[176:191]
 ds_read_b128 v[220:223], v197 offset:49152
 v_add_f32 v240, v242, v243
 v_cvt_pk_bf16_f32 v144, v242, v243
 v_exp_f32 v245, v99
 v_add_f32 v240, v244, v240
 s_waitcnt lgkmcnt(3)
 v_mfma_f32_32x32x16_bf16 v[64:79], v[224:227], a[4:7], v[64:79]
 v_add_f32 v240, v245, v240
 v_cvt_pk_bf16_f32 v145, v244, v245
 v_exp_f32 v242, v100
 v_exp_f32 v243, v101
 v_mfma_f32_32x32x16_bf16 v[80:95], v[224:227], a[12:15], v[80:95]
 ds_read_b128 v[224:227], v198 offset:49152
 v_add_f32 v240, v242, v240
 v_add_f32 v240, v243, v240
 v_cvt_pk_bf16_f32 v146, v242, v243
 v_exp_f32 v244, v102
 v_mfma_f32_32x32x16_bf16 v[64:79], v[228:231], a[16:19], v[64:79]
 v_exp_f32 v245, v103
 v_add_f32 v240, v244, v240
 v_add_f32 v240, v245, v240
 v_cvt_pk_bf16_f32 v147, v244, v245
 v_mfma_f32_32x32x16_bf16 v[80:95], v[228:231], a[24:27], v[80:95]
 ds_read_b128 v[228:231], v199 offset:49152
 v_exp_f32 v242, v104
 v_exp_f32 v243, v105
 v_add_f32 v240, v242, v240
 s_waitcnt lgkmcnt(3)
 v_mfma_f32_32x32x16_bf16 v[64:79], v[232:235], a[20:23], v[64:79]
 v_add_f32 v240, v243, v240
 v_cvt_pk_bf16_f32 v148, v242, v243
 v_exp_f32 v244, v106
 v_exp_f32 v245, v107
 v_mfma_f32_32x32x16_bf16 v[80:95], v[232:235], a[28:31], v[80:95]
 ds_read_b64_tr_b16 v[232:233], v200 offset:32768
 ds_read_b64_tr_b16 v[234:235], v200 offset:34816
 v_add_f32 v240, v244, v240
 v_add_f32 v240, v245, v240
 v_cvt_pk_bf16_f32 v149, v244, v245
 v_mfma_f32_32x32x16_bf16 v[64:79], v[236:239], a[32:35], v[64:79]
 v_exp_f32 v242, v108
 v_exp_f32 v243, v109
 v_add_f32 v240, v242, v240
 v_add_f32 v240, v243, v240
 v_mfma_f32_32x32x16_bf16 v[80:95], v[236:239], a[40:43], v[80:95]
 ds_read_b64_tr_b16 v[236:237], v201 offset:32768
 ds_read_b64_tr_b16 v[238:239], v201 offset:34816
 v_cvt_pk_bf16_f32 v150, v242, v243
 v_exp_f32 v244, v110
 s_waitcnt lgkmcnt(5)
 v_mfma_f32_32x32x16_bf16 v[64:79], v[220:223], a[36:39], v[64:79]
 v_exp_f32 v245, v111
 v_add_f32 v240, v244, v240
 v_add_f32 v240, v245, v240
 v_cvt_pk_bf16_f32 v151, v244, v245
 v_mfma_f32_32x32x16_bf16 v[80:95], v[220:223], a[44:47], v[80:95]
 ds_read_b64_tr_b16 v[220:221], v202 offset:32768
 ds_read_b64_tr_b16 v[222:223], v202 offset:34816
 v_exp_f32 v242, v112
 v_exp_f32 v243, v113
 v_mfma_f32_32x32x16_bf16 v[64:79], v[224:227], a[48:51], v[64:79]
 v_add_f32 v241, v242, v243
 v_cvt_pk_bf16_f32 v152, v242, v243
 v_exp_f32 v244, v114
 v_exp_f32 v245, v115
 v_mfma_f32_32x32x16_bf16 v[80:95], v[224:227], a[56:59], v[80:95]
 ds_read_b64_tr_b16 v[224:225], v203 offset:32768
 ds_read_b64_tr_b16 v[226:227], v203 offset:34816
 v_add_f32 v241, v244, v241
 v_add_f32 v241, v245, v241
 v_cvt_pk_bf16_f32 v153, v244, v245
 s_waitcnt lgkmcnt(6)
 v_mfma_f32_32x32x16_bf16 v[64:79], v[228:231], a[52:55], v[64:79]
 v_exp_f32 v242, v116
 v_exp_f32 v243, v117
 v_add_f32 v241, v242, v241
 v_add_f32 v241, v243, v241
 v_mfma_f32_32x32x16_bf16 v[80:95], v[228:231], a[60:63], v[80:95]
 ds_read_b64_tr_b16 v[228:229], v200 offset:36864
 ds_read_b64_tr_b16 v[230:231], v200 offset:38912
 v_cvt_pk_bf16_f32 v154, v242, v243
 v_exp_f32 v244, v118
 v_mfma_f32_32x32x16_bf16 a[64:79], v[232:235], v[128:131], a[64:79]
 v_exp_f32 v245, v119
 v_add_f32 v241, v244, v241
 v_add_f32 v241, v245, v241
 v_cvt_pk_bf16_f32 v155, v244, v245
 v_mfma_f32_32x32x16_bf16 a[80:95], v[232:235], v[136:139], a[80:95]
 ds_read_b64_tr_b16 v[232:233], v201 offset:36864
 ds_read_b64_tr_b16 v[234:235], v201 offset:38912
 v_exp_f32 v242, v120
 v_exp_f32 v243, v121
 s_waitcnt lgkmcnt(6)
 v_mfma_f32_32x32x16_bf16 a[96:111], v[236:239], v[128:131], a[96:111]
 v_add_f32 v241, v242, v241
 v_add_f32 v241, v243, v241
 v_cvt_pk_bf16_f32 v156, v242, v243
 v_exp_f32 v244, v122
 v_mfma_f32_32x32x16_bf16 a[112:127], v[236:239], v[136:139], a[112:127]
 ds_read_b64_tr_b16 v[236:237], v202 offset:36864
 ds_read_b64_tr_b16 v[238:239], v202 offset:38912
 v_exp_f32 v245, v123
 v_add_f32 v241, v244, v241
 v_add_f32 v241, v245, v241
 v_mfma_f32_32x32x16_bf16 v[0:15], v[220:223], v[128:131], v[0:15]
 v_cvt_pk_bf16_f32 v157, v244, v245
 v_exp_f32 v242, v124
 v_exp_f32 v243, v125
 v_add_f32 v241, v242, v241
 v_mfma_f32_32x32x16_bf16 v[16:31], v[220:223], v[136:139], v[16:31]
 ds_read_b64_tr_b16 v[220:221], v203 offset:36864
 ds_read_b64_tr_b16 v[222:223], v203 offset:38912
 v_add_f32 v241, v243, v241
 v_cvt_pk_bf16_f32 v158, v242, v243
 v_exp_f32 v244, v126
 s_waitcnt lgkmcnt(6)
 v_mfma_f32_32x32x16_bf16 v[32:47], v[224:227], v[128:131], v[32:47]
 v_exp_f32 v245, v127
 v_add_f32 v241, v244, v241
 v_add_f32 v241, v245, v241
 v_cvt_pk_bf16_f32 v159, v244, v245
 v_add_f32 v254, v240, v241
 v_mfma_f32_32x32x16_bf16 v[48:63], v[224:227], v[136:139], v[48:63]
 ds_read_b128 v[224:227], v192 offset:57344
 v_cmp_nge_f32 vcc, s30, v254
 v_mfma_f32_32x32x16_bf16 a[64:79], v[228:231], v[132:135], a[64:79]
 v_mfma_f32_32x32x16_bf16 a[80:95], v[228:231], v[140:143], a[80:95]
 ds_read_b128 v[228:231], v193 offset:57344
 s_waitcnt lgkmcnt(4)
 v_mfma_f32_32x32x16_bf16 a[96:111], v[232:235], v[132:135], a[96:111]
 v_mfma_f32_32x32x16_bf16 a[112:127], v[232:235], v[140:143], a[112:127]
 ds_read_b128 v[232:235], v194 offset:57344
 v_mfma_f32_32x32x16_bf16 v[0:15], v[236:239], v[132:135], v[0:15]
 v_mfma_f32_32x32x16_bf16 v[16:31], v[236:239], v[140:143], v[16:31]
 ds_read_b128 v[236:239], v195 offset:57344
 s_waitcnt lgkmcnt(3)
 v_mfma_f32_32x32x16_bf16 v[32:47], v[220:223], v[132:135], v[32:47]
 v_mfma_f32_32x32x16_bf16 v[48:63], v[220:223], v[140:143], v[48:63]
 s_cbranch_vccnz LR1_13
BR1_13:
 s_waitcnt vmcnt(8)
 s_barrier
 ds_read_b128 v[220:223], v196 offset:57344
 v_add_f32 v216, v240, v216
 v_add_f32 v217, v241, v217
 v_mfma_f32_32x32x16_bf16 v[96:111], v[224:227], a[0:3], v[160:175]
 v_exp_f32 v242, v64
 v_exp_f32 v243, v65
 v_exp_f32 v244, v66
 v_mfma_f32_32x32x16_bf16 v[112:127], v[224:227], a[8:11], v[176:191]
 ds_read_b128 v[224:227], v197 offset:57344
 v_add_f32 v240, v242, v243
 v_cvt_pk_bf16_f32 v128, v242, v243
 v_exp_f32 v245, v67
 v_add_f32 v240, v244, v240
 s_waitcnt lgkmcnt(3)
 v_mfma_f32_32x32x16_bf16 v[96:111], v[228:231], a[4:7], v[96:111]
 v_add_f32 v240, v245, v240
 v_cvt_pk_bf16_f32 v129, v244, v245
 v_exp_f32 v242, v68
 v_exp_f32 v243, v69
 v_mfma_f32_32x32x16_bf16 v[112:127], v[228:231], a[12:15], v[112:127]
 ds_read_b128 v[228:231], v198 offset:57344
 v_add_f32 v240, v242, v240
 v_add_f32 v240, v243, v240
 v_cvt_pk_bf16_f32 v130, v242, v243
 v_exp_f32 v244, v70
 v_mfma_f32_32x32x16_bf16 v[96:111], v[232:235], a[16:19], v[96:111]
 v_exp_f32 v245, v71
 v_add_f32 v240, v244, v240
 v_add_f32 v240, v245, v240
 v_cvt_pk_bf16_f32 v131, v244, v245
 v_mfma_f32_32x32x16_bf16 v[112:127], v[232:235], a[24:27], v[112:127]
 ds_read_b128 v[232:235], v199 offset:57344
 v_exp_f32 v242, v72
 v_exp_f32 v243, v73
 v_add_f32 v240, v242, v240
 s_waitcnt lgkmcnt(3)
 v_mfma_f32_32x32x16_bf16 v[96:111], v[236:239], a[20:23], v[96:111]
 v_add_f32 v240, v243, v240
 v_cvt_pk_bf16_f32 v132, v242, v243
 v_exp_f32 v244, v74
 v_exp_f32 v245, v75
 v_mfma_f32_32x32x16_bf16 v[112:127], v[236:239], a[28:31], v[112:127]
 ds_read_b64_tr_b16 v[236:237], v200 offset:40960
 ds_read_b64_tr_b16 v[238:239], v200 offset:43008
 v_add_f32 v240, v244, v240
 v_add_f32 v240, v245, v240
 v_cvt_pk_bf16_f32 v133, v244, v245
 v_mfma_f32_32x32x16_bf16 v[96:111], v[220:223], a[32:35], v[96:111]
 v_exp_f32 v242, v76
 v_exp_f32 v243, v77
 v_add_f32 v240, v242, v240
 v_add_f32 v240, v243, v240
 v_mfma_f32_32x32x16_bf16 v[112:127], v[220:223], a[40:43], v[112:127]
 ds_read_b64_tr_b16 v[220:221], v201 offset:40960
 ds_read_b64_tr_b16 v[222:223], v201 offset:43008
 v_cvt_pk_bf16_f32 v134, v242, v243
 v_exp_f32 v244, v78
 s_waitcnt lgkmcnt(5)
 v_mfma_f32_32x32x16_bf16 v[96:111], v[224:227], a[36:39], v[96:111]
 v_exp_f32 v245, v79
 v_add_f32 v240, v244, v240
 v_add_f32 v240, v245, v240
 v_cvt_pk_bf16_f32 v135, v244, v245
 v_mfma_f32_32x32x16_bf16 v[112:127], v[224:227], a[44:47], v[112:127]
 ds_read_b64_tr_b16 v[224:225], v202 offset:40960
 ds_read_b64_tr_b16 v[226:227], v202 offset:43008
 v_exp_f32 v242, v80
 v_exp_f32 v243, v81
 v_mfma_f32_32x32x16_bf16 v[96:111], v[228:231], a[48:51], v[96:111]
 v_add_f32 v241, v242, v243
 v_cvt_pk_bf16_f32 v136, v242, v243
 v_exp_f32 v244, v82
 v_exp_f32 v245, v83
 v_mfma_f32_32x32x16_bf16 v[112:127], v[228:231], a[56:59], v[112:127]
 ds_read_b64_tr_b16 v[228:229], v203 offset:40960
 ds_read_b64_tr_b16 v[230:231], v203 offset:43008
 v_add_f32 v241, v244, v241
 v_add_f32 v241, v245, v241
 v_cvt_pk_bf16_f32 v137, v244, v245
 s_waitcnt lgkmcnt(6)
 v_mfma_f32_32x32x16_bf16 v[96:111], v[232:235], a[52:55], v[96:111]
 v_exp_f32 v242, v84
 v_exp_f32 v243, v85
 v_add_f32 v241, v242, v241
 v_add_f32 v241, v243, v241
 v_mfma_f32_32x32x16_bf16 v[112:127], v[232:235], a[60:63], v[112:127]
 ds_read_b64_tr_b16 v[232:233], v200 offset:45056
 ds_read_b64_tr_b16 v[234:235], v200 offset:47104
 v_cvt_pk_bf16_f32 v138, v242, v243
 v_exp_f32 v244, v86
 v_mfma_f32_32x32x16_bf16 a[64:79], v[236:239], v[144:147], a[64:79]
 v_exp_f32 v245, v87
 v_add_f32 v241, v244, v241
 v_add_f32 v241, v245, v241
 v_cvt_pk_bf16_f32 v139, v244, v245
 v_mfma_f32_32x32x16_bf16 a[80:95], v[236:239], v[152:155], a[80:95]
 ds_read_b64_tr_b16 v[236:237], v201 offset:45056
 ds_read_b64_tr_b16 v[238:239], v201 offset:47104
 v_exp_f32 v242, v88
 v_exp_f32 v243, v89
 s_waitcnt lgkmcnt(6)
 v_mfma_f32_32x32x16_bf16 a[96:111], v[220:223], v[144:147], a[96:111]
 v_add_f32 v241, v242, v241
 v_add_f32 v241, v243, v241
 v_cvt_pk_bf16_f32 v140, v242, v243
 v_exp_f32 v244, v90
 v_mfma_f32_32x32x16_bf16 a[112:127], v[220:223], v[152:155], a[112:127]
 ds_read_b64_tr_b16 v[220:221], v202 offset:45056
 ds_read_b64_tr_b16 v[222:223], v202 offset:47104
 v_exp_f32 v245, v91
 v_add_f32 v241, v244, v241
 v_add_f32 v241, v245, v241
 v_mfma_f32_32x32x16_bf16 v[0:15], v[224:227], v[144:147], v[0:15]
 v_cvt_pk_bf16_f32 v141, v244, v245
 v_exp_f32 v242, v92
 v_exp_f32 v243, v93
 v_add_f32 v241, v242, v241
 v_mfma_f32_32x32x16_bf16 v[16:31], v[224:227], v[152:155], v[16:31]
 ds_read_b64_tr_b16 v[224:225], v203 offset:45056
 ds_read_b64_tr_b16 v[226:227], v203 offset:47104
 v_add_f32 v241, v243, v241
 v_cvt_pk_bf16_f32 v142, v242, v243
 v_exp_f32 v244, v94
 s_waitcnt lgkmcnt(6)
 v_mfma_f32_32x32x16_bf16 v[32:47], v[228:231], v[144:147], v[32:47]
 v_exp_f32 v245, v95
 v_add_f32 v241, v244, v241
 v_add_f32 v241, v245, v241
 v_cvt_pk_bf16_f32 v143, v244, v245
 v_add_f32 v254, v240, v241
 v_mfma_f32_32x32x16_bf16 v[48:63], v[228:231], v[152:155], v[48:63]
 ds_read_b64_tr_b16 v[228:229], v200 offset:49152
 ds_read_b64_tr_b16 v[230:231], v200 offset:51200
 v_cmp_nge_f32 vcc, s30, v254
 v_mfma_f32_32x32x16_bf16 a[64:79], v[232:235], v[148:151], a[64:79]
 v_mfma_f32_32x32x16_bf16 a[80:95], v[232:235], v[156:159], a[80:95]
 ds_read_b64_tr_b16 v[232:233], v201 offset:49152
 ds_read_b64_tr_b16 v[234:235], v201 offset:51200
 s_waitcnt lgkmcnt(6)
 v_mfma_f32_32x32x16_bf16 a[96:111], v[236:239], v[148:151], a[96:111]
 v_mfma_f32_32x32x16_bf16 a[112:127], v[236:239], v[156:159], a[112:127]
 ds_read_b64_tr_b16 v[236:237], v202 offset:49152
 ds_read_b64_tr_b16 v[238:239], v202 offset:51200
 v_mfma_f32_32x32x16_bf16 v[0:15], v[220:223], v[148:151], v[0:15]
 v_mfma_f32_32x32x16_bf16 v[16:31], v[220:223], v[156:159], v[16:31]
 ds_read_b64_tr_b16 v[220:221], v203 offset:49152
 ds_read_b64_tr_b16 v[222:223], v203 offset:51200
 s_waitcnt lgkmcnt(6)
 v_mfma_f32_32x32x16_bf16 v[32:47], v[224:227], v[148:151], v[32:47]
 v_mfma_f32_32x32x16_bf16 v[48:63], v[224:227], v[156:159], v[48:63]
 s_cbranch_vccnz LR1_14
BR1_14:
 s_waitcnt vmcnt(4)
 s_barrier
 ds_read_b64_tr_b16 v[224:225], v200 offset:53248
 ds_read_b64_tr_b16 v[226:227], v200 offset:55296
 v_add_f32 v216, v240, v216
 v_add_f32 v217, v241, v217
 v_mfma_f32_32x32x16_bf16 a[64:79], v[228:231], v[128:131], a[64:79]
 v_exp_f32 v242, v96
 v_exp_f32 v243, v97
 v_exp_f32 v244, v98
 v_mfma_f32_32x32x16_bf16 a[80:95], v[228:231], v[136:139], a[80:95]
 ds_read_b64_tr_b16 v[228:229], v201 offset:53248
 ds_read_b64_tr_b16 v[230:231], v201 offset:55296
 v_add_f32 v240, v242, v243
 v_cvt_pk_bf16_f32 v144, v242, v243
 v_exp_f32 v245, v99
 s_waitcnt lgkmcnt(6)
 v_mfma_f32_32x32x16_bf16 a[96:111], v[232:235], v[128:131], a[96:111]
 v_add_f32 v240, v244, v240
 v_add_f32 v240, v245, v240
 v_cvt_pk_bf16_f32 v145, v244, v245
 v_exp_f32 v242, v100
 v_mfma_f32_32x32x16_bf16 a[112:127], v[232:235], v[136:139], a[112:127]
 ds_read_b64_tr_b16 v[232:233], v202 offset:53248
 ds_read_b64_tr_b16 v[234:235], v202 offset:55296
 v_exp_f32 v243, v101
 v_add_f32 v240, v242, v240
 v_add_f32 v240, v243, v240
 v_mfma_f32_32x32x16_bf16 v[0:15], v[236:239], v[128:131], v[0:15]
 v_cvt_pk_bf16_f32 v146, v242, v243
 v_exp_f32 v244, v102
 v_exp_f32 v245, v103
 v_add_f32 v240, v244, v240
 v_mfma_f32_32x32x16_bf16 v[16:31], v[236:239], v[136:139], v[16:31]
 ds_read_b64_tr_b16 v[236:237], v203 offset:53248
 ds_read_b64_tr_b16 v[238:239], v203 offset:55296
 v_add_f32 v240, v245, v240
 v_cvt_pk_bf16_f32 v147, v244, v245
 v_exp_f32 v242, v104
 s_waitcnt lgkmcnt(6)
 v_mfma_f32_32x32x16_bf16 v[32:47], v[220:223], v[128:131], v[32:47]
 v_exp_f32 v243, v105
 v_add_f32 v240, v242, v240
 v_add_f32 v240, v243, v240
 v_cvt_pk_bf16_f32 v148, v242, v243
 v_mfma_f32_32x32x16_bf16 v[48:63], v[220:223], v[136:139], v[48:63]
 ds_read_b64_tr_b16 v[220:221], v200 offset:57344
 ds_read_b64_tr_b16 v[222:223], v200 offset:59392
 v_exp_f32 v244, v106
 v_exp_f32 v245, v107
 v_mfma_f32_32x32x16_bf16 a[64:79], v[224:227], v[132:135], a[64:79]
 v_add_f32 v240, v244, v240
 v_add_f32 v240, v245, v240
 v_cvt_pk_bf16_f32 v149, v244, v245
 v_exp_f32 v242, v108
 v_mfma_f32_32x32x16_bf16 a[80:95], v[224:227], v[140:143], a[80:95]
 ds_read_b64_tr_b16 v[224:225], v200 offset:61440
 ds_read_b64_tr_b16 v[226:227], v200 offset:63488
 v_exp_f32 v243, v109
 v_add_f32 v240, v242, v240
 v_add_f32 v240, v243, v240
 s_waitcnt lgkmcnt(6)
 v_mfma_f32_32x32x16_bf16 a[96:111], v[228:231], v[132:135], a[96:111]
 v_cvt_pk_bf16_f32 v150, v242, v243
 v_exp_f32 v244, v110
 v_exp_f32 v245, v111
 v_add_f32 v240, v244, v240
 v_mfma_f32_32x32x16_bf16 a[112:127], v[228:231], v[140:143], a[112:127]
 ds_read_b64_tr_b16 v[228:229], v201 offset:57344
 ds_read_b64_tr_b16 v[230:231], v201 offset:59392
 v_add_f32 v240, v245, v240
 v_cvt_pk_bf16_f32 v151, v244, v245
 v_exp_f32 v242, v112
 v_mfma_f32_32x32x16_bf16 v[0:15], v[232:235], v[132:135], v[0:15]
 v_exp_f32 v243, v113
 v_exp_f32 v244, v114
 v_add_f32 v241, v242, v243
 v_cvt_pk_bf16_f32 v152, v242, v243
 v_mfma_f32_32x32x16_bf16 v[16:31], v[232:235], v[140:143], v[16:31]
 ds_read_b64_tr_b16 v[232:233], v201 offset:61440
 ds_read_b64_tr_b16 v[234:235], v201 offset:63488
 v_exp_f32 v245, v115
 v_add_f32 v241, v244, v241
 v_add_f32 v241, v245, v241
 s_waitcnt lgkmcnt(6)
 v_mfma_f32_32x32x16_bf16 v[32:47], v[236:239], v[132:135], v[32:47]
 v_cvt_pk_bf16_f32 v153, v244, v245
 v_exp_f32 v242, v116
 v_exp_f32 v243, v117
 v_add_f32 v241, v242, v241
 v_mfma_f32_32x32x16_bf16 v[48:63], v[236:239], v[140:143], v[48:63]
 v_add_f32 v241, v243, v241
 v_cvt_pk_bf16_f32 v154, v242, v243
 v_exp_f32 v244, v118
 v_exp_f32 v245, v119
 v_add_f32 v241, v244, v241
 v_add_f32 v241, v245, v241
 v_cvt_pk_bf16_f32 v155, v244, v245
 v_exp_f32 v242, v120
 v_exp_f32 v243, v121
 v_add_f32 v241, v242, v241
 v_add_f32 v241, v243, v241
 v_cvt_pk_bf16_f32 v156, v242, v243
 v_exp_f32 v244, v122
 v_exp_f32 v245, v123
 v_add_f32 v241, v244, v241
 v_add_f32 v241, v245, v241
 v_cvt_pk_bf16_f32 v157, v244, v245
 v_exp_f32 v242, v124
 v_exp_f32 v243, v125
 v_add_f32 v241, v242, v241
 v_add_f32 v241, v243, v241
 v_cvt_pk_bf16_f32 v158, v242, v243
 v_exp_f32 v244, v126
 v_exp_f32 v245, v127
 v_add_f32 v241, v244, v241
 v_add_f32 v241, v245, v241
 v_cvt_pk_bf16_f32 v159, v244, v245
 v_add_f32 v254, v240, v241
 v_cmp_nge_f32 vcc, s30, v254
 s_cbranch_vccnz LR1_15
BR1_15:
 v_mfma_f32_32x32x16_bf16 a[64:79], v[220:223], v[144:147], a[64:79]
 ds_read_b64_tr_b16 v[236:237], v202 offset:57344
 ds_read_b64_tr_b16 v[238:239], v202 offset:59392
 v_add_f32 v216, v240, v216
 v_add_f32 v217, v241, v217
 v_mov_b32 v254, v216
 s_nop 1
 v_permlane32_swap_b32 v216, v254
 v_mfma_f32_32x32x16_bf16 a[80:95], v[220:223], v[152:155], a[80:95]
 ds_read_b64_tr_b16 v[220:221], v202 offset:61440
 ds_read_b64_tr_b16 v[222:223], v202 offset:63488
 v_add_f32 v216, v216, v254
 v_rcp_f32 v218, v216
 v_mov_b32 v255, v217
 s_waitcnt lgkmcnt(4)
 v_mfma_f32_32x32x16_bf16 a[64:79], v[224:227], v[148:151], a[64:79]
 v_permlane32_swap_b32 v217, v255
 v_add_f32 v217, v217, v255
 v_max_f32 v217, 8388608, v217
 v_rcp_f32 v219, v217
 v_mfma_f32_32x32x16_bf16 a[80:95], v[224:227], v[156:159], a[80:95]
 ds_read_b64_tr_b16 v[224:225], v203 offset:57344
 ds_read_b64_tr_b16 v[226:227], v203 offset:59392
 v_mfma_f32_32x32x16_bf16 a[96:111], v[228:231], v[144:147], a[96:111]
 s_nop 3
 v_accvgpr_read_b32 v240, a64
 v_accvgpr_read_b32 v241, a65
 v_accvgpr_read_b32 v242, a66
 v_accvgpr_read_b32 v243, a67
 v_accvgpr_read_b32 v244, a68
 v_accvgpr_read_b32 v245, a69
 v_mfma_f32_32x32x16_bf16 a[112:127], v[228:231], v[152:155], a[112:127]
 ds_read_b64_tr_b16 v[228:229], v203 offset:61440
 ds_read_b64_tr_b16 v[230:231], v203 offset:63488
 v_accvgpr_read_b32 v246, a70
 v_accvgpr_read_b32 v247, a71
 v_mul_f32 v240, v218, v240
 v_mul_f32 v241, v218, v241
 v_mfma_f32_32x32x16_bf16 a[96:111], v[232:235], v[148:151], a[96:111]
 v_mul_f32 v242, v218, v242
 v_mul_f32 v243, v218, v243
 v_mul_f32 v244, v218, v244
 v_mul_f32 v245, v218, v245
 v_mul_f32 v246, v218, v246
 v_mul_f32 v247, v218, v247
 v_mfma_f32_32x32x16_bf16 a[112:127], v[232:235], v[156:159], a[112:127]
 v_cvt_pk_bf16_f32 v240, v240, v241
 v_cvt_pk_bf16_f32 v241, v242, v243
 v_cvt_pk_bf16_f32 v242, v244, v245
 v_cvt_pk_bf16_f32 v243, v246, v247
 buffer_store_dwordx4 v[240:243], v214, s[24:27], s76 offen offset:0 sc1
 s_waitcnt lgkmcnt(4)
 v_mfma_f32_32x32x16_bf16 v[0:15], v[236:239], v[144:147], v[0:15]
 v_accvgpr_read_b32 v248, a72
 v_accvgpr_read_b32 v249, a73
 v_accvgpr_read_b32 v250, a74
 v_accvgpr_read_b32 v251, a75
 v_accvgpr_read_b32 v252, a76
 v_accvgpr_read_b32 v253, a77
 v_mfma_f32_32x32x16_bf16 v[16:31], v[236:239], v[152:155], v[16:31]
 v_accvgpr_read_b32 v254, a78
 v_accvgpr_read_b32 v255, a79
 v_mul_f32 v248, v218, v248
 v_mul_f32 v249, v218, v249
 v_mul_f32 v250, v218, v250
 v_mul_f32 v251, v218, v251
 v_mfma_f32_32x32x16_bf16 v[0:15], v[220:223], v[148:151], v[0:15]
 v_mul_f32 v252, v218, v252
 v_mul_f32 v253, v218, v253
 v_mul_f32 v254, v218, v254
 v_mul_f32 v255, v218, v255
 v_cvt_pk_bf16_f32 v248, v248, v249
 v_cvt_pk_bf16_f32 v249, v250, v251
 v_mfma_f32_32x32x16_bf16 v[16:31], v[220:223], v[156:159], v[16:31]
 v_cvt_pk_bf16_f32 v250, v252, v253
 v_cvt_pk_bf16_f32 v251, v254, v255
 buffer_store_dwordx4 v[248:251], v214, s[24:27], s77 offen offset:0 sc1
 v_accvgpr_read_b32 v240, a80
 v_accvgpr_read_b32 v241, a81
 s_waitcnt lgkmcnt(0)
 v_mfma_f32_32x32x16_bf16 v[32:47], v[224:227], v[144:147], v[32:47]
 v_accvgpr_read_b32 v242, a82
 v_accvgpr_read_b32 v243, a83
 v_accvgpr_read_b32 v244, a84
 v_accvgpr_read_b32 v245, a85
 v_accvgpr_read_b32 v246, a86
 v_accvgpr_read_b32 v247, a87
 v_mfma_f32_32x32x16_bf16 v[48:63], v[224:227], v[152:155], v[48:63]
 v_mul_f32 v240, v219, v240
 v_mul_f32 v241, v219, v241
 v_mul_f32 v242, v219, v242
 v_mul_f32 v243, v219, v243
 v_mul_f32 v244, v219, v244
 v_mul_f32 v245, v219, v245
 v_mfma_f32_32x32x16_bf16 v[32:47], v[228:231], v[148:151], v[32:47]
 v_mul_f32 v246, v219, v246
 v_mul_f32 v247, v219, v247
 v_cvt_pk_bf16_f32 v240, v240, v241
 v_cvt_pk_bf16_f32 v241, v242, v243
 v_cvt_pk_bf16_f32 v242, v244, v245
 v_cvt_pk_bf16_f32 v243, v246, v247
 v_mfma_f32_32x32x16_bf16 v[48:63], v[228:231], v[156:159], v[48:63]
 buffer_store_dwordx4 v[240:243], v214, s[24:27], s76 offen offset:1024 sc1
 v_accvgpr_read_b32 v248, a88
 v_accvgpr_read_b32 v249, a89
 v_accvgpr_read_b32 v250, a90
 v_accvgpr_read_b32 v251, a91
 v_accvgpr_read_b32 v252, a92
 v_accvgpr_read_b32 v253, a93
 v_accvgpr_read_b32 v254, a94
 v_accvgpr_read_b32 v255, a95
 v_mul_f32 v248, v219, v248
 v_mul_f32 v249, v219, v249
 v_mul_f32 v250, v219, v250
 v_mul_f32 v251, v219, v251
 v_mul_f32 v252, v219, v252
 v_mul_f32 v253, v219, v253
 v_mul_f32 v254, v219, v254
 v_mul_f32 v255, v219, v255
 v_cvt_pk_bf16_f32 v248, v248, v249
 v_cvt_pk_bf16_f32 v249, v250, v251
 v_cvt_pk_bf16_f32 v250, v252, v253
 v_cvt_pk_bf16_f32 v251, v254, v255
 buffer_store_dwordx4 v[248:251], v214, s[24:27], s77 offen offset:1024 sc1
 v_accvgpr_read_b32 v240, a96
 v_accvgpr_read_b32 v241, a97
 v_accvgpr_read_b32 v242, a98
 v_accvgpr_read_b32 v243, a99
 v_accvgpr_read_b32 v244, a100
 v_accvgpr_read_b32 v245, a101
 v_accvgpr_read_b32 v246, a102
 v_accvgpr_read_b32 v247, a103
 v_mul_f32 v240, v218, v240
 v_mul_f32 v241, v218, v241
 v_mul_f32 v242, v218, v242
 v_mul_f32 v243, v218, v243
 v_mul_f32 v244, v218, v244
 v_mul_f32 v245, v218, v245
 v_mul_f32 v246, v218, v246
 v_mul_f32 v247, v218, v247
 v_cvt_pk_bf16_f32 v240, v240, v241
 v_cvt_pk_bf16_f32 v241, v242, v243
 v_cvt_pk_bf16_f32 v242, v244, v245
 v_cvt_pk_bf16_f32 v243, v246, v247
 buffer_store_dwordx4 v[240:243], v214, s[24:27], s78 offen offset:0 sc1
 v_accvgpr_read_b32 v248, a104
 v_accvgpr_read_b32 v249, a105
 v_accvgpr_read_b32 v250, a106
 v_accvgpr_read_b32 v251, a107
 v_accvgpr_read_b32 v252, a108
 v_accvgpr_read_b32 v253, a109
 v_accvgpr_read_b32 v254, a110
 v_accvgpr_read_b32 v255, a111
 v_mul_f32 v248, v218, v248
 v_mul_f32 v249, v218, v249
 v_mul_f32 v250, v218, v250
 v_mul_f32 v251, v218, v251
 v_mul_f32 v252, v218, v252
 v_mul_f32 v253, v218, v253
 v_mul_f32 v254, v218, v254
 v_mul_f32 v255, v218, v255
 v_cvt_pk_bf16_f32 v248, v248, v249
 v_cvt_pk_bf16_f32 v249, v250, v251
 v_cvt_pk_bf16_f32 v250, v252, v253
 v_cvt_pk_bf16_f32 v251, v254, v255
 buffer_store_dwordx4 v[248:251], v214, s[24:27], s79 offen offset:0 sc1
 v_accvgpr_read_b32 v240, a112
 v_accvgpr_read_b32 v241, a113
 v_accvgpr_read_b32 v242, a114
 v_accvgpr_read_b32 v243, a115
 v_accvgpr_read_b32 v244, a116
 v_accvgpr_read_b32 v245, a117
 v_accvgpr_read_b32 v246, a118
 v_accvgpr_read_b32 v247, a119
 v_mul_f32 v240, v219, v240
 v_mul_f32 v241, v219, v241
 v_mul_f32 v242, v219, v242
 v_mul_f32 v243, v219, v243
 v_mul_f32 v244, v219, v244
 v_mul_f32 v245, v219, v245
 v_mul_f32 v246, v219, v246
 v_mul_f32 v247, v219, v247
 v_cvt_pk_bf16_f32 v240, v240, v241
 v_cvt_pk_bf16_f32 v241, v242, v243
 v_cvt_pk_bf16_f32 v242, v244, v245
 v_cvt_pk_bf16_f32 v243, v246, v247
 buffer_store_dwordx4 v[240:243], v214, s[24:27], s78 offen offset:1024 sc1
 v_accvgpr_read_b32 v248, a120
 v_accvgpr_read_b32 v249, a121
 v_accvgpr_read_b32 v250, a122
 v_accvgpr_read_b32 v251, a123
 v_accvgpr_read_b32 v252, a124
 v_accvgpr_read_b32 v253, a125
 v_accvgpr_read_b32 v254, a126
 v_accvgpr_read_b32 v255, a127
 v_mul_f32 v248, v219, v248
 v_mul_f32 v249, v219, v249
 v_mul_f32 v250, v219, v250
 v_mul_f32 v251, v219, v251
 v_mul_f32 v252, v219, v252
 v_mul_f32 v253, v219, v253
 v_mul_f32 v254, v219, v254
 v_mul_f32 v255, v219, v255
 v_cvt_pk_bf16_f32 v248, v248, v249
 v_cvt_pk_bf16_f32 v249, v250, v251
 v_cvt_pk_bf16_f32 v250, v252, v253
 v_cvt_pk_bf16_f32 v251, v254, v255
 buffer_store_dwordx4 v[248:251], v214, s[24:27], s79 offen offset:1024 sc1
 v_mul_f32 v0, v218, v0
 v_mul_f32 v1, v218, v1
 v_mul_f32 v2, v218, v2
 v_mul_f32 v3, v218, v3
 v_mul_f32 v4, v218, v4
 v_mul_f32 v5, v218, v5
 v_mul_f32 v6, v218, v6
 v_mul_f32 v7, v218, v7
 v_cvt_pk_bf16_f32 v0, v0, v1
 v_cvt_pk_bf16_f32 v1, v2, v3
 v_cvt_pk_bf16_f32 v2, v4, v5
 v_cvt_pk_bf16_f32 v3, v6, v7
 buffer_store_dwordx4 v[0:3], v214, s[24:27], s80 offen offset:0 sc1
 v_mul_f32 v8, v218, v8
 v_mul_f32 v9, v218, v9
 v_mul_f32 v10, v218, v10
 v_mul_f32 v11, v218, v11
 v_mul_f32 v12, v218, v12
 v_mul_f32 v13, v218, v13
 v_mul_f32 v14, v218, v14
 v_mul_f32 v15, v218, v15
 v_cvt_pk_bf16_f32 v8, v8, v9
 v_cvt_pk_bf16_f32 v9, v10, v11
 v_cvt_pk_bf16_f32 v10, v12, v13
 v_cvt_pk_bf16_f32 v11, v14, v15
 buffer_store_dwordx4 v[8:11], v214, s[24:27], s81 offen offset:0 sc1
 v_mul_f32 v16, v219, v16
 v_mul_f32 v17, v219, v17
 v_mul_f32 v18, v219, v18
 v_mul_f32 v19, v219, v19
 v_mul_f32 v20, v219, v20
 v_mul_f32 v21, v219, v21
 v_mul_f32 v22, v219, v22
 v_mul_f32 v23, v219, v23
 v_cvt_pk_bf16_f32 v16, v16, v17
 v_cvt_pk_bf16_f32 v17, v18, v19
 v_cvt_pk_bf16_f32 v18, v20, v21
 v_cvt_pk_bf16_f32 v19, v22, v23
 buffer_store_dwordx4 v[16:19], v214, s[24:27], s80 offen offset:1024 sc1
 v_mul_f32 v24, v219, v24
 v_mul_f32 v25, v219, v25
 v_mul_f32 v26, v219, v26
 v_mul_f32 v27, v219, v27
 v_mul_f32 v28, v219, v28
 v_mul_f32 v29, v219, v29
 v_mul_f32 v30, v219, v30
 v_mul_f32 v31, v219, v31
 v_cvt_pk_bf16_f32 v24, v24, v25
 v_cvt_pk_bf16_f32 v25, v26, v27
 v_cvt_pk_bf16_f32 v26, v28, v29
 v_cvt_pk_bf16_f32 v27, v30, v31
 buffer_store_dwordx4 v[24:27], v214, s[24:27], s81 offen offset:1024 sc1
 v_mul_f32 v32, v218, v32
 v_mul_f32 v33, v218, v33
 v_mul_f32 v34, v218, v34
 v_mul_f32 v35, v218, v35
 v_mul_f32 v36, v218, v36
 v_mul_f32 v37, v218, v37
 v_mul_f32 v38, v218, v38
 v_mul_f32 v39, v218, v39
 v_cvt_pk_bf16_f32 v32, v32, v33
 v_cvt_pk_bf16_f32 v33, v34, v35
 v_cvt_pk_bf16_f32 v34, v36, v37
 v_cvt_pk_bf16_f32 v35, v38, v39
 buffer_store_dwordx4 v[32:35], v214, s[24:27], s82 offen offset:0 sc1
 v_mul_f32 v40, v218, v40
 v_mul_f32 v41, v218, v41
 v_mul_f32 v42, v218, v42
 v_mul_f32 v43, v218, v43
 v_mul_f32 v44, v218, v44
 v_mul_f32 v45, v218, v45
 v_mul_f32 v46, v218, v46
 v_mul_f32 v47, v218, v47
 v_cvt_pk_bf16_f32 v40, v40, v41
 v_cvt_pk_bf16_f32 v41, v42, v43
 v_cvt_pk_bf16_f32 v42, v44, v45
 v_cvt_pk_bf16_f32 v43, v46, v47
 buffer_store_dwordx4 v[40:43], v214, s[24:27], s83 offen offset:0 sc1
 v_mul_f32 v48, v219, v48
 v_mul_f32 v49, v219, v49
 v_mul_f32 v50, v219, v50
 v_mul_f32 v51, v219, v51
 v_mul_f32 v52, v219, v52
 v_mul_f32 v53, v219, v53
 v_mul_f32 v54, v219, v54
 v_mul_f32 v55, v219, v55
 v_cvt_pk_bf16_f32 v48, v48, v49
 v_cvt_pk_bf16_f32 v49, v50, v51
 v_cvt_pk_bf16_f32 v50, v52, v53
 v_cvt_pk_bf16_f32 v51, v54, v55
 buffer_store_dwordx4 v[48:51], v214, s[24:27], s82 offen offset:1024 sc1
 v_mul_f32 v56, v219, v56
 v_mul_f32 v57, v219, v57
 v_mul_f32 v58, v219, v58
 v_mul_f32 v59, v219, v59
 v_mul_f32 v60, v219, v60
 v_mul_f32 v61, v219, v61
 v_mul_f32 v62, v219, v62
 v_mul_f32 v63, v219, v63
 v_cvt_pk_bf16_f32 v56, v56, v57
 v_cvt_pk_bf16_f32 v57, v58, v59
 v_cvt_pk_bf16_f32 v58, v60, v61
 v_cvt_pk_bf16_f32 v59, v62, v63
 buffer_store_dwordx4 v[56:59], v214, s[24:27], s83 offen offset:1024 sc1
A_END:
 s_endpgm
LR0_1:
 s_call_b64 s[40:41], RARE1
 s_branch BR0_1
LR0_2:
 s_call_b64 s[40:41], RARE0
 s_branch BR0_2
LR0_3:
 s_call_b64 s[40:41], RARE1
 s_branch BR0_3
LR0_4:
 s_call_b64 s[40:41], RARE0
 s_branch BR0_4
LR0_5:
 s_call_b64 s[40:41], RARE1
 s_branch BR0_5
LR0_6:
 s_call_b64 s[40:41], RARE0
 s_branch BR0_6
LR0_7:
 s_call_b64 s[40:41], RARE1
 s_branch BR0_7
LR0_8:
 s_call_b64 s[40:41], RARE0
 s_branch BR0_8
LR0_9:
 s_call_b64 s[40:41], RARE1
 s_branch BR0_9
LR0_10:
 s_call_b64 s[40:41], RARE0
 s_branch BR0_10
LR0_11:
 s_call_b64 s[40:41], RARE1
 s_branch BR0_11
LR0_12:
 s_call_b64 s[40:41], RARE0
 s_branch BR0_12
LR0_13:
 s_call_b64 s[40:41], RARE1
 s_branch BR0_13
LR0_14:
 s_call_b64 s[40:41], RARE0
 s_branch BR0_14
LR0_15:
 s_call_b64 s[40:41], RARE1
 s_branch BR0_15
LR1_1:
 s_call_b64 s[40:41], RARE3
 s_branch BR1_1
LR1_2:
 s_call_b64 s[40:41], RARE2
 s_branch BR1_2
LR1_3:
 s_call_b64 s[40:41], RARE3
 s_branch BR1_3
LR1_4:
 s_call_b64 s[40:41], RARE2
 s_branch BR1_4
LR1_5:
 s_call_b64 s[40:41], RARE3
 s_branch BR1_5
LR1_6:
 s_call_b64 s[40:41], RARE2
 s_branch BR1_6
LR1_7:
 s_call_b64 s[40:41], RARE3
 s_branch BR1_7
LR1_8:
 s_call_b64 s[40:41], RARE2
 s_branch BR1_8
LR1_9:
 s_call_b64 s[40:41], RARE3
 s_branch BR1_9
LR1_10:
 s_call_b64 s[40:41], RARE2
 s_branch BR1_10
LR1_11:
 s_call_b64 s[40:41], RARE3
 s_branch BR1_11
LR1_12:
 s_call_b64 s[40:41], RARE2
 s_branch BR1_12
LR1_13:
 s_call_b64 s[40:41], RARE3
 s_branch BR1_13
LR1_14:
 s_call_b64 s[40:41], RARE2
 s_branch BR1_14
LR1_15:
 s_call_b64 s[40:41], RARE3
 s_branch BR1_15
RARE0:
 s_nop 15
 s_nop 7
 v_max3_f32 v250, v64, v65, v66
 v_max3_f32 v250, v250, v67, v68
 v_max3_f32 v250, v250, v69, v70
 v_max3_f32 v250, v250, v71, v72
 v_max3_f32 v250, v250, v73, v74
 v_max3_f32 v250, v250, v75, v76
 v_max3_f32 v250, v250, v77, v78
 v_max_f32 v250, v79, v250
 v_mov_b32 v251, v250
 s_nop 1
 v_permlane32_swap_b32 v250, v251
 v_max3_f32 v250, v250, v251, 0
 v_sub_f32 v252, 0, v250
 v_exp_f32 v252, v252
 v_sub_f32 v64, v64, v250
 v_sub_f32 v96, v96, v250
 v_sub_f32 v160, v160, v250
 v_sub_f32 v65, v65, v250
 v_sub_f32 v97, v97, v250
 v_sub_f32 v161, v161, v250
 v_sub_f32 v66, v66, v250
 v_sub_f32 v98, v98, v250
 v_sub_f32 v162, v162, v250
 v_sub_f32 v67, v67, v250
 v_sub_f32 v99, v99, v250
 v_sub_f32 v163, v163, v250
 v_sub_f32 v68, v68, v250
 v_sub_f32 v100, v100, v250
 v_sub_f32 v164, v164, v250
 v_sub_f32 v69, v69, v250
 v_sub_f32 v101, v101, v250
 v_sub_f32 v165, v165, v250
 v_sub_f32 v70, v70, v250
 v_sub_f32 v102, v102, v250
 v_sub_f32 v166, v166, v250
 v_sub_f32 v71, v71, v250
 v_sub_f32 v103, v103, v250
 v_sub_f32 v167, v167, v250
 v_sub_f32 v72, v72, v250
 v_sub_f32 v104, v104, v250
 v_sub_f32 v168, v168, v250
 v_sub_f32 v73, v73, v250
 v_sub_f32 v105, v105, v250
 v_sub_f32 v169, v169, v250
 v_sub_f32 v74, v74, v250
 v_sub_f32 v106, v106, v250
 v_sub_f32 v170, v170, v250
 v_sub_f32 v75, v75, v250
 v_sub_f32 v107, v107, v250
 v_sub_f32 v171, v171, v250
 v_sub_f32 v76, v76, v250
 v_sub_f32 v108, v108, v250
 v_sub_f32 v172, v172, v250
 v_sub_f32 v77, v77, v250
 v_sub_f32 v109, v109, v250
 v_sub_f32 v173, v173, v250
 v_sub_f32 v78, v78, v250
 v_sub_f32 v110, v110, v250
 v_sub_f32 v174, v174, v250
 v_sub_f32 v79, v79, v250
 v_sub_f32 v111, v111, v250
 v_sub_f32 v175, v175, v250
 v_mul_f32 v216, v252, v216
 v_accvgpr_read_b32 v242, a128
 v_accvgpr_read_b32 v243, a129
 v_accvgpr_read_b32 v244, a130
 v_accvgpr_read_b32 v245, a131
 v_mul_f32 v242, v252, v242
 v_mul_f32 v243, v252, v243
 v_mul_f32 v244, v252, v244
 v_mul_f32 v245, v252, v245
 v_accvgpr_write_b32 a128, v242
 v_accvgpr_write_b32 a129, v243
 v_accvgpr_write_b32 a130, v244
 v_accvgpr_write_b32 a131, v245
 v_accvgpr_read_b32 v242, a132
 v_accvgpr_read_b32 v243, a133
 v_accvgpr_read_b32 v244, a134
 v_accvgpr_read_b32 v245, a135
 v_mul_f32 v242, v252, v242
 v_mul_f32 v243, v252, v243
 v_mul_f32 v244, v252, v244
 v_mul_f32 v245, v252, v245
 v_accvgpr_write_b32 a132, v242
 v_accvgpr_write_b32 a133, v243
 v_accvgpr_write_b32 a134, v244
 v_accvgpr_write_b32 a135, v245
 v_accvgpr_read_b32 v242, a136
 v_accvgpr_read_b32 v243, a137
 v_accvgpr_read_b32 v244, a138
 v_accvgpr_read_b32 v245, a139
 v_mul_f32 v242, v252, v242
 v_mul_f32 v243, v252, v243
 v_mul_f32 v244, v252, v244
 v_mul_f32 v245, v252, v245
 v_accvgpr_write_b32 a136, v242
 v_accvgpr_write_b32 a137, v243
 v_accvgpr_write_b32 a138, v244
 v_accvgpr_write_b32 a139, v245
 v_accvgpr_read_b32 v242, a140
 v_accvgpr_read_b32 v243, a141
 v_accvgpr_read_b32 v244, a142
 v_accvgpr_read_b32 v245, a143
 v_mul_f32 v242, v252, v242
 v_mul_f32 v243, v252, v243
 v_mul_f32 v244, v252, v244
 v_mul_f32 v245, v252, v245
 v_accvgpr_write_b32 a140, v242
 v_accvgpr_write_b32 a141, v243
 v_accvgpr_write_b32 a142, v244
 v_accvgpr_write_b32 a143, v245
 v_accvgpr_read_b32 v242, a160
 v_accvgpr_read_b32 v243, a161
 v_accvgpr_read_b32 v244, a162
 v_accvgpr_read_b32 v245, a163
 v_mul_f32 v242, v252, v242
 v_mul_f32 v243, v252, v243
 v_mul_f32 v244, v252, v244
 v_mul_f32 v245, v252, v245
 v_accvgpr_write_b32 a160, v242
 v_accvgpr_write_b32 a161, v243
 v_accvgpr_write_b32 a162, v244
 v_accvgpr_write_b32 a163, v245
 v_accvgpr_read_b32 v242, a164
 v_accvgpr_read_b32 v243, a165
 v_accvgpr_read_b32 v244, a166
 v_accvgpr_read_b32 v245, a167
 v_mul_f32 v242, v252, v242
 v_mul_f32 v243, v252, v243
 v_mul_f32 v244, v252, v244
 v_mul_f32 v245, v252, v245
 v_accvgpr_write_b32 a164, v242
 v_accvgpr_write_b32 a165, v243
 v_accvgpr_write_b32 a166, v244
 v_accvgpr_write_b32 a167, v245
 v_accvgpr_read_b32 v242, a168
 v_accvgpr_read_b32 v243, a169
 v_accvgpr_read_b32 v244, a170
 v_accvgpr_read_b32 v245, a171
 v_mul_f32 v242, v252, v242
 v_mul_f32 v243, v252, v243
 v_mul_f32 v244, v252, v244
 v_mul_f32 v245, v252, v245
 v_accvgpr_write_b32 a168, v242
 v_accvgpr_write_b32 a169, v243
 v_accvgpr_write_b32 a170, v244
 v_accvgpr_write_b32 a171, v245
 v_accvgpr_read_b32 v242, a172
 v_accvgpr_read_b32 v243, a173
 v_accvgpr_read_b32 v244, a174
 v_accvgpr_read_b32 v245, a175
 v_mul_f32 v242, v252, v242
 v_mul_f32 v243, v252, v243
 v_mul_f32 v244, v252, v244
 v_mul_f32 v245, v252, v245
 v_accvgpr_write_b32 a172, v242
 v_accvgpr_write_b32 a173, v243
 v_accvgpr_write_b32 a174, v244
 v_accvgpr_write_b32 a175, v245
 v_accvgpr_read_b32 v242, a192
 v_accvgpr_read_b32 v243, a193
 v_accvgpr_read_b32 v244, a194
 v_accvgpr_read_b32 v245, a195
 v_mul_f32 v242, v252, v242
 v_mul_f32 v243, v252, v243
 v_mul_f32 v244, v252, v244
 v_mul_f32 v245, v252, v245
 v_accvgpr_write_b32 a192, v242
 v_accvgpr_write_b32 a193, v243
 v_accvgpr_write_b32 a194, v244
 v_accvgpr_write_b32 a195, v245
 v_accvgpr_read_b32 v242, a196
 v_accvgpr_read_b32 v243, a197
 v_accvgpr_read_b32 v244, a198
 v_accvgpr_read_b32 v245, a199
 v_mul_f32 v242, v252, v242
 v_mul_f32 v243, v252, v243
 v_mul_f32 v244, v252, v244
 v_mul_f32 v245, v252, v245
 v_accvgpr_write_b32 a196, v242
 v_accvgpr_write_b32 a197, v243
 v_accvgpr_write_b32 a198, v244
 v_accvgpr_write_b32 a199, v245
 v_accvgpr_read_b32 v242, a200
 v_accvgpr_read_b32 v243, a201
 v_accvgpr_read_b32 v244, a202
 v_accvgpr_read_b32 v245, a203
 v_mul_f32 v242, v252, v242
 v_mul_f32 v243, v252, v243
 v_mul_f32 v244, v252, v244
 v_mul_f32 v245, v252, v245
 v_accvgpr_write_b32 a200, v242
 v_accvgpr_write_b32 a201, v243
 v_accvgpr_write_b32 a202, v244
 v_accvgpr_write_b32 a203, v245
 v_accvgpr_read_b32 v242, a204
 v_accvgpr_read_b32 v243, a205
 v_accvgpr_read_b32 v244, a206
 v_accvgpr_read_b32 v245, a207
 v_mul_f32 v242, v252, v242
 v_mul_f32 v243, v252, v243
 v_mul_f32 v244, v252, v244
 v_mul_f32 v245, v252, v245
 v_accvgpr_write_b32 a204, v242
 v_accvgpr_write_b32 a205, v243
 v_accvgpr_write_b32 a206, v244
 v_accvgpr_write_b32 a207, v245
 v_accvgpr_read_b32 v242, a224
 v_accvgpr_read_b32 v243, a225
 v_accvgpr_read_b32 v244, a226
 v_accvgpr_read_b32 v245, a227
 v_mul_f32 v242, v252, v242
 v_mul_f32 v243, v252, v243
 v_mul_f32 v244, v252, v244
 v_mul_f32 v245, v252, v245
 v_accvgpr_write_b32 a224, v242
 v_accvgpr_write_b32 a225, v243
 v_accvgpr_write_b32 a226, v244
 v_accvgpr_write_b32 a227, v245
 v_accvgpr_read_b32 v242, a228
 v_accvgpr_read_b32 v243, a229
 v_accvgpr_read_b32 v244, a230
 v_accvgpr_read_b32 v245, a231
 v_mul_f32 v242, v252, v242
 v_mul_f32 v243, v252, v243
 v_mul_f32 v244, v252, v244
 v_mul_f32 v245, v252, v245
 v_accvgpr_write_b32 a228, v242
 v_accvgpr_write_b32 a229, v243
 v_accvgpr_write_b32 a230, v244
 v_accvgpr_write_b32 a231, v245
 v_accvgpr_read_b32 v242, a232
 v_accvgpr_read_b32 v243, a233
 v_accvgpr_read_b32 v244, a234
 v_accvgpr_read_b32 v245, a235
 v_mul_f32 v242, v252, v242
 v_mul_f32 v243, v252, v243
 v_mul_f32 v244, v252, v244
 v_mul_f32 v245, v252, v245
 v_accvgpr_write_b32 a232, v242
 v_accvgpr_write_b32 a233, v243
 v_accvgpr_write_b32 a234, v244
 v_accvgpr_write_b32 a235, v245
 v_accvgpr_read_b32 v242, a236
 v_accvgpr_read_b32 v243, a237
 v_accvgpr_read_b32 v244, a238
 v_accvgpr_read_b32 v245, a239
 v_mul_f32 v242, v252, v242
 v_mul_f32 v243, v252, v243
 v_mul_f32 v244, v252, v244
 v_mul_f32 v245, v252, v245
 v_accvgpr_write_b32 a236, v242
 v_accvgpr_write_b32 a237, v243
 v_accvgpr_write_b32 a238, v244
 v_accvgpr_write_b32 a239, v245
 v_exp_f32 v242, v64
 v_exp_f32 v243, v65
 s_nop 0
 v_add_f32 v240, v242, v243
 v_cvt_pk_bf16_f32 v128, v242, v243
 v_exp_f32 v242, v66
 v_exp_f32 v243, v67
 s_nop 0
 v_add_f32 v240, v242, v240
 v_add_f32 v240, v243, v240
 v_cvt_pk_bf16_f32 v129, v242, v243
 v_exp_f32 v242, v68
 v_exp_f32 v243, v69
 s_nop 0
 v_add_f32 v240, v242, v240
 v_add_f32 v240, v243, v240
 v_cvt_pk_bf16_f32 v130, v242, v243
 v_exp_f32 v242, v70
 v_exp_f32 v243, v71
 s_nop 0
 v_add_f32 v240, v242, v240
 v_add_f32 v240, v243, v240
 v_cvt_pk_bf16_f32 v131, v242, v243
 v_exp_f32 v242, v72
 v_exp_f32 v243, v73
 s_nop 0
 v_add_f32 v240, v242, v240
 v_add_f32 v240, v243, v240
 v_cvt_pk_bf16_f32 v132, v242, v243
 v_exp_f32 v242, v74
 v_exp_f32 v243, v75
 s_nop 0
 v_add_f32 v240, v242, v240
 v_add_f32 v240, v243, v240
 v_cvt_pk_bf16_f32 v133, v242, v243
 v_exp_f32 v242, v76
 v_exp_f32 v243, v77
 s_nop 0
 v_add_f32 v240, v242, v240
 v_add_f32 v240, v243, v240
 v_cvt_pk_bf16_f32 v134, v242, v243
 v_exp_f32 v242, v78
 v_exp_f32 v243, v79
 s_nop 0
 v_add_f32 v240, v242, v240
 v_add_f32 v240, v243, v240
 v_cvt_pk_bf16_f32 v135, v242, v243
 v_max3_f32 v250, v80, v81, v82
 v_max3_f32 v250, v250, v83, v84
 v_max3_f32 v250, v250, v85, v86
 v_max3_f32 v250, v250, v87, v88
 v_max3_f32 v250, v250, v89, v90
 v_max3_f32 v250, v250, v91, v92
 v_max3_f32 v250, v250, v93, v94
 v_max_f32 v250, v95, v250
 v_mov_b32 v251, v250
 s_nop 1
 v_permlane32_swap_b32 v250, v251
 v_max3_f32 v250, v250, v251, 0
 v_sub_f32 v252, 0, v250
 v_exp_f32 v252, v252
 v_sub_f32 v80, v80, v250
 v_sub_f32 v112, v112, v250
 v_sub_f32 v176, v176, v250
 v_sub_f32 v81, v81, v250
 v_sub_f32 v113, v113, v250
 v_sub_f32 v177, v177, v250
 v_sub_f32 v82, v82, v250
 v_sub_f32 v114, v114, v250
 v_sub_f32 v178, v178, v250
 v_sub_f32 v83, v83, v250
 v_sub_f32 v115, v115, v250
 v_sub_f32 v179, v179, v250
 v_sub_f32 v84, v84, v250
 v_sub_f32 v116, v116, v250
 v_sub_f32 v180, v180, v250
 v_sub_f32 v85, v85, v250
 v_sub_f32 v117, v117, v250
 v_sub_f32 v181, v181, v250
 v_sub_f32 v86, v86, v250
 v_sub_f32 v118, v118, v250
 v_sub_f32 v182, v182, v250
 v_sub_f32 v87, v87, v250
 v_sub_f32 v119, v119, v250
 v_sub_f32 v183, v183, v250
 v_sub_f32 v88, v88, v250
 v_sub_f32 v120, v120, v250
 v_sub_f32 v184, v184, v250
 v_sub_f32 v89, v89, v250
 v_sub_f32 v121, v121, v250
 v_sub_f32 v185, v185, v250
 v_sub_f32 v90, v90, v250
 v_sub_f32 v122, v122, v250
 v_sub_f32 v186, v186, v250
 v_sub_f32 v91, v91, v250
 v_sub_f32 v123, v123, v250
 v_sub_f32 v187, v187, v250
 v_sub_f32 v92, v92, v250
 v_sub_f32 v124, v124, v250
 v_sub_f32 v188, v188, v250
 v_sub_f32 v93, v93, v250
 v_sub_f32 v125, v125, v250
 v_sub_f32 v189, v189, v250
 v_sub_f32 v94, v94, v250
 v_sub_f32 v126, v126, v250
 v_sub_f32 v190, v190, v250
 v_sub_f32 v95, v95, v250
 v_sub_f32 v127, v127, v250
 v_sub_f32 v191, v191, v250
 v_mul_f32 v217, v252, v217
 v_accvgpr_read_b32 v242, a144
 v_accvgpr_read_b32 v243, a145
 v_accvgpr_read_b32 v244, a146
 v_accvgpr_read_b32 v245, a147
 v_mul_f32 v242, v252, v242
 v_mul_f32 v243, v252, v243
 v_mul_f32 v244, v252, v244
 v_mul_f32 v245, v252, v245
 v_accvgpr_write_b32 a144, v242
 v_accvgpr_write_b32 a145, v243
 v_accvgpr_write_b32 a146, v244
 v_accvgpr_write_b32 a147, v245
 v_accvgpr_read_b32 v242, a148
 v_accvgpr_read_b32 v243, a149
 v_accvgpr_read_b32 v244, a150
 v_accvgpr_read_b32 v245, a151
 v_mul_f32 v242, v252, v242
 v_mul_f32 v243, v252, v243
 v_mul_f32 v244, v252, v244
 v_mul_f32 v245, v252, v245
 v_accvgpr_write_b32 a148, v242
 v_accvgpr_write_b32 a149, v243
 v_accvgpr_write_b32 a150, v244
 v_accvgpr_write_b32 a151, v245
 v_accvgpr_read_b32 v242, a152
 v_accvgpr_read_b32 v243, a153
 v_accvgpr_read_b32 v244, a154
 v_accvgpr_read_b32 v245, a155
 v_mul_f32 v242, v252, v242
 v_mul_f32 v243, v252, v243
 v_mul_f32 v244, v252, v244
 v_mul_f32 v245, v252, v245
 v_accvgpr_write_b32 a152, v242
 v_accvgpr_write_b32 a153, v243
 v_accvgpr_write_b32 a154, v244
 v_accvgpr_write_b32 a155, v245
 v_accvgpr_read_b32 v242, a156
 v_accvgpr_read_b32 v243, a157
 v_accvgpr_read_b32 v244, a158
 v_accvgpr_read_b32 v245, a159
 v_mul_f32 v242, v252, v242
 v_mul_f32 v243, v252, v243
 v_mul_f32 v244, v252, v244
 v_mul_f32 v245, v252, v245
 v_accvgpr_write_b32 a156, v242
 v_accvgpr_write_b32 a157, v243
 v_accvgpr_write_b32 a158, v244
 v_accvgpr_write_b32 a159, v245
 v_accvgpr_read_b32 v242, a176
 v_accvgpr_read_b32 v243, a177
 v_accvgpr_read_b32 v244, a178
 v_accvgpr_read_b32 v245, a179
 v_mul_f32 v242, v252, v242
 v_mul_f32 v243, v252, v243
 v_mul_f32 v244, v252, v244
 v_mul_f32 v245, v252, v245
 v_accvgpr_write_b32 a176, v242
 v_accvgpr_write_b32 a177, v243
 v_accvgpr_write_b32 a178, v244
 v_accvgpr_write_b32 a179, v245
 v_accvgpr_read_b32 v242, a180
 v_accvgpr_read_b32 v243, a181
 v_accvgpr_read_b32 v244, a182
 v_accvgpr_read_b32 v245, a183
 v_mul_f32 v242, v252, v242
 v_mul_f32 v243, v252, v243
 v_mul_f32 v244, v252, v244
 v_mul_f32 v245, v252, v245
 v_accvgpr_write_b32 a180, v242
 v_accvgpr_write_b32 a181, v243
 v_accvgpr_write_b32 a182, v244
 v_accvgpr_write_b32 a183, v245
 v_accvgpr_read_b32 v242, a184
 v_accvgpr_read_b32 v243, a185
 v_accvgpr_read_b32 v244, a186
 v_accvgpr_read_b32 v245, a187
 v_mul_f32 v242, v252, v242
 v_mul_f32 v243, v252, v243
 v_mul_f32 v244, v252, v244
 v_mul_f32 v245, v252, v245
 v_accvgpr_write_b32 a184, v242
 v_accvgpr_write_b32 a185, v243
 v_accvgpr_write_b32 a186, v244
 v_accvgpr_write_b32 a187, v245
 v_accvgpr_read_b32 v242, a188
 v_accvgpr_read_b32 v243, a189
 v_accvgpr_read_b32 v244, a190
 v_accvgpr_read_b32 v245, a191
 v_mul_f32 v242, v252, v242
 v_mul_f32 v243, v252, v243
 v_mul_f32 v244, v252, v244
 v_mul_f32 v245, v252, v245
 v_accvgpr_write_b32 a188, v242
 v_accvgpr_write_b32 a189, v243
 v_accvgpr_write_b32 a190, v244
 v_accvgpr_write_b32 a191, v245
 v_accvgpr_read_b32 v242, a208
 v_accvgpr_read_b32 v243, a209
 v_accvgpr_read_b32 v244, a210
 v_accvgpr_read_b32 v245, a211
 v_mul_f32 v242, v252, v242
 v_mul_f32 v243, v252, v243
 v_mul_f32 v244, v252, v244
 v_mul_f32 v245, v252, v245
 v_accvgpr_write_b32 a208, v242
 v_accvgpr_write_b32 a209, v243
 v_accvgpr_write_b32 a210, v244
 v_accvgpr_write_b32 a211, v245
 v_accvgpr_read_b32 v242, a212
 v_accvgpr_read_b32 v243, a213
 v_accvgpr_read_b32 v244, a214
 v_accvgpr_read_b32 v245, a215
 v_mul_f32 v242, v252, v242
 v_mul_f32 v243, v252, v243
 v_mul_f32 v244, v252, v244
 v_mul_f32 v245, v252, v245
 v_accvgpr_write_b32 a212, v242
 v_accvgpr_write_b32 a213, v243
 v_accvgpr_write_b32 a214, v244
 v_accvgpr_write_b32 a215, v245
 v_accvgpr_read_b32 v242, a216
 v_accvgpr_read_b32 v243, a217
 v_accvgpr_read_b32 v244, a218
 v_accvgpr_read_b32 v245, a219
 v_mul_f32 v242, v252, v242
 v_mul_f32 v243, v252, v243
 v_mul_f32 v244, v252, v244
 v_mul_f32 v245, v252, v245
 v_accvgpr_write_b32 a216, v242
 v_accvgpr_write_b32 a217, v243
 v_accvgpr_write_b32 a218, v244
 v_accvgpr_write_b32 a219, v245
 v_accvgpr_read_b32 v242, a220
 v_accvgpr_read_b32 v243, a221
 v_accvgpr_read_b32 v244, a222
 v_accvgpr_read_b32 v245, a223
 v_mul_f32 v242, v252, v242
 v_mul_f32 v243, v252, v243
 v_mul_f32 v244, v252, v244
 v_mul_f32 v245, v252, v245
 v_accvgpr_write_b32 a220, v242
 v_accvgpr_write_b32 a221, v243
 v_accvgpr_write_b32 a222, v244
 v_accvgpr_write_b32 a223, v245
 v_accvgpr_read_b32 v242, a240
 v_accvgpr_read_b32 v243, a241
 v_accvgpr_read_b32 v244, a242
 v_accvgpr_read_b32 v245, a243
 v_mul_f32 v242, v252, v242
 v_mul_f32 v243, v252, v243
 v_mul_f32 v244, v252, v244
 v_mul_f32 v245, v252, v245
 v_accvgpr_write_b32 a240, v242
 v_accvgpr_write_b32 a241, v243
 v_accvgpr_write_b32 a242, v244
 v_accvgpr_write_b32 a243, v245
 v_accvgpr_read_b32 v242, a244
 v_accvgpr_read_b32 v243, a245
 v_accvgpr_read_b32 v244, a246
 v_accvgpr_read_b32 v245, a247
 v_mul_f32 v242, v252, v242
 v_mul_f32 v243, v252, v243
 v_mul_f32 v244, v252, v244
 v_mul_f32 v245, v252, v245
 v_accvgpr_write_b32 a244, v242
 v_accvgpr_write_b32 a245, v243
 v_accvgpr_write_b32 a246, v244
 v_accvgpr_write_b32 a247, v245
 v_accvgpr_read_b32 v242, a248
 v_accvgpr_read_b32 v243, a249
 v_accvgpr_read_b32 v244, a250
 v_accvgpr_read_b32 v245, a251
 v_mul_f32 v242, v252, v242
 v_mul_f32 v243, v252, v243
 v_mul_f32 v244, v252, v244
 v_mul_f32 v245, v252, v245
 v_accvgpr_write_b32 a248, v242
 v_accvgpr_write_b32 a249, v243
 v_accvgpr_write_b32 a250, v244
 v_accvgpr_write_b32 a251, v245
 v_accvgpr_read_b32 v242, a252
 v_accvgpr_read_b32 v243, a253
 v_accvgpr_read_b32 v244, a254
 v_accvgpr_read_b32 v245, a255
 v_mul_f32 v242, v252, v242
 v_mul_f32 v243, v252, v243
 v_mul_f32 v244, v252, v244
 v_mul_f32 v245, v252, v245
 v_accvgpr_write_b32 a252, v242
 v_accvgpr_write_b32 a253, v243
 v_accvgpr_write_b32 a254, v244
 v_accvgpr_write_b32 a255, v245
 v_exp_f32 v242, v80
 v_exp_f32 v243, v81
 s_nop 0
 v_add_f32 v241, v242, v243
 v_cvt_pk_bf16_f32 v136, v242, v243
 v_exp_f32 v242, v82
 v_exp_f32 v243, v83
 s_nop 0
 v_add_f32 v241, v242, v241
 v_add_f32 v241, v243, v241
 v_cvt_pk_bf16_f32 v137, v242, v243
 v_exp_f32 v242, v84
 v_exp_f32 v243, v85
 s_nop 0
 v_add_f32 v241, v242, v241
 v_add_f32 v241, v243, v241
 v_cvt_pk_bf16_f32 v138, v242, v243
 v_exp_f32 v242, v86
 v_exp_f32 v243, v87
 s_nop 0
 v_add_f32 v241, v242, v241
 v_add_f32 v241, v243, v241
 v_cvt_pk_bf16_f32 v139, v242, v243
 v_exp_f32 v242, v88
 v_exp_f32 v243, v89
 s_nop 0
 v_add_f32 v241, v242, v241
 v_add_f32 v241, v243, v241
 v_cvt_pk_bf16_f32 v140, v242, v243
 v_exp_f32 v242, v90
 v_exp_f32 v243, v91
 s_nop 0
 v_add_f32 v241, v242, v241
 v_add_f32 v241, v243, v241
 v_cvt_pk_bf16_f32 v141, v242, v243
 v_exp_f32 v242, v92
 v_exp_f32 v243, v93
 s_nop 0
 v_add_f32 v241, v242, v241
 v_add_f32 v241, v243, v241
 v_cvt_pk_bf16_f32 v142, v242, v243
 v_exp_f32 v242, v94
 v_exp_f32 v243, v95
 s_nop 0
 v_add_f32 v241, v242, v241
 v_add_f32 v241, v243, v241
 v_cvt_pk_bf16_f32 v143, v242, v243
 s_nop 3
 s_setpc_b64 s[40:41]
RARE1:
 s_nop 15
 s_nop 7
 v_max3_f32 v250, v96, v97, v98
 v_max3_f32 v250, v250, v99, v100
 v_max3_f32 v250, v250, v101, v102
 v_max3_f32 v250, v250, v103, v104
 v_max3_f32 v250, v250, v105, v106
 v_max3_f32 v250, v250, v107, v108
 v_max3_f32 v250, v250, v109, v110
 v_max_f32 v250, v111, v250
 v_mov_b32 v251, v250
 s_nop 1
 v_permlane32_swap_b32 v250, v251
 v_max3_f32 v250, v250, v251, 0
 v_sub_f32 v252, 0, v250
 v_exp_f32 v252, v252
 v_sub_f32 v96, v96, v250
 v_sub_f32 v64, v64, v250
 v_sub_f32 v160, v160, v250
 v_sub_f32 v97, v97, v250
 v_sub_f32 v65, v65, v250
 v_sub_f32 v161, v161, v250
 v_sub_f32 v98, v98, v250
 v_sub_f32 v66, v66, v250
 v_sub_f32 v162, v162, v250
 v_sub_f32 v99, v99, v250
 v_sub_f32 v67, v67, v250
 v_sub_f32 v163, v163, v250
 v_sub_f32 v100, v100, v250
 v_sub_f32 v68, v68, v250
 v_sub_f32 v164, v164, v250
 v_sub_f32 v101, v101, v250
 v_sub_f32 v69, v69, v250
 v_sub_f32 v165, v165, v250
 v_sub_f32 v102, v102, v250
 v_sub_f32 v70, v70, v250
 v_sub_f32 v166, v166, v250
 v_sub_f32 v103, v103, v250
 v_sub_f32 v71, v71, v250
 v_sub_f32 v167, v167, v250
 v_sub_f32 v104, v104, v250
 v_sub_f32 v72, v72, v250
 v_sub_f32 v168, v168, v250
 v_sub_f32 v105, v105, v250
 v_sub_f32 v73, v73, v250
 v_sub_f32 v169, v169, v250
 v_sub_f32 v106, v106, v250
 v_sub_f32 v74, v74, v250
 v_sub_f32 v170, v170, v250
 v_sub_f32 v107, v107, v250
 v_sub_f32 v75, v75, v250
 v_sub_f32 v171, v171, v250
 v_sub_f32 v108, v108, v250
 v_sub_f32 v76, v76, v250
 v_sub_f32 v172, v172, v250
 v_sub_f32 v109, v109, v250
 v_sub_f32 v77, v77, v250
 v_sub_f32 v173, v173, v250
 v_sub_f32 v110, v110, v250
 v_sub_f32 v78, v78, v250
 v_sub_f32 v174, v174, v250
 v_sub_f32 v111, v111, v250
 v_sub_f32 v79, v79, v250
 v_sub_f32 v175, v175, v250
 v_mul_f32 v216, v252, v216
 v_accvgpr_read_b32 v242, a128
 v_accvgpr_read_b32 v243, a129
 v_accvgpr_read_b32 v244, a130
 v_accvgpr_read_b32 v245, a131
 v_mul_f32 v242, v252, v242
 v_mul_f32 v243, v252, v243
 v_mul_f32 v244, v252, v244
 v_mul_f32 v245, v252, v245
 v_accvgpr_write_b32 a128, v242
 v_accvgpr_write_b32 a129, v243
 v_accvgpr_write_b32 a130, v244
 v_accvgpr_write_b32 a131, v245
 v_accvgpr_read_b32 v242, a132
 v_accvgpr_read_b32 v243, a133
 v_accvgpr_read_b32 v244, a134
 v_accvgpr_read_b32 v245, a135
 v_mul_f32 v242, v252, v242
 v_mul_f32 v243, v252, v243
 v_mul_f32 v244, v252, v244
 v_mul_f32 v245, v252, v245
 v_accvgpr_write_b32 a132, v242
 v_accvgpr_write_b32 a133, v243
 v_accvgpr_write_b32 a134, v244
 v_accvgpr_write_b32 a135, v245
 v_accvgpr_read_b32 v242, a136
 v_accvgpr_read_b32 v243, a137
 v_accvgpr_read_b32 v244, a138
 v_accvgpr_read_b32 v245, a139
 v_mul_f32 v242, v252, v242
 v_mul_f32 v243, v252, v243
 v_mul_f32 v244, v252, v244
 v_mul_f32 v245, v252, v245
 v_accvgpr_write_b32 a136, v242
 v_accvgpr_write_b32 a137, v243
 v_accvgpr_write_b32 a138, v244
 v_accvgpr_write_b32 a139, v245
 v_accvgpr_read_b32 v242, a140
 v_accvgpr_read_b32 v243, a141
 v_accvgpr_read_b32 v244, a142
 v_accvgpr_read_b32 v245, a143
 v_mul_f32 v242, v252, v242
 v_mul_f32 v243, v252, v243
 v_mul_f32 v244, v252, v244
 v_mul_f32 v245, v252, v245
 v_accvgpr_write_b32 a140, v242
 v_accvgpr_write_b32 a141, v243
 v_accvgpr_write_b32 a142, v244
 v_accvgpr_write_b32 a143, v245
 v_accvgpr_read_b32 v242, a160
 v_accvgpr_read_b32 v243, a161
 v_accvgpr_read_b32 v244, a162
 v_accvgpr_read_b32 v245, a163
 v_mul_f32 v242, v252, v242
 v_mul_f32 v243, v252, v243
 v_mul_f32 v244, v252, v244
 v_mul_f32 v245, v252, v245
 v_accvgpr_write_b32 a160, v242
 v_accvgpr_write_b32 a161, v243
 v_accvgpr_write_b32 a162, v244
 v_accvgpr_write_b32 a163, v245
 v_accvgpr_read_b32 v242, a164
 v_accvgpr_read_b32 v243, a165
 v_accvgpr_read_b32 v244, a166
 v_accvgpr_read_b32 v245, a167
 v_mul_f32 v242, v252, v242
 v_mul_f32 v243, v252, v243
 v_mul_f32 v244, v252, v244
 v_mul_f32 v245, v252, v245
 v_accvgpr_write_b32 a164, v242
 v_accvgpr_write_b32 a165, v243
 v_accvgpr_write_b32 a166, v244
 v_accvgpr_write_b32 a167, v245
 v_accvgpr_read_b32 v242, a168
 v_accvgpr_read_b32 v243, a169
 v_accvgpr_read_b32 v244, a170
 v_accvgpr_read_b32 v245, a171
 v_mul_f32 v242, v252, v242
 v_mul_f32 v243, v252, v243
 v_mul_f32 v244, v252, v244
 v_mul_f32 v245, v252, v245
 v_accvgpr_write_b32 a168, v242
 v_accvgpr_write_b32 a169, v243
 v_accvgpr_write_b32 a170, v244
 v_accvgpr_write_b32 a171, v245
 v_accvgpr_read_b32 v242, a172
 v_accvgpr_read_b32 v243, a173
 v_accvgpr_read_b32 v244, a174
 v_accvgpr_read_b32 v245, a175
 v_mul_f32 v242, v252, v242
 v_mul_f32 v243, v252, v243
 v_mul_f32 v244, v252, v244
 v_mul_f32 v245, v252, v245
 v_accvgpr_write_b32 a172, v242
 v_accvgpr_write_b32 a173, v243
 v_accvgpr_write_b32 a174, v244
 v_accvgpr_write_b32 a175, v245
 v_accvgpr_read_b32 v242, a192
 v_accvgpr_read_b32 v243, a193
 v_accvgpr_read_b32 v244, a194
 v_accvgpr_read_b32 v245, a195
 v_mul_f32 v242, v252, v242
 v_mul_f32 v243, v252, v243
 v_mul_f32 v244, v252, v244
 v_mul_f32 v245, v252, v245
 v_accvgpr_write_b32 a192, v242
 v_accvgpr_write_b32 a193, v243
 v_accvgpr_write_b32 a194, v244
 v_accvgpr_write_b32 a195, v245
 v_accvgpr_read_b32 v242, a196
 v_accvgpr_read_b32 v243, a197
 v_accvgpr_read_b32 v244, a198
 v_accvgpr_read_b32 v245, a199
 v_mul_f32 v242, v252, v242
 v_mul_f32 v243, v252, v243
 v_mul_f32 v244, v252, v244
 v_mul_f32 v245, v252, v245
 v_accvgpr_write_b32 a196, v242
 v_accvgpr_write_b32 a197, v243
 v_accvgpr_write_b32 a198, v244
 v_accvgpr_write_b32 a199, v245
 v_accvgpr_read_b32 v242, a200
 v_accvgpr_read_b32 v243, a201
 v_accvgpr_read_b32 v244, a202
 v_accvgpr_read_b32 v245, a203
 v_mul_f32 v242, v252, v242
 v_mul_f32 v243, v252, v243
 v_mul_f32 v244, v252, v244
 v_mul_f32 v245, v252, v245
 v_accvgpr_write_b32 a200, v242
 v_accvgpr_write_b32 a201, v243
 v_accvgpr_write_b32 a202, v244
 v_accvgpr_write_b32 a203, v245
 v_accvgpr_read_b32 v242, a204
 v_accvgpr_read_b32 v243, a205
 v_accvgpr_read_b32 v244, a206
 v_accvgpr_read_b32 v245, a207
 v_mul_f32 v242, v252, v242
 v_mul_f32 v243, v252, v243
 v_mul_f32 v244, v252, v244
 v_mul_f32 v245, v252, v245
 v_accvgpr_write_b32 a204, v242
 v_accvgpr_write_b32 a205, v243
 v_accvgpr_write_b32 a206, v244
 v_accvgpr_write_b32 a207, v245
 v_accvgpr_read_b32 v242, a224
 v_accvgpr_read_b32 v243, a225
 v_accvgpr_read_b32 v244, a226
 v_accvgpr_read_b32 v245, a227
 v_mul_f32 v242, v252, v242
 v_mul_f32 v243, v252, v243
 v_mul_f32 v244, v252, v244
 v_mul_f32 v245, v252, v245
 v_accvgpr_write_b32 a224, v242
 v_accvgpr_write_b32 a225, v243
 v_accvgpr_write_b32 a226, v244
 v_accvgpr_write_b32 a227, v245
 v_accvgpr_read_b32 v242, a228
 v_accvgpr_read_b32 v243, a229
 v_accvgpr_read_b32 v244, a230
 v_accvgpr_read_b32 v245, a231
 v_mul_f32 v242, v252, v242
 v_mul_f32 v243, v252, v243
 v_mul_f32 v244, v252, v244
 v_mul_f32 v245, v252, v245
 v_accvgpr_write_b32 a228, v242
 v_accvgpr_write_b32 a229, v243
 v_accvgpr_write_b32 a230, v244
 v_accvgpr_write_b32 a231, v245
 v_accvgpr_read_b32 v242, a232
 v_accvgpr_read_b32 v243, a233
 v_accvgpr_read_b32 v244, a234
 v_accvgpr_read_b32 v245, a235
 v_mul_f32 v242, v252, v242
 v_mul_f32 v243, v252, v243
 v_mul_f32 v244, v252, v244
 v_mul_f32 v245, v252, v245
 v_accvgpr_write_b32 a232, v242
 v_accvgpr_write_b32 a233, v243
 v_accvgpr_write_b32 a234, v244
 v_accvgpr_write_b32 a235, v245
 v_accvgpr_read_b32 v242, a236
 v_accvgpr_read_b32 v243, a237
 v_accvgpr_read_b32 v244, a238
 v_accvgpr_read_b32 v245, a239
 v_mul_f32 v242, v252, v242
 v_mul_f32 v243, v252, v243
 v_mul_f32 v244, v252, v244
 v_mul_f32 v245, v252, v245
 v_accvgpr_write_b32 a236, v242
 v_accvgpr_write_b32 a237, v243
 v_accvgpr_write_b32 a238, v244
 v_accvgpr_write_b32 a239, v245
 v_exp_f32 v242, v96
 v_exp_f32 v243, v97
 s_nop 0
 v_add_f32 v240, v242, v243
 v_cvt_pk_bf16_f32 v144, v242, v243
 v_exp_f32 v242, v98
 v_exp_f32 v243, v99
 s_nop 0
 v_add_f32 v240, v242, v240
 v_add_f32 v240, v243, v240
 v_cvt_pk_bf16_f32 v145, v242, v243
 v_exp_f32 v242, v100
 v_exp_f32 v243, v101
 s_nop 0
 v_add_f32 v240, v242, v240
 v_add_f32 v240, v243, v240
 v_cvt_pk_bf16_f32 v146, v242, v243
 v_exp_f32 v242, v102
 v_exp_f32 v243, v103
 s_nop 0
 v_add_f32 v240, v242, v240
 v_add_f32 v240, v243, v240
 v_cvt_pk_bf16_f32 v147, v242, v243
 v_exp_f32 v242, v104
 v_exp_f32 v243, v105
 s_nop 0
 v_add_f32 v240, v242, v240
 v_add_f32 v240, v243, v240
 v_cvt_pk_bf16_f32 v148, v242, v243
 v_exp_f32 v242, v106
 v_exp_f32 v243, v107
 s_nop 0
 v_add_f32 v240, v242, v240
 v_add_f32 v240, v243, v240
 v_cvt_pk_bf16_f32 v149, v242, v243
 v_exp_f32 v242, v108
 v_exp_f32 v243, v109
 s_nop 0
 v_add_f32 v240, v242, v240
 v_add_f32 v240, v243, v240
 v_cvt_pk_bf16_f32 v150, v242, v243
 v_exp_f32 v242, v110
 v_exp_f32 v243, v111
 s_nop 0
 v_add_f32 v240, v242, v240
 v_add_f32 v240, v243, v240
 v_cvt_pk_bf16_f32 v151, v242, v243
 v_max3_f32 v250, v112, v113, v114
 v_max3_f32 v250, v250, v115, v116
 v_max3_f32 v250, v250, v117, v118
 v_max3_f32 v250, v250, v119, v120
 v_max3_f32 v250, v250, v121, v122
 v_max3_f32 v250, v250, v123, v124
 v_max3_f32 v250, v250, v125, v126
 v_max_f32 v250, v127, v250
 v_mov_b32 v251, v250
 s_nop 1
 v_permlane32_swap_b32 v250, v251
 v_max3_f32 v250, v250, v251, 0
 v_sub_f32 v252, 0, v250
 v_exp_f32 v252, v252
 v_sub_f32 v112, v112, v250
 v_sub_f32 v80, v80, v250
 v_sub_f32 v176, v176, v250
 v_sub_f32 v113, v113, v250
 v_sub_f32 v81, v81, v250
 v_sub_f32 v177, v177, v250
 v_sub_f32 v114, v114, v250
 v_sub_f32 v82, v82, v250
 v_sub_f32 v178, v178, v250
 v_sub_f32 v115, v115, v250
 v_sub_f32 v83, v83, v250
 v_sub_f32 v179, v179, v250
 v_sub_f32 v116, v116, v250
 v_sub_f32 v84, v84, v250
 v_sub_f32 v180, v180, v250
 v_sub_f32 v117, v117, v250
 v_sub_f32 v85, v85, v250
 v_sub_f32 v181, v181, v250
 v_sub_f32 v118, v118, v250
 v_sub_f32 v86, v86, v250
 v_sub_f32 v182, v182, v250
 v_sub_f32 v119, v119, v250
 v_sub_f32 v87, v87, v250
 v_sub_f32 v183, v183, v250
 v_sub_f32 v120, v120, v250
 v_sub_f32 v88, v88, v250
 v_sub_f32 v184, v184, v250
 v_sub_f32 v121, v121, v250
 v_sub_f32 v89, v89, v250
 v_sub_f32 v185, v185, v250
 v_sub_f32 v122, v122, v250
 v_sub_f32 v90, v90, v250
 v_sub_f32 v186, v186, v250
 v_sub_f32 v123, v123, v250
 v_sub_f32 v91, v91, v250
 v_sub_f32 v187, v187, v250
 v_sub_f32 v124, v124, v250
 v_sub_f32 v92, v92, v250
 v_sub_f32 v188, v188, v250
 v_sub_f32 v125, v125, v250
 v_sub_f32 v93, v93, v250
 v_sub_f32 v189, v189, v250
 v_sub_f32 v126, v126, v250
 v_sub_f32 v94, v94, v250
 v_sub_f32 v190, v190, v250
 v_sub_f32 v127, v127, v250
 v_sub_f32 v95, v95, v250
 v_sub_f32 v191, v191, v250
 v_mul_f32 v217, v252, v217
 v_accvgpr_read_b32 v242, a144
 v_accvgpr_read_b32 v243, a145
 v_accvgpr_read_b32 v244, a146
 v_accvgpr_read_b32 v245, a147
 v_mul_f32 v242, v252, v242
 v_mul_f32 v243, v252, v243
 v_mul_f32 v244, v252, v244
 v_mul_f32 v245, v252, v245
 v_accvgpr_write_b32 a144, v242
 v_accvgpr_write_b32 a145, v243
 v_accvgpr_write_b32 a146, v244
 v_accvgpr_write_b32 a147, v245
 v_accvgpr_read_b32 v242, a148
 v_accvgpr_read_b32 v243, a149
 v_accvgpr_read_b32 v244, a150
 v_accvgpr_read_b32 v245, a151
 v_mul_f32 v242, v252, v242
 v_mul_f32 v243, v252, v243
 v_mul_f32 v244, v252, v244
 v_mul_f32 v245, v252, v245
 v_accvgpr_write_b32 a148, v242
 v_accvgpr_write_b32 a149, v243
 v_accvgpr_write_b32 a150, v244
 v_accvgpr_write_b32 a151, v245
 v_accvgpr_read_b32 v242, a152
 v_accvgpr_read_b32 v243, a153
 v_accvgpr_read_b32 v244, a154
 v_accvgpr_read_b32 v245, a155
 v_mul_f32 v242, v252, v242
 v_mul_f32 v243, v252, v243
 v_mul_f32 v244, v252, v244
 v_mul_f32 v245, v252, v245
 v_accvgpr_write_b32 a152, v242
 v_accvgpr_write_b32 a153, v243
 v_accvgpr_write_b32 a154, v244
 v_accvgpr_write_b32 a155, v245
 v_accvgpr_read_b32 v242, a156
 v_accvgpr_read_b32 v243, a157
 v_accvgpr_read_b32 v244, a158
 v_accvgpr_read_b32 v245, a159
 v_mul_f32 v242, v252, v242
 v_mul_f32 v243, v252, v243
 v_mul_f32 v244, v252, v244
 v_mul_f32 v245, v252, v245
 v_accvgpr_write_b32 a156, v242
 v_accvgpr_write_b32 a157, v243
 v_accvgpr_write_b32 a158, v244
 v_accvgpr_write_b32 a159, v245
 v_accvgpr_read_b32 v242, a176
 v_accvgpr_read_b32 v243, a177
 v_accvgpr_read_b32 v244, a178
 v_accvgpr_read_b32 v245, a179
 v_mul_f32 v242, v252, v242
 v_mul_f32 v243, v252, v243
 v_mul_f32 v244, v252, v244
 v_mul_f32 v245, v252, v245
 v_accvgpr_write_b32 a176, v242
 v_accvgpr_write_b32 a177, v243
 v_accvgpr_write_b32 a178, v244
 v_accvgpr_write_b32 a179, v245
 v_accvgpr_read_b32 v242, a180
 v_accvgpr_read_b32 v243, a181
 v_accvgpr_read_b32 v244, a182
 v_accvgpr_read_b32 v245, a183
 v_mul_f32 v242, v252, v242
 v_mul_f32 v243, v252, v243
 v_mul_f32 v244, v252, v244
 v_mul_f32 v245, v252, v245
 v_accvgpr_write_b32 a180, v242
 v_accvgpr_write_b32 a181, v243
 v_accvgpr_write_b32 a182, v244
 v_accvgpr_write_b32 a183, v245
 v_accvgpr_read_b32 v242, a184
 v_accvgpr_read_b32 v243, a185
 v_accvgpr_read_b32 v244, a186
 v_accvgpr_read_b32 v245, a187
 v_mul_f32 v242, v252, v242
 v_mul_f32 v243, v252, v243
 v_mul_f32 v244, v252, v244
 v_mul_f32 v245, v252, v245
 v_accvgpr_write_b32 a184, v242
 v_accvgpr_write_b32 a185, v243
 v_accvgpr_write_b32 a186, v244
 v_accvgpr_write_b32 a187, v245
 v_accvgpr_read_b32 v242, a188
 v_accvgpr_read_b32 v243, a189
 v_accvgpr_read_b32 v244, a190
 v_accvgpr_read_b32 v245, a191
 v_mul_f32 v242, v252, v242
 v_mul_f32 v243, v252, v243
 v_mul_f32 v244, v252, v244
 v_mul_f32 v245, v252, v245
 v_accvgpr_write_b32 a188, v242
 v_accvgpr_write_b32 a189, v243
 v_accvgpr_write_b32 a190, v244
 v_accvgpr_write_b32 a191, v245
 v_accvgpr_read_b32 v242, a208
 v_accvgpr_read_b32 v243, a209
 v_accvgpr_read_b32 v244, a210
 v_accvgpr_read_b32 v245, a211
 v_mul_f32 v242, v252, v242
 v_mul_f32 v243, v252, v243
 v_mul_f32 v244, v252, v244
 v_mul_f32 v245, v252, v245
 v_accvgpr_write_b32 a208, v242
 v_accvgpr_write_b32 a209, v243
 v_accvgpr_write_b32 a210, v244
 v_accvgpr_write_b32 a211, v245
 v_accvgpr_read_b32 v242, a212
 v_accvgpr_read_b32 v243, a213
 v_accvgpr_read_b32 v244, a214
 v_accvgpr_read_b32 v245, a215
 v_mul_f32 v242, v252, v242
 v_mul_f32 v243, v252, v243
 v_mul_f32 v244, v252, v244
 v_mul_f32 v245, v252, v245
 v_accvgpr_write_b32 a212, v242
 v_accvgpr_write_b32 a213, v243
 v_accvgpr_write_b32 a214, v244
 v_accvgpr_write_b32 a215, v245
 v_accvgpr_read_b32 v242, a216
 v_accvgpr_read_b32 v243, a217
 v_accvgpr_read_b32 v244, a218
 v_accvgpr_read_b32 v245, a219
 v_mul_f32 v242, v252, v242
 v_mul_f32 v243, v252, v243
 v_mul_f32 v244, v252, v244
 v_mul_f32 v245, v252, v245
 v_accvgpr_write_b32 a216, v242
 v_accvgpr_write_b32 a217, v243
 v_accvgpr_write_b32 a218, v244
 v_accvgpr_write_b32 a219, v245
 v_accvgpr_read_b32 v242, a220
 v_accvgpr_read_b32 v243, a221
 v_accvgpr_read_b32 v244, a222
 v_accvgpr_read_b32 v245, a223
 v_mul_f32 v242, v252, v242
 v_mul_f32 v243, v252, v243
 v_mul_f32 v244, v252, v244
 v_mul_f32 v245, v252, v245
 v_accvgpr_write_b32 a220, v242
 v_accvgpr_write_b32 a221, v243
 v_accvgpr_write_b32 a222, v244
 v_accvgpr_write_b32 a223, v245
 v_accvgpr_read_b32 v242, a240
 v_accvgpr_read_b32 v243, a241
 v_accvgpr_read_b32 v244, a242
 v_accvgpr_read_b32 v245, a243
 v_mul_f32 v242, v252, v242
 v_mul_f32 v243, v252, v243
 v_mul_f32 v244, v252, v244
 v_mul_f32 v245, v252, v245
 v_accvgpr_write_b32 a240, v242
 v_accvgpr_write_b32 a241, v243
 v_accvgpr_write_b32 a242, v244
 v_accvgpr_write_b32 a243, v245
 v_accvgpr_read_b32 v242, a244
 v_accvgpr_read_b32 v243, a245
 v_accvgpr_read_b32 v244, a246
 v_accvgpr_read_b32 v245, a247
 v_mul_f32 v242, v252, v242
 v_mul_f32 v243, v252, v243
 v_mul_f32 v244, v252, v244
 v_mul_f32 v245, v252, v245
 v_accvgpr_write_b32 a244, v242
 v_accvgpr_write_b32 a245, v243
 v_accvgpr_write_b32 a246, v244
 v_accvgpr_write_b32 a247, v245
 v_accvgpr_read_b32 v242, a248
 v_accvgpr_read_b32 v243, a249
 v_accvgpr_read_b32 v244, a250
 v_accvgpr_read_b32 v245, a251
 v_mul_f32 v242, v252, v242
 v_mul_f32 v243, v252, v243
 v_mul_f32 v244, v252, v244
 v_mul_f32 v245, v252, v245
 v_accvgpr_write_b32 a248, v242
 v_accvgpr_write_b32 a249, v243
 v_accvgpr_write_b32 a250, v244
 v_accvgpr_write_b32 a251, v245
 v_accvgpr_read_b32 v242, a252
 v_accvgpr_read_b32 v243, a253
 v_accvgpr_read_b32 v244, a254
 v_accvgpr_read_b32 v245, a255
 v_mul_f32 v242, v252, v242
 v_mul_f32 v243, v252, v243
 v_mul_f32 v244, v252, v244
 v_mul_f32 v245, v252, v245
 v_accvgpr_write_b32 a252, v242
 v_accvgpr_write_b32 a253, v243
 v_accvgpr_write_b32 a254, v244
 v_accvgpr_write_b32 a255, v245
 v_exp_f32 v242, v112
 v_exp_f32 v243, v113
 s_nop 0
 v_add_f32 v241, v242, v243
 v_cvt_pk_bf16_f32 v152, v242, v243
 v_exp_f32 v242, v114
 v_exp_f32 v243, v115
 s_nop 0
 v_add_f32 v241, v242, v241
 v_add_f32 v241, v243, v241
 v_cvt_pk_bf16_f32 v153, v242, v243
 v_exp_f32 v242, v116
 v_exp_f32 v243, v117
 s_nop 0
 v_add_f32 v241, v242, v241
 v_add_f32 v241, v243, v241
 v_cvt_pk_bf16_f32 v154, v242, v243
 v_exp_f32 v242, v118
 v_exp_f32 v243, v119
 s_nop 0
 v_add_f32 v241, v242, v241
 v_add_f32 v241, v243, v241
 v_cvt_pk_bf16_f32 v155, v242, v243
 v_exp_f32 v242, v120
 v_exp_f32 v243, v121
 s_nop 0
 v_add_f32 v241, v242, v241
 v_add_f32 v241, v243, v241
 v_cvt_pk_bf16_f32 v156, v242, v243
 v_exp_f32 v242, v122
 v_exp_f32 v243, v123
 s_nop 0
 v_add_f32 v241, v242, v241
 v_add_f32 v241, v243, v241
 v_cvt_pk_bf16_f32 v157, v242, v243
 v_exp_f32 v242, v124
 v_exp_f32 v243, v125
 s_nop 0
 v_add_f32 v241, v242, v241
 v_add_f32 v241, v243, v241
 v_cvt_pk_bf16_f32 v158, v242, v243
 v_exp_f32 v242, v126
 v_exp_f32 v243, v127
 s_nop 0
 v_add_f32 v241, v242, v241
 v_add_f32 v241, v243, v241
 v_cvt_pk_bf16_f32 v159, v242, v243
 s_nop 3
 s_setpc_b64 s[40:41]
RARE2:
 s_nop 15
 s_nop 7
 v_max3_f32 v250, v64, v65, v66
 v_max3_f32 v250, v250, v67, v68
 v_max3_f32 v250, v250, v69, v70
 v_max3_f32 v250, v250, v71, v72
 v_max3_f32 v250, v250, v73, v74
 v_max3_f32 v250, v250, v75, v76
 v_max3_f32 v250, v250, v77, v78
 v_max_f32 v250, v79, v250
 v_mov_b32 v251, v250
 s_nop 1
 v_permlane32_swap_b32 v250, v251
 v_max3_f32 v250, v250, v251, 0
 v_sub_f32 v252, 0, v250
 v_exp_f32 v252, v252
 v_sub_f32 v64, v64, v250
 v_sub_f32 v96, v96, v250
 v_sub_f32 v160, v160, v250
 v_sub_f32 v65, v65, v250
 v_sub_f32 v97, v97, v250
 v_sub_f32 v161, v161, v250
 v_sub_f32 v66, v66, v250
 v_sub_f32 v98, v98, v250
 v_sub_f32 v162, v162, v250
 v_sub_f32 v67, v67, v250
 v_sub_f32 v99, v99, v250
 v_sub_f32 v163, v163, v250
 v_sub_f32 v68, v68, v250
 v_sub_f32 v100, v100, v250
 v_sub_f32 v164, v164, v250
 v_sub_f32 v69, v69, v250
 v_sub_f32 v101, v101, v250
 v_sub_f32 v165, v165, v250
 v_sub_f32 v70, v70, v250
 v_sub_f32 v102, v102, v250
 v_sub_f32 v166, v166, v250
 v_sub_f32 v71, v71, v250
 v_sub_f32 v103, v103, v250
 v_sub_f32 v167, v167, v250
 v_sub_f32 v72, v72, v250
 v_sub_f32 v104, v104, v250
 v_sub_f32 v168, v168, v250
 v_sub_f32 v73, v73, v250
 v_sub_f32 v105, v105, v250
 v_sub_f32 v169, v169, v250
 v_sub_f32 v74, v74, v250
 v_sub_f32 v106, v106, v250
 v_sub_f32 v170, v170, v250
 v_sub_f32 v75, v75, v250
 v_sub_f32 v107, v107, v250
 v_sub_f32 v171, v171, v250
 v_sub_f32 v76, v76, v250
 v_sub_f32 v108, v108, v250
 v_sub_f32 v172, v172, v250
 v_sub_f32 v77, v77, v250
 v_sub_f32 v109, v109, v250
 v_sub_f32 v173, v173, v250
 v_sub_f32 v78, v78, v250
 v_sub_f32 v110, v110, v250
 v_sub_f32 v174, v174, v250
 v_sub_f32 v79, v79, v250
 v_sub_f32 v111, v111, v250
 v_sub_f32 v175, v175, v250
 v_mul_f32 v216, v252, v216
 v_accvgpr_read_b32 v242, a64
 v_accvgpr_read_b32 v243, a65
 v_accvgpr_read_b32 v244, a66
 v_accvgpr_read_b32 v245, a67
 v_mul_f32 v242, v252, v242
 v_mul_f32 v243, v252, v243
 v_mul_f32 v244, v252, v244
 v_mul_f32 v245, v252, v245
 v_accvgpr_write_b32 a64, v242
 v_accvgpr_write_b32 a65, v243
 v_accvgpr_write_b32 a66, v244
 v_accvgpr_write_b32 a67, v245
 v_accvgpr_read_b32 v242, a68
 v_accvgpr_read_b32 v243, a69
 v_accvgpr_read_b32 v244, a70
 v_accvgpr_read_b32 v245, a71
 v_mul_f32 v242, v252, v242
 v_mul_f32 v243, v252, v243
 v_mul_f32 v244, v252, v244
 v_mul_f32 v245, v252, v245
 v_accvgpr_write_b32 a68, v242
 v_accvgpr_write_b32 a69, v243
 v_accvgpr_write_b32 a70, v244
 v_accvgpr_write_b32 a71, v245
 v_accvgpr_read_b32 v242, a72
 v_accvgpr_read_b32 v243, a73
 v_accvgpr_read_b32 v244, a74
 v_accvgpr_read_b32 v245, a75
 v_mul_f32 v242, v252, v242
 v_mul_f32 v243, v252, v243
 v_mul_f32 v244, v252, v244
 v_mul_f32 v245, v252, v245
 v_accvgpr_write_b32 a72, v242
 v_accvgpr_write_b32 a73, v243
 v_accvgpr_write_b32 a74, v244
 v_accvgpr_write_b32 a75, v245
 v_accvgpr_read_b32 v242, a76
 v_accvgpr_read_b32 v243, a77
 v_accvgpr_read_b32 v244, a78
 v_accvgpr_read_b32 v245, a79
 v_mul_f32 v242, v252, v242
 v_mul_f32 v243, v252, v243
 v_mul_f32 v244, v252, v244
 v_mul_f32 v245, v252, v245
 v_accvgpr_write_b32 a76, v242
 v_accvgpr_write_b32 a77, v243
 v_accvgpr_write_b32 a78, v244
 v_accvgpr_write_b32 a79, v245
 v_accvgpr_read_b32 v242, a96
 v_accvgpr_read_b32 v243, a97
 v_accvgpr_read_b32 v244, a98
 v_accvgpr_read_b32 v245, a99
 v_mul_f32 v242, v252, v242
 v_mul_f32 v243, v252, v243
 v_mul_f32 v244, v252, v244
 v_mul_f32 v245, v252, v245
 v_accvgpr_write_b32 a96, v242
 v_accvgpr_write_b32 a97, v243
 v_accvgpr_write_b32 a98, v244
 v_accvgpr_write_b32 a99, v245
 v_accvgpr_read_b32 v242, a100
 v_accvgpr_read_b32 v243, a101
 v_accvgpr_read_b32 v244, a102
 v_accvgpr_read_b32 v245, a103
 v_mul_f32 v242, v252, v242
 v_mul_f32 v243, v252, v243
 v_mul_f32 v244, v252, v244
 v_mul_f32 v245, v252, v245
 v_accvgpr_write_b32 a100, v242
 v_accvgpr_write_b32 a101, v243
 v_accvgpr_write_b32 a102, v244
 v_accvgpr_write_b32 a103, v245
 v_accvgpr_read_b32 v242, a104
 v_accvgpr_read_b32 v243, a105
 v_accvgpr_read_b32 v244, a106
 v_accvgpr_read_b32 v245, a107
 v_mul_f32 v242, v252, v242
 v_mul_f32 v243, v252, v243
 v_mul_f32 v244, v252, v244
 v_mul_f32 v245, v252, v245
 v_accvgpr_write_b32 a104, v242
 v_accvgpr_write_b32 a105, v243
 v_accvgpr_write_b32 a106, v244
 v_accvgpr_write_b32 a107, v245
 v_accvgpr_read_b32 v242, a108
 v_accvgpr_read_b32 v243, a109
 v_accvgpr_read_b32 v244, a110
 v_accvgpr_read_b32 v245, a111
 v_mul_f32 v242, v252, v242
 v_mul_f32 v243, v252, v243
 v_mul_f32 v244, v252, v244
 v_mul_f32 v245, v252, v245
 v_accvgpr_write_b32 a108, v242
 v_accvgpr_write_b32 a109, v243
 v_accvgpr_write_b32 a110, v244
 v_accvgpr_write_b32 a111, v245
 v_mul_f32 v0, v252, v0
 v_mul_f32 v1, v252, v1
 v_mul_f32 v2, v252, v2
 v_mul_f32 v3, v252, v3
 v_mul_f32 v4, v252, v4
 v_mul_f32 v5, v252, v5
 v_mul_f32 v6, v252, v6
 v_mul_f32 v7, v252, v7
 v_mul_f32 v8, v252, v8
 v_mul_f32 v9, v252, v9
 v_mul_f32 v10, v252, v10
 v_mul_f32 v11, v252, v11
 v_mul_f32 v12, v252, v12
 v_mul_f32 v13, v252, v13
 v_mul_f32 v14, v252, v14
 v_mul_f32 v15, v252, v15
 v_mul_f32 v32, v252, v32
 v_mul_f32 v33, v252, v33
 v_mul_f32 v34, v252, v34
 v_mul_f32 v35, v252, v35
 v_mul_f32 v36, v252, v36
 v_mul_f32 v37, v252, v37
 v_mul_f32 v38, v252, v38
 v_mul_f32 v39, v252, v39
 v_mul_f32 v40, v252, v40
 v_mul_f32 v41, v252, v41
 v_mul_f32 v42, v252, v42
 v_mul_f32 v43, v252, v43
 v_mul_f32 v44, v252, v44
 v_mul_f32 v45, v252, v45
 v_mul_f32 v46, v252, v46
 v_mul_f32 v47, v252, v47
 v_exp_f32 v242, v64
 v_exp_f32 v243, v65
 s_nop 0
 v_add_f32 v240, v242, v243
 v_cvt_pk_bf16_f32 v128, v242, v243
 v_exp_f32 v242, v66
 v_exp_f32 v243, v67
 s_nop 0
 v_add_f32 v240, v242, v240
 v_add_f32 v240, v243, v240
 v_cvt_pk_bf16_f32 v129, v242, v243
 v_exp_f32 v242, v68
 v_exp_f32 v243, v69
 s_nop 0
 v_add_f32 v240, v242, v240
 v_add_f32 v240, v243, v240
 v_cvt_pk_bf16_f32 v130, v242, v243
 v_exp_f32 v242, v70
 v_exp_f32 v243, v71
 s_nop 0
 v_add_f32 v240, v242, v240
 v_add_f32 v240, v243, v240
 v_cvt_pk_bf16_f32 v131, v242, v243
 v_exp_f32 v242, v72
 v_exp_f32 v243, v73
 s_nop 0
 v_add_f32 v240, v242, v240
 v_add_f32 v240, v243, v240
 v_cvt_pk_bf16_f32 v132, v242, v243
 v_exp_f32 v242, v74
 v_exp_f32 v243, v75
 s_nop 0
 v_add_f32 v240, v242, v240
 v_add_f32 v240, v243, v240
 v_cvt_pk_bf16_f32 v133, v242, v243
 v_exp_f32 v242, v76
 v_exp_f32 v243, v77
 s_nop 0
 v_add_f32 v240, v242, v240
 v_add_f32 v240, v243, v240
 v_cvt_pk_bf16_f32 v134, v242, v243
 v_exp_f32 v242, v78
 v_exp_f32 v243, v79
 s_nop 0
 v_add_f32 v240, v242, v240
 v_add_f32 v240, v243, v240
 v_cvt_pk_bf16_f32 v135, v242, v243
 v_max3_f32 v250, v80, v81, v82
 v_max3_f32 v250, v250, v83, v84
 v_max3_f32 v250, v250, v85, v86
 v_max3_f32 v250, v250, v87, v88
 v_max3_f32 v250, v250, v89, v90
 v_max3_f32 v250, v250, v91, v92
 v_max3_f32 v250, v250, v93, v94
 v_max_f32 v250, v95, v250
 v_mov_b32 v251, v250
 s_nop 1
 v_permlane32_swap_b32 v250, v251
 v_max3_f32 v250, v250, v251, 0
 v_sub_f32 v252, 0, v250
 v_exp_f32 v252, v252
 v_sub_f32 v80, v80, v250
 v_sub_f32 v112, v112, v250
 v_sub_f32 v176, v176, v250
 v_sub_f32 v81, v81, v250
 v_sub_f32 v113, v113, v250
 v_sub_f32 v177, v177, v250
 v_sub_f32 v82, v82, v250
 v_sub_f32 v114, v114, v250
 v_sub_f32 v178, v178, v250
 v_sub_f32 v83, v83, v250
 v_sub_f32 v115, v115, v250
 v_sub_f32 v179, v179, v250
 v_sub_f32 v84, v84, v250
 v_sub_f32 v116, v116, v250
 v_sub_f32 v180, v180, v250
 v_sub_f32 v85, v85, v250
 v_sub_f32 v117, v117, v250
 v_sub_f32 v181, v181, v250
 v_sub_f32 v86, v86, v250
 v_sub_f32 v118, v118, v250
 v_sub_f32 v182, v182, v250
 v_sub_f32 v87, v87, v250
 v_sub_f32 v119, v119, v250
 v_sub_f32 v183, v183, v250
 v_sub_f32 v88, v88, v250
 v_sub_f32 v120, v120, v250
 v_sub_f32 v184, v184, v250
 v_sub_f32 v89, v89, v250
 v_sub_f32 v121, v121, v250
 v_sub_f32 v185, v185, v250
 v_sub_f32 v90, v90, v250
 v_sub_f32 v122, v122, v250
 v_sub_f32 v186, v186, v250
 v_sub_f32 v91, v91, v250
 v_sub_f32 v123, v123, v250
 v_sub_f32 v187, v187, v250
 v_sub_f32 v92, v92, v250
 v_sub_f32 v124, v124, v250
 v_sub_f32 v188, v188, v250
 v_sub_f32 v93, v93, v250
 v_sub_f32 v125, v125, v250
 v_sub_f32 v189, v189, v250
 v_sub_f32 v94, v94, v250
 v_sub_f32 v126, v126, v250
 v_sub_f32 v190, v190, v250
 v_sub_f32 v95, v95, v250
 v_sub_f32 v127, v127, v250
 v_sub_f32 v191, v191, v250
 v_mul_f32 v217, v252, v217
 v_accvgpr_read_b32 v242, a80
 v_accvgpr_read_b32 v243, a81
 v_accvgpr_read_b32 v244, a82
 v_accvgpr_read_b32 v245, a83
 v_mul_f32 v242, v252, v242
 v_mul_f32 v243, v252, v243
 v_mul_f32 v244, v252, v244
 v_mul_f32 v245, v252, v245
 v_accvgpr_write_b32 a80, v242
 v_accvgpr_write_b32 a81, v243
 v_accvgpr_write_b32 a82, v244
 v_accvgpr_write_b32 a83, v245
 v_accvgpr_read_b32 v242, a84
 v_accvgpr_read_b32 v243, a85
 v_accvgpr_read_b32 v244, a86
 v_accvgpr_read_b32 v245, a87
 v_mul_f32 v242, v252, v242
 v_mul_f32 v243, v252, v243
 v_mul_f32 v244, v252, v244
 v_mul_f32 v245, v252, v245
 v_accvgpr_write_b32 a84, v242
 v_accvgpr_write_b32 a85, v243
 v_accvgpr_write_b32 a86, v244
 v_accvgpr_write_b32 a87, v245
 v_accvgpr_read_b32 v242, a88
 v_accvgpr_read_b32 v243, a89
 v_accvgpr_read_b32 v244, a90
 v_accvgpr_read_b32 v245, a91
 v_mul_f32 v242, v252, v242
 v_mul_f32 v243, v252, v243
 v_mul_f32 v244, v252, v244
 v_mul_f32 v245, v252, v245
 v_accvgpr_write_b32 a88, v242
 v_accvgpr_write_b32 a89, v243
 v_accvgpr_write_b32 a90, v244
 v_accvgpr_write_b32 a91, v245
 v_accvgpr_read_b32 v242, a92
 v_accvgpr_read_b32 v243, a93
 v_accvgpr_read_b32 v244, a94
 v_accvgpr_read_b32 v245, a95
 v_mul_f32 v242, v252, v242
 v_mul_f32 v243, v252, v243
 v_mul_f32 v244, v252, v244
 v_mul_f32 v245, v252, v245
 v_accvgpr_write_b32 a92, v242
 v_accvgpr_write_b32 a93, v243
 v_accvgpr_write_b32 a94, v244
 v_accvgpr_write_b32 a95, v245
 v_accvgpr_read_b32 v242, a112
 v_accvgpr_read_b32 v243, a113
 v_accvgpr_read_b32 v244, a114
 v_accvgpr_read_b32 v245, a115
 v_mul_f32 v242, v252, v242
 v_mul_f32 v243, v252, v243
 v_mul_f32 v244, v252, v244
 v_mul_f32 v245, v252, v245
 v_accvgpr_write_b32 a112, v242
 v_accvgpr_write_b32 a113, v243
 v_accvgpr_write_b32 a114, v244
 v_accvgpr_write_b32 a115, v245
 v_accvgpr_read_b32 v242, a116
 v_accvgpr_read_b32 v243, a117
 v_accvgpr_read_b32 v244, a118
 v_accvgpr_read_b32 v245, a119
 v_mul_f32 v242, v252, v242
 v_mul_f32 v243, v252, v243
 v_mul_f32 v244, v252, v244
 v_mul_f32 v245, v252, v245
 v_accvgpr_write_b32 a116, v242
 v_accvgpr_write_b32 a117, v243
 v_accvgpr_write_b32 a118, v244
 v_accvgpr_write_b32 a119, v245
 v_accvgpr_read_b32 v242, a120
 v_accvgpr_read_b32 v243, a121
 v_accvgpr_read_b32 v244, a122
 v_accvgpr_read_b32 v245, a123
 v_mul_f32 v242, v252, v242
 v_mul_f32 v243, v252, v243
 v_mul_f32 v244, v252, v244
 v_mul_f32 v245, v252, v245
 v_accvgpr_write_b32 a120, v242
 v_accvgpr_write_b32 a121, v243
 v_accvgpr_write_b32 a122, v244
 v_accvgpr_write_b32 a123, v245
 v_accvgpr_read_b32 v242, a124
 v_accvgpr_read_b32 v243, a125
 v_accvgpr_read_b32 v244, a126
 v_accvgpr_read_b32 v245, a127
 v_mul_f32 v242, v252, v242
 v_mul_f32 v243, v252, v243
 v_mul_f32 v244, v252, v244
 v_mul_f32 v245, v252, v245
 v_accvgpr_write_b32 a124, v242
 v_accvgpr_write_b32 a125, v243
 v_accvgpr_write_b32 a126, v244
 v_accvgpr_write_b32 a127, v245
 v_mul_f32 v16, v252, v16
 v_mul_f32 v17, v252, v17
 v_mul_f32 v18, v252, v18
 v_mul_f32 v19, v252, v19
 v_mul_f32 v20, v252, v20
 v_mul_f32 v21, v252, v21
 v_mul_f32 v22, v252, v22
 v_mul_f32 v23, v252, v23
 v_mul_f32 v24, v252, v24
 v_mul_f32 v25, v252, v25
 v_mul_f32 v26, v252, v26
 v_mul_f32 v27, v252, v27
 v_mul_f32 v28, v252, v28
 v_mul_f32 v29, v252, v29
 v_mul_f32 v30, v252, v30
 v_mul_f32 v31, v252, v31
 v_mul_f32 v48, v252, v48
 v_mul_f32 v49, v252, v49
 v_mul_f32 v50, v252, v50
 v_mul_f32 v51, v252, v51
 v_mul_f32 v52, v252, v52
 v_mul_f32 v53, v252, v53
 v_mul_f32 v54, v252, v54
 v_mul_f32 v55, v252, v55
 v_mul_f32 v56, v252, v56
 v_mul_f32 v57, v252, v57
 v_mul_f32 v58, v252, v58
 v_mul_f32 v59, v252, v59
 v_mul_f32 v60, v252, v60
 v_mul_f32 v61, v252, v61
 v_mul_f32 v62, v252, v62
 v_mul_f32 v63, v252, v63
 v_exp_f32 v242, v80
 v_exp_f32 v243, v81
 s_nop 0
 v_add_f32 v241, v242, v243
 v_cvt_pk_bf16_f32 v136, v242, v243
 v_exp_f32 v242, v82
 v_exp_f32 v243, v83
 s_nop 0
 v_add_f32 v241, v242, v241
 v_add_f32 v241, v243, v241
 v_cvt_pk_bf16_f32 v137, v242, v243
 v_exp_f32 v242, v84
 v_exp_f32 v243, v85
 s_nop 0
 v_add_f32 v241, v242, v241
 v_add_f32 v241, v243, v241
 v_cvt_pk_bf16_f32 v138, v242, v243
 v_exp_f32 v242, v86
 v_exp_f32 v243, v87
 s_nop 0
 v_add_f32 v241, v242, v241
 v_add_f32 v241, v243, v241
 v_cvt_pk_bf16_f32 v139, v242, v243
 v_exp_f32 v242, v88
 v_exp_f32 v243, v89
 s_nop 0
 v_add_f32 v241, v242, v241
 v_add_f32 v241, v243, v241
 v_cvt_pk_bf16_f32 v140, v242, v243
 v_exp_f32 v242, v90
 v_exp_f32 v243, v91
 s_nop 0
 v_add_f32 v241, v242, v241
 v_add_f32 v241, v243, v241
 v_cvt_pk_bf16_f32 v141, v242, v243
 v_exp_f32 v242, v92
 v_exp_f32 v243, v93
 s_nop 0
 v_add_f32 v241, v242, v241
 v_add_f32 v241, v243, v241
 v_cvt_pk_bf16_f32 v142, v242, v243
 v_exp_f32 v242, v94
 v_exp_f32 v243, v95
 s_nop 0
 v_add_f32 v241, v242, v241
 v_add_f32 v241, v243, v241
 v_cvt_pk_bf16_f32 v143, v242, v243
 s_nop 3
 s_setpc_b64 s[40:41]
RARE3:
 s_nop 15
 s_nop 7
 v_max3_f32 v250, v96, v97, v98
 v_max3_f32 v250, v250, v99, v100
 v_max3_f32 v250, v250, v101, v102
 v_max3_f32 v250, v250, v103, v104
 v_max3_f32 v250, v250, v105, v106
 v_max3_f32 v250, v250, v107, v108
 v_max3_f32 v250, v250, v109, v110
 v_max_f32 v250, v111, v250
 v_mov_b32 v251, v250
 s_nop 1
 v_permlane32_swap_b32 v250, v251
 v_max3_f32 v250, v250, v251, 0
 v_sub_f32 v252, 0, v250
 v_exp_f32 v252, v252
 v_sub_f32 v96, v96, v250
 v_sub_f32 v64, v64, v250
 v_sub_f32 v160, v160, v250
 v_sub_f32 v97, v97, v250
 v_sub_f32 v65, v65, v250
 v_sub_f32 v161, v161, v250
 v_sub_f32 v98, v98, v250
 v_sub_f32 v66, v66, v250
 v_sub_f32 v162, v162, v250
 v_sub_f32 v99, v99, v250
 v_sub_f32 v67, v67, v250
 v_sub_f32 v163, v163, v250
 v_sub_f32 v100, v100, v250
 v_sub_f32 v68, v68, v250
 v_sub_f32 v164, v164, v250
 v_sub_f32 v101, v101, v250
 v_sub_f32 v69, v69, v250
 v_sub_f32 v165, v165, v250
 v_sub_f32 v102, v102, v250
 v_sub_f32 v70, v70, v250
 v_sub_f32 v166, v166, v250
 v_sub_f32 v103, v103, v250
 v_sub_f32 v71, v71, v250
 v_sub_f32 v167, v167, v250
 v_sub_f32 v104, v104, v250
 v_sub_f32 v72, v72, v250
 v_sub_f32 v168, v168, v250
 v_sub_f32 v105, v105, v250
 v_sub_f32 v73, v73, v250
 v_sub_f32 v169, v169, v250
 v_sub_f32 v106, v106, v250
 v_sub_f32 v74, v74, v250
 v_sub_f32 v170, v170, v250
 v_sub_f32 v107, v107, v250
 v_sub_f32 v75, v75, v250
 v_sub_f32 v171, v171, v250
 v_sub_f32 v108, v108, v250
 v_sub_f32 v76, v76, v250
 v_sub_f32 v172, v172, v250
 v_sub_f32 v109, v109, v250
 v_sub_f32 v77, v77, v250
 v_sub_f32 v173, v173, v250
 v_sub_f32 v110, v110, v250
 v_sub_f32 v78, v78, v250
 v_sub_f32 v174, v174, v250
 v_sub_f32 v111, v111, v250
 v_sub_f32 v79, v79, v250
 v_sub_f32 v175, v175, v250
 v_mul_f32 v216, v252, v216
 v_accvgpr_read_b32 v242, a64
 v_accvgpr_read_b32 v243, a65
 v_accvgpr_read_b32 v244, a66
 v_accvgpr_read_b32 v245, a67
 v_mul_f32 v242, v252, v242
 v_mul_f32 v243, v252, v243
 v_mul_f32 v244, v252, v244
 v_mul_f32 v245, v252, v245
 v_accvgpr_write_b32 a64, v242
 v_accvgpr_write_b32 a65, v243
 v_accvgpr_write_b32 a66, v244
 v_accvgpr_write_b32 a67, v245
 v_accvgpr_read_b32 v242, a68
 v_accvgpr_read_b32 v243, a69
 v_accvgpr_read_b32 v244, a70
 v_accvgpr_read_b32 v245, a71
 v_mul_f32 v242, v252, v242
 v_mul_f32 v243, v252, v243
 v_mul_f32 v244, v252, v244
 v_mul_f32 v245, v252, v245
 v_accvgpr_write_b32 a68, v242
 v_accvgpr_write_b32 a69, v243
 v_accvgpr_write_b32 a70, v244
 v_accvgpr_write_b32 a71, v245
 v_accvgpr_read_b32 v242, a72
 v_accvgpr_read_b32 v243, a73
 v_accvgpr_read_b32 v244, a74
 v_accvgpr_read_b32 v245, a75
 v_mul_f32 v242, v252, v242
 v_mul_f32 v243, v252, v243
 v_mul_f32 v244, v252, v244
 v_mul_f32 v245, v252, v245
 v_accvgpr_write_b32 a72, v242
 v_accvgpr_write_b32 a73, v243
 v_accvgpr_write_b32 a74, v244
 v_accvgpr_write_b32 a75, v245
 v_accvgpr_read_b32 v242, a76
 v_accvgpr_read_b32 v243, a77
 v_accvgpr_read_b32 v244, a78
 v_accvgpr_read_b32 v245, a79
 v_mul_f32 v242, v252, v242
 v_mul_f32 v243, v252, v243
 v_mul_f32 v244, v252, v244
 v_mul_f32 v245, v252, v245
 v_accvgpr_write_b32 a76, v242
 v_accvgpr_write_b32 a77, v243
 v_accvgpr_write_b32 a78, v244
 v_accvgpr_write_b32 a79, v245
 v_accvgpr_read_b32 v242, a96
 v_accvgpr_read_b32 v243, a97
 v_accvgpr_read_b32 v244, a98
 v_accvgpr_read_b32 v245, a99
 v_mul_f32 v242, v252, v242
 v_mul_f32 v243, v252, v243
 v_mul_f32 v244, v252, v244
 v_mul_f32 v245, v252, v245
 v_accvgpr_write_b32 a96, v242
 v_accvgpr_write_b32 a97, v243
 v_accvgpr_write_b32 a98, v244
 v_accvgpr_write_b32 a99, v245
 v_accvgpr_read_b32 v242, a100
 v_accvgpr_read_b32 v243, a101
 v_accvgpr_read_b32 v244, a102
 v_accvgpr_read_b32 v245, a103
 v_mul_f32 v242, v252, v242
 v_mul_f32 v243, v252, v243
 v_mul_f32 v244, v252, v244
 v_mul_f32 v245, v252, v245
 v_accvgpr_write_b32 a100, v242
 v_accvgpr_write_b32 a101, v243
 v_accvgpr_write_b32 a102, v244
 v_accvgpr_write_b32 a103, v245
 v_accvgpr_read_b32 v242, a104
 v_accvgpr_read_b32 v243, a105
 v_accvgpr_read_b32 v244, a106
 v_accvgpr_read_b32 v245, a107
 v_mul_f32 v242, v252, v242
 v_mul_f32 v243, v252, v243
 v_mul_f32 v244, v252, v244
 v_mul_f32 v245, v252, v245
 v_accvgpr_write_b32 a104, v242
 v_accvgpr_write_b32 a105, v243
 v_accvgpr_write_b32 a106, v244
 v_accvgpr_write_b32 a107, v245
 v_accvgpr_read_b32 v242, a108
 v_accvgpr_read_b32 v243, a109
 v_accvgpr_read_b32 v244, a110
 v_accvgpr_read_b32 v245, a111
 v_mul_f32 v242, v252, v242
 v_mul_f32 v243, v252, v243
 v_mul_f32 v244, v252, v244
 v_mul_f32 v245, v252, v245
 v_accvgpr_write_b32 a108, v242
 v_accvgpr_write_b32 a109, v243
 v_accvgpr_write_b32 a110, v244
 v_accvgpr_write_b32 a111, v245
 v_mul_f32 v0, v252, v0
 v_mul_f32 v1, v252, v1
 v_mul_f32 v2, v252, v2
 v_mul_f32 v3, v252, v3
 v_mul_f32 v4, v252, v4
 v_mul_f32 v5, v252, v5
 v_mul_f32 v6, v252, v6
 v_mul_f32 v7, v252, v7
 v_mul_f32 v8, v252, v8
 v_mul_f32 v9, v252, v9
 v_mul_f32 v10, v252, v10
 v_mul_f32 v11, v252, v11
 v_mul_f32 v12, v252, v12
 v_mul_f32 v13, v252, v13
 v_mul_f32 v14, v252, v14
 v_mul_f32 v15, v252, v15
 v_mul_f32 v32, v252, v32
 v_mul_f32 v33, v252, v33
 v_mul_f32 v34, v252, v34
 v_mul_f32 v35, v252, v35
 v_mul_f32 v36, v252, v36
 v_mul_f32 v37, v252, v37
 v_mul_f32 v38, v252, v38
 v_mul_f32 v39, v252, v39
 v_mul_f32 v40, v252, v40
 v_mul_f32 v41, v252, v41
 v_mul_f32 v42, v252, v42
 v_mul_f32 v43, v252, v43
 v_mul_f32 v44, v252, v44
 v_mul_f32 v45, v252, v45
 v_mul_f32 v46, v252, v46
 v_mul_f32 v47, v252, v47
 v_exp_f32 v242, v96
 v_exp_f32 v243, v97
 s_nop 0
 v_add_f32 v240, v242, v243
 v_cvt_pk_bf16_f32 v144, v242, v243
 v_exp_f32 v242, v98
 v_exp_f32 v243, v99
 s_nop 0
 v_add_f32 v240, v242, v240
 v_add_f32 v240, v243, v240
 v_cvt_pk_bf16_f32 v145, v242, v243
 v_exp_f32 v242, v100
 v_exp_f32 v243, v101
 s_nop 0
 v_add_f32 v240, v242, v240
 v_add_f32 v240, v243, v240
 v_cvt_pk_bf16_f32 v146, v242, v243
 v_exp_f32 v242, v102
 v_exp_f32 v243, v103
 s_nop 0
 v_add_f32 v240, v242, v240
 v_add_f32 v240, v243, v240
 v_cvt_pk_bf16_f32 v147, v242, v243
 v_exp_f32 v242, v104
 v_exp_f32 v243, v105
 s_nop 0
 v_add_f32 v240, v242, v240
 v_add_f32 v240, v243, v240
 v_cvt_pk_bf16_f32 v148, v242, v243
 v_exp_f32 v242, v106
 v_exp_f32 v243, v107
 s_nop 0
 v_add_f32 v240, v242, v240
 v_add_f32 v240, v243, v240
 v_cvt_pk_bf16_f32 v149, v242, v243
 v_exp_f32 v242, v108
 v_exp_f32 v243, v109
 s_nop 0
 v_add_f32 v240, v242, v240
 v_add_f32 v240, v243, v240
 v_cvt_pk_bf16_f32 v150, v242, v243
 v_exp_f32 v242, v110
 v_exp_f32 v243, v111
 s_nop 0
 v_add_f32 v240, v242, v240
 v_add_f32 v240, v243, v240
 v_cvt_pk_bf16_f32 v151, v242, v243
 v_max3_f32 v250, v112, v113, v114
 v_max3_f32 v250, v250, v115, v116
 v_max3_f32 v250, v250, v117, v118
 v_max3_f32 v250, v250, v119, v120
 v_max3_f32 v250, v250, v121, v122
 v_max3_f32 v250, v250, v123, v124
 v_max3_f32 v250, v250, v125, v126
 v_max_f32 v250, v127, v250
 v_mov_b32 v251, v250
 s_nop 1
 v_permlane32_swap_b32 v250, v251
 v_max3_f32 v250, v250, v251, 0
 v_sub_f32 v252, 0, v250
 v_exp_f32 v252, v252
 v_sub_f32 v112, v112, v250
 v_sub_f32 v80, v80, v250
 v_sub_f32 v176, v176, v250
 v_sub_f32 v113, v113, v250
 v_sub_f32 v81, v81, v250
 v_sub_f32 v177, v177, v250
 v_sub_f32 v114, v114, v250
 v_sub_f32 v82, v82, v250
 v_sub_f32 v178, v178, v250
 v_sub_f32 v115, v115, v250
 v_sub_f32 v83, v83, v250
 v_sub_f32 v179, v179, v250
 v_sub_f32 v116, v116, v250
 v_sub_f32 v84, v84, v250
 v_sub_f32 v180, v180, v250
 v_sub_f32 v117, v117, v250
 v_sub_f32 v85, v85, v250
 v_sub_f32 v181, v181, v250
 v_sub_f32 v118, v118, v250
 v_sub_f32 v86, v86, v250
 v_sub_f32 v182, v182, v250
 v_sub_f32 v119, v119, v250
 v_sub_f32 v87, v87, v250
 v_sub_f32 v183, v183, v250
 v_sub_f32 v120, v120, v250
 v_sub_f32 v88, v88, v250
 v_sub_f32 v184, v184, v250
 v_sub_f32 v121, v121, v250
 v_sub_f32 v89, v89, v250
 v_sub_f32 v185, v185, v250
 v_sub_f32 v122, v122, v250
 v_sub_f32 v90, v90, v250
 v_sub_f32 v186, v186, v250
 v_sub_f32 v123, v123, v250
 v_sub_f32 v91, v91, v250
 v_sub_f32 v187, v187, v250
 v_sub_f32 v124, v124, v250
 v_sub_f32 v92, v92, v250
 v_sub_f32 v188, v188, v250
 v_sub_f32 v125, v125, v250
 v_sub_f32 v93, v93, v250
 v_sub_f32 v189, v189, v250
 v_sub_f32 v126, v126, v250
 v_sub_f32 v94, v94, v250
 v_sub_f32 v190, v190, v250
 v_sub_f32 v127, v127, v250
 v_sub_f32 v95, v95, v250
 v_sub_f32 v191, v191, v250
 v_mul_f32 v217, v252, v217
 v_accvgpr_read_b32 v242, a80
 v_accvgpr_read_b32 v243, a81
 v_accvgpr_read_b32 v244, a82
 v_accvgpr_read_b32 v245, a83
 v_mul_f32 v242, v252, v242
 v_mul_f32 v243, v252, v243
 v_mul_f32 v244, v252, v244
 v_mul_f32 v245, v252, v245
 v_accvgpr_write_b32 a80, v242
 v_accvgpr_write_b32 a81, v243
 v_accvgpr_write_b32 a82, v244
 v_accvgpr_write_b32 a83, v245
 v_accvgpr_read_b32 v242, a84
 v_accvgpr_read_b32 v243, a85
 v_accvgpr_read_b32 v244, a86
 v_accvgpr_read_b32 v245, a87
 v_mul_f32 v242, v252, v242
 v_mul_f32 v243, v252, v243
 v_mul_f32 v244, v252, v244
 v_mul_f32 v245, v252, v245
 v_accvgpr_write_b32 a84, v242
 v_accvgpr_write_b32 a85, v243
 v_accvgpr_write_b32 a86, v244
 v_accvgpr_write_b32 a87, v245
 v_accvgpr_read_b32 v242, a88
 v_accvgpr_read_b32 v243, a89
 v_accvgpr_read_b32 v244, a90
 v_accvgpr_read_b32 v245, a91
 v_mul_f32 v242, v252, v242
 v_mul_f32 v243, v252, v243
 v_mul_f32 v244, v252, v244
 v_mul_f32 v245, v252, v245
 v_accvgpr_write_b32 a88, v242
 v_accvgpr_write_b32 a89, v243
 v_accvgpr_write_b32 a90, v244
 v_accvgpr_write_b32 a91, v245
 v_accvgpr_read_b32 v242, a92
 v_accvgpr_read_b32 v243, a93
 v_accvgpr_read_b32 v244, a94
 v_accvgpr_read_b32 v245, a95
 v_mul_f32 v242, v252, v242
 v_mul_f32 v243, v252, v243
 v_mul_f32 v244, v252, v244
 v_mul_f32 v245, v252, v245
 v_accvgpr_write_b32 a92, v242
 v_accvgpr_write_b32 a93, v243
 v_accvgpr_write_b32 a94, v244
 v_accvgpr_write_b32 a95, v245
 v_accvgpr_read_b32 v242, a112
 v_accvgpr_read_b32 v243, a113
 v_accvgpr_read_b32 v244, a114
 v_accvgpr_read_b32 v245, a115
 v_mul_f32 v242, v252, v242
 v_mul_f32 v243, v252, v243
 v_mul_f32 v244, v252, v244
 v_mul_f32 v245, v252, v245
 v_accvgpr_write_b32 a112, v242
 v_accvgpr_write_b32 a113, v243
 v_accvgpr_write_b32 a114, v244
 v_accvgpr_write_b32 a115, v245
 v_accvgpr_read_b32 v242, a116
 v_accvgpr_read_b32 v243, a117
 v_accvgpr_read_b32 v244, a118
 v_accvgpr_read_b32 v245, a119
 v_mul_f32 v242, v252, v242
 v_mul_f32 v243, v252, v243
 v_mul_f32 v244, v252, v244
 v_mul_f32 v245, v252, v245
 v_accvgpr_write_b32 a116, v242
 v_accvgpr_write_b32 a117, v243
 v_accvgpr_write_b32 a118, v244
 v_accvgpr_write_b32 a119, v245
 v_accvgpr_read_b32 v242, a120
 v_accvgpr_read_b32 v243, a121
 v_accvgpr_read_b32 v244, a122
 v_accvgpr_read_b32 v245, a123
 v_mul_f32 v242, v252, v242
 v_mul_f32 v243, v252, v243
 v_mul_f32 v244, v252, v244
 v_mul_f32 v245, v252, v245
 v_accvgpr_write_b32 a120, v242
 v_accvgpr_write_b32 a121, v243
 v_accvgpr_write_b32 a122, v244
 v_accvgpr_write_b32 a123, v245
 v_accvgpr_read_b32 v242, a124
 v_accvgpr_read_b32 v243, a125
 v_accvgpr_read_b32 v244, a126
 v_accvgpr_read_b32 v245, a127
 v_mul_f32 v242, v252, v242
 v_mul_f32 v243, v252, v243
 v_mul_f32 v244, v252, v244
 v_mul_f32 v245, v252, v245
 v_accvgpr_write_b32 a124, v242
 v_accvgpr_write_b32 a125, v243
 v_accvgpr_write_b32 a126, v244
 v_accvgpr_write_b32 a127, v245
 v_mul_f32 v16, v252, v16
 v_mul_f32 v17, v252, v17
 v_mul_f32 v18, v252, v18
 v_mul_f32 v19, v252, v19
 v_mul_f32 v20, v252, v20
 v_mul_f32 v21, v252, v21
 v_mul_f32 v22, v252, v22
 v_mul_f32 v23, v252, v23
 v_mul_f32 v24, v252, v24
 v_mul_f32 v25, v252, v25
 v_mul_f32 v26, v252, v26
 v_mul_f32 v27, v252, v27
 v_mul_f32 v28, v252, v28
 v_mul_f32 v29, v252, v29
 v_mul_f32 v30, v252, v30
 v_mul_f32 v31, v252, v31
 v_mul_f32 v48, v252, v48
 v_mul_f32 v49, v252, v49
 v_mul_f32 v50, v252, v50
 v_mul_f32 v51, v252, v51
 v_mul_f32 v52, v252, v52
 v_mul_f32 v53, v252, v53
 v_mul_f32 v54, v252, v54
 v_mul_f32 v55, v252, v55
 v_mul_f32 v56, v252, v56
 v_mul_f32 v57, v252, v57
 v_mul_f32 v58, v252, v58
 v_mul_f32 v59, v252, v59
 v_mul_f32 v60, v252, v60
 v_mul_f32 v61, v252, v61
 v_mul_f32 v62, v252, v62
 v_mul_f32 v63, v252, v63
 v_exp_f32 v242, v112
 v_exp_f32 v243, v113
 s_nop 0
 v_add_f32 v241, v242, v243
 v_cvt_pk_bf16_f32 v152, v242, v243
 v_exp_f32 v242, v114
 v_exp_f32 v243, v115
 s_nop 0
 v_add_f32 v241, v242, v241
 v_add_f32 v241, v243, v241
 v_cvt_pk_bf16_f32 v153, v242, v243
 v_exp_f32 v242, v116
 v_exp_f32 v243, v117
 s_nop 0
 v_add_f32 v241, v242, v241
 v_add_f32 v241, v243, v241
 v_cvt_pk_bf16_f32 v154, v242, v243
 v_exp_f32 v242, v118
 v_exp_f32 v243, v119
 s_nop 0
 v_add_f32 v241, v242, v241
 v_add_f32 v241, v243, v241
 v_cvt_pk_bf16_f32 v155, v242, v243
 v_exp_f32 v242, v120
 v_exp_f32 v243, v121
 s_nop 0
 v_add_f32 v241, v242, v241
 v_add_f32 v241, v243, v241
 v_cvt_pk_bf16_f32 v156, v242, v243
 v_exp_f32 v242, v122
 v_exp_f32 v243, v123
 s_nop 0
 v_add_f32 v241, v242, v241
 v_add_f32 v241, v243, v241
 v_cvt_pk_bf16_f32 v157, v242, v243
 v_exp_f32 v242, v124
 v_exp_f32 v243, v125
 s_nop 0
 v_add_f32 v241, v242, v241
 v_add_f32 v241, v243, v241
 v_cvt_pk_bf16_f32 v158, v242, v243
 v_exp_f32 v242, v126
 v_exp_f32 v243, v127
 s_nop 0
 v_add_f32 v241, v242, v241
 v_add_f32 v241, v243, v241
 v_cvt_pk_bf16_f32 v159, v242, v243
 s_nop 3
 s_setpc_b64 s[40:41]
.globl oproj_kernel
.p2align 8
.type oproj_kernel,@function
oproj_kernel:
 s_cmp_ge_u32 s2, 256
 s_cbranch_scc1 P_END
 s_load_dwordx2 s[66:67], s[0:1], 40
 s_load_dwordx2 s[70:71], s[0:1], 56
 s_and_b32 s5, s2, 7
 s_lshr_b32 s6, s2, 3
 s_and_b32 s4, s6, 1
 s_bfe_u32 s7, s6, 0x20001
 s_lshr_b32 s6, s6, 3
 s_lshl_b32 s5, s5, 2
 s_add_u32 s5, s5, s6
 s_lshr_b32 s3, s5, 1
 s_and_b32 s6, s5, 1
 v_and_b32 v112, 63, v0
 v_lshrrev_b32 v113, 6, v0
 s_lshl_b32 s57, s6, 2
 v_readfirstlane_b32 s56, v113
 v_add_u32 v115, s57, v113
 v_lshlrev_b32 v115, 10, v115
 v_lshl_add_u32 v100, v112, 4, v115
 v_lshlrev_b32 v115, 11, v113
 v_lshl_add_u32 v101, v112, 4, v115
 s_lshl_b32 s28, s56, 11
 s_lshl_b32 s57, s7, 20
 s_lshl_b32 s58, s4, 18
 s_add_u32 s57, s57, s58
 s_lshl_b32 s58, s4, 19
 s_add_u32 s41, s57, s58
 s_xor_b32 s40, s41, 0x80000
 s_mov_b32 s10, 1048576
 s_mov_b32 s11, 0x20000
 s_mov_b32 s14, 4194304
 s_mov_b32 s15, 0x20000
 s_lshl_b32 s57, s3, 21
 s_lshl_b32 s58, s4, 20
 s_add_u32 s57, s57, s58
 s_waitcnt lgkmcnt(0)
 s_add_u32 s8, s70, s57
 s_addc_u32 s9, s71, 0
 s_add_u32 s12, s70, 0x4000000
 s_addc_u32 s13, s71, 0
.p2align 3
 s_add_u32 m0, s28, 0
 s_add_u32 s32, s40, 0
 buffer_load_dwordx4 v101, s[12:15], s32 offen lds
 buffer_load_dwordx4 v101, s[12:15], s32 offen offset:1024 lds
 s_add_u32 m0, s28, 8192
 s_add_u32 s33, s41, 0
 buffer_load_dwordx4 v101, s[12:15], s33 offen lds
 buffer_load_dwordx4 v101, s[12:15], s33 offen offset:1024 lds
 s_add_u32 m0, s28, 16384
 s_add_u32 s34, s40, 8192
 s_lshl_b32 s59, s5, 2
 s_add_u32 s59, s59, s7
 s_lshl_b32 s59, s59, 1
 s_add_u32 s59, s59, s4
 s_xor_b32 s58, s59, 1
 s_lshl_b32 s43, s59, 14
 s_lshl_b32 s42, s58, 14
 s_lshl_b32 s45, s59, 9
 s_lshl_b32 s44, s58, 9
 s_add_u32 s20, s70, 0x5000000
 s_addc_u32 s21, s71, 0
 s_mov_b32 s22, 4194304
 s_mov_b32 s23, 0x20000
 s_add_u32 s24, s70, 0x6000000
 s_addc_u32 s25, s71, 0
 s_mov_b32 s26, 131072
 s_mov_b32 s27, 0x20000
 s_mul_i32 s57, s3, 245760
 s_lshl_b32 s58, s7, 8
 s_lshl_b32 s62, s4, 7
 s_add_u32 s58, s58, s62
 s_add_u32 s57, s57, s58
 s_add_u32 s16, s66, s57
 s_addc_u32 s17, s67, 0
 s_sub_u32 s18, 245760, s58
 s_mov_b32 s19, 0x20000
 v_lshrrev_b32 v114, 5, v112
 v_bfe_u32 v115, v112, 2, 2
 v_lshl_add_u32 v116, v114, 2, v115
 v_lshlrev_b32 v116, 7, v116
 v_lshrrev_b32 v117, 1, v115
 v_lshl_add_u32 v116, v117, 6, v116
 v_bfe_u32 v117, v112, 4, 1
 v_lshl_add_u32 v116, v117, 5, v116
 v_and_b32 v117, 1, v112
 v_lshl_add_u32 v116, v117, 4, v116
 v_bfe_u32 v117, v112, 1, 1
 v_lshl_add_u32 v96, v117, 3, v116
 v_xor_b32 v97, 64, v96
 v_add_u32 v98, 0x10000, v96
 v_add_u32 v99, 0x10000, v97
 v_lshlrev_b32 v116, 12, v113
 v_lshl_add_u32 v103, v112, 4, v116
 v_lshlrev_b32 v104, 7, v113
 v_mov_b32 v105, 1
 s_lshl_b32 s57, s6, 7
 v_lshl_add_u32 v116, v113, 5, s57
 v_and_b32 v117, 31, v112
 v_add_u32 v116, v116, v117
 v_lshlrev_b32 v116, 10, v116
 v_lshl_add_u32 v102, v114, 4, v116
.p2align 3
 s_mov_b32 s36, 0
 buffer_load_dwordx4 a[0:3], v100, s[8:11], s36 offen
 s_mov_b32 s37, 8192
 buffer_load_dwordx4 a[4:7], v100, s[8:11], s37 offen
 s_mov_b32 s36, 16384
 buffer_load_dwordx4 a[8:11], v100, s[8:11], s36 offen
 s_mov_b32 s37, 24576
 buffer_load_dwordx4 a[12:15], v100, s[8:11], s37 offen
 s_mov_b32 s36, 32768
 buffer_load_dwordx4 a[16:19], v100, s[8:11], s36 offen
 s_mov_b32 s37, 40960
 buffer_load_dwordx4 a[20:23], v100, s[8:11], s37 offen
 buffer_load_dwordx4 v101, s[12:15], s34 offen lds
 buffer_load_dwordx4 v101, s[12:15], s34 offen offset:1024 lds
 s_mov_b32 s36, 49152
 buffer_load_dwordx4 a[24:27], v100, s[8:11], s36 offen
 s_mov_b32 s37, 57344
 buffer_load_dwordx4 a[28:31], v100, s[8:11], s37 offen
 s_mov_b32 s36, 65536
 buffer_load_dwordx4 a[32:35], v100, s[8:11], s36 offen
 s_waitcnt vmcnt(11)
 s_barrier
 ds_read_b64_tr_b16 v[64:65], v96 offset:0
 ds_read_b64_tr_b16 v[66:67], v96 offset:1024
 s_waitcnt vmcnt(10) lgkmcnt(0)
 v_mfma_f32_32x32x16_bf16 v[0:15], v[64:67], a[0:3], 0
 ds_read_b64_tr_b16 v[68:69], v97 offset:0
 ds_read_b64_tr_b16 v[70:71], v97 offset:1024
 ds_read_b64_tr_b16 v[72:73], v96 offset:2048
 ds_read_b64_tr_b16 v[74:75], v96 offset:3072
 ds_read_b64_tr_b16 v[76:77], v97 offset:2048
 ds_read_b64_tr_b16 v[78:79], v97 offset:3072
 s_add_u32 m0, s28, 24576
 s_add_u32 s35, s41, 8192
 buffer_load_dwordx4 v101, s[12:15], s35 offen lds
 s_mov_b32 s37, 73728
 s_mov_b32 s36, 81920
 s_waitcnt lgkmcnt(4)
 v_mfma_f32_32x32x16_bf16 v[16:31], v[68:71], a[0:3], 0
 ds_read_b64_tr_b16 v[80:81], v96 offset:4096
 ds_read_b64_tr_b16 v[82:83], v96 offset:5120
 ds_read_b64_tr_b16 v[84:85], v97 offset:4096
 ds_read_b64_tr_b16 v[86:87], v97 offset:5120
 ds_read_b64_tr_b16 v[88:89], v96 offset:6144
 ds_read_b64_tr_b16 v[90:91], v96 offset:7168
 buffer_load_dwordx4 v101, s[12:15], s35 offen offset:1024 lds
 s_add_u32 m0, s28, 32768
 s_add_u32 s32, s40, 16384
 s_waitcnt vmcnt(11) lgkmcnt(8)
 v_mfma_f32_32x32x16_bf16 v[0:15], v[72:75], a[4:7], v[0:15]
 ds_read_b64_tr_b16 v[92:93], v97 offset:6144
 ds_read_b64_tr_b16 v[94:95], v97 offset:7168
 ds_read_b64_tr_b16 v[64:65], v96 offset:8192
 ds_read_b64_tr_b16 v[66:67], v96 offset:9216
 ds_read_b64_tr_b16 v[68:69], v97 offset:8192
 ds_read_b64_tr_b16 v[70:71], v97 offset:9216
 buffer_load_dwordx4 v101, s[12:15], s32 offen lds
 s_waitcnt lgkmcnt(12)
 v_mfma_f32_32x32x16_bf16 v[16:31], v[76:79], a[4:7], v[16:31]
 ds_read_b64_tr_b16 v[72:73], v96 offset:10240
 ds_read_b64_tr_b16 v[74:75], v96 offset:11264
 ds_read_b64_tr_b16 v[76:77], v97 offset:10240
 ds_read_b64_tr_b16 v[78:79], v97 offset:11264
 buffer_load_dwordx4 v101, s[12:15], s32 offen offset:1024 lds
 s_add_u32 m0, s28, 40960
 s_add_u32 s33, s41, 16384
 s_waitcnt vmcnt(12) lgkmcnt(14)
 v_mfma_f32_32x32x16_bf16 v[0:15], v[80:83], a[8:11], v[0:15]
 ds_read_b64_tr_b16 v[80:81], v96 offset:12288
 ds_read_b64_tr_b16 v[82:83], v96 offset:13312
 buffer_load_dwordx4 v101, s[12:15], s33 offen lds
 s_waitcnt lgkmcnt(14)
 v_mfma_f32_32x32x16_bf16 v[16:31], v[84:87], a[8:11], v[16:31]
 ds_read_b64_tr_b16 v[84:85], v97 offset:12288
 ds_read_b64_tr_b16 v[86:87], v97 offset:13312
 buffer_load_dwordx4 v101, s[12:15], s33 offen offset:1024 lds
 s_add_u32 m0, s28, 49152
 s_add_u32 s34, s40, 24576
 s_waitcnt vmcnt(13) lgkmcnt(14)
 v_mfma_f32_32x32x16_bf16 v[0:15], v[88:91], a[12:15], v[0:15]
 ds_read_b64_tr_b16 v[88:89], v96 offset:14336
 ds_read_b64_tr_b16 v[90:91], v96 offset:15360
 buffer_load_dwordx4 v101, s[12:15], s34 offen lds
 s_waitcnt lgkmcnt(13)
 v_mfma_f32_32x32x16_bf16 v[16:31], v[92:95], a[12:15], v[16:31]
 s_waitcnt vmcnt(10)
 s_barrier
 ds_read_b64_tr_b16 v[92:93], v97 offset:14336
 ds_read_b64_tr_b16 v[94:95], v97 offset:15360
 buffer_load_dwordx4 v101, s[12:15], s34 offen offset:1024 lds
 s_add_u32 m0, s28, 57344
 s_add_u32 s35, s41, 24576
 s_waitcnt lgkmcnt(10)
 v_mfma_f32_32x32x16_bf16 v[32:47], v[64:67], a[0:3], 0
 ds_read_b64_tr_b16 v[64:65], v96 offset:16384
 ds_read_b64_tr_b16 v[66:67], v96 offset:17408
 buffer_load_dwordx4 v101, s[12:15], s35 offen lds
 v_mfma_f32_32x32x16_bf16 v[48:63], v[68:71], a[0:3], 0
 ds_read_b64_tr_b16 v[68:69], v97 offset:16384
 ds_read_b64_tr_b16 v[70:71], v97 offset:17408
 buffer_load_dwordx4 v101, s[12:15], s35 offen offset:1024 lds
 s_add_u32 m0, s28, 65536
 s_add_u32 s32, s40, 32768
 v_mfma_f32_32x32x16_bf16 v[32:47], v[72:75], a[4:7], v[32:47]
 ds_read_b64_tr_b16 v[72:73], v96 offset:18432
 ds_read_b64_tr_b16 v[74:75], v96 offset:19456
 buffer_load_dwordx4 v101, s[12:15], s32 offen lds
 s_waitcnt lgkmcnt(10)
 v_mfma_f32_32x32x16_bf16 v[48:63], v[76:79], a[4:7], v[48:63]
 ds_read_b64_tr_b16 v[76:77], v97 offset:18432
 ds_read_b64_tr_b16 v[78:79], v97 offset:19456
 buffer_load_dwordx4 v101, s[12:15], s32 offen offset:1024 lds
 s_add_u32 m0, s28, 73728
 s_add_u32 s33, s41, 32768
 v_mfma_f32_32x32x16_bf16 v[32:47], v[80:83], a[8:11], v[32:47]
 ds_read_b64_tr_b16 v[80:81], v96 offset:20480
 ds_read_b64_tr_b16 v[82:83], v96 offset:21504
 buffer_load_dwordx4 a[36:39], v100, s[8:11], s37 offen
 s_mov_b32 s37, 90112
 v_mfma_f32_32x32x16_bf16 v[48:63], v[84:87], a[8:11], v[48:63]
 ds_read_b64_tr_b16 v[84:85], v97 offset:20480
 ds_read_b64_tr_b16 v[86:87], v97 offset:21504
 buffer_load_dwordx4 a[40:43], v100, s[8:11], s36 offen
 s_mov_b32 s36, 98304
 s_waitcnt lgkmcnt(10)
 v_mfma_f32_32x32x16_bf16 v[32:47], v[88:91], a[12:15], v[32:47]
 ds_read_b64_tr_b16 v[88:89], v96 offset:22528
 ds_read_b64_tr_b16 v[90:91], v96 offset:23552
 buffer_load_dwordx4 a[44:47], v100, s[8:11], s37 offen
 s_mov_b32 s37, 106496
 v_mfma_f32_32x32x16_bf16 v[48:63], v[92:95], a[12:15], v[48:63]
 s_waitcnt vmcnt(13)
 s_barrier
 ds_read_b64_tr_b16 v[92:93], v97 offset:22528
 ds_read_b64_tr_b16 v[94:95], v97 offset:23552
 buffer_load_dwordx4 a[48:51], v100, s[8:11], s36 offen
 s_mov_b32 s36, 114688
 v_mfma_f32_32x32x16_bf16 v[0:15], v[64:67], a[16:19], v[0:15]
 ds_read_b64_tr_b16 v[64:65], v96 offset:24576
 ds_read_b64_tr_b16 v[66:67], v96 offset:25600
 s_waitcnt lgkmcnt(10)
 v_mfma_f32_32x32x16_bf16 v[16:31], v[68:71], a[16:19], v[16:31]
 ds_read_b64_tr_b16 v[68:69], v97 offset:24576
 ds_read_b64_tr_b16 v[70:71], v97 offset:25600
 buffer_load_dwordx4 a[52:55], v100, s[8:11], s37 offen
 s_mov_b32 s37, 122880
 v_mfma_f32_32x32x16_bf16 v[0:15], v[72:75], a[20:23], v[0:15]
 ds_read_b64_tr_b16 v[72:73], v96 offset:26624
 ds_read_b64_tr_b16 v[74:75], v96 offset:27648
 buffer_load_dwordx4 a[56:59], v100, s[8:11], s36 offen
 s_mov_b32 s36, 131072
 s_nop 0
 v_mfma_f32_32x32x16_bf16 v[16:31], v[76:79], a[20:23], v[16:31]
 ds_read_b64_tr_b16 v[76:77], v97 offset:26624
 ds_read_b64_tr_b16 v[78:79], v97 offset:27648
 buffer_load_dwordx4 a[60:63], v100, s[8:11], s37 offen
 s_mov_b32 s37, 139264
 s_waitcnt lgkmcnt(10)
 v_mfma_f32_32x32x16_bf16 v[0:15], v[80:83], a[24:27], v[0:15]
 ds_read_b64_tr_b16 v[80:81], v96 offset:28672
 ds_read_b64_tr_b16 v[82:83], v96 offset:29696
 buffer_load_dwordx4 v101, s[12:15], s33 offen lds
 s_nop 0
 v_mfma_f32_32x32x16_bf16 v[16:31], v[84:87], a[24:27], v[16:31]
 ds_read_b64_tr_b16 v[84:85], v97 offset:28672
 ds_read_b64_tr_b16 v[86:87], v97 offset:29696
 buffer_load_dwordx4 v101, s[12:15], s33 offen offset:1024 lds
 s_add_u32 m0, s28, 81920
 s_add_u32 s34, s40, 40960
 v_mfma_f32_32x32x16_bf16 v[0:15], v[88:91], a[28:31], v[0:15]
 ds_read_b64_tr_b16 v[88:89], v96 offset:30720
 ds_read_b64_tr_b16 v[90:91], v96 offset:31744
 buffer_load_dwordx4 v101, s[12:15], s34 offen lds
 s_waitcnt lgkmcnt(10)
 v_mfma_f32_32x32x16_bf16 v[16:31], v[92:95], a[28:31], v[16:31]
 s_waitcnt vmcnt(18)
 s_barrier
 ds_read_b64_tr_b16 v[92:93], v97 offset:30720
 ds_read_b64_tr_b16 v[94:95], v97 offset:31744
 buffer_load_dwordx4 v101, s[12:15], s34 offen offset:1024 lds
 s_add_u32 m0, s28, 90112
 s_add_u32 s35, s41, 40960
 v_mfma_f32_32x32x16_bf16 v[32:47], v[64:67], a[16:19], v[32:47]
 ds_read_b64_tr_b16 v[64:65], v96 offset:32768
 ds_read_b64_tr_b16 v[66:67], v96 offset:33792
 buffer_load_dwordx4 v101, s[12:15], s35 offen lds
 v_mfma_f32_32x32x16_bf16 v[48:63], v[68:71], a[16:19], v[48:63]
 ds_read_b64_tr_b16 v[68:69], v97 offset:32768
 ds_read_b64_tr_b16 v[70:71], v97 offset:33792
 buffer_load_dwordx4 v101, s[12:15], s35 offen offset:1024 lds
 s_add_u32 m0, s28, 98304
 s_add_u32 s32, s40, 49152
 s_waitcnt lgkmcnt(10)
 v_mfma_f32_32x32x16_bf16 v[32:47], v[72:75], a[20:23], v[32:47]
 ds_read_b64_tr_b16 v[72:73], v96 offset:34816
 ds_read_b64_tr_b16 v[74:75], v96 offset:35840
 buffer_load_dwordx4 v101, s[12:15], s32 offen lds
 v_mfma_f32_32x32x16_bf16 v[48:63], v[76:79], a[20:23], v[48:63]
 ds_read_b64_tr_b16 v[76:77], v97 offset:34816
 ds_read_b64_tr_b16 v[78:79], v97 offset:35840
 buffer_load_dwordx4 v101, s[12:15], s32 offen offset:1024 lds
 s_add_u32 m0, s28, 106496
 s_add_u32 s33, s41, 49152
 v_mfma_f32_32x32x16_bf16 v[32:47], v[80:83], a[24:27], v[32:47]
 ds_read_b64_tr_b16 v[80:81], v96 offset:36864
 ds_read_b64_tr_b16 v[82:83], v96 offset:37888
 buffer_load_dwordx4 a[64:67], v100, s[8:11], s36 offen
 s_mov_b32 s36, 147456
 s_waitcnt lgkmcnt(10)
 v_mfma_f32_32x32x16_bf16 v[48:63], v[84:87], a[24:27], v[48:63]
 ds_read_b64_tr_b16 v[84:85], v97 offset:36864
 ds_read_b64_tr_b16 v[86:87], v97 offset:37888
 buffer_load_dwordx4 a[68:71], v100, s[8:11], s37 offen
 s_mov_b32 s37, 155648
 v_mfma_f32_32x32x16_bf16 v[32:47], v[88:91], a[28:31], v[32:47]
 ds_read_b64_tr_b16 v[88:89], v96 offset:38912
 ds_read_b64_tr_b16 v[90:91], v96 offset:39936
 buffer_load_dwordx4 a[72:75], v100, s[8:11], s36 offen
 s_mov_b32 s36, 163840
 v_mfma_f32_32x32x16_bf16 v[48:63], v[92:95], a[28:31], v[48:63]
 s_waitcnt vmcnt(18)
 s_barrier
 ds_read_b64_tr_b16 v[92:93], v97 offset:38912
 ds_read_b64_tr_b16 v[94:95], v97 offset:39936
 buffer_load_dwordx4 a[76:79], v100, s[8:11], s37 offen
 s_mov_b32 s37, 172032
 s_waitcnt lgkmcnt(10)
 v_mfma_f32_32x32x16_bf16 v[0:15], v[64:67], a[32:35], v[0:15]
 ds_read_b64_tr_b16 v[64:65], v96 offset:40960
 ds_read_b64_tr_b16 v[66:67], v96 offset:41984
 v_mfma_f32_32x32x16_bf16 v[16:31], v[68:71], a[32:35], v[16:31]
 ds_read_b64_tr_b16 v[68:69], v97 offset:40960
 ds_read_b64_tr_b16 v[70:71], v97 offset:41984
 buffer_load_dwordx4 a[80:83], v100, s[8:11], s36 offen
 s_mov_b32 s36, 180224
 s_waitcnt vmcnt(19)
 v_mfma_f32_32x32x16_bf16 v[0:15], v[72:75], a[36:39], v[0:15]
 ds_read_b64_tr_b16 v[72:73], v96 offset:43008
 ds_read_b64_tr_b16 v[74:75], v96 offset:44032
 buffer_load_dwordx4 a[84:87], v100, s[8:11], s37 offen
 s_mov_b32 s37, 188416
 s_waitcnt lgkmcnt(10)
 v_mfma_f32_32x32x16_bf16 v[16:31], v[76:79], a[36:39], v[16:31]
 ds_read_b64_tr_b16 v[76:77], v97 offset:43008
 ds_read_b64_tr_b16 v[78:79], v97 offset:44032
 buffer_load_dwordx4 a[88:91], v100, s[8:11], s36 offen
 s_mov_b32 s36, 196608
 s_waitcnt vmcnt(20)
 v_mfma_f32_32x32x16_bf16 v[0:15], v[80:83], a[40:43], v[0:15]
 ds_read_b64_tr_b16 v[80:81], v96 offset:45056
 ds_read_b64_tr_b16 v[82:83], v96 offset:46080
 buffer_load_dwordx4 a[92:95], v100, s[8:11], s37 offen
 s_mov_b32 s37, 204800
 v_mfma_f32_32x32x16_bf16 v[16:31], v[84:87], a[40:43], v[16:31]
 ds_read_b64_tr_b16 v[84:85], v97 offset:45056
 ds_read_b64_tr_b16 v[86:87], v97 offset:46080
 buffer_load_dwordx4 v101, s[12:15], s33 offen lds
 s_waitcnt vmcnt(21) lgkmcnt(10)
 v_mfma_f32_32x32x16_bf16 v[0:15], v[88:91], a[44:47], v[0:15]
 ds_read_b64_tr_b16 v[88:89], v96 offset:47104
 ds_read_b64_tr_b16 v[90:91], v96 offset:48128
 buffer_load_dwordx4 v101, s[12:15], s33 offen offset:1024 lds
 s_add_u32 m0, s28, 114688
 s_add_u32 s34, s40, 57344
 v_mfma_f32_32x32x16_bf16 v[16:31], v[92:95], a[44:47], v[16:31]
 ds_read_b64_tr_b16 v[92:93], v97 offset:47104
 ds_read_b64_tr_b16 v[94:95], v97 offset:48128
 buffer_load_dwordx4 v101, s[12:15], s34 offen lds
 v_mfma_f32_32x32x16_bf16 v[32:47], v[64:67], a[32:35], v[32:47]
 ds_read_b64_tr_b16 v[64:65], v96 offset:49152
 ds_read_b64_tr_b16 v[66:67], v96 offset:50176
 buffer_load_dwordx4 v101, s[12:15], s34 offen offset:1024 lds
 s_add_u32 m0, s28, 122880
 s_add_u32 s35, s41, 57344
 s_waitcnt lgkmcnt(10)
 v_mfma_f32_32x32x16_bf16 v[48:63], v[68:71], a[32:35], v[48:63]
 ds_read_b64_tr_b16 v[68:69], v97 offset:49152
 ds_read_b64_tr_b16 v[70:71], v97 offset:50176
 buffer_load_dwordx4 v101, s[12:15], s35 offen lds
 v_mfma_f32_32x32x16_bf16 v[32:47], v[72:75], a[36:39], v[32:47]
 ds_read_b64_tr_b16 v[72:73], v96 offset:51200
 ds_read_b64_tr_b16 v[74:75], v96 offset:52224
 buffer_load_dwordx4 v101, s[12:15], s35 offen offset:1024 lds
 s_add_u32 m0, s28, 0
 s_add_u32 s32, s40, 65536
 v_mfma_f32_32x32x16_bf16 v[48:63], v[76:79], a[36:39], v[48:63]
 ds_read_b64_tr_b16 v[76:77], v97 offset:51200
 ds_read_b64_tr_b16 v[78:79], v97 offset:52224
 buffer_load_dwordx4 v101, s[12:15], s32 offen lds
 s_waitcnt lgkmcnt(10)
 v_mfma_f32_32x32x16_bf16 v[32:47], v[80:83], a[40:43], v[32:47]
 ds_read_b64_tr_b16 v[80:81], v96 offset:53248
 ds_read_b64_tr_b16 v[82:83], v96 offset:54272
 buffer_load_dwordx4 v101, s[12:15], s32 offen offset:1024 lds
 s_add_u32 m0, s28, 8192
 s_add_u32 s33, s41, 65536
 v_mfma_f32_32x32x16_bf16 v[48:63], v[84:87], a[40:43], v[48:63]
 ds_read_b64_tr_b16 v[84:85], v97 offset:53248
 ds_read_b64_tr_b16 v[86:87], v97 offset:54272
 buffer_load_dwordx4 a[96:99], v100, s[8:11], s36 offen
 s_mov_b32 s36, 212992
 v_mfma_f32_32x32x16_bf16 v[32:47], v[88:91], a[44:47], v[32:47]
 ds_read_b64_tr_b16 v[88:89], v96 offset:55296
 ds_read_b64_tr_b16 v[90:91], v96 offset:56320
 buffer_load_dwordx4 a[100:103], v100, s[8:11], s37 offen
 s_mov_b32 s37, 221184
 s_waitcnt lgkmcnt(10)
 v_mfma_f32_32x32x16_bf16 v[48:63], v[92:95], a[44:47], v[48:63]
 ds_read_b64_tr_b16 v[92:93], v97 offset:55296
 ds_read_b64_tr_b16 v[94:95], v97 offset:56320
 buffer_load_dwordx4 a[104:107], v100, s[8:11], s36 offen
 s_mov_b32 s36, 229376
 s_waitcnt vmcnt(30)
 v_mfma_f32_32x32x16_bf16 v[0:15], v[64:67], a[48:51], v[0:15]
 ds_read_b64_tr_b16 v[64:65], v96 offset:57344
 ds_read_b64_tr_b16 v[66:67], v96 offset:58368
 buffer_load_dwordx4 a[108:111], v100, s[8:11], s37 offen
 s_mov_b32 s37, 237568
 v_mfma_f32_32x32x16_bf16 v[16:31], v[68:71], a[48:51], v[16:31]
 ds_read_b64_tr_b16 v[68:69], v97 offset:57344
 ds_read_b64_tr_b16 v[70:71], v97 offset:58368
 buffer_load_dwordx4 a[112:115], v100, s[8:11], s36 offen
 s_mov_b32 s36, 245760
 s_waitcnt vmcnt(31) lgkmcnt(10)
 v_mfma_f32_32x32x16_bf16 v[0:15], v[72:75], a[52:55], v[0:15]
 ds_read_b64_tr_b16 v[72:73], v96 offset:59392
 ds_read_b64_tr_b16 v[74:75], v96 offset:60416
 buffer_load_dwordx4 a[116:119], v100, s[8:11], s37 offen
 s_mov_b32 s37, 253952
 v_mfma_f32_32x32x16_bf16 v[16:31], v[76:79], a[52:55], v[16:31]
 ds_read_b64_tr_b16 v[76:77], v97 offset:59392
 ds_read_b64_tr_b16 v[78:79], v97 offset:60416
 buffer_load_dwordx4 a[120:123], v100, s[8:11], s36 offen
 s_mov_b32 s36, 262144
 s_waitcnt vmcnt(32)
 v_mfma_f32_32x32x16_bf16 v[0:15], v[80:83], a[56:59], v[0:15]
 ds_read_b64_tr_b16 v[80:81], v96 offset:61440
 ds_read_b64_tr_b16 v[82:83], v96 offset:62464
 buffer_load_dwordx4 a[124:127], v100, s[8:11], s37 offen
 s_mov_b32 s37, 270336
 s_waitcnt lgkmcnt(10)
 v_mfma_f32_32x32x16_bf16 v[16:31], v[84:87], a[56:59], v[16:31]
 ds_read_b64_tr_b16 v[84:85], v97 offset:61440
 ds_read_b64_tr_b16 v[86:87], v97 offset:62464
 buffer_load_dwordx4 v101, s[12:15], s33 offen lds
 s_waitcnt vmcnt(33)
 v_mfma_f32_32x32x16_bf16 v[0:15], v[88:91], a[60:63], v[0:15]
 ds_read_b64_tr_b16 v[88:89], v96 offset:63488
 ds_read_b64_tr_b16 v[90:91], v96 offset:64512
 buffer_load_dwordx4 v101, s[12:15], s33 offen offset:1024 lds
 s_add_u32 m0, s28, 16384
 s_add_u32 s34, s40, 73728
 v_mfma_f32_32x32x16_bf16 v[16:31], v[92:95], a[60:63], v[16:31]
 ds_read_b64_tr_b16 v[92:93], v97 offset:63488
 ds_read_b64_tr_b16 v[94:95], v97 offset:64512
 buffer_load_dwordx4 v101, s[12:15], s34 offen lds
 s_waitcnt lgkmcnt(10)
 v_mfma_f32_32x32x16_bf16 v[32:47], v[64:67], a[48:51], v[32:47]
 ds_read_b64_tr_b16 v[64:65], v98 offset:0
 ds_read_b64_tr_b16 v[66:67], v98 offset:1024
 buffer_load_dwordx4 v101, s[12:15], s34 offen offset:1024 lds
 s_add_u32 m0, s28, 24576
 s_add_u32 s35, s41, 73728
 v_mfma_f32_32x32x16_bf16 v[48:63], v[68:71], a[48:51], v[48:63]
 ds_read_b64_tr_b16 v[68:69], v99 offset:0
 ds_read_b64_tr_b16 v[70:71], v99 offset:1024
 buffer_load_dwordx4 v101, s[12:15], s35 offen lds
 v_mfma_f32_32x32x16_bf16 v[32:47], v[72:75], a[52:55], v[32:47]
 ds_read_b64_tr_b16 v[72:73], v98 offset:2048
 ds_read_b64_tr_b16 v[74:75], v98 offset:3072
 buffer_load_dwordx4 v101, s[12:15], s35 offen offset:1024 lds
 s_waitcnt lgkmcnt(10)
 v_mfma_f32_32x32x16_bf16 v[48:63], v[76:79], a[52:55], v[48:63]
 ds_read_b64_tr_b16 v[76:77], v99 offset:2048
 ds_read_b64_tr_b16 v[78:79], v99 offset:3072
 buffer_load_dwordx4 a[128:131], v100, s[8:11], s36 offen
 s_mov_b32 s36, 278528
 v_mfma_f32_32x32x16_bf16 v[32:47], v[80:83], a[56:59], v[32:47]
 ds_read_b64_tr_b16 v[80:81], v98 offset:4096
 ds_read_b64_tr_b16 v[82:83], v98 offset:5120
 buffer_load_dwordx4 a[132:135], v100, s[8:11], s37 offen
 s_mov_b32 s37, 286720
 v_mfma_f32_32x32x16_bf16 v[48:63], v[84:87], a[56:59], v[48:63]
 ds_read_b64_tr_b16 v[84:85], v99 offset:4096
 ds_read_b64_tr_b16 v[86:87], v99 offset:5120
 buffer_load_dwordx4 a[136:139], v100, s[8:11], s36 offen
 s_mov_b32 s36, 294912
 s_waitcnt lgkmcnt(10)
 v_mfma_f32_32x32x16_bf16 v[32:47], v[88:91], a[60:63], v[32:47]
 ds_read_b64_tr_b16 v[88:89], v98 offset:6144
 ds_read_b64_tr_b16 v[90:91], v98 offset:7168
 buffer_load_dwordx4 a[140:143], v100, s[8:11], s37 offen
 s_mov_b32 s37, 303104
 v_mfma_f32_32x32x16_bf16 v[48:63], v[92:95], a[60:63], v[48:63]
 s_waitcnt vmcnt(34)
 s_barrier
 ds_read_b64_tr_b16 v[92:93], v99 offset:6144
 ds_read_b64_tr_b16 v[94:95], v99 offset:7168
 s_add_u32 m0, s28, 32768
 s_add_u32 s32, s40, 81920
 buffer_load_dwordx4 v101, s[12:15], s32 offen lds
 s_waitcnt vmcnt(34)
 v_mfma_f32_32x32x16_bf16 v[0:15], v[64:67], a[64:67], v[0:15]
 ds_read_b64_tr_b16 v[64:65], v98 offset:8192
 ds_read_b64_tr_b16 v[66:67], v98 offset:9216
 s_waitcnt lgkmcnt(10)
 v_mfma_f32_32x32x16_bf16 v[16:31], v[68:71], a[64:67], v[16:31]
 ds_read_b64_tr_b16 v[68:69], v99 offset:8192
 ds_read_b64_tr_b16 v[70:71], v99 offset:9216
 buffer_load_dwordx4 v101, s[12:15], s32 offen offset:1024 lds
 s_add_u32 m0, s28, 40960
 s_add_u32 s33, s41, 81920
 s_waitcnt vmcnt(34)
 v_mfma_f32_32x32x16_bf16 v[0:15], v[72:75], a[68:71], v[0:15]
 ds_read_b64_tr_b16 v[72:73], v98 offset:10240
 ds_read_b64_tr_b16 v[74:75], v98 offset:11264
 buffer_load_dwordx4 a[144:147], v100, s[8:11], s36 offen
 s_mov_b32 s36, 311296
 v_mfma_f32_32x32x16_bf16 v[16:31], v[76:79], a[68:71], v[16:31]
 ds_read_b64_tr_b16 v[76:77], v99 offset:10240
 ds_read_b64_tr_b16 v[78:79], v99 offset:11264
 buffer_load_dwordx4 a[148:151], v100, s[8:11], s37 offen
 s_mov_b32 s37, 319488
 s_waitcnt vmcnt(35) lgkmcnt(10)
 v_mfma_f32_32x32x16_bf16 v[0:15], v[80:83], a[72:75], v[0:15]
 ds_read_b64_tr_b16 v[80:81], v98 offset:12288
 ds_read_b64_tr_b16 v[82:83], v98 offset:13312
 buffer_load_dwordx4 a[152:155], v100, s[8:11], s36 offen
 s_mov_b32 s36, 327680
 v_mfma_f32_32x32x16_bf16 v[16:31], v[84:87], a[72:75], v[16:31]
 ds_read_b64_tr_b16 v[84:85], v99 offset:12288
 ds_read_b64_tr_b16 v[86:87], v99 offset:13312
 buffer_load_dwordx4 a[156:159], v100, s[8:11], s37 offen
 s_mov_b32 s37, 335872
 s_waitcnt vmcnt(36)
 v_mfma_f32_32x32x16_bf16 v[0:15], v[88:91], a[76:79], v[0:15]
 ds_read_b64_tr_b16 v[88:89], v98 offset:14336
 ds_read_b64_tr_b16 v[90:91], v98 offset:15360
 buffer_load_dwordx4 v101, s[12:15], s33 offen lds
 s_waitcnt lgkmcnt(10)
 v_mfma_f32_32x32x16_bf16 v[16:31], v[92:95], a[76:79], v[16:31]
 ds_read_b64_tr_b16 v[92:93], v99 offset:14336
 ds_read_b64_tr_b16 v[94:95], v99 offset:15360
 buffer_load_dwordx4 v101, s[12:15], s33 offen offset:1024 lds
 s_add_u32 m0, s28, 49152
 s_add_u32 s34, s40, 90112
 v_mfma_f32_32x32x16_bf16 v[32:47], v[64:67], a[64:67], v[32:47]
 ds_read_b64_tr_b16 v[64:65], v98 offset:16384
 ds_read_b64_tr_b16 v[66:67], v98 offset:17408
 buffer_load_dwordx4 v101, s[12:15], s34 offen lds
 v_mfma_f32_32x32x16_bf16 v[48:63], v[68:71], a[64:67], v[48:63]
 ds_read_b64_tr_b16 v[68:69], v99 offset:16384
 ds_read_b64_tr_b16 v[70:71], v99 offset:17408
 buffer_load_dwordx4 v101, s[12:15], s34 offen offset:1024 lds
 s_add_u32 m0, s28, 57344
 s_add_u32 s35, s41, 90112
 s_waitcnt lgkmcnt(10)
 v_mfma_f32_32x32x16_bf16 v[32:47], v[72:75], a[68:71], v[32:47]
 ds_read_b64_tr_b16 v[72:73], v98 offset:18432
 ds_read_b64_tr_b16 v[74:75], v98 offset:19456
 buffer_load_dwordx4 v101, s[12:15], s35 offen lds
 v_mfma_f32_32x32x16_bf16 v[48:63], v[76:79], a[68:71], v[48:63]
 ds_read_b64_tr_b16 v[76:77], v99 offset:18432
 ds_read_b64_tr_b16 v[78:79], v99 offset:19456
 buffer_load_dwordx4 v101, s[12:15], s35 offen offset:1024 lds
 v_mfma_f32_32x32x16_bf16 v[32:47], v[80:83], a[72:75], v[32:47]
 ds_read_b64_tr_b16 v[80:81], v98 offset:20480
 ds_read_b64_tr_b16 v[82:83], v98 offset:21504
 buffer_load_dwordx4 a[160:163], v100, s[8:11], s36 offen
 s_mov_b32 s36, 344064
 s_waitcnt lgkmcnt(10)
 v_mfma_f32_32x32x16_bf16 v[48:63], v[84:87], a[72:75], v[48:63]
 ds_read_b64_tr_b16 v[84:85], v99 offset:20480
 ds_read_b64_tr_b16 v[86:87], v99 offset:21504
 buffer_load_dwordx4 a[164:167], v100, s[8:11], s37 offen
 s_mov_b32 s37, 352256
 v_mfma_f32_32x32x16_bf16 v[32:47], v[88:91], a[76:79], v[32:47]
 ds_read_b64_tr_b16 v[88:89], v98 offset:22528
 ds_read_b64_tr_b16 v[90:91], v98 offset:23552
 buffer_load_dwordx4 a[168:171], v100, s[8:11], s36 offen
 v_mfma_f32_32x32x16_bf16 v[48:63], v[92:95], a[76:79], v[48:63]
 ds_read_b64_tr_b16 v[92:93], v99 offset:22528
 ds_read_b64_tr_b16 v[94:95], v99 offset:23552
 buffer_load_dwordx4 a[172:175], v100, s[8:11], s37 offen
 s_waitcnt vmcnt(45) lgkmcnt(10)
 v_mfma_f32_32x32x16_bf16 v[0:15], v[64:67], a[80:83], v[0:15]
 ds_read_b64_tr_b16 v[64:65], v98 offset:24576
 ds_read_b64_tr_b16 v[66:67], v98 offset:25600
 v_mfma_f32_32x32x16_bf16 v[16:31], v[68:71], a[80:83], v[16:31]
 ds_read_b64_tr_b16 v[68:69], v99 offset:24576
 ds_read_b64_tr_b16 v[70:71], v99 offset:25600
 s_waitcnt vmcnt(44)
 v_mfma_f32_32x32x16_bf16 v[0:15], v[72:75], a[84:87], v[0:15]
 ds_read_b64_tr_b16 v[72:73], v98 offset:26624
 ds_read_b64_tr_b16 v[74:75], v98 offset:27648
 s_waitcnt lgkmcnt(10)
 s_nop 2
 v_mfma_f32_32x32x16_bf16 v[16:31], v[76:79], a[84:87], v[16:31]
 ds_read_b64_tr_b16 v[76:77], v99 offset:26624
 ds_read_b64_tr_b16 v[78:79], v99 offset:27648
 s_mov_b32 s36, 360448
 buffer_load_dwordx4 a[176:179], v100, s[8:11], s36 offen
 s_waitcnt vmcnt(44)
 v_mfma_f32_32x32x16_bf16 v[0:15], v[80:83], a[88:91], v[0:15]
 ds_read_b64_tr_b16 v[80:81], v98 offset:28672
 ds_read_b64_tr_b16 v[82:83], v98 offset:29696
 s_nop 1
 v_mfma_f32_32x32x16_bf16 v[16:31], v[84:87], a[88:91], v[16:31]
 ds_read_b64_tr_b16 v[84:85], v99 offset:28672
 ds_read_b64_tr_b16 v[86:87], v99 offset:29696
 s_mov_b32 s37, 368640
 buffer_load_dwordx4 a[180:183], v100, s[8:11], s37 offen
 s_waitcnt vmcnt(44) lgkmcnt(10)
 v_mfma_f32_32x32x16_bf16 v[0:15], v[88:91], a[92:95], v[0:15]
 ds_read_b64_tr_b16 v[88:89], v98 offset:30720
 ds_read_b64_tr_b16 v[90:91], v98 offset:31744
 s_nop 1
 v_mfma_f32_32x32x16_bf16 v[16:31], v[92:95], a[92:95], v[16:31]
 ds_read_b64_tr_b16 v[92:93], v99 offset:30720
 ds_read_b64_tr_b16 v[94:95], v99 offset:31744
 s_mov_b32 s36, 376832
 buffer_load_dwordx4 a[184:187], v100, s[8:11], s36 offen
 v_mfma_f32_32x32x16_bf16 v[32:47], v[64:67], a[80:83], v[32:47]
 ds_read_b64_tr_b16 v[64:65], v98 offset:32768
 ds_read_b64_tr_b16 v[66:67], v98 offset:33792
 s_waitcnt lgkmcnt(10)
 v_mfma_f32_32x32x16_bf16 v[48:63], v[68:71], a[80:83], v[48:63]
 ds_read_b64_tr_b16 v[68:69], v99 offset:32768
 ds_read_b64_tr_b16 v[70:71], v99 offset:33792
 s_mov_b32 s37, 385024
 buffer_load_dwordx4 a[188:191], v100, s[8:11], s37 offen
 v_mfma_f32_32x32x16_bf16 v[32:47], v[72:75], a[84:87], v[32:47]
 ds_read_b64_tr_b16 v[72:73], v98 offset:34816
 ds_read_b64_tr_b16 v[74:75], v98 offset:35840
 v_mfma_f32_32x32x16_bf16 v[48:63], v[76:79], a[84:87], v[48:63]
 ds_read_b64_tr_b16 v[76:77], v99 offset:34816
 ds_read_b64_tr_b16 v[78:79], v99 offset:35840
 s_waitcnt lgkmcnt(10)
 v_mfma_f32_32x32x16_bf16 v[32:47], v[80:83], a[88:91], v[32:47]
 ds_read_b64_tr_b16 v[80:81], v98 offset:36864
 ds_read_b64_tr_b16 v[82:83], v98 offset:37888
 v_mfma_f32_32x32x16_bf16 v[48:63], v[84:87], a[88:91], v[48:63]
 ds_read_b64_tr_b16 v[84:85], v99 offset:36864
 ds_read_b64_tr_b16 v[86:87], v99 offset:37888
 v_mfma_f32_32x32x16_bf16 v[32:47], v[88:91], a[92:95], v[32:47]
 ds_read_b64_tr_b16 v[88:89], v98 offset:38912
 ds_read_b64_tr_b16 v[90:91], v98 offset:39936
 s_waitcnt lgkmcnt(10)
 v_mfma_f32_32x32x16_bf16 v[48:63], v[92:95], a[92:95], v[48:63]
 s_waitcnt vmcnt(38)
 s_barrier
 ds_read_b64_tr_b16 v[92:93], v99 offset:38912
 ds_read_b64_tr_b16 v[94:95], v99 offset:39936
 s_add_u32 m0, s28, 65536
 s_add_u32 s32, s40, 98304
 buffer_load_dwordx4 v101, s[12:15], s32 offen lds
 s_waitcnt vmcnt(38)
 v_mfma_f32_32x32x16_bf16 v[0:15], v[64:67], a[96:99], v[0:15]
 ds_read_b64_tr_b16 v[64:65], v98 offset:40960
 ds_read_b64_tr_b16 v[66:67], v98 offset:41984
 v_mfma_f32_32x32x16_bf16 v[16:31], v[68:71], a[96:99], v[16:31]
 ds_read_b64_tr_b16 v[68:69], v99 offset:40960
 ds_read_b64_tr_b16 v[70:71], v99 offset:41984
 buffer_load_dwordx4 v101, s[12:15], s32 offen offset:1024 lds
 s_add_u32 m0, s28, 73728
 s_add_u32 s33, s41, 98304
 s_waitcnt vmcnt(38) lgkmcnt(10)
 v_mfma_f32_32x32x16_bf16 v[0:15], v[72:75], a[100:103], v[0:15]
 ds_read_b64_tr_b16 v[72:73], v98 offset:43008
 ds_read_b64_tr_b16 v[74:75], v98 offset:44032
 buffer_load_dwordx4 v101, s[12:15], s33 offen lds
 v_mfma_f32_32x32x16_bf16 v[16:31], v[76:79], a[100:103], v[16:31]
 ds_read_b64_tr_b16 v[76:77], v99 offset:43008
 ds_read_b64_tr_b16 v[78:79], v99 offset:44032
 buffer_load_dwordx4 v101, s[12:15], s33 offen offset:1024 lds
 s_add_u32 m0, s28, 81920
 s_add_u32 s34, s40, 106496
 s_mov_b32 s36, 393216
 s_waitcnt vmcnt(39)
 v_mfma_f32_32x32x16_bf16 v[0:15], v[80:83], a[104:107], v[0:15]
 ds_read_b64_tr_b16 v[80:81], v98 offset:45056
 ds_read_b64_tr_b16 v[82:83], v98 offset:46080
 buffer_load_dwordx4 v101, s[12:15], s34 offen lds
 s_waitcnt lgkmcnt(10)
 v_mfma_f32_32x32x16_bf16 v[16:31], v[84:87], a[104:107], v[16:31]
 ds_read_b64_tr_b16 v[84:85], v99 offset:45056
 ds_read_b64_tr_b16 v[86:87], v99 offset:46080
 buffer_load_dwordx4 v101, s[12:15], s34 offen offset:1024 lds
 s_add_u32 m0, s28, 90112
 s_add_u32 s35, s41, 106496
 s_mov_b32 s37, 401408
 s_waitcnt vmcnt(40)
 v_mfma_f32_32x32x16_bf16 v[0:15], v[88:91], a[108:111], v[0:15]
 ds_read_b64_tr_b16 v[88:89], v98 offset:47104
 ds_read_b64_tr_b16 v[90:91], v98 offset:48128
 buffer_load_dwordx4 v101, s[12:15], s35 offen lds
 v_mfma_f32_32x32x16_bf16 v[16:31], v[92:95], a[108:111], v[16:31]
 ds_read_b64_tr_b16 v[92:93], v99 offset:47104
 ds_read_b64_tr_b16 v[94:95], v99 offset:48128
 buffer_load_dwordx4 v101, s[12:15], s35 offen offset:1024 lds
 s_waitcnt lgkmcnt(9)
 v_mfma_f32_32x32x16_bf16 v[32:47], v[64:67], a[96:99], v[32:47]
 ds_read_b64_tr_b16 v[64:65], v98 offset:49152
 ds_read_b64_tr_b16 v[66:67], v98 offset:50176
 buffer_load_dwordx4 a[192:195], v100, s[8:11], s36 offen
 s_mov_b32 s36, 409600
 v_mfma_f32_32x32x16_bf16 v[48:63], v[68:71], a[96:99], v[48:63]
 ds_read_b64_tr_b16 v[68:69], v99 offset:49152
 ds_read_b64_tr_b16 v[70:71], v99 offset:50176
 buffer_load_dwordx4 a[196:199], v100, s[8:11], s37 offen
 s_mov_b32 s37, 417792
 v_mfma_f32_32x32x16_bf16 v[32:47], v[72:75], a[100:103], v[32:47]
 ds_read_b64_tr_b16 v[72:73], v98 offset:51200
 ds_read_b64_tr_b16 v[74:75], v98 offset:52224
 buffer_load_dwordx4 a[200:203], v100, s[8:11], s36 offen
 s_waitcnt lgkmcnt(10)
 v_mfma_f32_32x32x16_bf16 v[48:63], v[76:79], a[100:103], v[48:63]
 ds_read_b64_tr_b16 v[76:77], v99 offset:51200
 ds_read_b64_tr_b16 v[78:79], v99 offset:52224
 buffer_load_dwordx4 a[204:207], v100, s[8:11], s37 offen
 v_mfma_f32_32x32x16_bf16 v[32:47], v[80:83], a[104:107], v[32:47]
 ds_read_b64_tr_b16 v[80:81], v98 offset:53248
 ds_read_b64_tr_b16 v[82:83], v98 offset:54272
 v_mfma_f32_32x32x16_bf16 v[48:63], v[84:87], a[104:107], v[48:63]
 ds_read_b64_tr_b16 v[84:85], v99 offset:53248
 ds_read_b64_tr_b16 v[86:87], v99 offset:54272
 s_waitcnt lgkmcnt(10)
 v_mfma_f32_32x32x16_bf16 v[32:47], v[88:91], a[108:111], v[32:47]
 ds_read_b64_tr_b16 v[88:89], v98 offset:55296
 ds_read_b64_tr_b16 v[90:91], v98 offset:56320
 v_mfma_f32_32x32x16_bf16 v[48:63], v[92:95], a[108:111], v[48:63]
 ds_read_b64_tr_b16 v[92:93], v99 offset:55296
 ds_read_b64_tr_b16 v[94:95], v99 offset:56320
 s_waitcnt vmcnt(45)
 v_mfma_f32_32x32x16_bf16 v[0:15], v[64:67], a[112:115], v[0:15]
 ds_read_b64_tr_b16 v[64:65], v98 offset:57344
 ds_read_b64_tr_b16 v[66:67], v98 offset:58368
 s_waitcnt lgkmcnt(10)
 v_mfma_f32_32x32x16_bf16 v[16:31], v[68:71], a[112:115], v[16:31]
 ds_read_b64_tr_b16 v[68:69], v99 offset:57344
 ds_read_b64_tr_b16 v[70:71], v99 offset:58368
 s_waitcnt vmcnt(44)
 v_mfma_f32_32x32x16_bf16 v[0:15], v[72:75], a[116:119], v[0:15]
 ds_read_b64_tr_b16 v[72:73], v98 offset:59392
 ds_read_b64_tr_b16 v[74:75], v98 offset:60416
 s_nop 3
 v_mfma_f32_32x32x16_bf16 v[16:31], v[76:79], a[116:119], v[16:31]
 ds_read_b64_tr_b16 v[76:77], v99 offset:59392
 ds_read_b64_tr_b16 v[78:79], v99 offset:60416
 s_mov_b32 s36, 425984
 buffer_load_dwordx4 a[208:211], v100, s[8:11], s36 offen
 s_waitcnt vmcnt(44) lgkmcnt(10)
 v_mfma_f32_32x32x16_bf16 v[0:15], v[80:83], a[120:123], v[0:15]
 ds_read_b64_tr_b16 v[80:81], v98 offset:61440
 ds_read_b64_tr_b16 v[82:83], v98 offset:62464
 s_nop 1
 v_mfma_f32_32x32x16_bf16 v[16:31], v[84:87], a[120:123], v[16:31]
 ds_read_b64_tr_b16 v[84:85], v99 offset:61440
 ds_read_b64_tr_b16 v[86:87], v99 offset:62464
 s_mov_b32 s37, 434176
 buffer_load_dwordx4 a[212:215], v100, s[8:11], s37 offen
 s_waitcnt vmcnt(44)
 v_mfma_f32_32x32x16_bf16 v[0:15], v[88:91], a[124:127], v[0:15]
 ds_read_b64_tr_b16 v[88:89], v98 offset:63488
 ds_read_b64_tr_b16 v[90:91], v98 offset:64512
 s_waitcnt lgkmcnt(10)
 s_nop 0
 v_mfma_f32_32x32x16_bf16 v[16:31], v[92:95], a[124:127], v[16:31]
 ds_read_b64_tr_b16 v[92:93], v99 offset:63488
 ds_read_b64_tr_b16 v[94:95], v99 offset:64512
 s_mov_b32 s36, 442368
 buffer_load_dwordx4 a[216:219], v100, s[8:11], s36 offen
 v_mfma_f32_32x32x16_bf16 v[32:47], v[64:67], a[112:115], v[32:47]
 ds_read_b64_tr_b16 v[64:65], v96 offset:0
 ds_read_b64_tr_b16 v[66:67], v96 offset:1024
 v_mfma_f32_32x32x16_bf16 v[48:63], v[68:71], a[112:115], v[48:63]
 ds_read_b64_tr_b16 v[68:69], v97 offset:0
 ds_read_b64_tr_b16 v[70:71], v97 offset:1024
 s_mov_b32 s37, 450560
 s_nop 0
 buffer_load_dwordx4 a[220:223], v100, s[8:11], s37 offen
 s_waitcnt lgkmcnt(10)
 v_mfma_f32_32x32x16_bf16 v[32:47], v[72:75], a[116:119], v[32:47]
 ds_read_b64_tr_b16 v[72:73], v96 offset:2048
 ds_read_b64_tr_b16 v[74:75], v96 offset:3072
 v_mfma_f32_32x32x16_bf16 v[48:63], v[76:79], a[116:119], v[48:63]
 ds_read_b64_tr_b16 v[76:77], v97 offset:2048
 ds_read_b64_tr_b16 v[78:79], v97 offset:3072
 v_mfma_f32_32x32x16_bf16 v[32:47], v[80:83], a[120:123], v[32:47]
 ds_read_b64_tr_b16 v[80:81], v96 offset:4096
 ds_read_b64_tr_b16 v[82:83], v96 offset:5120
 s_waitcnt lgkmcnt(10)
 v_mfma_f32_32x32x16_bf16 v[48:63], v[84:87], a[120:123], v[48:63]
 ds_read_b64_tr_b16 v[84:85], v97 offset:4096
 ds_read_b64_tr_b16 v[86:87], v97 offset:5120
 v_mfma_f32_32x32x16_bf16 v[32:47], v[88:91], a[124:127], v[32:47]
 ds_read_b64_tr_b16 v[88:89], v96 offset:6144
 ds_read_b64_tr_b16 v[90:91], v96 offset:7168
 v_mfma_f32_32x32x16_bf16 v[48:63], v[92:95], a[124:127], v[48:63]
 s_waitcnt vmcnt(34)
 s_barrier
 ds_read_b64_tr_b16 v[92:93], v97 offset:6144
 ds_read_b64_tr_b16 v[94:95], v97 offset:7168
 s_add_u32 m0, s28, 98304
 s_add_u32 s32, s40, 114688
 buffer_load_dwordx4 v101, s[12:15], s32 offen lds
 s_waitcnt lgkmcnt(10)
 v_mfma_f32_32x32x16_bf16 v[0:15], v[64:67], a[128:131], v[0:15]
 ds_read_b64_tr_b16 v[64:65], v96 offset:8192
 ds_read_b64_tr_b16 v[66:67], v96 offset:9216
 v_mfma_f32_32x32x16_bf16 v[16:31], v[68:71], a[128:131], v[16:31]
 ds_read_b64_tr_b16 v[68:69], v97 offset:8192
 ds_read_b64_tr_b16 v[70:71], v97 offset:9216
 buffer_load_dwordx4 v101, s[12:15], s32 offen offset:1024 lds
 s_add_u32 m0, s28, 106496
 s_add_u32 s33, s41, 114688
 v_mfma_f32_32x32x16_bf16 v[0:15], v[72:75], a[132:135], v[0:15]
 ds_read_b64_tr_b16 v[72:73], v96 offset:10240
 ds_read_b64_tr_b16 v[74:75], v96 offset:11264
 buffer_load_dwordx4 v101, s[12:15], s33 offen lds
 s_waitcnt lgkmcnt(10)
 v_mfma_f32_32x32x16_bf16 v[16:31], v[76:79], a[132:135], v[16:31]
 ds_read_b64_tr_b16 v[76:77], v97 offset:10240
 ds_read_b64_tr_b16 v[78:79], v97 offset:11264
 buffer_load_dwordx4 v101, s[12:15], s33 offen offset:1024 lds
 s_add_u32 m0, s28, 114688
 s_add_u32 s34, s40, 122880
 s_mov_b32 s36, 458752
 v_mfma_f32_32x32x16_bf16 v[0:15], v[80:83], a[136:139], v[0:15]
 ds_read_b64_tr_b16 v[80:81], v96 offset:12288
 ds_read_b64_tr_b16 v[82:83], v96 offset:13312
 buffer_load_dwordx4 v101, s[12:15], s34 offen lds
 v_mfma_f32_32x32x16_bf16 v[16:31], v[84:87], a[136:139], v[16:31]
 ds_read_b64_tr_b16 v[84:85], v97 offset:12288
 ds_read_b64_tr_b16 v[86:87], v97 offset:13312
 buffer_load_dwordx4 v101, s[12:15], s34 offen offset:1024 lds
 s_add_u32 m0, s28, 122880
 s_add_u32 s35, s41, 122880
 s_mov_b32 s37, 466944
 s_waitcnt lgkmcnt(9)
 v_mfma_f32_32x32x16_bf16 v[0:15], v[88:91], a[140:143], v[0:15]
 ds_read_b64_tr_b16 v[88:89], v96 offset:14336
 ds_read_b64_tr_b16 v[90:91], v96 offset:15360
 buffer_load_dwordx4 v101, s[12:15], s35 offen lds
 v_mfma_f32_32x32x16_bf16 v[16:31], v[92:95], a[140:143], v[16:31]
 ds_read_b64_tr_b16 v[92:93], v97 offset:14336
 ds_read_b64_tr_b16 v[94:95], v97 offset:15360
 buffer_load_dwordx4 v101, s[12:15], s35 offen offset:1024 lds
 v_mfma_f32_32x32x16_bf16 v[32:47], v[64:67], a[128:131], v[32:47]
 ds_read_b64_tr_b16 v[64:65], v96 offset:16384
 ds_read_b64_tr_b16 v[66:67], v96 offset:17408
 buffer_load_dwordx4 a[224:227], v100, s[8:11], s36 offen
 s_mov_b32 s36, 475136
 s_waitcnt lgkmcnt(10)
 v_mfma_f32_32x32x16_bf16 v[48:63], v[68:71], a[128:131], v[48:63]
 ds_read_b64_tr_b16 v[68:69], v97 offset:16384
 ds_read_b64_tr_b16 v[70:71], v97 offset:17408
 buffer_load_dwordx4 a[228:231], v100, s[8:11], s37 offen
 s_mov_b32 s37, 483328
 v_mfma_f32_32x32x16_bf16 v[32:47], v[72:75], a[132:135], v[32:47]
 ds_read_b64_tr_b16 v[72:73], v96 offset:18432
 ds_read_b64_tr_b16 v[74:75], v96 offset:19456
 buffer_load_dwordx4 a[232:235], v100, s[8:11], s36 offen
 v_mfma_f32_32x32x16_bf16 v[48:63], v[76:79], a[132:135], v[48:63]
 ds_read_b64_tr_b16 v[76:77], v97 offset:18432
 ds_read_b64_tr_b16 v[78:79], v97 offset:19456
 buffer_load_dwordx4 a[236:239], v100, s[8:11], s37 offen
 s_waitcnt lgkmcnt(10)
 v_mfma_f32_32x32x16_bf16 v[32:47], v[80:83], a[136:139], v[32:47]
 ds_read_b64_tr_b16 v[80:81], v96 offset:20480
 ds_read_b64_tr_b16 v[82:83], v96 offset:21504
 v_mfma_f32_32x32x16_bf16 v[48:63], v[84:87], a[136:139], v[48:63]
 ds_read_b64_tr_b16 v[84:85], v97 offset:20480
 ds_read_b64_tr_b16 v[86:87], v97 offset:21504
 v_mfma_f32_32x32x16_bf16 v[32:47], v[88:91], a[140:143], v[32:47]
 ds_read_b64_tr_b16 v[88:89], v96 offset:22528
 ds_read_b64_tr_b16 v[90:91], v96 offset:23552
 s_waitcnt lgkmcnt(10)
 v_mfma_f32_32x32x16_bf16 v[48:63], v[92:95], a[140:143], v[48:63]
 ds_read_b64_tr_b16 v[92:93], v97 offset:22528
 ds_read_b64_tr_b16 v[94:95], v97 offset:23552
 s_waitcnt vmcnt(45)
 v_mfma_f32_32x32x16_bf16 v[0:15], v[64:67], a[144:147], v[0:15]
 ds_read_b64_tr_b16 v[64:65], v96 offset:24576
 ds_read_b64_tr_b16 v[66:67], v96 offset:25600
 v_mfma_f32_32x32x16_bf16 v[16:31], v[68:71], a[144:147], v[16:31]
 ds_read_b64_tr_b16 v[68:69], v97 offset:24576
 ds_read_b64_tr_b16 v[70:71], v97 offset:25600
 s_waitcnt vmcnt(44) lgkmcnt(10)
 v_mfma_f32_32x32x16_bf16 v[0:15], v[72:75], a[148:151], v[0:15]
 ds_read_b64_tr_b16 v[72:73], v96 offset:26624
 ds_read_b64_tr_b16 v[74:75], v96 offset:27648
 s_nop 3
 v_mfma_f32_32x32x16_bf16 v[16:31], v[76:79], a[148:151], v[16:31]
 ds_read_b64_tr_b16 v[76:77], v97 offset:26624
 ds_read_b64_tr_b16 v[78:79], v97 offset:27648
 s_mov_b32 s36, 491520
 buffer_load_dwordx4 a[240:243], v100, s[8:11], s36 offen
 s_waitcnt vmcnt(44)
 v_mfma_f32_32x32x16_bf16 v[0:15], v[80:83], a[152:155], v[0:15]
 ds_read_b64_tr_b16 v[80:81], v96 offset:28672
 ds_read_b64_tr_b16 v[82:83], v96 offset:29696
 s_waitcnt lgkmcnt(10)
 s_nop 0
 v_mfma_f32_32x32x16_bf16 v[16:31], v[84:87], a[152:155], v[16:31]
 ds_read_b64_tr_b16 v[84:85], v97 offset:28672
 ds_read_b64_tr_b16 v[86:87], v97 offset:29696
 s_mov_b32 s37, 499712
 buffer_load_dwordx4 a[244:247], v100, s[8:11], s37 offen
 s_waitcnt vmcnt(44)
 v_mfma_f32_32x32x16_bf16 v[0:15], v[88:91], a[156:159], v[0:15]
 ds_read_b64_tr_b16 v[88:89], v96 offset:30720
 ds_read_b64_tr_b16 v[90:91], v96 offset:31744
 s_nop 1
 v_mfma_f32_32x32x16_bf16 v[16:31], v[92:95], a[156:159], v[16:31]
 ds_read_b64_tr_b16 v[92:93], v97 offset:30720
 ds_read_b64_tr_b16 v[94:95], v97 offset:31744
 s_mov_b32 s36, 507904
 buffer_load_dwordx4 a[248:251], v100, s[8:11], s36 offen
 s_waitcnt lgkmcnt(10)
 v_mfma_f32_32x32x16_bf16 v[32:47], v[64:67], a[144:147], v[32:47]
 ds_read_b64_tr_b16 v[64:65], v96 offset:32768
 ds_read_b64_tr_b16 v[66:67], v96 offset:33792
 v_mfma_f32_32x32x16_bf16 v[48:63], v[68:71], a[144:147], v[48:63]
 ds_read_b64_tr_b16 v[68:69], v97 offset:32768
 ds_read_b64_tr_b16 v[70:71], v97 offset:33792
 s_mov_b32 s37, 516096
 buffer_load_dwordx4 a[252:255], v100, s[8:11], s37 offen
 v_mfma_f32_32x32x16_bf16 v[32:47], v[72:75], a[148:151], v[32:47]
 ds_read_b64_tr_b16 v[72:73], v96 offset:34816
 ds_read_b64_tr_b16 v[74:75], v96 offset:35840
 s_waitcnt lgkmcnt(10)
 v_mfma_f32_32x32x16_bf16 v[48:63], v[76:79], a[148:151], v[48:63]
 ds_read_b64_tr_b16 v[76:77], v97 offset:34816
 ds_read_b64_tr_b16 v[78:79], v97 offset:35840
 v_mfma_f32_32x32x16_bf16 v[32:47], v[80:83], a[152:155], v[32:47]
 ds_read_b64_tr_b16 v[80:81], v96 offset:36864
 ds_read_b64_tr_b16 v[82:83], v96 offset:37888
 v_mfma_f32_32x32x16_bf16 v[48:63], v[84:87], a[152:155], v[48:63]
 ds_read_b64_tr_b16 v[84:85], v97 offset:36864
 ds_read_b64_tr_b16 v[86:87], v97 offset:37888
 s_waitcnt lgkmcnt(10)
 v_mfma_f32_32x32x16_bf16 v[32:47], v[88:91], a[156:159], v[32:47]
 ds_read_b64_tr_b16 v[88:89], v96 offset:38912
 ds_read_b64_tr_b16 v[90:91], v96 offset:39936
 v_mfma_f32_32x32x16_bf16 v[48:63], v[92:95], a[156:159], v[48:63]
 s_waitcnt vmcnt(30)
 s_barrier
 ds_read_b64_tr_b16 v[92:93], v97 offset:38912
 ds_read_b64_tr_b16 v[94:95], v97 offset:39936
 s_add_u32 m0, s28, 0
 s_add_u32 s32, s40, 131072
 buffer_load_dwordx4 v101, s[12:15], s32 offen lds
 v_mfma_f32_32x32x16_bf16 v[0:15], v[64:67], a[160:163], v[0:15]
 ds_read_b64_tr_b16 v[64:65], v96 offset:40960
 ds_read_b64_tr_b16 v[66:67], v96 offset:41984
 s_waitcnt lgkmcnt(10)
 v_mfma_f32_32x32x16_bf16 v[16:31], v[68:71], a[160:163], v[16:31]
 ds_read_b64_tr_b16 v[68:69], v97 offset:40960
 ds_read_b64_tr_b16 v[70:71], v97 offset:41984
 buffer_load_dwordx4 v101, s[12:15], s32 offen offset:1024 lds
 s_add_u32 m0, s28, 8192
 s_add_u32 s33, s41, 131072
 v_mfma_f32_32x32x16_bf16 v[0:15], v[72:75], a[164:167], v[0:15]
 ds_read_b64_tr_b16 v[72:73], v96 offset:43008
 ds_read_b64_tr_b16 v[74:75], v96 offset:44032
 buffer_load_dwordx4 v101, s[12:15], s33 offen lds
 s_nop 0
 v_mfma_f32_32x32x16_bf16 v[16:31], v[76:79], a[164:167], v[16:31]
 ds_read_b64_tr_b16 v[76:77], v97 offset:43008
 ds_read_b64_tr_b16 v[78:79], v97 offset:44032
 buffer_load_dwordx4 v101, s[12:15], s33 offen offset:1024 lds
 s_add_u32 m0, s28, 16384
 s_add_u32 s34, s40, 139264
 s_mov_b32 s36, 524288
 s_waitcnt lgkmcnt(10)
 v_mfma_f32_32x32x16_bf16 v[0:15], v[80:83], a[168:171], v[0:15]
 ds_read_b64_tr_b16 v[80:81], v96 offset:45056
 ds_read_b64_tr_b16 v[82:83], v96 offset:46080
 buffer_load_dwordx4 v101, s[12:15], s34 offen lds
 v_mfma_f32_32x32x16_bf16 v[16:31], v[84:87], a[168:171], v[16:31]
 ds_read_b64_tr_b16 v[84:85], v97 offset:45056
 ds_read_b64_tr_b16 v[86:87], v97 offset:46080
 buffer_load_dwordx4 v101, s[12:15], s34 offen offset:1024 lds
 s_add_u32 m0, s28, 24576
 s_add_u32 s35, s41, 139264
 s_mov_b32 s37, 532480
 v_mfma_f32_32x32x16_bf16 v[0:15], v[88:91], a[172:175], v[0:15]
 ds_read_b64_tr_b16 v[88:89], v96 offset:47104
 ds_read_b64_tr_b16 v[90:91], v96 offset:48128
 buffer_load_dwordx4 v101, s[12:15], s35 offen lds
 s_waitcnt lgkmcnt(9)
 v_mfma_f32_32x32x16_bf16 v[16:31], v[92:95], a[172:175], v[16:31]
 ds_read_b64_tr_b16 v[92:93], v97 offset:47104
 ds_read_b64_tr_b16 v[94:95], v97 offset:48128
 buffer_load_dwordx4 v101, s[12:15], s35 offen offset:1024 lds
 v_mfma_f32_32x32x16_bf16 v[32:47], v[64:67], a[160:163], v[32:47]
 ds_read_b64_tr_b16 v[64:65], v96 offset:49152
 ds_read_b64_tr_b16 v[66:67], v96 offset:50176
 buffer_load_dwordx4 a[0:3], v100, s[8:11], s36 offen
 s_mov_b32 s36, 540672
 v_mfma_f32_32x32x16_bf16 v[48:63], v[68:71], a[160:163], v[48:63]
 ds_read_b64_tr_b16 v[68:69], v97 offset:49152
 ds_read_b64_tr_b16 v[70:71], v97 offset:50176
 buffer_load_dwordx4 a[4:7], v100, s[8:11], s37 offen
 s_mov_b32 s37, 548864
 s_waitcnt lgkmcnt(10)
 v_mfma_f32_32x32x16_bf16 v[32:47], v[72:75], a[164:167], v[32:47]
 ds_read_b64_tr_b16 v[72:73], v96 offset:51200
 ds_read_b64_tr_b16 v[74:75], v96 offset:52224
 buffer_load_dwordx4 a[8:11], v100, s[8:11], s36 offen
 v_mfma_f32_32x32x16_bf16 v[48:63], v[76:79], a[164:167], v[48:63]
 ds_read_b64_tr_b16 v[76:77], v97 offset:51200
 ds_read_b64_tr_b16 v[78:79], v97 offset:52224
 buffer_load_dwordx4 a[12:15], v100, s[8:11], s37 offen
 v_mfma_f32_32x32x16_bf16 v[32:47], v[80:83], a[168:171], v[32:47]
 ds_read_b64_tr_b16 v[80:81], v96 offset:53248
 ds_read_b64_tr_b16 v[82:83], v96 offset:54272
 s_waitcnt lgkmcnt(10)
 v_mfma_f32_32x32x16_bf16 v[48:63], v[84:87], a[168:171], v[48:63]
 ds_read_b64_tr_b16 v[84:85], v97 offset:53248
 ds_read_b64_tr_b16 v[86:87], v97 offset:54272
 v_mfma_f32_32x32x16_bf16 v[32:47], v[88:91], a[172:175], v[32:47]
 ds_read_b64_tr_b16 v[88:89], v96 offset:55296
 ds_read_b64_tr_b16 v[90:91], v96 offset:56320
 v_mfma_f32_32x32x16_bf16 v[48:63], v[92:95], a[172:175], v[48:63]
 ds_read_b64_tr_b16 v[92:93], v97 offset:55296
 ds_read_b64_tr_b16 v[94:95], v97 offset:56320
 s_waitcnt lgkmcnt(10)
 v_mfma_f32_32x32x16_bf16 v[0:15], v[64:67], a[176:179], v[0:15]
 ds_read_b64_tr_b16 v[64:65], v96 offset:57344
 ds_read_b64_tr_b16 v[66:67], v96 offset:58368
 v_mfma_f32_32x32x16_bf16 v[16:31], v[68:71], a[176:179], v[16:31]
 ds_read_b64_tr_b16 v[68:69], v97 offset:57344
 ds_read_b64_tr_b16 v[70:71], v97 offset:58368
 v_mfma_f32_32x32x16_bf16 v[0:15], v[72:75], a[180:183], v[0:15]
 ds_read_b64_tr_b16 v[72:73], v96 offset:59392
 ds_read_b64_tr_b16 v[74:75], v96 offset:60416
 s_waitcnt lgkmcnt(10)
 s_nop 3
 v_mfma_f32_32x32x16_bf16 v[16:31], v[76:79], a[180:183], v[16:31]
 ds_read_b64_tr_b16 v[76:77], v97 offset:59392
 ds_read_b64_tr_b16 v[78:79], v97 offset:60416
 s_mov_b32 s36, 557056
 buffer_load_dwordx4 a[16:19], v100, s[8:11], s36 offen
 v_mfma_f32_32x32x16_bf16 v[0:15], v[80:83], a[184:187], v[0:15]
 ds_read_b64_tr_b16 v[80:81], v96 offset:61440
 ds_read_b64_tr_b16 v[82:83], v96 offset:62464
 s_nop 2
 v_mfma_f32_32x32x16_bf16 v[16:31], v[84:87], a[184:187], v[16:31]
 ds_read_b64_tr_b16 v[84:85], v97 offset:61440
 ds_read_b64_tr_b16 v[86:87], v97 offset:62464
 s_mov_b32 s37, 565248
 buffer_load_dwordx4 a[20:23], v100, s[8:11], s37 offen
 s_waitcnt lgkmcnt(10)
 v_mfma_f32_32x32x16_bf16 v[0:15], v[88:91], a[188:191], v[0:15]
 ds_read_b64_tr_b16 v[88:89], v96 offset:63488
 ds_read_b64_tr_b16 v[90:91], v96 offset:64512
 s_nop 1
 v_mfma_f32_32x32x16_bf16 v[16:31], v[92:95], a[188:191], v[16:31]
 ds_read_b64_tr_b16 v[92:93], v97 offset:63488
 ds_read_b64_tr_b16 v[94:95], v97 offset:64512
 s_mov_b32 s36, 573440
 buffer_load_dwordx4 a[24:27], v100, s[8:11], s36 offen
 v_mfma_f32_32x32x16_bf16 v[32:47], v[64:67], a[176:179], v[32:47]
 ds_read_b64_tr_b16 v[64:65], v98 offset:0
 ds_read_b64_tr_b16 v[66:67], v98 offset:1024
 s_waitcnt lgkmcnt(10)
 v_mfma_f32_32x32x16_bf16 v[48:63], v[68:71], a[176:179], v[48:63]
 ds_read_b64_tr_b16 v[68:69], v99 offset:0
 ds_read_b64_tr_b16 v[70:71], v99 offset:1024
 s_mov_b32 s37, 581632
 buffer_load_dwordx4 a[28:31], v100, s[8:11], s37 offen
 v_mfma_f32_32x32x16_bf16 v[32:47], v[72:75], a[180:183], v[32:47]
 ds_read_b64_tr_b16 v[72:73], v98 offset:2048
 ds_read_b64_tr_b16 v[74:75], v98 offset:3072
 v_mfma_f32_32x32x16_bf16 v[48:63], v[76:79], a[180:183], v[48:63]
 ds_read_b64_tr_b16 v[76:77], v99 offset:2048
 ds_read_b64_tr_b16 v[78:79], v99 offset:3072
 s_waitcnt lgkmcnt(10)
 v_mfma_f32_32x32x16_bf16 v[32:47], v[80:83], a[184:187], v[32:47]
 ds_read_b64_tr_b16 v[80:81], v98 offset:4096
 ds_read_b64_tr_b16 v[82:83], v98 offset:5120
 v_mfma_f32_32x32x16_bf16 v[48:63], v[84:87], a[184:187], v[48:63]
 ds_read_b64_tr_b16 v[84:85], v99 offset:4096
 ds_read_b64_tr_b16 v[86:87], v99 offset:5120
 v_mfma_f32_32x32x16_bf16 v[32:47], v[88:91], a[188:191], v[32:47]
 ds_read_b64_tr_b16 v[88:89], v98 offset:6144
 ds_read_b64_tr_b16 v[90:91], v98 offset:7168
 s_waitcnt lgkmcnt(10)
 v_mfma_f32_32x32x16_bf16 v[48:63], v[92:95], a[188:191], v[48:63]
 s_waitcnt vmcnt(30)
 s_barrier
 ds_read_b64_tr_b16 v[92:93], v99 offset:6144
 ds_read_b64_tr_b16 v[94:95], v99 offset:7168
 s_add_u32 m0, s28, 32768
 s_add_u32 s32, s40, 147456
 buffer_load_dwordx4 v101, s[12:15], s32 offen lds
 v_mfma_f32_32x32x16_bf16 v[0:15], v[64:67], a[192:195], v[0:15]
 ds_read_b64_tr_b16 v[64:65], v98 offset:8192
 ds_read_b64_tr_b16 v[66:67], v98 offset:9216
 v_mfma_f32_32x32x16_bf16 v[16:31], v[68:71], a[192:195], v[16:31]
 ds_read_b64_tr_b16 v[68:69], v99 offset:8192
 ds_read_b64_tr_b16 v[70:71], v99 offset:9216
 buffer_load_dwordx4 v101, s[12:15], s32 offen offset:1024 lds
 s_add_u32 m0, s28, 40960
 s_add_u32 s33, s41, 147456
 s_waitcnt lgkmcnt(10)
 v_mfma_f32_32x32x16_bf16 v[0:15], v[72:75], a[196:199], v[0:15]
 ds_read_b64_tr_b16 v[72:73], v98 offset:10240
 ds_read_b64_tr_b16 v[74:75], v98 offset:11264
 buffer_load_dwordx4 v101, s[12:15], s33 offen lds
 v_mfma_f32_32x32x16_bf16 v[16:31], v[76:79], a[196:199], v[16:31]
 ds_read_b64_tr_b16 v[76:77], v99 offset:10240
 ds_read_b64_tr_b16 v[78:79], v99 offset:11264
 buffer_load_dwordx4 v101, s[12:15], s33 offen offset:1024 lds
 s_add_u32 m0, s28, 49152
 s_add_u32 s34, s40, 155648
 s_mov_b32 s36, 589824
 v_mfma_f32_32x32x16_bf16 v[0:15], v[80:83], a[200:203], v[0:15]
 ds_read_b64_tr_b16 v[80:81], v98 offset:12288
 ds_read_b64_tr_b16 v[82:83], v98 offset:13312
 buffer_load_dwordx4 v101, s[12:15], s34 offen lds
 s_waitcnt lgkmcnt(10)
 v_mfma_f32_32x32x16_bf16 v[16:31], v[84:87], a[200:203], v[16:31]
 ds_read_b64_tr_b16 v[84:85], v99 offset:12288
 ds_read_b64_tr_b16 v[86:87], v99 offset:13312
 buffer_load_dwordx4 v101, s[12:15], s34 offen offset:1024 lds
 s_add_u32 m0, s28, 57344
 s_add_u32 s35, s41, 155648
 s_mov_b32 s37, 598016
 v_mfma_f32_32x32x16_bf16 v[0:15], v[88:91], a[204:207], v[0:15]
 ds_read_b64_tr_b16 v[88:89], v98 offset:14336
 ds_read_b64_tr_b16 v[90:91], v98 offset:15360
 buffer_load_dwordx4 v101, s[12:15], s35 offen lds
 v_mfma_f32_32x32x16_bf16 v[16:31], v[92:95], a[204:207], v[16:31]
 ds_read_b64_tr_b16 v[92:93], v99 offset:14336
 ds_read_b64_tr_b16 v[94:95], v99 offset:15360
 buffer_load_dwordx4 v101, s[12:15], s35 offen offset:1024 lds
 s_waitcnt lgkmcnt(9)
 v_mfma_f32_32x32x16_bf16 v[32:47], v[64:67], a[192:195], v[32:47]
 ds_read_b64_tr_b16 v[64:65], v98 offset:16384
 ds_read_b64_tr_b16 v[66:67], v98 offset:17408
 buffer_load_dwordx4 a[32:35], v100, s[8:11], s36 offen
 s_mov_b32 s36, 606208
 v_mfma_f32_32x32x16_bf16 v[48:63], v[68:71], a[192:195], v[48:63]
 ds_read_b64_tr_b16 v[68:69], v99 offset:16384
 ds_read_b64_tr_b16 v[70:71], v99 offset:17408
 buffer_load_dwordx4 a[36:39], v100, s[8:11], s37 offen
 s_mov_b32 s37, 614400
 v_mfma_f32_32x32x16_bf16 v[32:47], v[72:75], a[196:199], v[32:47]
 ds_read_b64_tr_b16 v[72:73], v98 offset:18432
 ds_read_b64_tr_b16 v[74:75], v98 offset:19456
 buffer_load_dwordx4 a[40:43], v100, s[8:11], s36 offen
 s_waitcnt lgkmcnt(10)
 v_mfma_f32_32x32x16_bf16 v[48:63], v[76:79], a[196:199], v[48:63]
 ds_read_b64_tr_b16 v[76:77], v99 offset:18432
 ds_read_b64_tr_b16 v[78:79], v99 offset:19456
 buffer_load_dwordx4 a[44:47], v100, s[8:11], s37 offen
 v_mfma_f32_32x32x16_bf16 v[32:47], v[80:83], a[200:203], v[32:47]
 ds_read_b64_tr_b16 v[80:81], v98 offset:20480
 ds_read_b64_tr_b16 v[82:83], v98 offset:21504
 v_mfma_f32_32x32x16_bf16 v[48:63], v[84:87], a[200:203], v[48:63]
 ds_read_b64_tr_b16 v[84:85], v99 offset:20480
 ds_read_b64_tr_b16 v[86:87], v99 offset:21504
 s_waitcnt lgkmcnt(10)
 v_mfma_f32_32x32x16_bf16 v[32:47], v[88:91], a[204:207], v[32:47]
 ds_read_b64_tr_b16 v[88:89], v98 offset:22528
 ds_read_b64_tr_b16 v[90:91], v98 offset:23552
 v_mfma_f32_32x32x16_bf16 v[48:63], v[92:95], a[204:207], v[48:63]
 ds_read_b64_tr_b16 v[92:93], v99 offset:22528
 ds_read_b64_tr_b16 v[94:95], v99 offset:23552
 v_mfma_f32_32x32x16_bf16 v[0:15], v[64:67], a[208:211], v[0:15]
 ds_read_b64_tr_b16 v[64:65], v98 offset:24576
 ds_read_b64_tr_b16 v[66:67], v98 offset:25600
 s_waitcnt lgkmcnt(10)
 v_mfma_f32_32x32x16_bf16 v[16:31], v[68:71], a[208:211], v[16:31]
 ds_read_b64_tr_b16 v[68:69], v99 offset:24576
 ds_read_b64_tr_b16 v[70:71], v99 offset:25600
 v_mfma_f32_32x32x16_bf16 v[0:15], v[72:75], a[212:215], v[0:15]
 ds_read_b64_tr_b16 v[72:73], v98 offset:26624
 ds_read_b64_tr_b16 v[74:75], v98 offset:27648
 s_nop 4
 v_mfma_f32_32x32x16_bf16 v[16:31], v[76:79], a[212:215], v[16:31]
 ds_read_b64_tr_b16 v[76:77], v99 offset:26624
 ds_read_b64_tr_b16 v[78:79], v99 offset:27648
 s_mov_b32 s36, 622592
 buffer_load_dwordx4 a[48:51], v100, s[8:11], s36 offen
 s_waitcnt lgkmcnt(10)
 v_mfma_f32_32x32x16_bf16 v[0:15], v[80:83], a[216:219], v[0:15]
 ds_read_b64_tr_b16 v[80:81], v98 offset:28672
 ds_read_b64_tr_b16 v[82:83], v98 offset:29696
 s_nop 1
 v_mfma_f32_32x32x16_bf16 v[16:31], v[84:87], a[216:219], v[16:31]
 ds_read_b64_tr_b16 v[84:85], v99 offset:28672
 ds_read_b64_tr_b16 v[86:87], v99 offset:29696
 s_mov_b32 s37, 630784
 buffer_load_dwordx4 a[52:55], v100, s[8:11], s37 offen
 v_mfma_f32_32x32x16_bf16 v[0:15], v[88:91], a[220:223], v[0:15]
 ds_read_b64_tr_b16 v[88:89], v98 offset:30720
 ds_read_b64_tr_b16 v[90:91], v98 offset:31744
 s_waitcnt lgkmcnt(10)
 s_nop 1
 v_mfma_f32_32x32x16_bf16 v[16:31], v[92:95], a[220:223], v[16:31]
 ds_read_b64_tr_b16 v[92:93], v99 offset:30720
 ds_read_b64_tr_b16 v[94:95], v99 offset:31744
 s_mov_b32 s36, 638976
 buffer_load_dwordx4 a[56:59], v100, s[8:11], s36 offen
 v_mfma_f32_32x32x16_bf16 v[32:47], v[64:67], a[208:211], v[32:47]
 ds_read_b64_tr_b16 v[64:65], v98 offset:32768
 ds_read_b64_tr_b16 v[66:67], v98 offset:33792
 v_mfma_f32_32x32x16_bf16 v[48:63], v[68:71], a[208:211], v[48:63]
 ds_read_b64_tr_b16 v[68:69], v99 offset:32768
 ds_read_b64_tr_b16 v[70:71], v99 offset:33792
 s_mov_b32 s37, 647168
 s_nop 0
 buffer_load_dwordx4 a[60:63], v100, s[8:11], s37 offen
 s_waitcnt lgkmcnt(10)
 v_mfma_f32_32x32x16_bf16 v[32:47], v[72:75], a[212:215], v[32:47]
 ds_read_b64_tr_b16 v[72:73], v98 offset:34816
 ds_read_b64_tr_b16 v[74:75], v98 offset:35840
 v_mfma_f32_32x32x16_bf16 v[48:63], v[76:79], a[212:215], v[48:63]
 ds_read_b64_tr_b16 v[76:77], v99 offset:34816
 ds_read_b64_tr_b16 v[78:79], v99 offset:35840
 v_mfma_f32_32x32x16_bf16 v[32:47], v[80:83], a[216:219], v[32:47]
 ds_read_b64_tr_b16 v[80:81], v98 offset:36864
 ds_read_b64_tr_b16 v[82:83], v98 offset:37888
 s_waitcnt lgkmcnt(10)
 v_mfma_f32_32x32x16_bf16 v[48:63], v[84:87], a[216:219], v[48:63]
 ds_read_b64_tr_b16 v[84:85], v99 offset:36864
 ds_read_b64_tr_b16 v[86:87], v99 offset:37888
 v_mfma_f32_32x32x16_bf16 v[32:47], v[88:91], a[220:223], v[32:47]
 ds_read_b64_tr_b16 v[88:89], v98 offset:38912
 ds_read_b64_tr_b16 v[90:91], v98 offset:39936
 v_mfma_f32_32x32x16_bf16 v[48:63], v[92:95], a[220:223], v[48:63]
 s_waitcnt vmcnt(30)
 s_barrier
 ds_read_b64_tr_b16 v[92:93], v99 offset:38912
 ds_read_b64_tr_b16 v[94:95], v99 offset:39936
 s_add_u32 m0, s28, 65536
 s_add_u32 s32, s40, 163840
 buffer_load_dwordx4 v101, s[12:15], s32 offen lds
 s_waitcnt lgkmcnt(10)
 v_mfma_f32_32x32x16_bf16 v[0:15], v[64:67], a[224:227], v[0:15]
 ds_read_b64_tr_b16 v[64:65], v98 offset:40960
 ds_read_b64_tr_b16 v[66:67], v98 offset:41984
 v_mfma_f32_32x32x16_bf16 v[16:31], v[68:71], a[224:227], v[16:31]
 ds_read_b64_tr_b16 v[68:69], v99 offset:40960
 ds_read_b64_tr_b16 v[70:71], v99 offset:41984
 buffer_load_dwordx4 v101, s[12:15], s32 offen offset:1024 lds
 s_add_u32 m0, s28, 73728
 s_add_u32 s33, s41, 163840
 v_mfma_f32_32x32x16_bf16 v[0:15], v[72:75], a[228:231], v[0:15]
 ds_read_b64_tr_b16 v[72:73], v98 offset:43008
 ds_read_b64_tr_b16 v[74:75], v98 offset:44032
 buffer_load_dwordx4 v101, s[12:15], s33 offen lds
 s_waitcnt lgkmcnt(10)
 v_mfma_f32_32x32x16_bf16 v[16:31], v[76:79], a[228:231], v[16:31]
 ds_read_b64_tr_b16 v[76:77], v99 offset:43008
 ds_read_b64_tr_b16 v[78:79], v99 offset:44032
 buffer_load_dwordx4 v101, s[12:15], s33 offen offset:1024 lds
 s_add_u32 m0, s28, 81920
 s_add_u32 s34, s40, 172032
 s_mov_b32 s36, 655360
 v_mfma_f32_32x32x16_bf16 v[0:15], v[80:83], a[232:235], v[0:15]
 ds_read_b64_tr_b16 v[80:81], v98 offset:45056
 ds_read_b64_tr_b16 v[82:83], v98 offset:46080
 buffer_load_dwordx4 v101, s[12:15], s34 offen lds
 v_mfma_f32_32x32x16_bf16 v[16:31], v[84:87], a[232:235], v[16:31]
 ds_read_b64_tr_b16 v[84:85], v99 offset:45056
 ds_read_b64_tr_b16 v[86:87], v99 offset:46080
 buffer_load_dwordx4 v101, s[12:15], s34 offen offset:1024 lds
 s_add_u32 m0, s28, 90112
 s_add_u32 s35, s41, 172032
 s_mov_b32 s37, 663552
 s_waitcnt lgkmcnt(9)
 v_mfma_f32_32x32x16_bf16 v[0:15], v[88:91], a[236:239], v[0:15]
 ds_read_b64_tr_b16 v[88:89], v98 offset:47104
 ds_read_b64_tr_b16 v[90:91], v98 offset:48128
 buffer_load_dwordx4 v101, s[12:15], s35 offen lds
 v_mfma_f32_32x32x16_bf16 v[16:31], v[92:95], a[236:239], v[16:31]
 ds_read_b64_tr_b16 v[92:93], v99 offset:47104
 ds_read_b64_tr_b16 v[94:95], v99 offset:48128
 buffer_load_dwordx4 v101, s[12:15], s35 offen offset:1024 lds
 v_mfma_f32_32x32x16_bf16 v[32:47], v[64:67], a[224:227], v[32:47]
 ds_read_b64_tr_b16 v[64:65], v98 offset:49152
 ds_read_b64_tr_b16 v[66:67], v98 offset:50176
 buffer_load_dwordx4 a[64:67], v100, s[8:11], s36 offen
 s_mov_b32 s36, 671744
 s_waitcnt lgkmcnt(10)
 v_mfma_f32_32x32x16_bf16 v[48:63], v[68:71], a[224:227], v[48:63]
 ds_read_b64_tr_b16 v[68:69], v99 offset:49152
 ds_read_b64_tr_b16 v[70:71], v99 offset:50176
 buffer_load_dwordx4 a[68:71], v100, s[8:11], s37 offen
 s_mov_b32 s37, 679936
 v_mfma_f32_32x32x16_bf16 v[32:47], v[72:75], a[228:231], v[32:47]
 ds_read_b64_tr_b16 v[72:73], v98 offset:51200
 ds_read_b64_tr_b16 v[74:75], v98 offset:52224
 buffer_load_dwordx4 a[72:75], v100, s[8:11], s36 offen
 v_mfma_f32_32x32x16_bf16 v[48:63], v[76:79], a[228:231], v[48:63]
 ds_read_b64_tr_b16 v[76:77], v99 offset:51200
 ds_read_b64_tr_b16 v[78:79], v99 offset:52224
 buffer_load_dwordx4 a[76:79], v100, s[8:11], s37 offen
 s_waitcnt lgkmcnt(10)
 v_mfma_f32_32x32x16_bf16 v[32:47], v[80:83], a[232:235], v[32:47]
 ds_read_b64_tr_b16 v[80:81], v98 offset:53248
 ds_read_b64_tr_b16 v[82:83], v98 offset:54272
 v_mfma_f32_32x32x16_bf16 v[48:63], v[84:87], a[232:235], v[48:63]
 ds_read_b64_tr_b16 v[84:85], v99 offset:53248
 ds_read_b64_tr_b16 v[86:87], v99 offset:54272
 v_mfma_f32_32x32x16_bf16 v[32:47], v[88:91], a[236:239], v[32:47]
 ds_read_b64_tr_b16 v[88:89], v98 offset:55296
 ds_read_b64_tr_b16 v[90:91], v98 offset:56320
 s_waitcnt lgkmcnt(10)
 v_mfma_f32_32x32x16_bf16 v[48:63], v[92:95], a[236:239], v[48:63]
 ds_read_b64_tr_b16 v[92:93], v99 offset:55296
 ds_read_b64_tr_b16 v[94:95], v99 offset:56320
 v_mfma_f32_32x32x16_bf16 v[0:15], v[64:67], a[240:243], v[0:15]
 ds_read_b64_tr_b16 v[64:65], v98 offset:57344
 ds_read_b64_tr_b16 v[66:67], v98 offset:58368
 v_mfma_f32_32x32x16_bf16 v[16:31], v[68:71], a[240:243], v[16:31]
 ds_read_b64_tr_b16 v[68:69], v99 offset:57344
 ds_read_b64_tr_b16 v[70:71], v99 offset:58368
 s_waitcnt lgkmcnt(10)
 v_mfma_f32_32x32x16_bf16 v[0:15], v[72:75], a[244:247], v[0:15]
 ds_read_b64_tr_b16 v[72:73], v98 offset:59392
 ds_read_b64_tr_b16 v[74:75], v98 offset:60416
 s_nop 3
 v_mfma_f32_32x32x16_bf16 v[16:31], v[76:79], a[244:247], v[16:31]
 ds_read_b64_tr_b16 v[76:77], v99 offset:59392
 ds_read_b64_tr_b16 v[78:79], v99 offset:60416
 s_mov_b32 s36, 688128
 buffer_load_dwordx4 a[80:83], v100, s[8:11], s36 offen
 v_mfma_f32_32x32x16_bf16 v[0:15], v[80:83], a[248:251], v[0:15]
 ds_read_b64_tr_b16 v[80:81], v98 offset:61440
 ds_read_b64_tr_b16 v[82:83], v98 offset:62464
 s_waitcnt lgkmcnt(10)
 s_nop 1
 v_mfma_f32_32x32x16_bf16 v[16:31], v[84:87], a[248:251], v[16:31]
 ds_read_b64_tr_b16 v[84:85], v99 offset:61440
 ds_read_b64_tr_b16 v[86:87], v99 offset:62464
 s_mov_b32 s37, 696320
 buffer_load_dwordx4 a[84:87], v100, s[8:11], s37 offen
 v_mfma_f32_32x32x16_bf16 v[0:15], v[88:91], a[252:255], v[0:15]
 ds_read_b64_tr_b16 v[88:89], v98 offset:63488
 ds_read_b64_tr_b16 v[90:91], v98 offset:64512
 s_nop 2
 v_mfma_f32_32x32x16_bf16 v[16:31], v[92:95], a[252:255], v[16:31]
 ds_read_b64_tr_b16 v[92:93], v99 offset:63488
 ds_read_b64_tr_b16 v[94:95], v99 offset:64512
 s_mov_b32 s36, 704512
 buffer_load_dwordx4 a[88:91], v100, s[8:11], s36 offen
 s_waitcnt lgkmcnt(10)
 v_mfma_f32_32x32x16_bf16 v[32:47], v[64:67], a[240:243], v[32:47]
 ds_read_b64_tr_b16 v[64:65], v96 offset:0
 ds_read_b64_tr_b16 v[66:67], v96 offset:1024
 v_mfma_f32_32x32x16_bf16 v[48:63], v[68:71], a[240:243], v[48:63]
 ds_read_b64_tr_b16 v[68:69], v97 offset:0
 ds_read_b64_tr_b16 v[70:71], v97 offset:1024
 s_mov_b32 s37, 712704
 buffer_load_dwordx4 a[92:95], v100, s[8:11], s37 offen
 v_mfma_f32_32x32x16_bf16 v[32:47], v[72:75], a[244:247], v[32:47]
 ds_read_b64_tr_b16 v[72:73], v96 offset:2048
 ds_read_b64_tr_b16 v[74:75], v96 offset:3072
 s_waitcnt lgkmcnt(10)
 v_mfma_f32_32x32x16_bf16 v[48:63], v[76:79], a[244:247], v[48:63]
 ds_read_b64_tr_b16 v[76:77], v97 offset:2048
 ds_read_b64_tr_b16 v[78:79], v97 offset:3072
 v_mfma_f32_32x32x16_bf16 v[32:47], v[80:83], a[248:251], v[32:47]
 ds_read_b64_tr_b16 v[80:81], v96 offset:4096
 ds_read_b64_tr_b16 v[82:83], v96 offset:5120
 v_mfma_f32_32x32x16_bf16 v[48:63], v[84:87], a[248:251], v[48:63]
 ds_read_b64_tr_b16 v[84:85], v97 offset:4096
 ds_read_b64_tr_b16 v[86:87], v97 offset:5120
 s_waitcnt lgkmcnt(10)
 v_mfma_f32_32x32x16_bf16 v[32:47], v[88:91], a[252:255], v[32:47]
 ds_read_b64_tr_b16 v[88:89], v96 offset:6144
 ds_read_b64_tr_b16 v[90:91], v96 offset:7168
 v_mfma_f32_32x32x16_bf16 v[48:63], v[92:95], a[252:255], v[48:63]
 s_waitcnt vmcnt(30)
 s_barrier
 ds_read_b64_tr_b16 v[92:93], v97 offset:6144
 ds_read_b64_tr_b16 v[94:95], v97 offset:7168
 s_add_u32 m0, s28, 98304
 s_add_u32 s32, s40, 180224
 buffer_load_dwordx4 v101, s[12:15], s32 offen lds
 v_mfma_f32_32x32x16_bf16 v[0:15], v[64:67], a[0:3], v[0:15]
 ds_read_b64_tr_b16 v[64:65], v96 offset:8192
 ds_read_b64_tr_b16 v[66:67], v96 offset:9216
 s_waitcnt lgkmcnt(10)
 v_mfma_f32_32x32x16_bf16 v[16:31], v[68:71], a[0:3], v[16:31]
 ds_read_b64_tr_b16 v[68:69], v97 offset:8192
 ds_read_b64_tr_b16 v[70:71], v97 offset:9216
 buffer_load_dwordx4 v101, s[12:15], s32 offen offset:1024 lds
 s_add_u32 m0, s28, 106496
 s_add_u32 s33, s40, 188416
 v_mfma_f32_32x32x16_bf16 v[0:15], v[72:75], a[4:7], v[0:15]
 ds_read_b64_tr_b16 v[72:73], v96 offset:10240
 ds_read_b64_tr_b16 v[74:75], v96 offset:11264
 buffer_load_dwordx4 v101, s[12:15], s33 offen lds
 s_nop 0
 v_mfma_f32_32x32x16_bf16 v[16:31], v[76:79], a[4:7], v[16:31]
 ds_read_b64_tr_b16 v[76:77], v97 offset:10240
 ds_read_b64_tr_b16 v[78:79], v97 offset:11264
 buffer_load_dwordx4 v101, s[12:15], s33 offen offset:1024 lds
 s_add_u32 m0, s28, 114688
 s_add_u32 s34, s40, 196608
 s_mov_b32 s36, 720896
 s_waitcnt lgkmcnt(10)
 v_mfma_f32_32x32x16_bf16 v[0:15], v[80:83], a[8:11], v[0:15]
 ds_read_b64_tr_b16 v[80:81], v96 offset:12288
 ds_read_b64_tr_b16 v[82:83], v96 offset:13312
 buffer_load_dwordx4 v101, s[12:15], s34 offen lds
 v_mfma_f32_32x32x16_bf16 v[16:31], v[84:87], a[8:11], v[16:31]
 ds_read_b64_tr_b16 v[84:85], v97 offset:12288
 ds_read_b64_tr_b16 v[86:87], v97 offset:13312
 buffer_load_dwordx4 v101, s[12:15], s34 offen offset:1024 lds
 s_add_u32 m0, s28, 122880
 s_add_u32 s35, s40, 204800
 s_mov_b32 s37, 729088
 v_mfma_f32_32x32x16_bf16 v[0:15], v[88:91], a[12:15], v[0:15]
 ds_read_b64_tr_b16 v[88:89], v96 offset:14336
 ds_read_b64_tr_b16 v[90:91], v96 offset:15360
 buffer_load_dwordx4 v101, s[12:15], s35 offen lds
 s_waitcnt lgkmcnt(9)
 v_mfma_f32_32x32x16_bf16 v[16:31], v[92:95], a[12:15], v[16:31]
 ds_read_b64_tr_b16 v[92:93], v97 offset:14336
 ds_read_b64_tr_b16 v[94:95], v97 offset:15360
 buffer_load_dwordx4 v101, s[12:15], s35 offen offset:1024 lds
 v_mfma_f32_32x32x16_bf16 v[32:47], v[64:67], a[0:3], v[32:47]
 ds_read_b64_tr_b16 v[64:65], v96 offset:16384
 ds_read_b64_tr_b16 v[66:67], v96 offset:17408
 buffer_load_dwordx4 a[96:99], v100, s[8:11], s36 offen
 s_mov_b32 s36, 737280
 v_mfma_f32_32x32x16_bf16 v[48:63], v[68:71], a[0:3], v[48:63]
 ds_read_b64_tr_b16 v[68:69], v97 offset:16384
 ds_read_b64_tr_b16 v[70:71], v97 offset:17408
 buffer_load_dwordx4 a[100:103], v100, s[8:11], s37 offen
 s_mov_b32 s37, 745472
 s_waitcnt lgkmcnt(10)
 v_mfma_f32_32x32x16_bf16 v[32:47], v[72:75], a[4:7], v[32:47]
 ds_read_b64_tr_b16 v[72:73], v96 offset:18432
 ds_read_b64_tr_b16 v[74:75], v96 offset:19456
 buffer_load_dwordx4 a[104:107], v100, s[8:11], s36 offen
 v_mfma_f32_32x32x16_bf16 v[48:63], v[76:79], a[4:7], v[48:63]
 ds_read_b64_tr_b16 v[76:77], v97 offset:18432
 ds_read_b64_tr_b16 v[78:79], v97 offset:19456
 buffer_load_dwordx4 a[108:111], v100, s[8:11], s37 offen
 v_mfma_f32_32x32x16_bf16 v[32:47], v[80:83], a[8:11], v[32:47]
 ds_read_b64_tr_b16 v[80:81], v96 offset:20480
 ds_read_b64_tr_b16 v[82:83], v96 offset:21504
 s_waitcnt lgkmcnt(10)
 v_mfma_f32_32x32x16_bf16 v[48:63], v[84:87], a[8:11], v[48:63]
 ds_read_b64_tr_b16 v[84:85], v97 offset:20480
 ds_read_b64_tr_b16 v[86:87], v97 offset:21504
 v_mfma_f32_32x32x16_bf16 v[32:47], v[88:91], a[12:15], v[32:47]
 ds_read_b64_tr_b16 v[88:89], v96 offset:22528
 ds_read_b64_tr_b16 v[90:91], v96 offset:23552
 v_mfma_f32_32x32x16_bf16 v[48:63], v[92:95], a[12:15], v[48:63]
 ds_read_b64_tr_b16 v[92:93], v97 offset:22528
 ds_read_b64_tr_b16 v[94:95], v97 offset:23552
 s_waitcnt lgkmcnt(10)
 v_mfma_f32_32x32x16_bf16 v[0:15], v[64:67], a[16:19], v[0:15]
 ds_read_b64_tr_b16 v[64:65], v96 offset:24576
 ds_read_b64_tr_b16 v[66:67], v96 offset:25600
 v_mfma_f32_32x32x16_bf16 v[16:31], v[68:71], a[16:19], v[16:31]
 ds_read_b64_tr_b16 v[68:69], v97 offset:24576
 ds_read_b64_tr_b16 v[70:71], v97 offset:25600
 v_mfma_f32_32x32x16_bf16 v[0:15], v[72:75], a[20:23], v[0:15]
 ds_read_b64_tr_b16 v[72:73], v96 offset:26624
 ds_read_b64_tr_b16 v[74:75], v96 offset:27648
 s_waitcnt lgkmcnt(10)
 s_nop 3
 v_mfma_f32_32x32x16_bf16 v[16:31], v[76:79], a[20:23], v[16:31]
 ds_read_b64_tr_b16 v[76:77], v97 offset:26624
 ds_read_b64_tr_b16 v[78:79], v97 offset:27648
 s_mov_b32 s36, 753664
 buffer_load_dwordx4 a[112:115], v100, s[8:11], s36 offen
 v_mfma_f32_32x32x16_bf16 v[0:15], v[80:83], a[24:27], v[0:15]
 ds_read_b64_tr_b16 v[80:81], v96 offset:28672
 ds_read_b64_tr_b16 v[82:83], v96 offset:29696
 s_nop 2
 v_mfma_f32_32x32x16_bf16 v[16:31], v[84:87], a[24:27], v[16:31]
 ds_read_b64_tr_b16 v[84:85], v97 offset:28672
 ds_read_b64_tr_b16 v[86:87], v97 offset:29696
 s_mov_b32 s37, 761856
 buffer_load_dwordx4 a[116:119], v100, s[8:11], s37 offen
 s_waitcnt lgkmcnt(10)
 v_mfma_f32_32x32x16_bf16 v[0:15], v[88:91], a[28:31], v[0:15]
 ds_read_b64_tr_b16 v[88:89], v96 offset:30720
 ds_read_b64_tr_b16 v[90:91], v96 offset:31744
 s_nop 1
 v_mfma_f32_32x32x16_bf16 v[16:31], v[92:95], a[28:31], v[16:31]
 ds_read_b64_tr_b16 v[92:93], v97 offset:30720
 ds_read_b64_tr_b16 v[94:95], v97 offset:31744
 s_mov_b32 s36, 770048
 buffer_load_dwordx4 a[120:123], v100, s[8:11], s36 offen
 v_mfma_f32_32x32x16_bf16 v[32:47], v[64:67], a[16:19], v[32:47]
 ds_read_b64_tr_b16 v[64:65], v96 offset:32768
 ds_read_b64_tr_b16 v[66:67], v96 offset:33792
 s_waitcnt lgkmcnt(10)
 v_mfma_f32_32x32x16_bf16 v[48:63], v[68:71], a[16:19], v[48:63]
 ds_read_b64_tr_b16 v[68:69], v97 offset:32768
 ds_read_b64_tr_b16 v[70:71], v97 offset:33792
 s_mov_b32 s37, 778240
 buffer_load_dwordx4 a[124:127], v100, s[8:11], s37 offen
 v_mfma_f32_32x32x16_bf16 v[32:47], v[72:75], a[20:23], v[32:47]
 ds_read_b64_tr_b16 v[72:73], v96 offset:34816
 ds_read_b64_tr_b16 v[74:75], v96 offset:35840
 v_mfma_f32_32x32x16_bf16 v[48:63], v[76:79], a[20:23], v[48:63]
 ds_read_b64_tr_b16 v[76:77], v97 offset:34816
 ds_read_b64_tr_b16 v[78:79], v97 offset:35840
 s_waitcnt lgkmcnt(10)
 v_mfma_f32_32x32x16_bf16 v[32:47], v[80:83], a[24:27], v[32:47]
 ds_read_b64_tr_b16 v[80:81], v96 offset:36864
 ds_read_b64_tr_b16 v[82:83], v96 offset:37888
 v_mfma_f32_32x32x16_bf16 v[48:63], v[84:87], a[24:27], v[48:63]
 ds_read_b64_tr_b16 v[84:85], v97 offset:36864
 ds_read_b64_tr_b16 v[86:87], v97 offset:37888
 v_mfma_f32_32x32x16_bf16 v[32:47], v[88:91], a[28:31], v[32:47]
 ds_read_b64_tr_b16 v[88:89], v96 offset:38912
 ds_read_b64_tr_b16 v[90:91], v96 offset:39936
 s_waitcnt lgkmcnt(10)
 v_mfma_f32_32x32x16_bf16 v[48:63], v[92:95], a[28:31], v[48:63]
 s_waitcnt vmcnt(30)
 s_barrier
 ds_read_b64_tr_b16 v[92:93], v97 offset:38912
 ds_read_b64_tr_b16 v[94:95], v97 offset:39936
 s_add_u32 m0, s28, 0
 s_add_u32 s32, s40, 212992
 buffer_load_dwordx4 v101, s[12:15], s32 offen lds
 v_mfma_f32_32x32x16_bf16 v[0:15], v[64:67], a[32:35], v[0:15]
 ds_read_b64_tr_b16 v[64:65], v96 offset:40960
 ds_read_b64_tr_b16 v[66:67], v96 offset:41984
 v_mfma_f32_32x32x16_bf16 v[16:31], v[68:71], a[32:35], v[16:31]
 ds_read_b64_tr_b16 v[68:69], v97 offset:40960
 ds_read_b64_tr_b16 v[70:71], v97 offset:41984
 buffer_load_dwordx4 v101, s[12:15], s32 offen offset:1024 lds
 s_add_u32 m0, s28, 8192
 s_add_u32 s33, s40, 221184
 s_waitcnt lgkmcnt(10)
 v_mfma_f32_32x32x16_bf16 v[0:15], v[72:75], a[36:39], v[0:15]
 ds_read_b64_tr_b16 v[72:73], v96 offset:43008
 ds_read_b64_tr_b16 v[74:75], v96 offset:44032
 buffer_load_dwordx4 v101, s[12:15], s33 offen lds
 v_mfma_f32_32x32x16_bf16 v[16:31], v[76:79], a[36:39], v[16:31]
 ds_read_b64_tr_b16 v[76:77], v97 offset:43008
 ds_read_b64_tr_b16 v[78:79], v97 offset:44032
 s_mov_b32 s36, 786432
 buffer_load_dwordx4 a[128:131], v100, s[8:11], s36 offen
 v_mfma_f32_32x32x16_bf16 v[0:15], v[80:83], a[40:43], v[0:15]
 ds_read_b64_tr_b16 v[80:81], v96 offset:45056
 ds_read_b64_tr_b16 v[82:83], v96 offset:46080
 s_waitcnt lgkmcnt(10)
 s_nop 1
 v_mfma_f32_32x32x16_bf16 v[16:31], v[84:87], a[40:43], v[16:31]
 ds_read_b64_tr_b16 v[84:85], v97 offset:45056
 ds_read_b64_tr_b16 v[86:87], v97 offset:46080
 s_mov_b32 s37, 794624
 buffer_load_dwordx4 a[132:135], v100, s[8:11], s37 offen
 v_mfma_f32_32x32x16_bf16 v[0:15], v[88:91], a[44:47], v[0:15]
 ds_read_b64_tr_b16 v[88:89], v96 offset:47104
 ds_read_b64_tr_b16 v[90:91], v96 offset:48128
 s_nop 2
 v_mfma_f32_32x32x16_bf16 v[16:31], v[92:95], a[44:47], v[16:31]
 ds_read_b64_tr_b16 v[92:93], v97 offset:47104
 ds_read_b64_tr_b16 v[94:95], v97 offset:48128
 s_mov_b32 s36, 802816
 buffer_load_dwordx4 a[136:139], v100, s[8:11], s36 offen
 s_waitcnt lgkmcnt(10)
 v_mfma_f32_32x32x16_bf16 v[32:47], v[64:67], a[32:35], v[32:47]
 ds_read_b64_tr_b16 v[64:65], v96 offset:49152
 ds_read_b64_tr_b16 v[66:67], v96 offset:50176
 v_mfma_f32_32x32x16_bf16 v[48:63], v[68:71], a[32:35], v[48:63]
 ds_read_b64_tr_b16 v[68:69], v97 offset:49152
 ds_read_b64_tr_b16 v[70:71], v97 offset:50176
 s_mov_b32 s37, 811008
 buffer_load_dwordx4 a[140:143], v100, s[8:11], s37 offen
 v_mfma_f32_32x32x16_bf16 v[32:47], v[72:75], a[36:39], v[32:47]
 ds_read_b64_tr_b16 v[72:73], v96 offset:51200
 ds_read_b64_tr_b16 v[74:75], v96 offset:52224
 s_waitcnt lgkmcnt(10)
 v_mfma_f32_32x32x16_bf16 v[48:63], v[76:79], a[36:39], v[48:63]
 ds_read_b64_tr_b16 v[76:77], v97 offset:51200
 ds_read_b64_tr_b16 v[78:79], v97 offset:52224
 buffer_load_dwordx4 v101, s[12:15], s33 offen offset:1024 lds
 s_add_u32 m0, s28, 16384
 s_add_u32 s34, s40, 229376
 v_mfma_f32_32x32x16_bf16 v[32:47], v[80:83], a[40:43], v[32:47]
 ds_read_b64_tr_b16 v[80:81], v96 offset:53248
 ds_read_b64_tr_b16 v[82:83], v96 offset:54272
 buffer_load_dwordx4 v101, s[12:15], s34 offen lds
 v_mfma_f32_32x32x16_bf16 v[48:63], v[84:87], a[40:43], v[48:63]
 ds_read_b64_tr_b16 v[84:85], v97 offset:53248
 ds_read_b64_tr_b16 v[86:87], v97 offset:54272
 buffer_load_dwordx4 v101, s[12:15], s34 offen offset:1024 lds
 s_add_u32 m0, s28, 24576
 s_add_u32 s35, s40, 237568
 s_waitcnt lgkmcnt(10)
 v_mfma_f32_32x32x16_bf16 v[32:47], v[88:91], a[44:47], v[32:47]
 ds_read_b64_tr_b16 v[88:89], v96 offset:55296
 ds_read_b64_tr_b16 v[90:91], v96 offset:56320
 buffer_load_dwordx4 v101, s[12:15], s35 offen lds
 v_mfma_f32_32x32x16_bf16 v[48:63], v[92:95], a[44:47], v[48:63]
 ds_read_b64_tr_b16 v[92:93], v97 offset:55296
 ds_read_b64_tr_b16 v[94:95], v97 offset:56320
 buffer_load_dwordx4 v101, s[12:15], s35 offen offset:1024 lds
 v_mfma_f32_32x32x16_bf16 v[0:15], v[64:67], a[48:51], v[0:15]
 ds_read_b64_tr_b16 v[64:65], v96 offset:57344
 ds_read_b64_tr_b16 v[66:67], v96 offset:58368
 s_waitcnt lgkmcnt(10)
 v_mfma_f32_32x32x16_bf16 v[16:31], v[68:71], a[48:51], v[16:31]
 ds_read_b64_tr_b16 v[68:69], v97 offset:57344
 ds_read_b64_tr_b16 v[70:71], v97 offset:58368
 v_mfma_f32_32x32x16_bf16 v[0:15], v[72:75], a[52:55], v[0:15]
 ds_read_b64_tr_b16 v[72:73], v96 offset:59392
 ds_read_b64_tr_b16 v[74:75], v96 offset:60416
 s_nop 4
 v_mfma_f32_32x32x16_bf16 v[16:31], v[76:79], a[52:55], v[16:31]
 ds_read_b64_tr_b16 v[76:77], v97 offset:59392
 ds_read_b64_tr_b16 v[78:79], v97 offset:60416
 s_mov_b32 s36, 819200
 buffer_load_dwordx4 a[144:147], v100, s[8:11], s36 offen
 s_waitcnt lgkmcnt(10)
 v_mfma_f32_32x32x16_bf16 v[0:15], v[80:83], a[56:59], v[0:15]
 ds_read_b64_tr_b16 v[80:81], v96 offset:61440
 ds_read_b64_tr_b16 v[82:83], v96 offset:62464
 s_nop 1
 v_mfma_f32_32x32x16_bf16 v[16:31], v[84:87], a[56:59], v[16:31]
 ds_read_b64_tr_b16 v[84:85], v97 offset:61440
 ds_read_b64_tr_b16 v[86:87], v97 offset:62464
 s_mov_b32 s37, 827392
 buffer_load_dwordx4 a[148:151], v100, s[8:11], s37 offen
 v_mfma_f32_32x32x16_bf16 v[0:15], v[88:91], a[60:63], v[0:15]
 ds_read_b64_tr_b16 v[88:89], v96 offset:63488
 ds_read_b64_tr_b16 v[90:91], v96 offset:64512
 s_waitcnt lgkmcnt(10)
 s_nop 1
 v_mfma_f32_32x32x16_bf16 v[16:31], v[92:95], a[60:63], v[16:31]
 ds_read_b64_tr_b16 v[92:93], v97 offset:63488
 ds_read_b64_tr_b16 v[94:95], v97 offset:64512
 s_mov_b32 s36, 835584
 buffer_load_dwordx4 a[152:155], v100, s[8:11], s36 offen
 v_mfma_f32_32x32x16_bf16 v[32:47], v[64:67], a[48:51], v[32:47]
 ds_read_b64_tr_b16 v[64:65], v98 offset:0
 ds_read_b64_tr_b16 v[66:67], v98 offset:1024
 v_mfma_f32_32x32x16_bf16 v[48:63], v[68:71], a[48:51], v[48:63]
 ds_read_b64_tr_b16 v[68:69], v99 offset:0
 ds_read_b64_tr_b16 v[70:71], v99 offset:1024
 s_mov_b32 s37, 843776
 s_nop 0
 buffer_load_dwordx4 a[156:159], v100, s[8:11], s37 offen
 s_waitcnt lgkmcnt(10)
 v_mfma_f32_32x32x16_bf16 v[32:47], v[72:75], a[52:55], v[32:47]
 ds_read_b64_tr_b16 v[72:73], v98 offset:2048
 ds_read_b64_tr_b16 v[74:75], v98 offset:3072
 v_mfma_f32_32x32x16_bf16 v[48:63], v[76:79], a[52:55], v[48:63]
 ds_read_b64_tr_b16 v[76:77], v99 offset:2048
 ds_read_b64_tr_b16 v[78:79], v99 offset:3072
 v_mfma_f32_32x32x16_bf16 v[32:47], v[80:83], a[56:59], v[32:47]
 ds_read_b64_tr_b16 v[80:81], v98 offset:4096
 ds_read_b64_tr_b16 v[82:83], v98 offset:5120
 s_waitcnt lgkmcnt(10)
 v_mfma_f32_32x32x16_bf16 v[48:63], v[84:87], a[56:59], v[48:63]
 ds_read_b64_tr_b16 v[84:85], v99 offset:4096
 ds_read_b64_tr_b16 v[86:87], v99 offset:5120
 v_mfma_f32_32x32x16_bf16 v[32:47], v[88:91], a[60:63], v[32:47]
 ds_read_b64_tr_b16 v[88:89], v98 offset:6144
 ds_read_b64_tr_b16 v[90:91], v98 offset:7168
 v_mfma_f32_32x32x16_bf16 v[48:63], v[92:95], a[60:63], v[48:63]
 s_waitcnt vmcnt(30)
 s_barrier
 ds_read_b64_tr_b16 v[92:93], v99 offset:6144
 ds_read_b64_tr_b16 v[94:95], v99 offset:7168
 s_add_u32 m0, s28, 32768
 s_add_u32 s32, s40, 245760
 buffer_load_dwordx4 v101, s[12:15], s32 offen lds
 s_waitcnt lgkmcnt(10)
 v_mfma_f32_32x32x16_bf16 v[0:15], v[64:67], a[64:67], v[0:15]
 ds_read_b64_tr_b16 v[64:65], v98 offset:8192
 ds_read_b64_tr_b16 v[66:67], v98 offset:9216
 v_mfma_f32_32x32x16_bf16 v[16:31], v[68:71], a[64:67], v[16:31]
 ds_read_b64_tr_b16 v[68:69], v99 offset:8192
 ds_read_b64_tr_b16 v[70:71], v99 offset:9216
 buffer_load_dwordx4 v101, s[12:15], s32 offen offset:1024 lds
 s_add_u32 m0, s28, 40960
 s_add_u32 s33, s40, 253952
 v_mfma_f32_32x32x16_bf16 v[0:15], v[72:75], a[68:71], v[0:15]
 ds_read_b64_tr_b16 v[72:73], v98 offset:10240
 ds_read_b64_tr_b16 v[74:75], v98 offset:11264
 buffer_load_dwordx4 v101, s[12:15], s33 offen lds
 s_waitcnt lgkmcnt(10)
 v_mfma_f32_32x32x16_bf16 v[16:31], v[76:79], a[68:71], v[16:31]
 ds_read_b64_tr_b16 v[76:77], v99 offset:10240
 ds_read_b64_tr_b16 v[78:79], v99 offset:11264
 s_mov_b32 s36, 851968
 buffer_load_dwordx4 a[160:163], v100, s[8:11], s36 offen
 v_mfma_f32_32x32x16_bf16 v[0:15], v[80:83], a[72:75], v[0:15]
 ds_read_b64_tr_b16 v[80:81], v98 offset:12288
 ds_read_b64_tr_b16 v[82:83], v98 offset:13312
 s_nop 2
 v_mfma_f32_32x32x16_bf16 v[16:31], v[84:87], a[72:75], v[16:31]
 ds_read_b64_tr_b16 v[84:85], v99 offset:12288
 ds_read_b64_tr_b16 v[86:87], v99 offset:13312
 s_mov_b32 s37, 860160
 buffer_load_dwordx4 a[164:167], v100, s[8:11], s37 offen
 s_waitcnt lgkmcnt(10)
 v_mfma_f32_32x32x16_bf16 v[0:15], v[88:91], a[76:79], v[0:15]
 ds_read_b64_tr_b16 v[88:89], v98 offset:14336
 ds_read_b64_tr_b16 v[90:91], v98 offset:15360
 s_nop 1
 v_mfma_f32_32x32x16_bf16 v[16:31], v[92:95], a[76:79], v[16:31]
 ds_read_b64_tr_b16 v[92:93], v99 offset:14336
 ds_read_b64_tr_b16 v[94:95], v99 offset:15360
 s_mov_b32 s36, 868352
 buffer_load_dwordx4 a[168:171], v100, s[8:11], s36 offen
 v_mfma_f32_32x32x16_bf16 v[32:47], v[64:67], a[64:67], v[32:47]
 ds_read_b64_tr_b16 v[64:65], v98 offset:16384
 ds_read_b64_tr_b16 v[66:67], v98 offset:17408
 s_waitcnt lgkmcnt(10)
 v_mfma_f32_32x32x16_bf16 v[48:63], v[68:71], a[64:67], v[48:63]
 ds_read_b64_tr_b16 v[68:69], v99 offset:16384
 ds_read_b64_tr_b16 v[70:71], v99 offset:17408
 s_mov_b32 s37, 876544
 buffer_load_dwordx4 a[172:175], v100, s[8:11], s37 offen
 v_mfma_f32_32x32x16_bf16 v[32:47], v[72:75], a[68:71], v[32:47]
 ds_read_b64_tr_b16 v[72:73], v98 offset:18432
 ds_read_b64_tr_b16 v[74:75], v98 offset:19456
 v_mfma_f32_32x32x16_bf16 v[48:63], v[76:79], a[68:71], v[48:63]
 ds_read_b64_tr_b16 v[76:77], v99 offset:18432
 ds_read_b64_tr_b16 v[78:79], v99 offset:19456
 buffer_load_dwordx4 v101, s[12:15], s33 offen offset:1024 lds
 s_add_u32 m0, s28, 49152
 s_add_u32 s34, s41, 180224
 s_waitcnt lgkmcnt(10)
 v_mfma_f32_32x32x16_bf16 v[32:47], v[80:83], a[72:75], v[32:47]
 ds_read_b64_tr_b16 v[80:81], v98 offset:20480
 ds_read_b64_tr_b16 v[82:83], v98 offset:21504
 buffer_load_dwordx4 v101, s[12:15], s34 offen lds
 v_mfma_f32_32x32x16_bf16 v[48:63], v[84:87], a[72:75], v[48:63]
 ds_read_b64_tr_b16 v[84:85], v99 offset:20480
 ds_read_b64_tr_b16 v[86:87], v99 offset:21504
 buffer_load_dwordx4 v101, s[12:15], s34 offen offset:1024 lds
 s_add_u32 m0, s28, 57344
 s_add_u32 s35, s41, 188416
 v_mfma_f32_32x32x16_bf16 v[32:47], v[88:91], a[76:79], v[32:47]
 ds_read_b64_tr_b16 v[88:89], v98 offset:22528
 ds_read_b64_tr_b16 v[90:91], v98 offset:23552
 buffer_load_dwordx4 v101, s[12:15], s35 offen lds
 s_waitcnt lgkmcnt(10)
 v_mfma_f32_32x32x16_bf16 v[48:63], v[92:95], a[76:79], v[48:63]
 ds_read_b64_tr_b16 v[92:93], v99 offset:22528
 ds_read_b64_tr_b16 v[94:95], v99 offset:23552
 buffer_load_dwordx4 v101, s[12:15], s35 offen offset:1024 lds
 v_mfma_f32_32x32x16_bf16 v[0:15], v[64:67], a[80:83], v[0:15]
 ds_read_b64_tr_b16 v[64:65], v98 offset:24576
 ds_read_b64_tr_b16 v[66:67], v98 offset:25600
 v_mfma_f32_32x32x16_bf16 v[16:31], v[68:71], a[80:83], v[16:31]
 ds_read_b64_tr_b16 v[68:69], v99 offset:24576
 ds_read_b64_tr_b16 v[70:71], v99 offset:25600
 s_waitcnt lgkmcnt(10)
 v_mfma_f32_32x32x16_bf16 v[0:15], v[72:75], a[84:87], v[0:15]
 ds_read_b64_tr_b16 v[72:73], v98 offset:26624
 ds_read_b64_tr_b16 v[74:75], v98 offset:27648
 s_nop 3
 v_mfma_f32_32x32x16_bf16 v[16:31], v[76:79], a[84:87], v[16:31]
 ds_read_b64_tr_b16 v[76:77], v99 offset:26624
 ds_read_b64_tr_b16 v[78:79], v99 offset:27648
 s_mov_b32 s36, 884736
 buffer_load_dwordx4 a[176:179], v100, s[8:11], s36 offen
 v_mfma_f32_32x32x16_bf16 v[0:15], v[80:83], a[88:91], v[0:15]
 ds_read_b64_tr_b16 v[80:81], v98 offset:28672
 ds_read_b64_tr_b16 v[82:83], v98 offset:29696
 s_waitcnt lgkmcnt(10)
 s_nop 1
 v_mfma_f32_32x32x16_bf16 v[16:31], v[84:87], a[88:91], v[16:31]
 ds_read_b64_tr_b16 v[84:85], v99 offset:28672
 ds_read_b64_tr_b16 v[86:87], v99 offset:29696
 s_mov_b32 s37, 892928
 buffer_load_dwordx4 a[180:183], v100, s[8:11], s37 offen
 v_mfma_f32_32x32x16_bf16 v[0:15], v[88:91], a[92:95], v[0:15]
 ds_read_b64_tr_b16 v[88:89], v98 offset:30720
 ds_read_b64_tr_b16 v[90:91], v98 offset:31744
 s_nop 2
 v_mfma_f32_32x32x16_bf16 v[16:31], v[92:95], a[92:95], v[16:31]
 ds_read_b64_tr_b16 v[92:93], v99 offset:30720
 ds_read_b64_tr_b16 v[94:95], v99 offset:31744
 s_mov_b32 s36, 901120
 buffer_load_dwordx4 a[184:187], v100, s[8:11], s36 offen
 s_waitcnt lgkmcnt(10)
 v_mfma_f32_32x32x16_bf16 v[32:47], v[64:67], a[80:83], v[32:47]
 ds_read_b64_tr_b16 v[64:65], v98 offset:32768
 ds_read_b64_tr_b16 v[66:67], v98 offset:33792
 v_mfma_f32_32x32x16_bf16 v[48:63], v[68:71], a[80:83], v[48:63]
 ds_read_b64_tr_b16 v[68:69], v99 offset:32768
 ds_read_b64_tr_b16 v[70:71], v99 offset:33792
 s_mov_b32 s37, 909312
 buffer_load_dwordx4 a[188:191], v100, s[8:11], s37 offen
 v_mfma_f32_32x32x16_bf16 v[32:47], v[72:75], a[84:87], v[32:47]
 ds_read_b64_tr_b16 v[72:73], v98 offset:34816
 ds_read_b64_tr_b16 v[74:75], v98 offset:35840
 s_waitcnt lgkmcnt(10)
 v_mfma_f32_32x32x16_bf16 v[48:63], v[76:79], a[84:87], v[48:63]
 ds_read_b64_tr_b16 v[76:77], v99 offset:34816
 ds_read_b64_tr_b16 v[78:79], v99 offset:35840
 v_mfma_f32_32x32x16_bf16 v[32:47], v[80:83], a[88:91], v[32:47]
 ds_read_b64_tr_b16 v[80:81], v98 offset:36864
 ds_read_b64_tr_b16 v[82:83], v98 offset:37888
 v_mfma_f32_32x32x16_bf16 v[48:63], v[84:87], a[88:91], v[48:63]
 ds_read_b64_tr_b16 v[84:85], v99 offset:36864
 ds_read_b64_tr_b16 v[86:87], v99 offset:37888
 s_waitcnt lgkmcnt(10)
 v_mfma_f32_32x32x16_bf16 v[32:47], v[88:91], a[92:95], v[32:47]
 ds_read_b64_tr_b16 v[88:89], v98 offset:38912
 ds_read_b64_tr_b16 v[90:91], v98 offset:39936
 v_mfma_f32_32x32x16_bf16 v[48:63], v[92:95], a[92:95], v[48:63]
 s_waitcnt vmcnt(30)
 s_barrier
 ds_read_b64_tr_b16 v[92:93], v99 offset:38912
 ds_read_b64_tr_b16 v[94:95], v99 offset:39936
 s_add_u32 m0, s28, 65536
 s_add_u32 s32, s41, 196608
 buffer_load_dwordx4 v101, s[12:15], s32 offen lds
 v_mfma_f32_32x32x16_bf16 v[0:15], v[64:67], a[96:99], v[0:15]
 ds_read_b64_tr_b16 v[64:65], v98 offset:40960
 ds_read_b64_tr_b16 v[66:67], v98 offset:41984
 s_waitcnt lgkmcnt(10)
 v_mfma_f32_32x32x16_bf16 v[16:31], v[68:71], a[96:99], v[16:31]
 ds_read_b64_tr_b16 v[68:69], v99 offset:40960
 ds_read_b64_tr_b16 v[70:71], v99 offset:41984
 buffer_load_dwordx4 v101, s[12:15], s32 offen offset:1024 lds
 s_add_u32 m0, s28, 73728
 s_add_u32 s33, s41, 204800
 v_mfma_f32_32x32x16_bf16 v[0:15], v[72:75], a[100:103], v[0:15]
 ds_read_b64_tr_b16 v[72:73], v98 offset:43008
 ds_read_b64_tr_b16 v[74:75], v98 offset:44032
 buffer_load_dwordx4 v101, s[12:15], s33 offen lds
 s_nop 0
 v_mfma_f32_32x32x16_bf16 v[16:31], v[76:79], a[100:103], v[16:31]
 ds_read_b64_tr_b16 v[76:77], v99 offset:43008
 ds_read_b64_tr_b16 v[78:79], v99 offset:44032
 s_mov_b32 s36, 917504
 buffer_load_dwordx4 a[192:195], v100, s[8:11], s36 offen
 s_waitcnt lgkmcnt(10)
 v_mfma_f32_32x32x16_bf16 v[0:15], v[80:83], a[104:107], v[0:15]
 ds_read_b64_tr_b16 v[80:81], v98 offset:45056
 ds_read_b64_tr_b16 v[82:83], v98 offset:46080
 s_nop 1
 v_mfma_f32_32x32x16_bf16 v[16:31], v[84:87], a[104:107], v[16:31]
 ds_read_b64_tr_b16 v[84:85], v99 offset:45056
 ds_read_b64_tr_b16 v[86:87], v99 offset:46080
 s_mov_b32 s37, 925696
 buffer_load_dwordx4 a[196:199], v100, s[8:11], s37 offen
 v_mfma_f32_32x32x16_bf16 v[0:15], v[88:91], a[108:111], v[0:15]
 ds_read_b64_tr_b16 v[88:89], v98 offset:47104
 ds_read_b64_tr_b16 v[90:91], v98 offset:48128
 s_waitcnt lgkmcnt(10)
 s_nop 1
 v_mfma_f32_32x32x16_bf16 v[16:31], v[92:95], a[108:111], v[16:31]
 ds_read_b64_tr_b16 v[92:93], v99 offset:47104
 ds_read_b64_tr_b16 v[94:95], v99 offset:48128
 s_mov_b32 s36, 933888
 buffer_load_dwordx4 a[200:203], v100, s[8:11], s36 offen
 v_mfma_f32_32x32x16_bf16 v[0:15], v[64:67], a[112:115], v[0:15]
 ds_read_b64_tr_b16 v[64:65], v98 offset:49152
 ds_read_b64_tr_b16 v[66:67], v98 offset:50176
 s_nop 2
 v_mfma_f32_32x32x16_bf16 v[16:31], v[68:71], a[112:115], v[16:31]
 ds_read_b64_tr_b16 v[68:69], v99 offset:49152
 ds_read_b64_tr_b16 v[70:71], v99 offset:50176
 s_mov_b32 s37, 942080
 buffer_load_dwordx4 a[204:207], v100, s[8:11], s37 offen
 s_waitcnt lgkmcnt(10)
 v_mfma_f32_32x32x16_bf16 v[0:15], v[72:75], a[116:119], v[0:15]
 ds_read_b64_tr_b16 v[72:73], v98 offset:51200
 ds_read_b64_tr_b16 v[74:75], v98 offset:52224
 s_nop 1
 v_mfma_f32_32x32x16_bf16 v[16:31], v[76:79], a[116:119], v[16:31]
 ds_read_b64_tr_b16 v[76:77], v99 offset:51200
 ds_read_b64_tr_b16 v[78:79], v99 offset:52224
 s_mov_b32 s36, 950272
 buffer_load_dwordx4 a[208:211], v100, s[8:11], s36 offen
 v_mfma_f32_32x32x16_bf16 v[0:15], v[80:83], a[120:123], v[0:15]
 ds_read_b64_tr_b16 v[80:81], v98 offset:53248
 ds_read_b64_tr_b16 v[82:83], v98 offset:54272
 s_waitcnt lgkmcnt(10)
 s_nop 1
 v_mfma_f32_32x32x16_bf16 v[16:31], v[84:87], a[120:123], v[16:31]
 ds_read_b64_tr_b16 v[84:85], v99 offset:53248
 ds_read_b64_tr_b16 v[86:87], v99 offset:54272
 s_mov_b32 s37, 958464
 buffer_load_dwordx4 a[212:215], v100, s[8:11], s37 offen
 v_mfma_f32_32x32x16_bf16 v[0:15], v[88:91], a[124:127], v[0:15]
 ds_read_b64_tr_b16 v[88:89], v98 offset:55296
 ds_read_b64_tr_b16 v[90:91], v98 offset:56320
 s_nop 2
 v_mfma_f32_32x32x16_bf16 v[16:31], v[92:95], a[124:127], v[16:31]
 ds_read_b64_tr_b16 v[92:93], v99 offset:55296
 ds_read_b64_tr_b16 v[94:95], v99 offset:56320
 s_mov_b32 s36, 966656
 buffer_load_dwordx4 a[216:219], v100, s[8:11], s36 offen
 s_waitcnt vmcnt(38) lgkmcnt(10)
 v_mfma_f32_32x32x16_bf16 v[0:15], v[64:67], a[128:131], v[0:15]
 ds_read_b64_tr_b16 v[64:65], v98 offset:57344
 ds_read_b64_tr_b16 v[66:67], v98 offset:58368
 s_nop 1
 v_mfma_f32_32x32x16_bf16 v[16:31], v[68:71], a[128:131], v[16:31]
 ds_read_b64_tr_b16 v[68:69], v99 offset:57344
 ds_read_b64_tr_b16 v[70:71], v99 offset:58368
 s_mov_b32 s37, 974848
 buffer_load_dwordx4 a[220:223], v100, s[8:11], s37 offen
 s_waitcnt vmcnt(38)
 v_mfma_f32_32x32x16_bf16 v[0:15], v[72:75], a[132:135], v[0:15]
 ds_read_b64_tr_b16 v[72:73], v98 offset:59392
 ds_read_b64_tr_b16 v[74:75], v98 offset:60416
 s_waitcnt lgkmcnt(10)
 s_nop 0
 v_mfma_f32_32x32x16_bf16 v[16:31], v[76:79], a[132:135], v[16:31]
 ds_read_b64_tr_b16 v[76:77], v99 offset:59392
 ds_read_b64_tr_b16 v[78:79], v99 offset:60416
 s_mov_b32 s36, 983040
 buffer_load_dwordx4 a[224:227], v100, s[8:11], s36 offen
 s_waitcnt vmcnt(38)
 v_mfma_f32_32x32x16_bf16 v[0:15], v[80:83], a[136:139], v[0:15]
 ds_read_b64_tr_b16 v[80:81], v98 offset:61440
 ds_read_b64_tr_b16 v[82:83], v98 offset:62464
 s_nop 1
 v_mfma_f32_32x32x16_bf16 v[16:31], v[84:87], a[136:139], v[16:31]
 ds_read_b64_tr_b16 v[84:85], v99 offset:61440
 ds_read_b64_tr_b16 v[86:87], v99 offset:62464
 s_mov_b32 s37, 991232
 buffer_load_dwordx4 a[228:231], v100, s[8:11], s37 offen
 s_waitcnt vmcnt(38) lgkmcnt(10)
 v_mfma_f32_32x32x16_bf16 v[0:15], v[88:91], a[140:143], v[0:15]
 ds_read_b64_tr_b16 v[88:89], v98 offset:63488
 ds_read_b64_tr_b16 v[90:91], v98 offset:64512
 s_nop 1
 v_mfma_f32_32x32x16_bf16 v[16:31], v[92:95], a[140:143], v[16:31]
 ds_read_b64_tr_b16 v[92:93], v99 offset:63488
 ds_read_b64_tr_b16 v[94:95], v99 offset:64512
 s_mov_b32 s36, 999424
 buffer_load_dwordx4 a[232:235], v100, s[8:11], s36 offen
 s_waitcnt vmcnt(33)
 v_mfma_f32_32x32x16_bf16 v[0:15], v[64:67], a[144:147], v[0:15]
 ds_read_b64_tr_b16 v[64:65], v96 offset:0
 ds_read_b64_tr_b16 v[66:67], v96 offset:1024
 s_waitcnt lgkmcnt(10)
 s_nop 0
 v_mfma_f32_32x32x16_bf16 v[16:31], v[68:71], a[144:147], v[16:31]
 ds_read_b64_tr_b16 v[68:69], v97 offset:0
 ds_read_b64_tr_b16 v[70:71], v97 offset:1024
 s_mov_b32 s37, 1007616
 buffer_load_dwordx4 a[236:239], v100, s[8:11], s37 offen
 s_waitcnt vmcnt(33)
 v_mfma_f32_32x32x16_bf16 v[0:15], v[72:75], a[148:151], v[0:15]
 ds_read_b64_tr_b16 v[72:73], v96 offset:2048
 ds_read_b64_tr_b16 v[74:75], v96 offset:3072
 s_nop 1
 v_mfma_f32_32x32x16_bf16 v[16:31], v[76:79], a[148:151], v[16:31]
 ds_read_b64_tr_b16 v[76:77], v97 offset:2048
 ds_read_b64_tr_b16 v[78:79], v97 offset:3072
 s_mov_b32 s36, 1015808
 buffer_load_dwordx4 a[240:243], v100, s[8:11], s36 offen
 s_waitcnt vmcnt(33) lgkmcnt(10)
 v_mfma_f32_32x32x16_bf16 v[0:15], v[80:83], a[152:155], v[0:15]
 ds_read_b64_tr_b16 v[80:81], v96 offset:4096
 ds_read_b64_tr_b16 v[82:83], v96 offset:5120
 s_nop 1
 v_mfma_f32_32x32x16_bf16 v[16:31], v[84:87], a[152:155], v[16:31]
 ds_read_b64_tr_b16 v[84:85], v97 offset:4096
 ds_read_b64_tr_b16 v[86:87], v97 offset:5120
 s_mov_b32 s37, 1024000
 buffer_load_dwordx4 a[244:247], v100, s[8:11], s37 offen
 s_waitcnt vmcnt(33)
 v_mfma_f32_32x32x16_bf16 v[0:15], v[88:91], a[156:159], v[0:15]
 ds_read_b64_tr_b16 v[88:89], v96 offset:6144
 ds_read_b64_tr_b16 v[90:91], v96 offset:7168
 s_waitcnt lgkmcnt(10)
 s_nop 0
 v_mfma_f32_32x32x16_bf16 v[16:31], v[92:95], a[156:159], v[16:31]
 s_mov_b32 s36, 1032192
 buffer_load_dwordx4 a[248:251], v100, s[8:11], s36 offen
 s_waitcnt vmcnt(32)
 s_barrier
 ds_read_b64_tr_b16 v[92:93], v97 offset:6144
 ds_read_b64_tr_b16 v[94:95], v97 offset:7168
 s_waitcnt vmcnt(30)
 v_mfma_f32_32x32x16_bf16 v[0:15], v[64:67], a[160:163], v[0:15]
 ds_read_b64_tr_b16 v[64:65], v96 offset:8192
 ds_read_b64_tr_b16 v[66:67], v96 offset:9216
 buffer_load_dwordx4 v101, s[12:15], s33 offen offset:1024 lds
 s_add_u32 m0, s28, 81920
 s_add_u32 s34, s41, 212992
 s_mov_b32 s37, 1040384
 v_mfma_f32_32x32x16_bf16 v[16:31], v[68:71], a[160:163], v[16:31]
 ds_read_b64_tr_b16 v[68:69], v97 offset:8192
 ds_read_b64_tr_b16 v[70:71], v97 offset:9216
 buffer_load_dwordx4 a[252:255], v100, s[8:11], s37 offen
 s_waitcnt vmcnt(31) lgkmcnt(10)
 v_mfma_f32_32x32x16_bf16 v[0:15], v[72:75], a[164:167], v[0:15]
 ds_read_b64_tr_b16 v[72:73], v96 offset:10240
 ds_read_b64_tr_b16 v[74:75], v96 offset:11264
 buffer_load_dwordx4 v101, s[12:15], s34 offen lds
 s_nop 1
 v_mfma_f32_32x32x16_bf16 v[16:31], v[76:79], a[164:167], v[16:31]
 ds_read_b64_tr_b16 v[76:77], v97 offset:10240
 ds_read_b64_tr_b16 v[78:79], v97 offset:11264
 buffer_load_dwordx4 v101, s[12:15], s34 offen offset:1024 lds
 s_add_u32 m0, s28, 90112
 s_add_u32 s35, s41, 221184
 s_waitcnt vmcnt(32)
 v_mfma_f32_32x32x16_bf16 v[0:15], v[80:83], a[168:171], v[0:15]
 ds_read_b64_tr_b16 v[80:81], v96 offset:12288
 ds_read_b64_tr_b16 v[82:83], v96 offset:13312
 buffer_load_dwordx4 v101, s[12:15], s35 offen lds
 s_waitcnt lgkmcnt(10)
 v_mfma_f32_32x32x16_bf16 v[16:31], v[84:87], a[168:171], v[16:31]
 ds_read_b64_tr_b16 v[84:85], v97 offset:12288
 ds_read_b64_tr_b16 v[86:87], v97 offset:13312
 buffer_load_dwordx4 v101, s[12:15], s35 offen offset:1024 lds
 s_add_u32 m0, s28, 98304
 s_add_u32 s32, s41, 229376
 s_waitcnt vmcnt(33)
 v_mfma_f32_32x32x16_bf16 v[0:15], v[88:91], a[172:175], v[0:15]
 ds_read_b64_tr_b16 v[88:89], v96 offset:14336
 ds_read_b64_tr_b16 v[90:91], v96 offset:15360
 buffer_load_dwordx4 v101, s[12:15], s32 offen lds
 v_mfma_f32_32x32x16_bf16 v[16:31], v[92:95], a[172:175], v[16:31]
 ds_read_b64_tr_b16 v[92:93], v97 offset:14336
 ds_read_b64_tr_b16 v[94:95], v97 offset:15360
 buffer_load_dwordx4 v101, s[12:15], s32 offen offset:1024 lds
 s_add_u32 m0, s28, 106496
 s_add_u32 s33, s41, 237568
 s_waitcnt vmcnt(29) lgkmcnt(10)
 v_mfma_f32_32x32x16_bf16 v[0:15], v[64:67], a[176:179], v[0:15]
 ds_read_b64_tr_b16 v[64:65], v96 offset:16384
 ds_read_b64_tr_b16 v[66:67], v96 offset:17408
 buffer_load_dwordx4 v101, s[12:15], s33 offen lds
 v_mfma_f32_32x32x16_bf16 v[16:31], v[68:71], a[176:179], v[16:31]
 ds_read_b64_tr_b16 v[68:69], v97 offset:16384
 ds_read_b64_tr_b16 v[70:71], v97 offset:17408
 buffer_load_dwordx4 v101, s[12:15], s33 offen offset:1024 lds
 s_add_u32 m0, s28, 114688
 s_add_u32 s34, s41, 245760
 s_waitcnt vmcnt(30)
 v_mfma_f32_32x32x16_bf16 v[0:15], v[72:75], a[180:183], v[0:15]
 ds_read_b64_tr_b16 v[72:73], v96 offset:18432
 ds_read_b64_tr_b16 v[74:75], v96 offset:19456
 buffer_load_dwordx4 v101, s[12:15], s34 offen lds
 s_waitcnt lgkmcnt(10)
 v_mfma_f32_32x32x16_bf16 v[16:31], v[76:79], a[180:183], v[16:31]
 ds_read_b64_tr_b16 v[76:77], v97 offset:18432
 ds_read_b64_tr_b16 v[78:79], v97 offset:19456
 buffer_load_dwordx4 v101, s[12:15], s34 offen offset:1024 lds
 s_add_u32 m0, s28, 122880
 s_add_u32 s35, s41, 253952
 s_waitcnt vmcnt(31)
 v_mfma_f32_32x32x16_bf16 v[0:15], v[80:83], a[184:187], v[0:15]
 ds_read_b64_tr_b16 v[80:81], v96 offset:20480
 ds_read_b64_tr_b16 v[82:83], v96 offset:21504
 buffer_load_dwordx4 v101, s[12:15], s35 offen lds
 v_mfma_f32_32x32x16_bf16 v[16:31], v[84:87], a[184:187], v[16:31]
 ds_read_b64_tr_b16 v[84:85], v97 offset:20480
 ds_read_b64_tr_b16 v[86:87], v97 offset:21504
 buffer_load_dwordx4 v101, s[12:15], s35 offen offset:1024 lds
 s_waitcnt vmcnt(32) lgkmcnt(10)
 v_mfma_f32_32x32x16_bf16 v[0:15], v[88:91], a[188:191], v[0:15]
 ds_read_b64_tr_b16 v[88:89], v96 offset:22528
 ds_read_b64_tr_b16 v[90:91], v96 offset:23552
 s_nop 2
 v_mfma_f32_32x32x16_bf16 v[16:31], v[92:95], a[188:191], v[16:31]
 ds_read_b64_tr_b16 v[92:93], v97 offset:22528
 ds_read_b64_tr_b16 v[94:95], v97 offset:23552
 s_waitcnt vmcnt(28)
 v_mfma_f32_32x32x16_bf16 v[0:15], v[64:67], a[192:195], v[0:15]
 ds_read_b64_tr_b16 v[64:65], v96 offset:24576
 ds_read_b64_tr_b16 v[66:67], v96 offset:25600
 s_waitcnt lgkmcnt(10)
 s_nop 2
 v_mfma_f32_32x32x16_bf16 v[16:31], v[68:71], a[192:195], v[16:31]
 ds_read_b64_tr_b16 v[68:69], v97 offset:24576
 ds_read_b64_tr_b16 v[70:71], v97 offset:25600
 s_waitcnt vmcnt(27)
 v_mfma_f32_32x32x16_bf16 v[0:15], v[72:75], a[196:199], v[0:15]
 ds_read_b64_tr_b16 v[72:73], v96 offset:26624
 ds_read_b64_tr_b16 v[74:75], v96 offset:27648
 s_nop 3
 v_mfma_f32_32x32x16_bf16 v[16:31], v[76:79], a[196:199], v[16:31]
 ds_read_b64_tr_b16 v[76:77], v97 offset:26624
 ds_read_b64_tr_b16 v[78:79], v97 offset:27648
 s_waitcnt vmcnt(26) lgkmcnt(10)
 v_mfma_f32_32x32x16_bf16 v[0:15], v[80:83], a[200:203], v[0:15]
 ds_read_b64_tr_b16 v[80:81], v96 offset:28672
 ds_read_b64_tr_b16 v[82:83], v96 offset:29696
 s_nop 3
 v_mfma_f32_32x32x16_bf16 v[16:31], v[84:87], a[200:203], v[16:31]
 ds_read_b64_tr_b16 v[84:85], v97 offset:28672
 ds_read_b64_tr_b16 v[86:87], v97 offset:29696
 s_waitcnt vmcnt(25)
 v_mfma_f32_32x32x16_bf16 v[0:15], v[88:91], a[204:207], v[0:15]
 ds_read_b64_tr_b16 v[88:89], v96 offset:30720
 ds_read_b64_tr_b16 v[90:91], v96 offset:31744
 s_waitcnt lgkmcnt(10)
 s_nop 2
 v_mfma_f32_32x32x16_bf16 v[16:31], v[92:95], a[204:207], v[16:31]
 ds_read_b64_tr_b16 v[92:93], v97 offset:30720
 ds_read_b64_tr_b16 v[94:95], v97 offset:31744
 s_waitcnt vmcnt(24)
 v_mfma_f32_32x32x16_bf16 v[0:15], v[64:67], a[208:211], v[0:15]
 ds_read_b64_tr_b16 v[64:65], v96 offset:32768
 ds_read_b64_tr_b16 v[66:67], v96 offset:33792
 s_nop 3
 v_mfma_f32_32x32x16_bf16 v[16:31], v[68:71], a[208:211], v[16:31]
 ds_read_b64_tr_b16 v[68:69], v97 offset:32768
 ds_read_b64_tr_b16 v[70:71], v97 offset:33792
 s_waitcnt vmcnt(23) lgkmcnt(10)
 v_mfma_f32_32x32x16_bf16 v[0:15], v[72:75], a[212:215], v[0:15]
 ds_read_b64_tr_b16 v[72:73], v96 offset:34816
 ds_read_b64_tr_b16 v[74:75], v96 offset:35840
 s_nop 3
 v_mfma_f32_32x32x16_bf16 v[16:31], v[76:79], a[212:215], v[16:31]
 ds_read_b64_tr_b16 v[76:77], v97 offset:34816
 ds_read_b64_tr_b16 v[78:79], v97 offset:35840
 s_waitcnt vmcnt(22)
 v_mfma_f32_32x32x16_bf16 v[0:15], v[80:83], a[216:219], v[0:15]
 ds_read_b64_tr_b16 v[80:81], v96 offset:36864
 ds_read_b64_tr_b16 v[82:83], v96 offset:37888
 s_waitcnt lgkmcnt(10)
 s_nop 2
 v_mfma_f32_32x32x16_bf16 v[16:31], v[84:87], a[216:219], v[16:31]
 ds_read_b64_tr_b16 v[84:85], v97 offset:36864
 ds_read_b64_tr_b16 v[86:87], v97 offset:37888
 s_waitcnt vmcnt(21)
 v_mfma_f32_32x32x16_bf16 v[0:15], v[88:91], a[220:223], v[0:15]
 ds_read_b64_tr_b16 v[88:89], v96 offset:38912
 ds_read_b64_tr_b16 v[90:91], v96 offset:39936
 s_nop 3
 v_mfma_f32_32x32x16_bf16 v[16:31], v[92:95], a[220:223], v[16:31]
 s_barrier
 ds_read_b64_tr_b16 v[92:93], v97 offset:38912
 ds_read_b64_tr_b16 v[94:95], v97 offset:39936
 s_waitcnt vmcnt(20) lgkmcnt(10)
 v_mfma_f32_32x32x16_bf16 v[0:15], v[64:67], a[224:227], v[0:15]
 ds_read_b64_tr_b16 v[64:65], v96 offset:40960
 ds_read_b64_tr_b16 v[66:67], v96 offset:41984
 s_nop 2
 v_mfma_f32_32x32x16_bf16 v[16:31], v[68:71], a[224:227], v[16:31]
 ds_read_b64_tr_b16 v[68:69], v97 offset:40960
 ds_read_b64_tr_b16 v[70:71], v97 offset:41984
 s_waitcnt vmcnt(19)
 v_mfma_f32_32x32x16_bf16 v[0:15], v[72:75], a[228:231], v[0:15]
 ds_read_b64_tr_b16 v[72:73], v96 offset:43008
 ds_read_b64_tr_b16 v[74:75], v96 offset:44032
 s_waitcnt lgkmcnt(10)
 s_nop 2
 v_mfma_f32_32x32x16_bf16 v[16:31], v[76:79], a[228:231], v[16:31]
 ds_read_b64_tr_b16 v[76:77], v97 offset:43008
 ds_read_b64_tr_b16 v[78:79], v97 offset:44032
 s_waitcnt vmcnt(18)
 v_mfma_f32_32x32x16_bf16 v[0:15], v[80:83], a[232:235], v[0:15]
 ds_read_b64_tr_b16 v[80:81], v96 offset:45056
 ds_read_b64_tr_b16 v[82:83], v96 offset:46080
 s_nop 3
 v_mfma_f32_32x32x16_bf16 v[16:31], v[84:87], a[232:235], v[16:31]
 ds_read_b64_tr_b16 v[84:85], v97 offset:45056
 ds_read_b64_tr_b16 v[86:87], v97 offset:46080
 s_waitcnt vmcnt(17) lgkmcnt(10)
 v_mfma_f32_32x32x16_bf16 v[0:15], v[88:91], a[236:239], v[0:15]
 ds_read_b64_tr_b16 v[88:89], v96 offset:47104
 ds_read_b64_tr_b16 v[90:91], v96 offset:48128
 s_nop 3
 v_mfma_f32_32x32x16_bf16 v[16:31], v[92:95], a[236:239], v[16:31]
 ds_read_b64_tr_b16 v[92:93], v97 offset:47104
 ds_read_b64_tr_b16 v[94:95], v97 offset:48128
 s_waitcnt vmcnt(16)
 v_mfma_f32_32x32x16_bf16 v[0:15], v[64:67], a[240:243], v[0:15]
 ds_read_b64_tr_b16 v[64:65], v96 offset:49152
 ds_read_b64_tr_b16 v[66:67], v96 offset:50176
 s_waitcnt lgkmcnt(10)
 s_nop 2
 v_mfma_f32_32x32x16_bf16 v[16:31], v[68:71], a[240:243], v[16:31]
 ds_read_b64_tr_b16 v[68:69], v97 offset:49152
 ds_read_b64_tr_b16 v[70:71], v97 offset:50176
 s_waitcnt vmcnt(15)
 v_mfma_f32_32x32x16_bf16 v[0:15], v[72:75], a[244:247], v[0:15]
 ds_read_b64_tr_b16 v[72:73], v96 offset:51200
 ds_read_b64_tr_b16 v[74:75], v96 offset:52224
 s_nop 3
 v_mfma_f32_32x32x16_bf16 v[16:31], v[76:79], a[244:247], v[16:31]
 ds_read_b64_tr_b16 v[76:77], v97 offset:51200
 ds_read_b64_tr_b16 v[78:79], v97 offset:52224
 s_waitcnt vmcnt(14) lgkmcnt(10)
 v_mfma_f32_32x32x16_bf16 v[0:15], v[80:83], a[248:251], v[0:15]
 ds_read_b64_tr_b16 v[80:81], v96 offset:53248
 ds_read_b64_tr_b16 v[82:83], v96 offset:54272
 s_nop 3
 v_mfma_f32_32x32x16_bf16 v[16:31], v[84:87], a[248:251], v[16:31]
 ds_read_b64_tr_b16 v[84:85], v97 offset:53248
 ds_read_b64_tr_b16 v[86:87], v97 offset:54272
 s_waitcnt vmcnt(12)
 v_mfma_f32_32x32x16_bf16 v[0:15], v[88:91], a[252:255], v[0:15]
 ds_read_b64_tr_b16 v[88:89], v96 offset:55296
 ds_read_b64_tr_b16 v[90:91], v96 offset:56320
 s_waitcnt lgkmcnt(10)
 s_nop 2
 v_mfma_f32_32x32x16_bf16 v[16:31], v[92:95], a[252:255], v[16:31]
 ds_read_b64_tr_b16 v[92:93], v97 offset:55296
 ds_read_b64_tr_b16 v[94:95], v97 offset:56320
 v_mfma_f32_32x32x16_bf16 v[32:47], v[64:67], a[96:99], v[32:47]
 ds_read_b64_tr_b16 v[64:65], v96 offset:57344
 ds_read_b64_tr_b16 v[66:67], v96 offset:58368
 v_cvt_pk_bf16_f32 v112, v0, v1
 v_cvt_pk_bf16_f32 v113, v2, v3
 v_cvt_pk_bf16_f32 v114, v4, v5
 v_cvt_pk_bf16_f32 v115, v6, v7
 v_cvt_pk_bf16_f32 v116, v8, v9
 v_cvt_pk_bf16_f32 v117, v10, v11
 v_cvt_pk_bf16_f32 v118, v12, v13
 v_cvt_pk_bf16_f32 v119, v14, v15
 v_cvt_pk_bf16_f32 v120, v16, v17
 v_cvt_pk_bf16_f32 v121, v18, v19
 v_cvt_pk_bf16_f32 v122, v20, v21
 v_cvt_pk_bf16_f32 v123, v22, v23
 v_cvt_pk_bf16_f32 v124, v24, v25
 v_cvt_pk_bf16_f32 v125, v26, v27
 v_cvt_pk_bf16_f32 v126, v28, v29
 v_cvt_pk_bf16_f32 v127, v30, v31
 buffer_store_dwordx4 v[112:115], v103, s[20:23], s42 offen offset:0 sc1
 v_mfma_f32_32x32x16_bf16 v[48:63], v[68:71], a[96:99], v[48:63]
 ds_read_b64_tr_b16 v[68:69], v97 offset:57344
 ds_read_b64_tr_b16 v[70:71], v97 offset:58368
 s_waitcnt lgkmcnt(6)
 v_mfma_f32_32x32x16_bf16 v[32:47], v[72:75], a[100:103], v[32:47]
 ds_read_b64_tr_b16 v[72:73], v96 offset:59392
 ds_read_b64_tr_b16 v[74:75], v96 offset:60416
 buffer_store_dwordx4 v[116:119], v103, s[20:23], s42 offen offset:1024 sc1
 v_mfma_f32_32x32x16_bf16 v[48:63], v[76:79], a[100:103], v[48:63]
 ds_read_b64_tr_b16 v[76:77], v97 offset:59392
 ds_read_b64_tr_b16 v[78:79], v97 offset:60416
 buffer_store_dwordx4 v[120:123], v103, s[20:23], s42 offen offset:2048 sc1
 v_mfma_f32_32x32x16_bf16 v[32:47], v[80:83], a[104:107], v[32:47]
 ds_read_b64_tr_b16 v[80:81], v96 offset:61440
 ds_read_b64_tr_b16 v[82:83], v96 offset:62464
 buffer_store_dwordx4 v[124:127], v103, s[20:23], s42 offen offset:3072 sc1
 v_mfma_f32_32x32x16_bf16 v[48:63], v[84:87], a[104:107], v[48:63]
 ds_read_b64_tr_b16 v[84:85], v97 offset:61440
 ds_read_b64_tr_b16 v[86:87], v97 offset:62464
 v_mfma_f32_32x32x16_bf16 v[32:47], v[88:91], a[108:111], v[32:47]
 ds_read_b64_tr_b16 v[88:89], v96 offset:63488
 ds_read_b64_tr_b16 v[90:91], v96 offset:64512
 s_waitcnt lgkmcnt(10)
 v_mfma_f32_32x32x16_bf16 v[48:63], v[92:95], a[108:111], v[48:63]
 ds_read_b64_tr_b16 v[92:93], v97 offset:63488
 ds_read_b64_tr_b16 v[94:95], v97 offset:64512
 v_mfma_f32_32x32x16_bf16 v[32:47], v[64:67], a[112:115], v[32:47]
 ds_read_b64_tr_b16 v[64:65], v98 offset:0
 ds_read_b64_tr_b16 v[66:67], v98 offset:1024
 s_nop 4
 v_mfma_f32_32x32x16_bf16 v[48:63], v[68:71], a[112:115], v[48:63]
 ds_read_b64_tr_b16 v[68:69], v99 offset:0
 ds_read_b64_tr_b16 v[70:71], v99 offset:1024
 s_waitcnt lgkmcnt(10)
 v_mfma_f32_32x32x16_bf16 v[32:47], v[72:75], a[116:119], v[32:47]
 ds_read_b64_tr_b16 v[72:73], v98 offset:2048
 ds_read_b64_tr_b16 v[74:75], v98 offset:3072
 v_mfma_f32_32x32x16_bf16 v[48:63], v[76:79], a[116:119], v[48:63]
 ds_read_b64_tr_b16 v[76:77], v99 offset:2048
 ds_read_b64_tr_b16 v[78:79], v99 offset:3072
 v_mfma_f32_32x32x16_bf16 v[32:47], v[80:83], a[120:123], v[32:47]
 ds_read_b64_tr_b16 v[80:81], v98 offset:4096
 ds_read_b64_tr_b16 v[82:83], v98 offset:5120
 s_waitcnt lgkmcnt(10)
 v_mfma_f32_32x32x16_bf16 v[48:63], v[84:87], a[120:123], v[48:63]
 ds_read_b64_tr_b16 v[84:85], v99 offset:4096
 ds_read_b64_tr_b16 v[86:87], v99 offset:5120
 v_mfma_f32_32x32x16_bf16 v[32:47], v[88:91], a[124:127], v[32:47]
 ds_read_b64_tr_b16 v[88:89], v98 offset:6144
 ds_read_b64_tr_b16 v[90:91], v98 offset:7168
 v_mfma_f32_32x32x16_bf16 v[48:63], v[92:95], a[124:127], v[48:63]
 s_waitcnt vmcnt(10)
 s_barrier
 ds_read_b64_tr_b16 v[92:93], v99 offset:6144
 ds_read_b64_tr_b16 v[94:95], v99 offset:7168
 s_waitcnt lgkmcnt(10)
 v_mfma_f32_32x32x16_bf16 v[32:47], v[64:67], a[128:131], v[32:47]
 ds_read_b64_tr_b16 v[64:65], v98 offset:8192
 ds_read_b64_tr_b16 v[66:67], v98 offset:9216
 s_nop 1
 v_mfma_f32_32x32x16_bf16 v[48:63], v[68:71], a[128:131], v[48:63]
 ds_read_b64_tr_b16 v[68:69], v99 offset:8192
 ds_read_b64_tr_b16 v[70:71], v99 offset:9216
 v_mfma_f32_32x32x16_bf16 v[32:47], v[72:75], a[132:135], v[32:47]
 ds_read_b64_tr_b16 v[72:73], v98 offset:10240
 ds_read_b64_tr_b16 v[74:75], v98 offset:11264
 s_waitcnt lgkmcnt(10)
 v_mfma_f32_32x32x16_bf16 v[48:63], v[76:79], a[132:135], v[48:63]
 ds_read_b64_tr_b16 v[76:77], v99 offset:10240
 ds_read_b64_tr_b16 v[78:79], v99 offset:11264
 v_mfma_f32_32x32x16_bf16 v[32:47], v[80:83], a[136:139], v[32:47]
 ds_read_b64_tr_b16 v[80:81], v98 offset:12288
 ds_read_b64_tr_b16 v[82:83], v98 offset:13312
 v_mfma_f32_32x32x16_bf16 v[48:63], v[84:87], a[136:139], v[48:63]
 ds_read_b64_tr_b16 v[84:85], v99 offset:12288
 ds_read_b64_tr_b16 v[86:87], v99 offset:13312
 s_waitcnt lgkmcnt(10)
 v_mfma_f32_32x32x16_bf16 v[32:47], v[88:91], a[140:143], v[32:47]
 ds_read_b64_tr_b16 v[88:89], v98 offset:14336
 ds_read_b64_tr_b16 v[90:91], v98 offset:15360
 v_mfma_f32_32x32x16_bf16 v[48:63], v[92:95], a[140:143], v[48:63]
 ds_read_b64_tr_b16 v[92:93], v99 offset:14336
 ds_read_b64_tr_b16 v[94:95], v99 offset:15360
 v_mfma_f32_32x32x16_bf16 v[32:47], v[64:67], a[144:147], v[32:47]
 ds_read_b64_tr_b16 v[64:65], v98 offset:16384
 ds_read_b64_tr_b16 v[66:67], v98 offset:17408
 s_waitcnt lgkmcnt(10)
 s_nop 3
 v_mfma_f32_32x32x16_bf16 v[48:63], v[68:71], a[144:147], v[48:63]
 ds_read_b64_tr_b16 v[68:69], v99 offset:16384
 ds_read_b64_tr_b16 v[70:71], v99 offset:17408
 s_waitcnt vmcnt(0)
 s_mov_b64 exec, 1
 buffer_store_dword v105, v104, s[24:27], s44 offen sc1
 s_mov_b64 exec, -1
 v_mfma_f32_32x32x16_bf16 v[32:47], v[72:75], a[148:151], v[32:47]
 ds_read_b64_tr_b16 v[72:73], v98 offset:18432
 ds_read_b64_tr_b16 v[74:75], v98 offset:19456
 v_mfma_f32_32x32x16_bf16 v[48:63], v[76:79], a[148:151], v[48:63]
 ds_read_b64_tr_b16 v[76:77], v99 offset:18432
 ds_read_b64_tr_b16 v[78:79], v99 offset:19456
 s_waitcnt lgkmcnt(10)
 v_mfma_f32_32x32x16_bf16 v[32:47], v[80:83], a[152:155], v[32:47]
 ds_read_b64_tr_b16 v[80:81], v98 offset:20480
 ds_read_b64_tr_b16 v[82:83], v98 offset:21504
 v_mfma_f32_32x32x16_bf16 v[48:63], v[84:87], a[152:155], v[48:63]
 ds_read_b64_tr_b16 v[84:85], v99 offset:20480
 ds_read_b64_tr_b16 v[86:87], v99 offset:21504
 v_mfma_f32_32x32x16_bf16 v[32:47], v[88:91], a[156:159], v[32:47]
 ds_read_b64_tr_b16 v[88:89], v98 offset:22528
 ds_read_b64_tr_b16 v[90:91], v98 offset:23552
 s_waitcnt lgkmcnt(10)
 v_mfma_f32_32x32x16_bf16 v[48:63], v[92:95], a[156:159], v[48:63]
 ds_read_b64_tr_b16 v[92:93], v99 offset:22528
 ds_read_b64_tr_b16 v[94:95], v99 offset:23552
 v_mfma_f32_32x32x16_bf16 v[32:47], v[64:67], a[160:163], v[32:47]
 ds_read_b64_tr_b16 v[64:65], v98 offset:24576
 ds_read_b64_tr_b16 v[66:67], v98 offset:25600
 s_nop 4
 v_mfma_f32_32x32x16_bf16 v[48:63], v[68:71], a[160:163], v[48:63]
 ds_read_b64_tr_b16 v[68:69], v99 offset:24576
 ds_read_b64_tr_b16 v[70:71], v99 offset:25600
 s_waitcnt lgkmcnt(10)
 v_mfma_f32_32x32x16_bf16 v[32:47], v[72:75], a[164:167], v[32:47]
 ds_read_b64_tr_b16 v[72:73], v98 offset:26624
 ds_read_b64_tr_b16 v[74:75], v98 offset:27648
 v_mfma_f32_32x32x16_bf16 v[48:63], v[76:79], a[164:167], v[48:63]
 ds_read_b64_tr_b16 v[76:77], v99 offset:26624
 ds_read_b64_tr_b16 v[78:79], v99 offset:27648
 v_mfma_f32_32x32x16_bf16 v[32:47], v[80:83], a[168:171], v[32:47]
 ds_read_b64_tr_b16 v[80:81], v98 offset:28672
 ds_read_b64_tr_b16 v[82:83], v98 offset:29696
 s_waitcnt lgkmcnt(10)
 v_mfma_f32_32x32x16_bf16 v[48:63], v[84:87], a[168:171], v[48:63]
 ds_read_b64_tr_b16 v[84:85], v99 offset:28672
 ds_read_b64_tr_b16 v[86:87], v99 offset:29696
 v_mfma_f32_32x32x16_bf16 v[32:47], v[88:91], a[172:175], v[32:47]
 ds_read_b64_tr_b16 v[88:89], v98 offset:30720
 ds_read_b64_tr_b16 v[90:91], v98 offset:31744
 v_mfma_f32_32x32x16_bf16 v[48:63], v[92:95], a[172:175], v[48:63]
 ds_read_b64_tr_b16 v[92:93], v99 offset:30720
 ds_read_b64_tr_b16 v[94:95], v99 offset:31744
 s_waitcnt lgkmcnt(10)
 v_mfma_f32_32x32x16_bf16 v[32:47], v[64:67], a[176:179], v[32:47]
 ds_read_b64_tr_b16 v[64:65], v98 offset:32768
 ds_read_b64_tr_b16 v[66:67], v98 offset:33792
 s_nop 3
 v_mfma_f32_32x32x16_bf16 v[48:63], v[68:71], a[176:179], v[48:63]
 ds_read_b64_tr_b16 v[68:69], v99 offset:32768
 ds_read_b64_tr_b16 v[70:71], v99 offset:33792
 v_mfma_f32_32x32x16_bf16 v[32:47], v[72:75], a[180:183], v[32:47]
 ds_read_b64_tr_b16 v[72:73], v98 offset:34816
 ds_read_b64_tr_b16 v[74:75], v98 offset:35840
 s_waitcnt lgkmcnt(10)
 v_mfma_f32_32x32x16_bf16 v[48:63], v[76:79], a[180:183], v[48:63]
 ds_read_b64_tr_b16 v[76:77], v99 offset:34816
 ds_read_b64_tr_b16 v[78:79], v99 offset:35840
 v_mfma_f32_32x32x16_bf16 v[32:47], v[80:83], a[184:187], v[32:47]
 ds_read_b64_tr_b16 v[80:81], v98 offset:36864
 ds_read_b64_tr_b16 v[82:83], v98 offset:37888
 v_mfma_f32_32x32x16_bf16 v[48:63], v[84:87], a[184:187], v[48:63]
 ds_read_b64_tr_b16 v[84:85], v99 offset:36864
 ds_read_b64_tr_b16 v[86:87], v99 offset:37888
 s_waitcnt lgkmcnt(10)
 v_mfma_f32_32x32x16_bf16 v[32:47], v[88:91], a[188:191], v[32:47]
 ds_read_b64_tr_b16 v[88:89], v98 offset:38912
 ds_read_b64_tr_b16 v[90:91], v98 offset:39936
 v_mfma_f32_32x32x16_bf16 v[48:63], v[92:95], a[188:191], v[48:63]
 s_barrier
 ds_read_b64_tr_b16 v[92:93], v99 offset:38912
 ds_read_b64_tr_b16 v[94:95], v99 offset:39936
 v_mfma_f32_32x32x16_bf16 v[32:47], v[64:67], a[192:195], v[32:47]
 ds_read_b64_tr_b16 v[64:65], v98 offset:40960
 ds_read_b64_tr_b16 v[66:67], v98 offset:41984
 s_waitcnt lgkmcnt(10)
 s_nop 2
 v_mfma_f32_32x32x16_bf16 v[48:63], v[68:71], a[192:195], v[48:63]
 ds_read_b64_tr_b16 v[68:69], v99 offset:40960
 ds_read_b64_tr_b16 v[70:71], v99 offset:41984
 buffer_load_dword v106, v104, s[24:27], s45 offen sc1
 v_mfma_f32_32x32x16_bf16 v[32:47], v[72:75], a[196:199], v[32:47]
 ds_read_b64_tr_b16 v[72:73], v98 offset:43008
 ds_read_b64_tr_b16 v[74:75], v98 offset:44032
 v_mfma_f32_32x32x16_bf16 v[48:63], v[76:79], a[196:199], v[48:63]
 ds_read_b64_tr_b16 v[76:77], v99 offset:43008
 ds_read_b64_tr_b16 v[78:79], v99 offset:44032
 s_waitcnt lgkmcnt(10)
 v_mfma_f32_32x32x16_bf16 v[32:47], v[80:83], a[200:203], v[32:47]
 ds_read_b64_tr_b16 v[80:81], v98 offset:45056
 ds_read_b64_tr_b16 v[82:83], v98 offset:46080
 v_mfma_f32_32x32x16_bf16 v[48:63], v[84:87], a[200:203], v[48:63]
 ds_read_b64_tr_b16 v[84:85], v99 offset:45056
 ds_read_b64_tr_b16 v[86:87], v99 offset:46080
 v_mfma_f32_32x32x16_bf16 v[32:47], v[88:91], a[204:207], v[32:47]
 ds_read_b64_tr_b16 v[88:89], v98 offset:47104
 ds_read_b64_tr_b16 v[90:91], v98 offset:48128
 s_waitcnt lgkmcnt(10)
 v_mfma_f32_32x32x16_bf16 v[48:63], v[92:95], a[204:207], v[48:63]
 ds_read_b64_tr_b16 v[92:93], v99 offset:47104
 ds_read_b64_tr_b16 v[94:95], v99 offset:48128
 v_mfma_f32_32x32x16_bf16 v[32:47], v[64:67], a[208:211], v[32:47]
 ds_read_b64_tr_b16 v[64:65], v98 offset:49152
 ds_read_b64_tr_b16 v[66:67], v98 offset:50176
 s_nop 4
 v_mfma_f32_32x32x16_bf16 v[48:63], v[68:71], a[208:211], v[48:63]
 ds_read_b64_tr_b16 v[68:69], v99 offset:49152
 ds_read_b64_tr_b16 v[70:71], v99 offset:50176
 s_waitcnt vmcnt(0)
 v_readfirstlane_b32 s46, v106
 s_nop 4
 buffer_load_dwordx4 v[128:131], v103, s[20:23], s43 offen offset:0 sc1
 s_cmp_eq_u32 s46, 1
 s_waitcnt lgkmcnt(10)
 v_mfma_f32_32x32x16_bf16 v[32:47], v[72:75], a[212:215], v[32:47]
 ds_read_b64_tr_b16 v[72:73], v98 offset:51200
 ds_read_b64_tr_b16 v[74:75], v98 offset:52224
 v_mfma_f32_32x32x16_bf16 v[48:63], v[76:79], a[212:215], v[48:63]
 ds_read_b64_tr_b16 v[76:77], v99 offset:51200
 ds_read_b64_tr_b16 v[78:79], v99 offset:52224
 buffer_load_dwordx4 v[132:135], v103, s[20:23], s43 offen offset:1024 sc1
 v_mfma_f32_32x32x16_bf16 v[32:47], v[80:83], a[216:219], v[32:47]
 ds_read_b64_tr_b16 v[80:81], v98 offset:53248
 ds_read_b64_tr_b16 v[82:83], v98 offset:54272
 buffer_load_dwordx4 v[136:139], v103, s[20:23], s43 offen offset:2048 sc1
 s_waitcnt lgkmcnt(10)
 v_mfma_f32_32x32x16_bf16 v[48:63], v[84:87], a[216:219], v[48:63]
 ds_read_b64_tr_b16 v[84:85], v99 offset:53248
 ds_read_b64_tr_b16 v[86:87], v99 offset:54272
 buffer_load_dwordx4 v[140:143], v103, s[20:23], s43 offen offset:3072 sc1
 v_mfma_f32_32x32x16_bf16 v[32:47], v[88:91], a[220:223], v[32:47]
 ds_read_b64_tr_b16 v[88:89], v98 offset:55296
 ds_read_b64_tr_b16 v[90:91], v98 offset:56320
 v_mfma_f32_32x32x16_bf16 v[48:63], v[92:95], a[220:223], v[48:63]
 ds_read_b64_tr_b16 v[92:93], v99 offset:55296
 ds_read_b64_tr_b16 v[94:95], v99 offset:56320
 s_waitcnt lgkmcnt(10)
 v_mfma_f32_32x32x16_bf16 v[32:47], v[64:67], a[224:227], v[32:47]
 ds_read_b64_tr_b16 v[64:65], v98 offset:57344
 ds_read_b64_tr_b16 v[66:67], v98 offset:58368
 s_nop 3
 v_mfma_f32_32x32x16_bf16 v[48:63], v[68:71], a[224:227], v[48:63]
 ds_read_b64_tr_b16 v[68:69], v99 offset:57344
 ds_read_b64_tr_b16 v[70:71], v99 offset:58368
 v_mfma_f32_32x32x16_bf16 v[32:47], v[72:75], a[228:231], v[32:47]
 ds_read_b64_tr_b16 v[72:73], v98 offset:59392
 ds_read_b64_tr_b16 v[74:75], v98 offset:60416
 s_waitcnt lgkmcnt(10)
 v_mfma_f32_32x32x16_bf16 v[48:63], v[76:79], a[228:231], v[48:63]
 ds_read_b64_tr_b16 v[76:77], v99 offset:59392
 ds_read_b64_tr_b16 v[78:79], v99 offset:60416
 v_mfma_f32_32x32x16_bf16 v[32:47], v[80:83], a[232:235], v[32:47]
 ds_read_b64_tr_b16 v[80:81], v98 offset:61440
 ds_read_b64_tr_b16 v[82:83], v98 offset:62464
 v_mfma_f32_32x32x16_bf16 v[48:63], v[84:87], a[232:235], v[48:63]
 ds_read_b64_tr_b16 v[84:85], v99 offset:61440
 ds_read_b64_tr_b16 v[86:87], v99 offset:62464
 s_waitcnt lgkmcnt(10)
 v_mfma_f32_32x32x16_bf16 v[32:47], v[88:91], a[236:239], v[32:47]
 ds_read_b64_tr_b16 v[88:89], v98 offset:63488
 ds_read_b64_tr_b16 v[90:91], v98 offset:64512
 v_mfma_f32_32x32x16_bf16 v[48:63], v[92:95], a[236:239], v[48:63]
 ds_read_b64_tr_b16 v[92:93], v99 offset:63488
 ds_read_b64_tr_b16 v[94:95], v99 offset:64512
 v_mfma_f32_32x32x16_bf16 v[32:47], v[64:67], a[240:243], v[32:47]
 s_waitcnt lgkmcnt(8)
 s_nop 5
 v_mfma_f32_32x32x16_bf16 v[48:63], v[68:71], a[240:243], v[48:63]
 v_mfma_f32_32x32x16_bf16 v[32:47], v[72:75], a[244:247], v[32:47]
 v_mfma_f32_32x32x16_bf16 v[48:63], v[76:79], a[244:247], v[48:63]
 s_waitcnt lgkmcnt(2)
 v_mfma_f32_32x32x16_bf16 v[32:47], v[80:83], a[248:251], v[32:47]
 v_mfma_f32_32x32x16_bf16 v[48:63], v[84:87], a[248:251], v[48:63]
 v_mfma_f32_32x32x16_bf16 v[32:47], v[88:91], a[252:255], v[32:47]
 s_waitcnt lgkmcnt(0)
 v_mfma_f32_32x32x16_bf16 v[48:63], v[92:95], a[252:255], v[48:63]
 s_waitcnt vmcnt(3)
 s_nop 10
 v_lshlrev_b32 v0, 16, v128
 v_and_b32 v1, 4294901760, v128
 v_lshlrev_b32 v2, 16, v129
 v_and_b32 v3, 4294901760, v129
 v_lshlrev_b32 v4, 16, v130
 v_and_b32 v5, 4294901760, v130
 v_lshlrev_b32 v6, 16, v131
 v_and_b32 v7, 4294901760, v131
 s_waitcnt vmcnt(2)
 v_lshlrev_b32 v8, 16, v132
 v_and_b32 v9, 4294901760, v132
 v_lshlrev_b32 v10, 16, v133
 v_and_b32 v11, 4294901760, v133
 v_lshlrev_b32 v12, 16, v134
 v_and_b32 v13, 4294901760, v134
 v_lshlrev_b32 v14, 16, v135
 v_and_b32 v15, 4294901760, v135
 s_waitcnt vmcnt(1)
 v_lshlrev_b32 v16, 16, v136
 v_and_b32 v17, 4294901760, v136
 v_lshlrev_b32 v18, 16, v137
 v_and_b32 v19, 4294901760, v137
 v_lshlrev_b32 v20, 16, v138
 v_and_b32 v21, 4294901760, v138
 v_lshlrev_b32 v22, 16, v139
 v_and_b32 v23, 4294901760, v139
 s_waitcnt vmcnt(0)
 v_lshlrev_b32 v24, 16, v140
 v_and_b32 v25, 4294901760, v140
 v_lshlrev_b32 v26, 16, v141
 v_and_b32 v27, 4294901760, v141
 v_lshlrev_b32 v28, 16, v142
 v_and_b32 v29, 4294901760, v142
 v_lshlrev_b32 v30, 16, v143
 v_and_b32 v31, 4294901760, v143
 s_cbranch_scc0 P_SLOW
P_BACK:
 v_add_f32 v32, v0, v32
 v_add_f32 v33, v1, v33
 v_add_f32 v34, v2, v34
 v_add_f32 v35, v3, v35
 v_add_f32 v36, v4, v36
 v_add_f32 v37, v5, v37
 v_add_f32 v38, v6, v38
 v_add_f32 v39, v7, v39
 v_add_f32 v40, v8, v40
 v_add_f32 v41, v9, v41
 v_add_f32 v42, v10, v42
 v_add_f32 v43, v11, v43
 v_add_f32 v44, v12, v44
 v_add_f32 v45, v13, v45
 v_add_f32 v46, v14, v46
 v_add_f32 v47, v15, v47
 v_cvt_pk_bf16_f32 v112, v32, v33
 v_cvt_pk_bf16_f32 v113, v34, v35
 v_cvt_pk_bf16_f32 v114, v36, v37
 v_cvt_pk_bf16_f32 v115, v38, v39
 buffer_store_dwordx4 v[112:115], v102, s[16:19], 0 offen offset:0
 v_cvt_pk_bf16_f32 v116, v40, v41
 v_cvt_pk_bf16_f32 v117, v42, v43
 v_cvt_pk_bf16_f32 v118, v44, v45
 v_cvt_pk_bf16_f32 v119, v46, v47
 buffer_store_dwordx4 v[116:119], v102, s[16:19], 0 offen offset:32
 v_add_f32 v48, v16, v48
 v_add_f32 v49, v17, v49
 v_add_f32 v50, v18, v50
 v_add_f32 v51, v19, v51
 v_add_f32 v52, v20, v52
 v_add_f32 v53, v21, v53
 v_add_f32 v54, v22, v54
 v_add_f32 v55, v23, v55
 v_add_f32 v56, v24, v56
 v_add_f32 v57, v25, v57
 v_add_f32 v58, v26, v58
 v_add_f32 v59, v27, v59
 v_add_f32 v60, v28, v60
 v_add_f32 v61, v29, v61
 v_add_f32 v62, v30, v62
 v_add_f32 v63, v31, v63
 v_cvt_pk_bf16_f32 v120, v48, v49
 v_cvt_pk_bf16_f32 v121, v50, v51
 v_cvt_pk_bf16_f32 v122, v52, v53
 v_cvt_pk_bf16_f32 v123, v54, v55
 buffer_store_dwordx4 v[120:123], v102, s[16:19], 0 offen offset:64
 v_cvt_pk_bf16_f32 v124, v56, v57
 v_cvt_pk_bf16_f32 v125, v58, v59
 v_cvt_pk_bf16_f32 v126, v60, v61
 v_cvt_pk_bf16_f32 v127, v62, v63
 buffer_store_dwordx4 v[124:127], v102, s[16:19], 0 offen offset:96
P_END:
 s_endpgm
P_SLOW:
 s_waitcnt vmcnt(0)
 s_mov_b32 s57, 0
P_SPIN:
 s_sleep 1
 s_add_u32 s57, s57, 1
 s_cmp_gt_u32 s57, 0x40000
 s_cbranch_scc1 P_GO
 buffer_load_dword v106, v104, s[24:27], s45 offen sc1
 s_waitcnt vmcnt(0)
 v_readfirstlane_b32 s46, v106
 s_nop 3
 s_cmp_eq_u32 s46, 1
 s_cbranch_scc0 P_SPIN
P_GO:
 buffer_load_dwordx4 v[128:131], v103, s[20:23], s43 offen offset:0 sc1
 buffer_load_dwordx4 v[132:135], v103, s[20:23], s43 offen offset:1024 sc1
 buffer_load_dwordx4 v[136:139], v103, s[20:23], s43 offen offset:2048 sc1
 buffer_load_dwordx4 v[140:143], v103, s[20:23], s43 offen offset:3072 sc1
 s_waitcnt vmcnt(0)
 v_lshlrev_b32 v0, 16, v128
 v_and_b32 v1, 4294901760, v128
 v_lshlrev_b32 v2, 16, v129
 v_and_b32 v3, 4294901760, v129
 v_lshlrev_b32 v4, 16, v130
 v_and_b32 v5, 4294901760, v130
 v_lshlrev_b32 v6, 16, v131
 v_and_b32 v7, 4294901760, v131
 v_lshlrev_b32 v8, 16, v132
 v_and_b32 v9, 4294901760, v132
 v_lshlrev_b32 v10, 16, v133
 v_and_b32 v11, 4294901760, v133
 v_lshlrev_b32 v12, 16, v134
 v_and_b32 v13, 4294901760, v134
 v_lshlrev_b32 v14, 16, v135
 v_and_b32 v15, 4294901760, v135
 v_lshlrev_b32 v16, 16, v136
 v_and_b32 v17, 4294901760, v136
 v_lshlrev_b32 v18, 16, v137
 v_and_b32 v19, 4294901760, v137
 v_lshlrev_b32 v20, 16, v138
 v_and_b32 v21, 4294901760, v138
 v_lshlrev_b32 v22, 16, v139
 v_and_b32 v23, 4294901760, v139
 v_lshlrev_b32 v24, 16, v140
 v_and_b32 v25, 4294901760, v140
 v_lshlrev_b32 v26, 16, v141
 v_and_b32 v27, 4294901760, v141
 v_lshlrev_b32 v28, 16, v142
 v_and_b32 v29, 4294901760, v142
 v_lshlrev_b32 v30, 16, v143
 v_and_b32 v31, 4294901760, v143
 s_branch P_BACK
CODE_END:
.section .rodata,"a"
.p2align 6
.amdhsa_kernel attn_kernel
  .amdhsa_next_free_vgpr 512
  .amdhsa_next_free_sgpr 102
  .amdhsa_accum_offset 256
  .amdhsa_group_segment_fixed_size 0
  .amdhsa_kernarg_size 64
  .amdhsa_user_sgpr_count 2
  .amdhsa_user_sgpr_kernarg_segment_ptr 1
  .amdhsa_system_sgpr_workgroup_id_x 1
.end_amdhsa_kernel
.p2align 6
.amdhsa_kernel oproj_kernel
  .amdhsa_next_free_vgpr 400
  .amdhsa_next_free_sgpr 102
  .amdhsa_accum_offset 144
  .amdhsa_group_segment_fixed_size 0
  .amdhsa_kernarg_size 64
  .amdhsa_user_sgpr_count 2
  .amdhsa_user_sgpr_kernarg_segment_ptr 1
  .amdhsa_system_sgpr_workgroup_id_x 1
.end_amdhsa_kernel
```
